```python
import torch

def _softmax(x, axis=-1):
    return torch.softmax(x, dim=axis)
def _gelu(x):
    return torch.nn.functional.gelu(x, approximate="tanh")
def _silu(x):
    return torch.nn.functional.silu(x)
def _sigmoid(x):
    return torch.sigmoid(x)
def _layernorm(x, axis=-1, eps=1e-5):
    m = x.mean(dim=axis, keepdim=True)
    v = x.var(dim=axis, keepdim=True, unbiased=False)
    return (x - m) / torch.sqrt(v + eps)
def _scatter_add(tgt, idx, src, axis=0):
    return tgt.clone().index_add_(axis, idx, src)
def _segment_sum(src, seg, n):
    out = torch.zeros((n,) + src.shape[1:], dtype=src.dtype)
    return out.index_add_(0, seg, src)
def _pad(x, pw):
    flat = tuple(v for pair in reversed(pw) for v in pair)
    return torch.nn.functional.pad(x, flat)

kernel_name = 'recurrent_scan__sliding_block_cached__glu_gated_glu__prompt'

def setup_inputs():

    _w = (lambda a: (lambda t: t.to(torch.bfloat16) if t.is_floating_point() else t)(torch.as_tensor(a)))
    def _A_setup():
        B, Sq, D = 1, 2048, 1024
        Hq, Hkv, Sk, Dh = 32, 4, 2048, 128
        assert Hq % Hkv == 0, (Hq, Hkv)
        return {
            "x": _w((lambda *s: torch.randn(*s, dtype=torch.bfloat16) * 0.05)(B, Sq, D)),
            "k_cache": _w((lambda *s: torch.randn(*s, dtype=torch.bfloat16) * 0.8)(B, Hkv, Sk, Dh)),
            "v_cache": _w((lambda *s: torch.randn(*s, dtype=torch.bfloat16) * 0.2)(B, Hkv, Sk, Dh)),
            "wq": _w((lambda *s: torch.randn(*s, dtype=torch.bfloat16) * 0.8)(D, Hq * Dh) * (D ** -0.5)),
            "wo": _w((lambda *s: torch.randn(*s, dtype=torch.bfloat16) * 0.2)(Hq * Dh, D) * ((Hq * Dh) ** -0.5)),
        }
    _A_in = _A_setup()

    def _B_setup():
        B, S, D, F = 1, 2048, 1024, 3584
        return {
            "x": _w((lambda *s: torch.randn(*s, dtype=torch.bfloat16) * 0.05)(B, S, D)),
            "w_gate": _w((lambda *s: torch.randn(*s, dtype=torch.bfloat16) * 0.2)(D, F)),
            "w_up": _w((lambda *s: torch.randn(*s, dtype=torch.bfloat16) * 0.1)(D, F)),
            "w_down": _w((lambda *s: torch.randn(*s, dtype=torch.bfloat16) * 0.1)(F, D)),
        }
    _B_in = _B_setup()

    return {
        "A_x": _A_in["x"],
        "A_k_cache": _A_in["k_cache"],
        "A_v_cache": _A_in["v_cache"],
        "A_wq": _A_in["wq"],
        "A_wo": _A_in["wo"],
        "B_x": _B_in["x"],
        "B_w_gate": _B_in["w_gate"],
        "B_w_up": _B_in["w_up"],
        "B_w_down": _B_in["w_down"],
    }

def reference(A_x, A_k_cache, A_v_cache, A_wq, A_wo, B_x, B_w_gate, B_w_up, B_w_down):
    def _A_ref(x, k_cache, v_cache, wq, wo):
        B, Sq, D = x.shape
        Hq, Dh = 32, 128
        Hkv, Sk = k_cache.shape[1], k_cache.shape[2]
        W = min(4096, max(256, Sk // 4))
        rep = Hq // Hkv
        q = (lambda x, *d: x.permute(*d))((x @ wq).reshape(B, Sq, Hq, Dh), 0, 2, 1, 3)
        k = (lambda x, n, axis: torch.repeat_interleave(x, n, dim=axis))(k_cache[:, :, Sk - W:, :], rep, axis=1)
        v = (lambda x, n, axis: torch.repeat_interleave(x, n, dim=axis))(v_cache[:, :, Sk - W:, :], rep, axis=1)
        scores = torch.einsum("bhqd,bhkd->bhqk", q, k) * (Dh ** -0.5)
        p = _softmax(scores, axis=-1)
        o = torch.einsum("bhqk,bhkd->bhqd", p, v)
        return (lambda x, *d: x.permute(*d))(o, 0, 2, 1, 3).reshape(B, Sq, Hq * Dh) @ wo

    def _B_ref(x, w_gate, w_up, w_down):
        g = torch.einsum("bsd,df->bsf", x, w_gate)
        u = torch.einsum("bsd,df->bsf", x, w_up)
        h = _sigmoid(g) * u
        return torch.einsum("bsf,fd->bsd", h, w_down)

    x = A_x
    xn = _layernorm(x, axis=-1)
    s = _A_ref(xn, A_k_cache, A_v_cache, A_wq, A_wo)
    g = _silu(_B_ref(xn, B_w_gate, B_w_up, B_w_down))
    return x + s * g
```

```asm
; @launch grid=(256,1,1) block=(256,1,1) lds=163840
.amdgcn_target "amdgcn-amd-amdhsa--gfx950"
.text
.globl recurrent_scan__sliding_block_cached__glu_gated_glu__prompt_kernel
.p2align 8
.type recurrent_scan__sliding_block_cached__glu_gated_glu__prompt_kernel,@function
recurrent_scan__sliding_block_cached__glu_gated_glu__prompt_kernel:
s_cmp_ge_u32 s2,256
s_cbranch_scc1 L_end
s_load_dwordx8 s[60:67],s[0:1],0
s_load_dwordx2 s[70:71],s[0:1],88
s_load_dwordx8 s[72:79],s[0:1],48
s_load_dwordx2 s[68:69],s[0:1],32
s_getpc_b64 s[4:5]
L_pc:
v_lshrrev_b32 v24,6,v0
v_and_b32 v2,63,v0
v_lshlrev_b32 v1,4,v2
v_readfirstlane_b32 s44,v24
s_and_b32 s50,s2,7
s_lshr_b32 s51,s2,3
s_and_b32 s46,s50,1
s_lshl_b32 s46,s46,2
s_lshr_b32 s52,s51,3
s_add_u32 s46,s46,s52
s_lshr_b32 s47,s50,1
s_and_b32 s48,s51,7
s_lshl_b32 s45,s47,3
s_add_u32 s45,s45,s48
s_lshl_b32 s50,s46,8
s_lshl_b32 s52,s45,3
s_add_u32 s50,s50,s52
s_lshl_b32 s52,s44,1
s_add_u32 s52,s52,s50
s_lshl_b32 s52,s52,11
s_mov_b32 s30,0x400000
s_mov_b32 s31,0x20000
s_mov_b32 s10,0x10000000
s_mov_b32 s11,0x20000
s_mov_b32 s6,L_code_end-L_pc
s_mov_b32 s7,0x20000
s_lshl_b32 s51,s51,15
v_lshlrev_b32 v25,7,v0
v_mov_b32 v28,0
s_lshl_b32 s53,s46,7
s_add_u32 s54,s53,0x4200000
s_waitcnt lgkmcnt(0)
s_mov_b64 s[28:29],s[60:61]
s_mov_b64 s[8:9],s[70:71]
buffer_load_dwordx4 v[144:147],v1,s[28:31],s52 offen offset:0
buffer_load_dwordx4 v[148:151],v1,s[28:31],s52 offen offset:1024
buffer_load_dwordx4 v[152:155],v1,s[28:31],s52 offen offset:2048
buffer_load_dwordx4 v[156:159],v1,s[28:31],s52 offen offset:3072
buffer_load_dword v29,v28,s[8:11],s54 offen sc1
buffer_load_dword v47,v25,s[4:7],s51 offen
v_lshrrev_b32 v25,2,v2
v_and_b32 v26,3,v2
s_mov_b32 s90,0xffff0000
v_and_b32 v24,1,v2
v_and_b32 v27,3,v25
v_lshl_add_u32 v27,v24,2,v27
s_lshl_b32 s57,s44,1
v_xor_b32 v27,s57,v27
v_lshlrev_b32 v30,9,v25
v_lshl_add_u32 v30,v24,8,v30
v_bfe_u32 v24,v2,1,1
v_lshl_add_u32 v30,v24,3,v30
v_add_u32 v30,147456,v30
v_lshl_add_u32 v8,v27,4,v30
v_xor_b32 v9,16,v8
v_lshlrev_b32 v10,4,v0
v_add_u32 v10,147456,v10
v_lshrrev_b32 v24,5,v0
v_bfe_u32 v27,v0,3,2
v_and_b32 v30,3,v24
v_bfe_u32 v31,v0,4,1
v_lshl_add_u32 v30,v31,2,v30
v_and_b32 v31,7,v0
v_xor_b32 v30,v30,v31
v_lshlrev_b32 v4,17,v24
v_lshl_add_u32 v4,v27,8,v4
v_lshl_add_u32 v4,v30,4,v4
s_lshr_b32 s51,s50,4
s_lshl_b32 s51,s51,10
s_and_b32 s56,s50,15
s_lshl_b32 s56,s56,4
s_add_u32 s51,s51,s56
s_mov_b64 s[12:13],s[66:67]
s_mov_b32 s14,0x800000
s_mov_b32 s15,0x20000
s_cmp_lt_u32 s44,2
s_cselect_b32 s16,s72,s74
s_cselect_b32 s17,s73,s75
s_mov_b32 s18,0x700000
s_mov_b32 s19,0x20000
s_and_b32 s54,s44,1
s_lshr_b32 s55,s44,1
s_lshl_b32 s56,s54,4
v_add_u32 v24,s56,v25
v_bfe_u32 v30,v2,4,1
v_lshlrev_b32 v30,1,v30
v_xor_b32 v30,v30,v26
v_lshlrev_b32 v30,4,v30
v_lshl_add_u32 v5,v24,13,v30
s_lshl_b32 s56,s45,8
s_lshl_b32 s57,s55,7
s_add_u32 s56,s56,s57
v_add_u32 v5,s56,v5
s_movk_i32 s58,7168
v_mul_lo_u32 v27,v24,s58
s_mul_i32 s56,s45,224
s_and_b32 s59,s45,1
s_lshl_b32 s57,s59,5
s_add_u32 s57,s57,s56
v_add3_u32 v6,v27,v30,s57
v_bfe_u32 v24,v2,1,4
s_lshl_b32 s57,s54,4
v_add_u32 v24,s57,v24
v_mul_lo_u32 v27,v24,s58
v_and_b32 v30,1,v2
v_lshlrev_b32 v30,4,v30
s_cmp_eq_u32 s59,0
s_cselect_b32 s57,192,0
s_add_u32 s57,s57,s56
v_add3_u32 v7,v27,v30,s57
v_mov_b32 v30,0x7ff00000
v_cmp_gt_u32 vcc,32,v2
s_nop 1
v_cndmask_b32 v7,v30,v7,vcc
s_lshl_b32 s80,s55,12
s_lshl_b32 s57,s54,10
s_add_u32 s80,s80,s57
s_lshl_b32 s81,s55,13
s_add_u32 s81,s81,8192
s_add_u32 s81,s81,s57
s_add_u32 s82,s81,6144
s_mov_b32 s83,0
s_mov_b32 s84,0
s_mov_b32 s85,0x0
s_mov_b32 s86,0
s_mov_b32 s87,0
s_and_b32 s56,s46,3
s_lshl_b32 s56,s56,3
s_add_u32 s56,s56,s48
v_mov_b32 v30,0x7ff00000
s_mov_b32 s99,0x20000
v_lshlrev_b32 v24,7,v2
s_cmp_eq_u32 s44,0
s_cbranch_scc1 L_pf0
s_cmp_eq_u32 s44,3
s_cbranch_scc1 L_pf3
s_mul_i32 s56,s56,7168
s_mul_i32 s57,s47,1792
s_add_u32 s56,s56,s57
v_add_u32 v24,s56,v24
v_cmp_gt_u32 vcc,14,v2
s_nop 1
v_cndmask_b32 v44,v30,v24,vcc
s_mov_b64 s[96:97],s[16:17]
s_mov_b32 s98,s18
s_mov_b32 s72,s84
s_mov_b32 s73,0x38000
s_mov_b32 s74,0x700000
s_mov_b32 s75,0x7ff00000
s_branch L_pfj
L_pf0:
s_lshl_b32 s56,s56,13
s_lshl_b32 s57,s47,11
s_add_u32 s56,s56,s57
v_add_u32 v24,s56,v24
v_cmp_gt_u32 vcc,16,v2
s_nop 1
v_cndmask_b32 v44,v30,v24,vcc
s_mov_b64 s[96:97],s[12:13]
s_mov_b32 s98,s14
s_mov_b32 s72,s83
s_mov_b32 s73,0x40000
s_mov_b32 s74,0x800000
s_mov_b32 s75,0x7ff00000
s_branch L_pfj
L_pf3:
v_lshlrev_b32 v24,7,v2
s_lshl_b32 s57,s46,14
v_add_u32 v24,s57,v24
s_lshl_b32 s57,s48,11
v_add_u32 v24,s57,v24
v_cmp_gt_u32 vcc,16,v2
s_nop 1
v_cndmask_b32 v44,v30,v24,vcc
s_mov_b64 s[96:97],s[8:9]
s_mov_b32 s98,0
s_sub_u32 s72,s85,0x20000
s_mov_b32 s73,0x20000
s_mov_b32 s74,0x400000
s_mov_b32 s75,0x7ff00000
L_pfj:
buffer_load_dword v45,v44,s[96:99],s72 offen
s_add_u32 s72,s72,s73
s_cmp_eq_u32 s72,s74
s_cselect_b32 s72,s75,s72
buffer_load_dword v45,v44,s[96:99],s72 offen
s_add_u32 s72,s72,s73
s_cmp_eq_u32 s72,s74
s_cselect_b32 s72,s75,s72
L_lnreal:
s_cmp_eq_u32 s90,0
s_waitcnt vmcnt(7)
v_lshlrev_b32 v176,16,v144
v_and_b32 v177,s90,v144
v_lshlrev_b32 v178,16,v145
v_and_b32 v179,s90,v145
v_lshlrev_b32 v180,16,v146
v_and_b32 v181,s90,v146
v_lshlrev_b32 v182,16,v147
v_and_b32 v183,s90,v147
s_waitcnt vmcnt(6)
v_lshlrev_b32 v184,16,v148
v_and_b32 v185,s90,v148
v_lshlrev_b32 v186,16,v149
v_and_b32 v187,s90,v149
v_lshlrev_b32 v188,16,v150
v_and_b32 v189,s90,v150
v_lshlrev_b32 v190,16,v151
v_and_b32 v191,s90,v151
s_waitcnt vmcnt(5)
v_lshlrev_b32 v192,16,v152
v_and_b32 v193,s90,v152
v_lshlrev_b32 v194,16,v153
v_and_b32 v195,s90,v153
v_lshlrev_b32 v196,16,v154
v_and_b32 v197,s90,v154
v_lshlrev_b32 v198,16,v155
v_and_b32 v199,s90,v155
s_waitcnt vmcnt(4)
v_lshlrev_b32 v200,16,v156
v_and_b32 v201,s90,v156
v_lshlrev_b32 v202,16,v157
v_and_b32 v203,s90,v157
v_lshlrev_b32 v204,16,v158
v_and_b32 v205,s90,v158
v_lshlrev_b32 v206,16,v159
v_and_b32 v207,s90,v159
v_pk_add_f32 v[208:209],v[176:177],v[178:179]
v_pk_add_f32 v[210:211],v[192:193],v[194:195]
v_pk_add_f32 v[208:209],v[208:209],v[180:181]
v_pk_add_f32 v[210:211],v[210:211],v[196:197]
v_pk_add_f32 v[208:209],v[208:209],v[182:183]
v_pk_add_f32 v[210:211],v[210:211],v[198:199]
v_pk_add_f32 v[208:209],v[208:209],v[184:185]
v_pk_add_f32 v[210:211],v[210:211],v[200:201]
v_pk_add_f32 v[208:209],v[208:209],v[186:187]
v_pk_add_f32 v[210:211],v[210:211],v[202:203]
v_pk_add_f32 v[208:209],v[208:209],v[188:189]
v_pk_add_f32 v[210:211],v[210:211],v[204:205]
v_pk_add_f32 v[208:209],v[208:209],v[190:191]
v_pk_add_f32 v[210:211],v[210:211],v[206:207]
v_add_f32 v208,v208,v209
v_add_f32 v210,v210,v211
L_lnq1:
s_nop 0
v_add_f32 v208,v208,v208 quad_perm:[1,0,3,2] row_mask:0xf bank_mask:0xf
v_add_f32 v210,v210,v210 quad_perm:[1,0,3,2] row_mask:0xf bank_mask:0xf
s_nop 0
v_add_f32 v208,v208,v208 quad_perm:[2,3,0,1] row_mask:0xf bank_mask:0xf
v_add_f32 v210,v210,v210 quad_perm:[2,3,0,1] row_mask:0xf bank_mask:0xf
s_nop 0
v_add_f32 v208,v208,v208 row_half_mirror row_mask:0xf bank_mask:0xf
v_add_f32 v210,v210,v210 row_half_mirror row_mask:0xf bank_mask:0xf
s_nop 0
v_add_f32 v208,v208,v208 row_mirror row_mask:0xf bank_mask:0xf
v_add_f32 v210,v210,v210 row_mirror row_mask:0xf bank_mask:0xf
v_mov_b32 v216,v208
v_mov_b32 v218,v210
s_nop 0
v_permlane16_swap_b32 v208,v216
v_permlane16_swap_b32 v210,v218
v_add_f32 v208,v208,v216
v_add_f32 v210,v210,v218
v_mov_b32 v216,v208
v_mov_b32 v218,v210
s_nop 0
v_permlane32_swap_b32 v208,v216
v_permlane32_swap_b32 v210,v218
v_add_f32 v208,v208,v216
v_add_f32 v210,v210,v218
v_mul_f32 v208,0xba800000,v208
v_mul_f32 v210,0xba800000,v210
v_mov_b32 v209,v208
v_mov_b32 v211,v210
v_pk_add_f32 v[216:217],v[176:177],v[208:209]
v_pk_add_f32 v[218:219],v[192:193],v[210:211]
v_pk_mul_f32 v[212:213],v[216:217],v[216:217]
v_pk_mul_f32 v[214:215],v[218:219],v[218:219]
v_pk_add_f32 v[216:217],v[178:179],v[208:209]
v_pk_add_f32 v[218:219],v[194:195],v[210:211]
v_pk_fma_f32 v[212:213],v[216:217],v[216:217],v[212:213]
v_pk_fma_f32 v[214:215],v[218:219],v[218:219],v[214:215]
v_pk_add_f32 v[216:217],v[180:181],v[208:209]
v_pk_add_f32 v[218:219],v[196:197],v[210:211]
v_pk_fma_f32 v[212:213],v[216:217],v[216:217],v[212:213]
v_pk_fma_f32 v[214:215],v[218:219],v[218:219],v[214:215]
v_pk_add_f32 v[216:217],v[182:183],v[208:209]
v_pk_add_f32 v[218:219],v[198:199],v[210:211]
v_pk_fma_f32 v[212:213],v[216:217],v[216:217],v[212:213]
v_pk_fma_f32 v[214:215],v[218:219],v[218:219],v[214:215]
v_pk_add_f32 v[216:217],v[184:185],v[208:209]
v_pk_add_f32 v[218:219],v[200:201],v[210:211]
v_pk_fma_f32 v[212:213],v[216:217],v[216:217],v[212:213]
v_pk_fma_f32 v[214:215],v[218:219],v[218:219],v[214:215]
v_pk_add_f32 v[216:217],v[186:187],v[208:209]
v_pk_add_f32 v[218:219],v[202:203],v[210:211]
v_pk_fma_f32 v[212:213],v[216:217],v[216:217],v[212:213]
v_pk_fma_f32 v[214:215],v[218:219],v[218:219],v[214:215]
v_pk_add_f32 v[216:217],v[188:189],v[208:209]
v_pk_add_f32 v[218:219],v[204:205],v[210:211]
v_pk_fma_f32 v[212:213],v[216:217],v[216:217],v[212:213]
v_pk_fma_f32 v[214:215],v[218:219],v[218:219],v[214:215]
v_pk_add_f32 v[216:217],v[190:191],v[208:209]
v_pk_add_f32 v[218:219],v[206:207],v[210:211]
v_pk_fma_f32 v[212:213],v[216:217],v[216:217],v[212:213]
v_pk_fma_f32 v[214:215],v[218:219],v[218:219],v[214:215]
v_add_f32 v212,v212,v213
v_add_f32 v214,v214,v215
s_nop 0
v_add_f32 v212,v212,v212 quad_perm:[1,0,3,2] row_mask:0xf bank_mask:0xf
v_add_f32 v214,v214,v214 quad_perm:[1,0,3,2] row_mask:0xf bank_mask:0xf
s_nop 0
v_add_f32 v212,v212,v212 quad_perm:[2,3,0,1] row_mask:0xf bank_mask:0xf
v_add_f32 v214,v214,v214 quad_perm:[2,3,0,1] row_mask:0xf bank_mask:0xf
s_nop 0
v_add_f32 v212,v212,v212 row_half_mirror row_mask:0xf bank_mask:0xf
v_add_f32 v214,v214,v214 row_half_mirror row_mask:0xf bank_mask:0xf
s_nop 0
v_add_f32 v212,v212,v212 row_mirror row_mask:0xf bank_mask:0xf
v_add_f32 v214,v214,v214 row_mirror row_mask:0xf bank_mask:0xf
s_cbranch_scc1 L_lnreal
L_lnq2:
v_mov_b32 v216,v212
v_mov_b32 v218,v214
s_nop 0
v_permlane16_swap_b32 v212,v216
v_permlane16_swap_b32 v214,v218
v_add_f32 v212,v212,v216
v_add_f32 v214,v214,v218
v_mov_b32 v216,v212
v_mov_b32 v218,v214
s_nop 0
v_permlane32_swap_b32 v212,v216
v_permlane32_swap_b32 v214,v218
v_add_f32 v212,v212,v216
v_add_f32 v214,v214,v218
v_mul_f32 v212,0x3a800000,v212
v_mul_f32 v214,0x3a800000,v214
v_cvt_pk_bf16_f32 v216,v208,v212
v_cvt_pk_bf16_f32 v218,v210,v214
v_lshlrev_b32 v208,16,v216
v_and_b32 v212,s90,v216
v_lshlrev_b32 v210,16,v218
v_and_b32 v214,s90,v218
v_add_f32 v212,0x3727c5ac,v212
v_add_f32 v214,0x3727c5ac,v214
v_cvt_pk_bf16_f32 v212,v212,v212
v_cvt_pk_bf16_f32 v214,v214,v214
v_and_b32 v212,s90,v212
v_and_b32 v214,s90,v214
v_sqrt_f32 v212,v212
v_sqrt_f32 v214,v214
v_cvt_pk_bf16_f32 v212,v212,v212
v_cvt_pk_bf16_f32 v214,v214,v214
v_and_b32 v212,s90,v212
v_and_b32 v214,s90,v214
v_rcp_f32 v212,v212
v_rcp_f32 v214,v214
v_mov_b32 v209,v208
v_mov_b32 v213,v212
v_mov_b32 v211,v210
v_mov_b32 v215,v214
v_pk_add_f32 v[176:177],v[176:177],v[208:209]
v_pk_add_f32 v[192:193],v[192:193],v[210:211]
v_cvt_pk_bf16_f32 v160,v176,v177
v_cvt_pk_bf16_f32 v168,v192,v193
v_lshlrev_b32 v176,16,v160
v_and_b32 v177,s90,v160
v_lshlrev_b32 v192,16,v168
v_and_b32 v193,s90,v168
v_pk_mul_f32 v[176:177],v[176:177],v[212:213]
v_pk_mul_f32 v[192:193],v[192:193],v[214:215]
v_cvt_pk_bf16_f32 v160,v176,v177
v_cvt_pk_bf16_f32 v168,v192,v193
v_pk_add_f32 v[178:179],v[178:179],v[208:209]
v_pk_add_f32 v[194:195],v[194:195],v[210:211]
v_cvt_pk_bf16_f32 v161,v178,v179
v_cvt_pk_bf16_f32 v169,v194,v195
v_lshlrev_b32 v178,16,v161
v_and_b32 v179,s90,v161
v_lshlrev_b32 v194,16,v169
v_and_b32 v195,s90,v169
v_pk_mul_f32 v[178:179],v[178:179],v[212:213]
v_pk_mul_f32 v[194:195],v[194:195],v[214:215]
v_cvt_pk_bf16_f32 v161,v178,v179
v_cvt_pk_bf16_f32 v169,v194,v195
v_pk_add_f32 v[180:181],v[180:181],v[208:209]
v_pk_add_f32 v[196:197],v[196:197],v[210:211]
v_cvt_pk_bf16_f32 v162,v180,v181
v_cvt_pk_bf16_f32 v170,v196,v197
v_lshlrev_b32 v180,16,v162
s_cbranch_scc1 L_lnreal
L_lnq3:
v_and_b32 v181,s90,v162
v_lshlrev_b32 v196,16,v170
v_and_b32 v197,s90,v170
v_pk_mul_f32 v[180:181],v[180:181],v[212:213]
v_pk_mul_f32 v[196:197],v[196:197],v[214:215]
v_cvt_pk_bf16_f32 v162,v180,v181
v_cvt_pk_bf16_f32 v170,v196,v197
v_pk_add_f32 v[182:183],v[182:183],v[208:209]
v_pk_add_f32 v[198:199],v[198:199],v[210:211]
v_cvt_pk_bf16_f32 v163,v182,v183
v_cvt_pk_bf16_f32 v171,v198,v199
v_lshlrev_b32 v182,16,v163
v_and_b32 v183,s90,v163
v_lshlrev_b32 v198,16,v171
v_and_b32 v199,s90,v171
v_pk_mul_f32 v[182:183],v[182:183],v[212:213]
v_pk_mul_f32 v[198:199],v[198:199],v[214:215]
v_cvt_pk_bf16_f32 v163,v182,v183
v_cvt_pk_bf16_f32 v171,v198,v199
v_pk_add_f32 v[184:185],v[184:185],v[208:209]
v_pk_add_f32 v[200:201],v[200:201],v[210:211]
v_cvt_pk_bf16_f32 v164,v184,v185
v_cvt_pk_bf16_f32 v172,v200,v201
v_lshlrev_b32 v184,16,v164
v_and_b32 v185,s90,v164
v_lshlrev_b32 v200,16,v172
v_and_b32 v201,s90,v172
v_pk_mul_f32 v[184:185],v[184:185],v[212:213]
v_pk_mul_f32 v[200:201],v[200:201],v[214:215]
v_cvt_pk_bf16_f32 v164,v184,v185
v_cvt_pk_bf16_f32 v172,v200,v201
v_pk_add_f32 v[186:187],v[186:187],v[208:209]
v_pk_add_f32 v[202:203],v[202:203],v[210:211]
v_cvt_pk_bf16_f32 v165,v186,v187
v_cvt_pk_bf16_f32 v173,v202,v203
v_lshlrev_b32 v186,16,v165
v_and_b32 v187,s90,v165
v_lshlrev_b32 v202,16,v173
v_and_b32 v203,s90,v173
v_pk_mul_f32 v[186:187],v[186:187],v[212:213]
v_pk_mul_f32 v[202:203],v[202:203],v[214:215]
v_cvt_pk_bf16_f32 v165,v186,v187
v_cvt_pk_bf16_f32 v173,v202,v203
v_pk_add_f32 v[188:189],v[188:189],v[208:209]
v_pk_add_f32 v[204:205],v[204:205],v[210:211]
v_cvt_pk_bf16_f32 v166,v188,v189
v_cvt_pk_bf16_f32 v174,v204,v205
v_lshlrev_b32 v188,16,v166
v_and_b32 v189,s90,v166
v_lshlrev_b32 v204,16,v174
v_and_b32 v205,s90,v174
v_pk_mul_f32 v[188:189],v[188:189],v[212:213]
v_pk_mul_f32 v[204:205],v[204:205],v[214:215]
v_cvt_pk_bf16_f32 v166,v188,v189
v_cvt_pk_bf16_f32 v174,v204,v205
v_pk_add_f32 v[190:191],v[190:191],v[208:209]
v_pk_add_f32 v[206:207],v[206:207],v[210:211]
v_cvt_pk_bf16_f32 v167,v190,v191
v_cvt_pk_bf16_f32 v175,v206,v207
v_lshlrev_b32 v190,16,v167
v_and_b32 v191,s90,v167
v_lshlrev_b32 v206,16,v175
v_and_b32 v207,s90,v175
v_pk_mul_f32 v[190:191],v[190:191],v[212:213]
v_pk_mul_f32 v[206:207],v[206:207],v[214:215]
v_cvt_pk_bf16_f32 v167,v190,v191
v_cvt_pk_bf16_f32 v175,v206,v207
s_cbranch_scc1 L_lnreal
ds_write2_b64 v8,v[160:161],v[162:163] offset0:0 offset1:16
ds_write_b64 v8,v[164:165] offset:8192
ds_write_b64 v8,v[166:167] offset:8320
ds_write2_b64 v9,v[168:169],v[170:171] offset0:0 offset1:16
ds_write_b64 v9,v[172:173] offset:8192
ds_write_b64 v9,v[174:175] offset:8320
s_waitcnt vmcnt(3)
v_readfirstlane_b32 s57,v29
v_mov_b32 v30,0x7ff00000
v_cmp_eq_u32 vcc,0,v0
s_nop 1
v_cndmask_b32 v23,v30,v28,vcc
s_waitcnt lgkmcnt(0)
s_barrier
ds_read_b128 v[144:147],v10 offset:0
ds_read_b128 v[148:151],v10 offset:4096
ds_read_b128 v[152:155],v10 offset:8192
ds_read_b128 v[156:159],v10 offset:12288
s_mul_i32 s49,s57,0x9e3779b1
s_xor_b32 s49,s49,0x5bd1e995
s_add_u32 s57,s57,1
v_mov_b32 v46,s49
v_mov_b32 v29,s57
s_waitcnt lgkmcnt(3)
buffer_store_dwordx4 v[144:147],v4,s[8:11],s51 offen sc1
s_add_u32 s51,s51,0x100000
s_waitcnt lgkmcnt(2)
buffer_store_dwordx4 v[148:151],v4,s[8:11],s51 offen sc1
s_add_u32 s51,s51,0x100000
s_waitcnt lgkmcnt(1)
buffer_store_dwordx4 v[152:155],v4,s[8:11],s51 offen sc1
s_add_u32 s51,s51,0x100000
s_waitcnt lgkmcnt(0)
buffer_store_dwordx4 v[156:159],v4,s[8:11],s51 offen sc1
s_lshl_b32 s56,s45,2
s_add_u32 s56,s56,s44
s_add_u32 s56,s56,s53
s_lshl_b32 s56,s56,2
s_add_u32 s56,s56,0x4208000
v_lshlrev_b32 v31,12,v2
v_cmp_gt_u32 vcc,1,v2
s_nop 1
v_cndmask_b32 v31,v30,v31,vcc
s_waitcnt vmcnt(0)
buffer_store_dword v46,v31,s[8:11],s56 offen sc1
s_mov_b64 s[20:21],s[62:63]
s_mov_b32 s22,0x200000
s_mov_b32 s23,0x20000
s_mov_b64 s[24:25],s[64:65]
s_mov_b32 s26,0x200000
s_mov_b32 s27,0x20000
s_mov_b64 s[32:33],s[76:77]
s_mov_b32 s34,0x700000
s_mov_b32 s35,0x20000
s_mov_b64 s[36:37],s[68:69]
s_mov_b32 s38,0x800000
s_mov_b32 s39,0x20000
s_mov_b64 s[40:41],s[78:79]
s_mov_b32 s42,0x400000
s_mov_b32 s43,0x20000
v_mov_b32 v48,0
v_mov_b32 v49,0
v_mov_b32 v50,0
v_mov_b32 v51,0
s_nop 1
v_mfma_f32_32x32x16_bf16 a[0:15],v[48:51],v[48:51],0
s_add_u32 s88,s86,s80
s_add_u32 s89,s86,s81
s_add_u32 m0,s88,0
s_lshl_b32 s56,s46,2
s_add_u32 s56,s56,s44
s_lshl_b32 s56,s56,12
v_mfma_f32_32x32x16_bf16 a[16:31],v[48:51],v[48:51],0
buffer_load_dwordx4 v5,s[12:15],s83 offen offset:0 lds
s_add_u32 m0,s88,1984
v_add_u32 v4,s56,v1
v_lshrrev_b32 v24,4,v2
v_bfe_u32 v25,v2,2,2
v_lshl_add_u32 v27,v24,2,v25
v_mfma_f32_32x32x16_bf16 a[32:47],v[48:51],v[48:51],0
buffer_load_dwordx4 v5,s[12:15],s83 offen offset:64 lds
s_add_u32 m0,s89,0
v_lshlrev_b32 v30,6,v27
v_lshl_add_u32 v30,v26,3,v30
v_and_b32 v31,1,v24
v_lshl_add_u32 v8,v31,5,v30
v_mfma_f32_32x32x16_bf16 a[48:63],v[48:51],v[48:51],0
v_xor_b32 v9,32,v8
v_lshlrev_b32 v10,3,v2
v_and_b32 v31,7,v27
v_lshlrev_b32 v30,8,v27
v_lshl_add_u32 v30,v26,3,v30
v_mfma_f32_32x32x16_bf16 a[64:79],v[48:51],v[48:51],0
buffer_load_dwordx4 v6,s[16:19],s84 offen offset:0 lds
s_add_u32 m0,s89,1984
v_lshl_add_u32 v30,v31,5,v30
v_add_u32 v30,98304,v30
v_xor_b32 v36,0,v30
v_xor_b32 v37,32,v30
v_mfma_f32_32x32x16_bf16 a[80:95],v[48:51],v[48:51],0
v_xor_b32 v38,64,v30
v_xor_b32 v39,96,v30
v_xor_b32 v40,128,v30
v_xor_b32 v41,160,v30
v_xor_b32 v42,192,v30
v_mfma_f32_32x32x16_bf16 a[96:111],v[48:51],v[48:51],0
buffer_load_dwordx4 v6,s[16:19],s84 offen offset:64 lds
s_add_u32 m0,s89,3968
v_xor_b32 v43,224,v30
v_lshrrev_b32 v27,2,v2
v_mfma_f32_32x32x16_bf16 a[112:127],v[48:51],v[48:51],0
buffer_load_dwordx4 v6,s[16:19],s84 offen offset:128 lds
s_add_u32 m0,s86,s82
s_lshl_b32 s56,s44,4
v_add_u32 v27,s56,v27
v_lshlrev_b32 v27,8,v27
v_xor_b32 v31,v24,v26
v_mfma_f32_32x32x16_bf16 a[128:143],v[48:51],v[48:51],0
v_lshl_add_u32 v11,v31,4,v27
v_and_b32 v31,1,v24
v_lshlrev_b32 v31,1,v31
v_xor_b32 v31,v31,v26
v_lshl_add_u32 v12,v31,4,v27
v_mfma_f32_32x32x16_bf16 a[144:159],v[48:51],v[48:51],0
buffer_load_dwordx4 v7,s[16:19],s84 offen lds
s_add_u32 s83,s83,0x40000
s_add_u32 s84,s84,0x38000
s_add_u32 s86,s86,24576
s_cmp_eq_u32 s86,147456
s_cselect_b32 s86,0,s86
v_mfma_f32_32x32x16_bf16 a[160:175],v[48:51],v[48:51],0
s_add_u32 s88,s86,s80
s_add_u32 s89,s86,s81
s_add_u32 m0,s88,0
s_lshl_b32 s91,s44,10
s_lshl_b32 s92,s44,12
v_add_u32 v27,s56,v24
v_mfma_f32_32x32x16_bf16 a[176:191],v[48:51],v[48:51],0
buffer_load_dwordx4 v5,s[12:15],s83 offen offset:0 lds
s_add_u32 m0,s88,1984
v_and_b32 v30,15,v2
v_lshlrev_b32 v31,1,v24
v_xor_b32 v30,v30,v31
v_xor_b32 v31,8,v30
v_mfma_f32_32x32x16_bf16 a[192:207],v[48:51],v[48:51],0
s_lshl_b32 s57,s48,8
v_lshlrev_b32 v27,11,v27
v_add_u32 v27,s57,v27
v_lshl_add_u32 v32,v30,4,v27
v_lshl_add_u32 v33,v31,4,v27
v_add_u32 v33,0x2000,v33
v_mfma_f32_32x32x16_bf16 a[208:223],v[48:51],v[48:51],0
buffer_load_dwordx4 v5,s[12:15],s83 offen offset:64 lds
s_add_u32 m0,s89,0
v_add_u32 v34,0x4000,v32
v_add_u32 v35,0x4000,v33
v_mfma_f32_32x32x16_bf16 a[224:239],v[48:51],v[48:51],0
buffer_load_dwordx4 v6,s[16:19],s84 offen offset:0 lds
s_add_u32 m0,s89,1984
s_lshl_b32 s56,s46,3
s_lshl_b32 s57,s44,1
s_add_u32 s56,s56,s57
s_lshl_b32 s56,s56,12
v_mfma_f32_32x32x16_bf16 v[144:159],v[48:51],v[48:51],0
v_add_u32 v20,s56,v1
v_add_u32 v21,0x1000,v20
v_mfma_f32_32x32x16_bf16 v[160:175],v[48:51],v[48:51],0
buffer_load_dwordx4 v6,s[16:19],s84 offen offset:64 lds
s_add_u32 m0,s89,3968
s_mov_b32 s93,0xfffe2000
s_mov_b32 s94,24576
s_mov_b32 s100,0
s_mov_b32 s95,0
v_mfma_f32_32x32x16_bf16 v[176:191],v[48:51],v[48:51],0
s_lshl_b32 s50,s47,19
s_add_u32 s50,s50,0x60000
s_mul_i32 s52,s47,0x1c0000
v_mfma_f32_32x32x16_bf16 v[192:207],v[48:51],v[48:51],0
buffer_load_dwordx4 v6,s[16:19],s84 offen offset:128 lds
s_add_u32 m0,s86,s82
v_mfma_f32_32x32x16_bf16 v[208:223],v[48:51],v[48:51],0
v_mfma_f32_32x32x16_bf16 v[224:239],v[48:51],v[48:51],0
buffer_load_dwordx4 v7,s[16:19],s84 offen lds
v_mfma_f32_32x32x16_bf16 v[240:255],v[48:51],v[48:51],0
buffer_load_dword v45,v44,s[96:99],s72 offen
s_add_u32 s72,s72,s73
s_cmp_eq_u32 s72,s74
s_cselect_b32 s72,s75,s72
buffer_load_dword v45,v44,s[96:99],s72 offen
s_add_u32 s72,s72,s73
s_cmp_eq_u32 s72,s74
s_cselect_b32 s72,s75,s72
buffer_load_dword v45,v44,s[96:99],s72 offen
s_add_u32 s72,s72,s73
s_cmp_eq_u32 s72,s74
s_cselect_b32 s72,s75,s72
s_and_b32 s64,s46,3
s_lshl_b32 s64,s64,3
s_add_u32 s64,s64,s48
s_lshl_b32 s64,s64,2
s_add_u32 s64,s64,s44
s_mul_i32 s69,s64,384
s_add_u32 s58,s69,L_glu-L_pc
s_mov_b32 s55,7
v_lshlrev_b32 v27,7,v2
v_mov_b32 v26,0x7ff00000
v_cmp_gt_u32 vcc,16,v2
s_nop 1
v_cndmask_b32 v0,v26,v27,vcc
v_cmp_gt_u32 vcc,3,v2
s_nop 1
v_cndmask_b32 v28,v26,v27,vcc
s_mov_b32 s66,0x7ff00000
s_cmp_lt_u32 s64,64
s_cselect_b32 s60,s20,s24
s_cselect_b32 s61,s21,s25
s_mov_b32 s62,0x200000
s_mov_b32 s63,0x20000
s_and_b32 s64,s64,63
s_lshl_b32 s64,s64,11
s_add_u32 s64,s64,s50
v_and_b32 v27,31,v2
v_lshlrev_b32 v27,2,v27
s_lshl_b32 s56,s53,2
s_lshl_b32 s57,s44,7
s_add_u32 s56,s56,s57
s_and_b32 s57,s45,0
s_lshl_b32 s57,s57,12
s_add_u32 s56,s56,s57
s_add_u32 s56,s56,0x4208000
s_waitcnt vmcnt(3)
s_barrier
L_lnpoll:
buffer_load_dword v47,v27,s[8:11],s56 offen sc1
s_waitcnt vmcnt(0)
v_cmp_ne_u32 vcc,s49,v47
s_add_u32 s100,s100,1
s_cmp_gt_u32 s100,524288
s_cbranch_scc1 L_lnjoin
s_nop 1
s_cbranch_vccnz L_lnpoll
L_lnjoin:
buffer_load_dwordx4 v[80:83],v4,s[8:11],s85 offen offset:0 sc1
buffer_load_dwordx4 v[84:87],v4,s[8:11],s85 offen offset:1024 sc1
buffer_load_dwordx4 v[88:91],v4,s[8:11],s85 offen offset:2048 sc1
buffer_load_dwordx4 v[92:95],v4,s[8:11],s85 offen offset:3072 sc1
s_add_u32 s85,s85,0x20000
buffer_load_dwordx4 v[96:99],v4,s[8:11],s85 offen offset:0 sc1
buffer_load_dwordx4 v[100:103],v4,s[8:11],s85 offen offset:1024 sc1
buffer_load_dwordx4 v[104:107],v4,s[8:11],s85 offen offset:2048 sc1
buffer_load_dwordx4 v[108:111],v4,s[8:11],s85 offen offset:3072 sc1
s_add_u32 s85,s85,0x20000
buffer_load_dwordx4 v[112:115],v4,s[8:11],s85 offen offset:0 sc1
buffer_load_dwordx4 v[116:119],v4,s[8:11],s85 offen offset:1024 sc1
buffer_load_dwordx4 v[120:123],v4,s[8:11],s85 offen offset:2048 sc1
buffer_load_dwordx4 v[124:127],v4,s[8:11],s85 offen offset:3072 sc1
s_add_u32 s85,s85,0x20000
s_add_u32 s83,s83,0x40000
s_add_u32 s84,s84,0x38000
s_add_u32 s86,s86,24576
s_cmp_eq_u32 s86,147456
s_cselect_b32 s86,0,s86
s_add_u32 s88,s86,s80
s_add_u32 s89,s86,s81
s_add_u32 m0,s88,0
s_nop 0
buffer_load_dwordx4 v5,s[12:15],s83 offen offset:0 lds
s_add_u32 m0,s88,1984
s_nop 0
buffer_load_dwordx4 v5,s[12:15],s83 offen offset:64 lds
s_add_u32 m0,s89,0
s_nop 0
buffer_load_dwordx4 v6,s[16:19],s84 offen offset:0 lds
s_add_u32 m0,s89,1984
s_nop 0
buffer_load_dwordx4 v6,s[16:19],s84 offen offset:64 lds
s_add_u32 m0,s89,3968
s_nop 0
buffer_load_dwordx4 v6,s[16:19],s84 offen offset:128 lds
s_add_u32 m0,s86,s82
s_nop 0
buffer_load_dwordx4 v7,s[16:19],s84 offen lds
s_add_u32 s83,s83,0x40000
s_add_u32 s84,s84,0x38000
s_add_u32 s86,s86,24576
s_cmp_eq_u32 s86,147456
s_cselect_b32 s86,0,s86
s_cmp_eq_u32 s44,3
s_cselect_b32 s98,s10,s98
s_add_u32 s67,s53,0x4200000
s_cmp_eq_u32 s45,0
s_cselect_b32 s67,s67,0x7ff00000
s_lshl_b32 s53,s47,21
ds_read_b64_tr_b16 v[48:49],v8 offset:8192
ds_read_b64_tr_b16 v[50:51],v8 offset:9216
ds_read_b64_tr_b16 v[52:53],v8 offset:16384
ds_read_b64_tr_b16 v[54:55],v8 offset:17408
ds_read_b64_tr_b16 v[56:57],v9 offset:8192
ds_read_b64_tr_b16 v[58:59],v9 offset:9216
ds_read_b64_tr_b16 v[60:61],v9 offset:16384
ds_read_b64_tr_b16 v[62:63],v9 offset:17408
ds_read_b64_tr_b16 v[64:65],v8 offset:10240
ds_read_b64_tr_b16 v[66:67],v8 offset:11264
L_kloop:
s_waitcnt vmcnt(14) lgkmcnt(8)
v_mfma_f32_16x16x32_bf16 v[144:147],v[48:51],v[80:83],v[144:147]
ds_read_b64_tr_b16 v[68:69],v8 offset:18432
v_mfma_f32_16x16x32_bf16 v[148:151],v[48:51],v[84:87],v[148:151]
v_mfma_f32_16x16x32_bf16 v[152:155],v[48:51],v[88:91],v[152:155]
ds_read_b64_tr_b16 v[70:71],v8 offset:19456
v_mfma_f32_16x16x32_bf16 v[156:159],v[48:51],v[92:95],v[156:159]
s_waitcnt lgkmcnt(6)
v_mfma_f32_16x16x32_bf16 a[140:143],v[52:55],v[92:95],a[140:143]
ds_read_b64_tr_b16 v[72:73],v9 offset:10240
v_mfma_f32_16x16x32_bf16 a[136:139],v[52:55],v[88:91],a[136:139]
buffer_load_dwordx4 v[128:131],v4,s[8:11],s85 offen offset:0 sc1
v_mfma_f32_16x16x32_bf16 a[132:135],v[52:55],v[84:87],a[132:135]
ds_read_b64_tr_b16 v[74:75],v9 offset:11264
v_mfma_f32_16x16x32_bf16 a[128:131],v[52:55],v[80:83],a[128:131]
v_mfma_f32_16x16x32_bf16 v[160:163],v[56:59],v[80:83],v[160:163]
ds_read_b64_tr_b16 v[76:77],v9 offset:18432
v_mfma_f32_16x16x32_bf16 v[164:167],v[56:59],v[84:87],v[164:167]
v_mfma_f32_16x16x32_bf16 v[168:171],v[56:59],v[88:91],v[168:171]
ds_read_b64_tr_b16 v[78:79],v9 offset:19456
v_mfma_f32_16x16x32_bf16 v[172:175],v[56:59],v[92:95],v[172:175]
buffer_load_dwordx4 v[132:135],v4,s[8:11],s85 offen offset:1024 sc1
s_waitcnt lgkmcnt(6)
v_mfma_f32_16x16x32_bf16 a[156:159],v[60:63],v[92:95],a[156:159]
ds_read_b64_tr_b16 v[48:49],v8 offset:12288
v_mfma_f32_16x16x32_bf16 a[152:155],v[60:63],v[88:91],a[152:155]
v_mfma_f32_16x16x32_bf16 a[148:151],v[60:63],v[84:87],a[148:151]
ds_read_b64_tr_b16 v[50:51],v8 offset:13312
v_mfma_f32_16x16x32_bf16 a[144:147],v[60:63],v[80:83],a[144:147]
v_mfma_f32_16x16x32_bf16 v[176:179],v[64:67],v[80:83],v[176:179]
ds_read_b64_tr_b16 v[52:53],v8 offset:20480
v_mfma_f32_16x16x32_bf16 v[180:183],v[64:67],v[84:87],v[180:183]
buffer_load_dwordx4 v[136:139],v4,s[8:11],s85 offen offset:2048 sc1
v_mfma_f32_16x16x32_bf16 v[184:187],v[64:67],v[88:91],v[184:187]
ds_read_b64_tr_b16 v[54:55],v8 offset:21504
v_mfma_f32_16x16x32_bf16 v[188:191],v[64:67],v[92:95],v[188:191]
s_waitcnt lgkmcnt(6)
v_mfma_f32_16x16x32_bf16 a[172:175],v[68:71],v[92:95],a[172:175]
ds_read_b64_tr_b16 v[56:57],v9 offset:12288
v_mfma_f32_16x16x32_bf16 a[168:171],v[68:71],v[88:91],a[168:171]
v_mfma_f32_16x16x32_bf16 a[164:167],v[68:71],v[84:87],a[164:167]
ds_read_b64_tr_b16 v[58:59],v9 offset:13312
v_mfma_f32_16x16x32_bf16 a[160:163],v[68:71],v[80:83],a[160:163]
v_mfma_f32_16x16x32_bf16 v[192:195],v[72:75],v[80:83],v[192:195]
ds_read_b64_tr_b16 v[60:61],v9 offset:20480
v_mfma_f32_16x16x32_bf16 v[196:199],v[72:75],v[84:87],v[196:199]
buffer_load_dwordx4 v[140:143],v4,s[8:11],s85 offen offset:3072 sc1
v_mfma_f32_16x16x32_bf16 v[200:203],v[72:75],v[88:91],v[200:203]
ds_read_b64_tr_b16 v[62:63],v9 offset:21504
s_add_u32 s85,s85,0x20000
v_mfma_f32_16x16x32_bf16 v[204:207],v[72:75],v[92:95],v[204:207]
s_add_u32 s88,s86,s80
s_waitcnt lgkmcnt(6)
v_mfma_f32_16x16x32_bf16 a[188:191],v[76:79],v[92:95],a[188:191]
ds_read_b64_tr_b16 v[64:65],v10 offset:14336
s_add_u32 s89,s86,s81
v_mfma_f32_16x16x32_bf16 a[184:187],v[76:79],v[88:91],a[184:187]
s_add_u32 m0,s88,0
v_mfma_f32_16x16x32_bf16 a[180:183],v[76:79],v[84:87],a[180:183]
ds_read_b64_tr_b16 v[66:67],v10 offset:15360
v_mfma_f32_16x16x32_bf16 a[176:179],v[76:79],v[80:83],a[176:179]
buffer_load_dwordx4 v5,s[12:15],s83 offen offset:0 lds
v_mfma_f32_16x16x32_bf16 v[208:211],v[48:51],v[80:83],v[208:211]
ds_read_b64_tr_b16 v[68:69],v10 offset:22528
s_add_u32 m0,s88,1984
v_mfma_f32_16x16x32_bf16 v[212:215],v[48:51],v[84:87],v[212:215]
v_mfma_f32_16x16x32_bf16 v[216:219],v[48:51],v[88:91],v[216:219]
ds_read_b64_tr_b16 v[70:71],v10 offset:23552
v_mfma_f32_16x16x32_bf16 v[220:223],v[48:51],v[92:95],v[220:223]
s_waitcnt lgkmcnt(6)
v_mfma_f32_16x16x32_bf16 a[204:207],v[52:55],v[92:95],a[204:207]
ds_read_b64_tr_b16 v[72:73],v8 offset:0
v_mfma_f32_16x16x32_bf16 a[200:203],v[52:55],v[88:91],a[200:203]
v_mfma_f32_16x16x32_bf16 a[196:199],v[52:55],v[84:87],a[196:199]
ds_read_b64_tr_b16 v[74:75],v8 offset:1024
v_mfma_f32_16x16x32_bf16 a[192:195],v[52:55],v[80:83],a[192:195]
buffer_load_dwordx4 v5,s[12:15],s83 offen offset:64 lds
v_mfma_f32_16x16x32_bf16 v[224:227],v[56:59],v[80:83],v[224:227]
ds_read_b64_tr_b16 v[76:77],v9 offset:0
s_add_u32 m0,s89,0
v_mfma_f32_16x16x32_bf16 v[228:231],v[56:59],v[84:87],v[228:231]
v_mfma_f32_16x16x32_bf16 v[232:235],v[56:59],v[88:91],v[232:235]
ds_read_b64_tr_b16 v[78:79],v9 offset:1024
v_mfma_f32_16x16x32_bf16 v[236:239],v[56:59],v[92:95],v[236:239]
s_waitcnt lgkmcnt(6)
v_mfma_f32_16x16x32_bf16 a[220:223],v[60:63],v[92:95],a[220:223]
ds_read_b64_tr_b16 v[48:49],v8 offset:2048
v_mfma_f32_16x16x32_bf16 a[216:219],v[60:63],v[88:91],a[216:219]
buffer_load_dwordx4 v6,s[16:19],s84 offen offset:0 lds
v_mfma_f32_16x16x32_bf16 a[212:215],v[60:63],v[84:87],a[212:215]
ds_read_b64_tr_b16 v[50:51],v8 offset:3072
s_add_u32 m0,s89,1984
v_mfma_f32_16x16x32_bf16 a[208:211],v[60:63],v[80:83],a[208:211]
v_mfma_f32_16x16x32_bf16 v[240:243],v[64:67],v[80:83],v[240:243]
ds_read_b64_tr_b16 v[52:53],v9 offset:2048
v_mfma_f32_16x16x32_bf16 v[244:247],v[64:67],v[84:87],v[244:247]
v_mfma_f32_16x16x32_bf16 v[248:251],v[64:67],v[88:91],v[248:251]
ds_read_b64_tr_b16 v[54:55],v9 offset:3072
v_mfma_f32_16x16x32_bf16 v[252:255],v[64:67],v[92:95],v[252:255]
s_waitcnt lgkmcnt(6)
v_mfma_f32_16x16x32_bf16 a[236:239],v[68:71],v[92:95],a[236:239]
ds_read_b64_tr_b16 v[56:57],v8 offset:4096
v_mfma_f32_16x16x32_bf16 a[232:235],v[68:71],v[88:91],a[232:235]
s_add_u32 s87,s87,24576
s_cmp_eq_u32 s87,147456
s_cselect_b32 s87,0,s87
s_cselect_b32 s54,s93,s94
v_mfma_f32_16x16x32_bf16 a[228:231],v[68:71],v[84:87],a[228:231]
ds_read_b64_tr_b16 v[58:59],v8 offset:5120
v_mfma_f32_16x16x32_bf16 a[224:227],v[68:71],v[80:83],a[224:227]
buffer_load_dwordx4 v6,s[16:19],s84 offen offset:64 lds
v_mfma_f32_16x16x32_bf16 a[0:3],v[72:75],v[80:83],a[0:3]
ds_read_b64_tr_b16 v[60:61],v9 offset:4096
s_add_u32 m0,s89,3968
v_mfma_f32_16x16x32_bf16 a[4:7],v[72:75],v[84:87],a[4:7]
v_mfma_f32_16x16x32_bf16 a[8:11],v[72:75],v[88:91],a[8:11]
ds_read_b64_tr_b16 v[62:63],v9 offset:5120
v_mfma_f32_16x16x32_bf16 a[12:15],v[72:75],v[92:95],a[12:15]
buffer_load_dwordx4 v6,s[16:19],s84 offen offset:128 lds
s_waitcnt lgkmcnt(6)
v_mfma_f32_16x16x32_bf16 a[28:31],v[76:79],v[92:95],a[28:31]
ds_read_b64_tr_b16 v[64:65],v8 offset:6144
s_add_u32 m0,s86,s82
v_mfma_f32_16x16x32_bf16 a[24:27],v[76:79],v[88:91],a[24:27]
v_add_u32 v10,s54,v10
v_mfma_f32_16x16x32_bf16 a[20:23],v[76:79],v[84:87],a[20:23]
ds_read_b64_tr_b16 v[66:67],v8 offset:7168
v_mfma_f32_16x16x32_bf16 a[16:19],v[76:79],v[80:83],a[16:19]
v_mfma_f32_16x16x32_bf16 a[32:35],v[48:51],v[80:83],a[32:35]
ds_read_b64_tr_b16 v[68:69],v9 offset:6144
v_mfma_f32_16x16x32_bf16 a[36:39],v[48:51],v[84:87],a[36:39]
v_add_u32 v8,s54,v8
v_mfma_f32_16x16x32_bf16 a[40:43],v[48:51],v[88:91],a[40:43]
ds_read_b64_tr_b16 v[70:71],v9 offset:7168
v_mfma_f32_16x16x32_bf16 a[44:47],v[48:51],v[92:95],a[44:47]
s_waitcnt vmcnt(22)
s_barrier
s_waitcnt lgkmcnt(6)
v_mfma_f32_16x16x32_bf16 a[60:63],v[52:55],v[92:95],a[60:63]
ds_read_b64_tr_b16 v[72:73],v8 offset:8192
v_mfma_f32_16x16x32_bf16 a[56:59],v[52:55],v[88:91],a[56:59]
buffer_load_dwordx4 v7,s[16:19],s84 offen lds
v_add_u32 v9,s54,v9
v_mfma_f32_16x16x32_bf16 a[52:55],v[52:55],v[84:87],a[52:55]
ds_read_b64_tr_b16 v[74:75],v8 offset:9216
s_add_u32 s83,s83,0x40000
v_mfma_f32_16x16x32_bf16 a[48:51],v[52:55],v[80:83],a[48:51]
s_add_u32 s84,s84,0x38000
v_mfma_f32_16x16x32_bf16 a[64:67],v[56:59],v[80:83],a[64:67]
ds_read_b64_tr_b16 v[76:77],v8 offset:16384
v_mfma_f32_16x16x32_bf16 a[68:71],v[56:59],v[84:87],a[68:71]
buffer_load_dword v45,v44,s[96:99],s72 offen
v_mfma_f32_16x16x32_bf16 a[72:75],v[56:59],v[88:91],a[72:75]
ds_read_b64_tr_b16 v[78:79],v8 offset:17408
v_mfma_f32_16x16x32_bf16 a[76:79],v[56:59],v[92:95],a[76:79]
s_waitcnt lgkmcnt(6)
v_mfma_f32_16x16x32_bf16 a[92:95],v[60:63],v[92:95],a[92:95]
ds_read_b64_tr_b16 v[48:49],v9 offset:8192
v_mfma_f32_16x16x32_bf16 a[88:91],v[60:63],v[88:91],a[88:91]
s_add_u32 s72,s72,s73
s_cmp_eq_u32 s72,s74
s_cselect_b32 s72,s75,s72
v_mfma_f32_16x16x32_bf16 a[84:87],v[60:63],v[84:87],a[84:87]
ds_read_b64_tr_b16 v[50:51],v9 offset:9216
v_mfma_f32_16x16x32_bf16 a[80:83],v[60:63],v[80:83],a[80:83]
v_mfma_f32_16x16x32_bf16 a[96:99],v[64:67],v[80:83],a[96:99]
ds_read_b64_tr_b16 v[52:53],v9 offset:16384
v_mfma_f32_16x16x32_bf16 a[100:103],v[64:67],v[84:87],a[100:103]
s_add_u32 s86,s86,24576
s_cmp_eq_u32 s86,147456
s_cselect_b32 s86,0,s86
v_mfma_f32_16x16x32_bf16 a[104:107],v[64:67],v[88:91],a[104:107]
ds_read_b64_tr_b16 v[54:55],v9 offset:17408
v_mfma_f32_16x16x32_bf16 a[108:111],v[64:67],v[92:95],a[108:111]
s_waitcnt lgkmcnt(8)
v_mfma_f32_16x16x32_bf16 a[124:127],v[68:71],v[92:95],a[124:127]
ds_read_b64_tr_b16 v[56:57],v8 offset:10240
s_cmp_eq_u32 s55,1
s_cselect_b32 s57,s58,0x7ff00000
v_mfma_f32_16x16x32_bf16 a[120:123],v[68:71],v[88:91],a[120:123]
v_mfma_f32_16x16x32_bf16 a[116:119],v[68:71],v[84:87],a[116:119]
ds_read_b64_tr_b16 v[58:59],v8 offset:11264
s_cmp_eq_u32 s55,1
s_cselect_b32 s65,s64,0x7ff00000
v_mfma_f32_16x16x32_bf16 a[112:115],v[68:71],v[80:83],a[112:115]
s_waitcnt vmcnt(21) lgkmcnt(8)
v_mfma_f32_16x16x32_bf16 v[144:147],v[72:75],v[96:99],v[144:147]
ds_read_b64_tr_b16 v[60:61],v8 offset:18432
v_mfma_f32_16x16x32_bf16 v[148:151],v[72:75],v[100:103],v[148:151]
v_mfma_f32_16x16x32_bf16 v[152:155],v[72:75],v[104:107],v[152:155]
ds_read_b64_tr_b16 v[62:63],v8 offset:19456
v_mfma_f32_16x16x32_bf16 v[156:159],v[72:75],v[108:111],v[156:159]
s_waitcnt lgkmcnt(6)
v_mfma_f32_16x16x32_bf16 a[140:143],v[76:79],v[108:111],a[140:143]
ds_read_b64_tr_b16 v[64:65],v9 offset:10240
v_mfma_f32_16x16x32_bf16 a[136:139],v[76:79],v[104:107],a[136:139]
buffer_load_dwordx4 v[80:83],v4,s[8:11],s85 offen offset:0 sc1
v_mfma_f32_16x16x32_bf16 a[132:135],v[76:79],v[100:103],a[132:135]
ds_read_b64_tr_b16 v[66:67],v9 offset:11264
v_mfma_f32_16x16x32_bf16 a[128:131],v[76:79],v[96:99],a[128:131]
v_mfma_f32_16x16x32_bf16 v[160:163],v[48:51],v[96:99],v[160:163]
ds_read_b64_tr_b16 v[68:69],v9 offset:18432
v_mfma_f32_16x16x32_bf16 v[164:167],v[48:51],v[100:103],v[164:167]
buffer_load_dwordx4 v[84:87],v4,s[8:11],s85 offen offset:1024 sc1
v_mfma_f32_16x16x32_bf16 v[168:171],v[48:51],v[104:107],v[168:171]
ds_read_b64_tr_b16 v[70:71],v9 offset:19456
v_mfma_f32_16x16x32_bf16 v[172:175],v[48:51],v[108:111],v[172:175]
s_waitcnt lgkmcnt(6)
v_mfma_f32_16x16x32_bf16 a[156:159],v[52:55],v[108:111],a[156:159]
ds_read_b64_tr_b16 v[72:73],v8 offset:12288
v_mfma_f32_16x16x32_bf16 a[152:155],v[52:55],v[104:107],a[152:155]
v_mfma_f32_16x16x32_bf16 a[148:151],v[52:55],v[100:103],a[148:151]
ds_read_b64_tr_b16 v[74:75],v8 offset:13312
v_mfma_f32_16x16x32_bf16 a[144:147],v[52:55],v[96:99],a[144:147]
buffer_load_dwordx4 v[88:91],v4,s[8:11],s85 offen offset:2048 sc1
v_mfma_f32_16x16x32_bf16 v[176:179],v[56:59],v[96:99],v[176:179]
ds_read_b64_tr_b16 v[76:77],v8 offset:20480
v_mfma_f32_16x16x32_bf16 v[180:183],v[56:59],v[100:103],v[180:183]
v_mfma_f32_16x16x32_bf16 v[184:187],v[56:59],v[104:107],v[184:187]
ds_read_b64_tr_b16 v[78:79],v8 offset:21504
v_mfma_f32_16x16x32_bf16 v[188:191],v[56:59],v[108:111],v[188:191]
s_waitcnt lgkmcnt(6)
v_mfma_f32_16x16x32_bf16 a[172:175],v[60:63],v[108:111],a[172:175]
ds_read_b64_tr_b16 v[48:49],v9 offset:12288
v_mfma_f32_16x16x32_bf16 a[168:171],v[60:63],v[104:107],a[168:171]
v_mfma_f32_16x16x32_bf16 a[164:167],v[60:63],v[100:103],a[164:167]
ds_read_b64_tr_b16 v[50:51],v9 offset:13312
v_mfma_f32_16x16x32_bf16 a[160:163],v[60:63],v[96:99],a[160:163]
buffer_load_dwordx4 v[92:95],v4,s[8:11],s85 offen offset:3072 sc1
v_mfma_f32_16x16x32_bf16 v[192:195],v[64:67],v[96:99],v[192:195]
ds_read_b64_tr_b16 v[52:53],v9 offset:20480
s_add_u32 s85,s85,0x20000
v_mfma_f32_16x16x32_bf16 v[196:199],v[64:67],v[100:103],v[196:199]
s_add_u32 s88,s86,s80
s_add_u32 s89,s86,s81
v_mfma_f32_16x16x32_bf16 v[200:203],v[64:67],v[104:107],v[200:203]
ds_read_b64_tr_b16 v[54:55],v9 offset:21504
s_add_u32 m0,s88,0
v_mfma_f32_16x16x32_bf16 v[204:207],v[64:67],v[108:111],v[204:207]
s_waitcnt lgkmcnt(6)
v_mfma_f32_16x16x32_bf16 a[188:191],v[68:71],v[108:111],a[188:191]
ds_read_b64_tr_b16 v[56:57],v10 offset:14336
v_mfma_f32_16x16x32_bf16 a[184:187],v[68:71],v[104:107],a[184:187]
buffer_load_dwordx4 v5,s[12:15],s83 offen offset:0 lds
v_mfma_f32_16x16x32_bf16 a[180:183],v[68:71],v[100:103],a[180:183]
ds_read_b64_tr_b16 v[58:59],v10 offset:15360
s_add_u32 m0,s88,1984
v_mfma_f32_16x16x32_bf16 a[176:179],v[68:71],v[96:99],a[176:179]
v_mfma_f32_16x16x32_bf16 v[208:211],v[72:75],v[96:99],v[208:211]
ds_read_b64_tr_b16 v[60:61],v10 offset:22528
v_mfma_f32_16x16x32_bf16 v[212:215],v[72:75],v[100:103],v[212:215]
v_mfma_f32_16x16x32_bf16 v[216:219],v[72:75],v[104:107],v[216:219]
ds_read_b64_tr_b16 v[62:63],v10 offset:23552
v_mfma_f32_16x16x32_bf16 v[220:223],v[72:75],v[108:111],v[220:223]
s_waitcnt lgkmcnt(6)
v_mfma_f32_16x16x32_bf16 a[204:207],v[76:79],v[108:111],a[204:207]
ds_read_b64_tr_b16 v[64:65],v8 offset:0
v_mfma_f32_16x16x32_bf16 a[200:203],v[76:79],v[104:107],a[200:203]
buffer_load_dwordx4 v5,s[12:15],s83 offen offset:64 lds
v_mfma_f32_16x16x32_bf16 a[196:199],v[76:79],v[100:103],a[196:199]
ds_read_b64_tr_b16 v[66:67],v8 offset:1024
s_add_u32 m0,s89,0
v_mfma_f32_16x16x32_bf16 a[192:195],v[76:79],v[96:99],a[192:195]
v_mfma_f32_16x16x32_bf16 v[224:227],v[48:51],v[96:99],v[224:227]
ds_read_b64_tr_b16 v[68:69],v9 offset:0
v_mfma_f32_16x16x32_bf16 v[228:231],v[48:51],v[100:103],v[228:231]
buffer_load_dwordx4 v6,s[16:19],s84 offen offset:0 lds
v_mfma_f32_16x16x32_bf16 v[232:235],v[48:51],v[104:107],v[232:235]
ds_read_b64_tr_b16 v[70:71],v9 offset:1024
s_add_u32 m0,s89,1984
v_mfma_f32_16x16x32_bf16 v[236:239],v[48:51],v[108:111],v[236:239]
s_waitcnt lgkmcnt(6)
v_mfma_f32_16x16x32_bf16 a[220:223],v[52:55],v[108:111],a[220:223]
ds_read_b64_tr_b16 v[72:73],v8 offset:2048
v_mfma_f32_16x16x32_bf16 a[216:219],v[52:55],v[104:107],a[216:219]
v_mfma_f32_16x16x32_bf16 a[212:215],v[52:55],v[100:103],a[212:215]
ds_read_b64_tr_b16 v[74:75],v8 offset:3072
v_mfma_f32_16x16x32_bf16 a[208:211],v[52:55],v[96:99],a[208:211]
buffer_load_dwordx4 v6,s[16:19],s84 offen offset:64 lds
v_mfma_f32_16x16x32_bf16 v[240:243],v[56:59],v[96:99],v[240:243]
ds_read_b64_tr_b16 v[76:77],v9 offset:2048
s_add_u32 m0,s89,3968
v_mfma_f32_16x16x32_bf16 v[244:247],v[56:59],v[100:103],v[244:247]
v_mfma_f32_16x16x32_bf16 v[248:251],v[56:59],v[104:107],v[248:251]
ds_read_b64_tr_b16 v[78:79],v9 offset:3072
v_mfma_f32_16x16x32_bf16 v[252:255],v[56:59],v[108:111],v[252:255]
s_waitcnt lgkmcnt(6)
v_mfma_f32_16x16x32_bf16 a[236:239],v[60:63],v[108:111],a[236:239]
ds_read_b64_tr_b16 v[48:49],v8 offset:4096
v_mfma_f32_16x16x32_bf16 a[232:235],v[60:63],v[104:107],a[232:235]
s_add_u32 s87,s87,24576
s_cmp_eq_u32 s87,147456
s_cselect_b32 s87,0,s87
s_cselect_b32 s54,s93,s94
v_mfma_f32_16x16x32_bf16 a[228:231],v[60:63],v[100:103],a[228:231]
ds_read_b64_tr_b16 v[50:51],v8 offset:5120
v_mfma_f32_16x16x32_bf16 a[224:227],v[60:63],v[96:99],a[224:227]
buffer_load_dwordx4 v6,s[16:19],s84 offen offset:128 lds
v_mfma_f32_16x16x32_bf16 a[0:3],v[64:67],v[96:99],a[0:3]
ds_read_b64_tr_b16 v[52:53],v9 offset:4096
s_add_u32 m0,s86,s82
v_mfma_f32_16x16x32_bf16 a[4:7],v[64:67],v[100:103],a[4:7]
v_mfma_f32_16x16x32_bf16 a[8:11],v[64:67],v[104:107],a[8:11]
ds_read_b64_tr_b16 v[54:55],v9 offset:5120
v_mfma_f32_16x16x32_bf16 a[12:15],v[64:67],v[108:111],a[12:15]
s_waitcnt lgkmcnt(6)
v_mfma_f32_16x16x32_bf16 a[28:31],v[68:71],v[108:111],a[28:31]
ds_read_b64_tr_b16 v[56:57],v8 offset:6144
v_mfma_f32_16x16x32_bf16 a[24:27],v[68:71],v[104:107],a[24:27]
buffer_load_dwordx4 v7,s[16:19],s84 offen lds
v_add_u32 v10,s54,v10
v_mfma_f32_16x16x32_bf16 a[20:23],v[68:71],v[100:103],a[20:23]
ds_read_b64_tr_b16 v[58:59],v8 offset:7168
s_add_u32 s83,s83,0x40000
v_mfma_f32_16x16x32_bf16 a[16:19],v[68:71],v[96:99],a[16:19]
s_add_u32 s84,s84,0x38000
v_mfma_f32_16x16x32_bf16 a[32:35],v[72:75],v[96:99],a[32:35]
ds_read_b64_tr_b16 v[60:61],v9 offset:6144
v_mfma_f32_16x16x32_bf16 a[36:39],v[72:75],v[100:103],a[36:39]
v_add_u32 v8,s54,v8
v_mfma_f32_16x16x32_bf16 a[40:43],v[72:75],v[104:107],a[40:43]
ds_read_b64_tr_b16 v[62:63],v9 offset:7168
v_mfma_f32_16x16x32_bf16 a[44:47],v[72:75],v[108:111],a[44:47]
s_waitcnt vmcnt(21)
s_barrier
s_waitcnt lgkmcnt(6)
v_mfma_f32_16x16x32_bf16 a[60:63],v[76:79],v[108:111],a[60:63]
ds_read_b64_tr_b16 v[64:65],v8 offset:8192
v_mfma_f32_16x16x32_bf16 a[56:59],v[76:79],v[104:107],a[56:59]
buffer_load_dword v24,v28,s[4:7],s57 offen
v_add_u32 v9,s54,v9
v_mfma_f32_16x16x32_bf16 a[52:55],v[76:79],v[100:103],a[52:55]
ds_read_b64_tr_b16 v[66:67],v8 offset:9216
v_mfma_f32_16x16x32_bf16 a[48:51],v[76:79],v[96:99],a[48:51]
v_mfma_f32_16x16x32_bf16 a[64:67],v[48:51],v[96:99],a[64:67]
ds_read_b64_tr_b16 v[68:69],v8 offset:16384
v_mfma_f32_16x16x32_bf16 a[68:71],v[48:51],v[100:103],a[68:71]
buffer_load_dword v45,v44,s[96:99],s72 offen
v_mfma_f32_16x16x32_bf16 a[72:75],v[48:51],v[104:107],a[72:75]
ds_read_b64_tr_b16 v[70:71],v8 offset:17408
v_mfma_f32_16x16x32_bf16 a[76:79],v[48:51],v[108:111],a[76:79]
s_waitcnt lgkmcnt(6)
v_mfma_f32_16x16x32_bf16 a[92:95],v[52:55],v[108:111],a[92:95]
ds_read_b64_tr_b16 v[72:73],v9 offset:8192
v_mfma_f32_16x16x32_bf16 a[88:91],v[52:55],v[104:107],a[88:91]
s_add_u32 s72,s72,s73
s_cmp_eq_u32 s72,s74
s_cselect_b32 s72,s75,s72
v_mfma_f32_16x16x32_bf16 a[84:87],v[52:55],v[100:103],a[84:87]
ds_read_b64_tr_b16 v[74:75],v9 offset:9216
v_mfma_f32_16x16x32_bf16 a[80:83],v[52:55],v[96:99],a[80:83]
v_mfma_f32_16x16x32_bf16 a[96:99],v[56:59],v[96:99],a[96:99]
ds_read_b64_tr_b16 v[76:77],v9 offset:16384
v_mfma_f32_16x16x32_bf16 a[100:103],v[56:59],v[100:103],a[100:103]
s_add_u32 s86,s86,24576
s_cmp_eq_u32 s86,147456
s_cselect_b32 s86,0,s86
v_mfma_f32_16x16x32_bf16 a[104:107],v[56:59],v[104:107],a[104:107]
ds_read_b64_tr_b16 v[78:79],v9 offset:17408
v_mfma_f32_16x16x32_bf16 a[108:111],v[56:59],v[108:111],a[108:111]
s_waitcnt lgkmcnt(8)
v_mfma_f32_16x16x32_bf16 a[124:127],v[60:63],v[108:111],a[124:127]
ds_read_b64_tr_b16 v[48:49],v8 offset:10240
v_mfma_f32_16x16x32_bf16 a[120:123],v[60:63],v[104:107],a[120:123]
v_mfma_f32_16x16x32_bf16 a[116:119],v[60:63],v[100:103],a[116:119]
ds_read_b64_tr_b16 v[50:51],v8 offset:11264
v_mfma_f32_16x16x32_bf16 a[112:115],v[60:63],v[96:99],a[112:115]
s_waitcnt lgkmcnt(8)
v_mfma_f32_16x16x32_bf16 v[144:147],v[64:67],v[112:115],v[144:147]
ds_read_b64_tr_b16 v[52:53],v8 offset:18432
v_mfma_f32_16x16x32_bf16 v[148:151],v[64:67],v[116:119],v[148:151]
v_mfma_f32_16x16x32_bf16 v[152:155],v[64:67],v[120:123],v[152:155]
ds_read_b64_tr_b16 v[54:55],v8 offset:19456
v_mfma_f32_16x16x32_bf16 v[156:159],v[64:67],v[124:127],v[156:159]
s_waitcnt lgkmcnt(6)
v_mfma_f32_16x16x32_bf16 a[140:143],v[68:71],v[124:127],a[140:143]
ds_read_b64_tr_b16 v[56:57],v9 offset:10240
v_mfma_f32_16x16x32_bf16 a[136:139],v[68:71],v[120:123],a[136:139]
buffer_load_dwordx4 v[96:99],v4,s[8:11],s85 offen offset:0 sc1
v_mfma_f32_16x16x32_bf16 a[132:135],v[68:71],v[116:119],a[132:135]
ds_read_b64_tr_b16 v[58:59],v9 offset:11264
v_mfma_f32_16x16x32_bf16 a[128:131],v[68:71],v[112:115],a[128:131]
v_mfma_f32_16x16x32_bf16 v[160:163],v[72:75],v[112:115],v[160:163]
ds_read_b64_tr_b16 v[60:61],v9 offset:18432
v_mfma_f32_16x16x32_bf16 v[164:167],v[72:75],v[116:119],v[164:167]
buffer_load_dwordx4 v[100:103],v4,s[8:11],s85 offen offset:1024 sc1
v_mfma_f32_16x16x32_bf16 v[168:171],v[72:75],v[120:123],v[168:171]
ds_read_b64_tr_b16 v[62:63],v9 offset:19456
v_mfma_f32_16x16x32_bf16 v[172:175],v[72:75],v[124:127],v[172:175]
s_waitcnt lgkmcnt(6)
v_mfma_f32_16x16x32_bf16 a[156:159],v[76:79],v[124:127],a[156:159]
ds_read_b64_tr_b16 v[64:65],v8 offset:12288
v_mfma_f32_16x16x32_bf16 a[152:155],v[76:79],v[120:123],a[152:155]
v_mfma_f32_16x16x32_bf16 a[148:151],v[76:79],v[116:119],a[148:151]
ds_read_b64_tr_b16 v[66:67],v8 offset:13312
v_mfma_f32_16x16x32_bf16 a[144:147],v[76:79],v[112:115],a[144:147]
buffer_load_dwordx4 v[104:107],v4,s[8:11],s85 offen offset:2048 sc1
v_mfma_f32_16x16x32_bf16 v[176:179],v[48:51],v[112:115],v[176:179]
ds_read_b64_tr_b16 v[68:69],v8 offset:20480
v_mfma_f32_16x16x32_bf16 v[180:183],v[48:51],v[116:119],v[180:183]
v_mfma_f32_16x16x32_bf16 v[184:187],v[48:51],v[120:123],v[184:187]
ds_read_b64_tr_b16 v[70:71],v8 offset:21504
v_mfma_f32_16x16x32_bf16 v[188:191],v[48:51],v[124:127],v[188:191]
s_waitcnt lgkmcnt(6)
v_mfma_f32_16x16x32_bf16 a[172:175],v[52:55],v[124:127],a[172:175]
ds_read_b64_tr_b16 v[72:73],v9 offset:12288
v_mfma_f32_16x16x32_bf16 a[168:171],v[52:55],v[120:123],a[168:171]
v_mfma_f32_16x16x32_bf16 a[164:167],v[52:55],v[116:119],a[164:167]
ds_read_b64_tr_b16 v[74:75],v9 offset:13312
v_mfma_f32_16x16x32_bf16 a[160:163],v[52:55],v[112:115],a[160:163]
buffer_load_dwordx4 v[108:111],v4,s[8:11],s85 offen offset:3072 sc1
v_mfma_f32_16x16x32_bf16 v[192:195],v[56:59],v[112:115],v[192:195]
ds_read_b64_tr_b16 v[76:77],v9 offset:20480
s_add_u32 s85,s85,0x20000
v_mfma_f32_16x16x32_bf16 v[196:199],v[56:59],v[116:119],v[196:199]
s_add_u32 s88,s86,s80
s_add_u32 s89,s86,s81
v_mfma_f32_16x16x32_bf16 v[200:203],v[56:59],v[120:123],v[200:203]
ds_read_b64_tr_b16 v[78:79],v9 offset:21504
s_add_u32 m0,s88,0
v_mfma_f32_16x16x32_bf16 v[204:207],v[56:59],v[124:127],v[204:207]
s_waitcnt lgkmcnt(6)
v_mfma_f32_16x16x32_bf16 a[188:191],v[60:63],v[124:127],a[188:191]
ds_read_b64_tr_b16 v[48:49],v10 offset:14336
v_mfma_f32_16x16x32_bf16 a[184:187],v[60:63],v[120:123],a[184:187]
buffer_load_dwordx4 v5,s[12:15],s83 offen offset:0 lds
v_mfma_f32_16x16x32_bf16 a[180:183],v[60:63],v[116:119],a[180:183]
ds_read_b64_tr_b16 v[50:51],v10 offset:15360
s_add_u32 m0,s88,1984
v_mfma_f32_16x16x32_bf16 a[176:179],v[60:63],v[112:115],a[176:179]
v_mfma_f32_16x16x32_bf16 v[208:211],v[64:67],v[112:115],v[208:211]
ds_read_b64_tr_b16 v[52:53],v10 offset:22528
v_mfma_f32_16x16x32_bf16 v[212:215],v[64:67],v[116:119],v[212:215]
v_mfma_f32_16x16x32_bf16 v[216:219],v[64:67],v[120:123],v[216:219]
ds_read_b64_tr_b16 v[54:55],v10 offset:23552
v_mfma_f32_16x16x32_bf16 v[220:223],v[64:67],v[124:127],v[220:223]
s_waitcnt lgkmcnt(6)
v_mfma_f32_16x16x32_bf16 a[204:207],v[68:71],v[124:127],a[204:207]
ds_read_b64_tr_b16 v[56:57],v8 offset:0
v_mfma_f32_16x16x32_bf16 a[200:203],v[68:71],v[120:123],a[200:203]
buffer_load_dwordx4 v5,s[12:15],s83 offen offset:64 lds
v_mfma_f32_16x16x32_bf16 a[196:199],v[68:71],v[116:119],a[196:199]
ds_read_b64_tr_b16 v[58:59],v8 offset:1024
s_add_u32 m0,s89,0
v_mfma_f32_16x16x32_bf16 a[192:195],v[68:71],v[112:115],a[192:195]
v_mfma_f32_16x16x32_bf16 v[224:227],v[72:75],v[112:115],v[224:227]
ds_read_b64_tr_b16 v[60:61],v9 offset:0
v_mfma_f32_16x16x32_bf16 v[228:231],v[72:75],v[116:119],v[228:231]
buffer_load_dwordx4 v6,s[16:19],s84 offen offset:0 lds
v_mfma_f32_16x16x32_bf16 v[232:235],v[72:75],v[120:123],v[232:235]
ds_read_b64_tr_b16 v[62:63],v9 offset:1024
s_add_u32 m0,s89,1984
v_mfma_f32_16x16x32_bf16 v[236:239],v[72:75],v[124:127],v[236:239]
s_waitcnt lgkmcnt(6)
v_mfma_f32_16x16x32_bf16 a[220:223],v[76:79],v[124:127],a[220:223]
ds_read_b64_tr_b16 v[64:65],v8 offset:2048
v_mfma_f32_16x16x32_bf16 a[216:219],v[76:79],v[120:123],a[216:219]
v_mfma_f32_16x16x32_bf16 a[212:215],v[76:79],v[116:119],a[212:215]
ds_read_b64_tr_b16 v[66:67],v8 offset:3072
v_mfma_f32_16x16x32_bf16 a[208:211],v[76:79],v[112:115],a[208:211]
buffer_load_dwordx4 v6,s[16:19],s84 offen offset:64 lds
v_mfma_f32_16x16x32_bf16 v[240:243],v[48:51],v[112:115],v[240:243]
ds_read_b64_tr_b16 v[68:69],v9 offset:2048
s_add_u32 m0,s89,3968
v_mfma_f32_16x16x32_bf16 v[244:247],v[48:51],v[116:119],v[244:247]
v_mfma_f32_16x16x32_bf16 v[248:251],v[48:51],v[120:123],v[248:251]
ds_read_b64_tr_b16 v[70:71],v9 offset:3072
v_mfma_f32_16x16x32_bf16 v[252:255],v[48:51],v[124:127],v[252:255]
s_waitcnt lgkmcnt(6)
v_mfma_f32_16x16x32_bf16 a[236:239],v[52:55],v[124:127],a[236:239]
ds_read_b64_tr_b16 v[72:73],v8 offset:4096
v_mfma_f32_16x16x32_bf16 a[232:235],v[52:55],v[120:123],a[232:235]
s_add_u32 s87,s87,24576
s_cmp_eq_u32 s87,147456
s_cselect_b32 s87,0,s87
s_cselect_b32 s54,s93,s94
v_mfma_f32_16x16x32_bf16 a[228:231],v[52:55],v[116:119],a[228:231]
ds_read_b64_tr_b16 v[74:75],v8 offset:5120
v_mfma_f32_16x16x32_bf16 a[224:227],v[52:55],v[112:115],a[224:227]
buffer_load_dwordx4 v6,s[16:19],s84 offen offset:128 lds
v_mfma_f32_16x16x32_bf16 a[0:3],v[56:59],v[112:115],a[0:3]
ds_read_b64_tr_b16 v[76:77],v9 offset:4096
s_add_u32 m0,s86,s82
v_mfma_f32_16x16x32_bf16 a[4:7],v[56:59],v[116:119],a[4:7]
v_mfma_f32_16x16x32_bf16 a[8:11],v[56:59],v[120:123],a[8:11]
ds_read_b64_tr_b16 v[78:79],v9 offset:5120
v_mfma_f32_16x16x32_bf16 a[12:15],v[56:59],v[124:127],a[12:15]
s_waitcnt lgkmcnt(6)
v_mfma_f32_16x16x32_bf16 a[28:31],v[60:63],v[124:127],a[28:31]
ds_read_b64_tr_b16 v[48:49],v8 offset:6144
v_mfma_f32_16x16x32_bf16 a[24:27],v[60:63],v[120:123],a[24:27]
buffer_load_dwordx4 v7,s[16:19],s84 offen lds
v_add_u32 v10,s54,v10
v_mfma_f32_16x16x32_bf16 a[20:23],v[60:63],v[116:119],a[20:23]
ds_read_b64_tr_b16 v[50:51],v8 offset:7168
s_add_u32 s83,s83,0x40000
v_mfma_f32_16x16x32_bf16 a[16:19],v[60:63],v[112:115],a[16:19]
s_add_u32 s84,s84,0x38000
v_mfma_f32_16x16x32_bf16 a[32:35],v[64:67],v[112:115],a[32:35]
ds_read_b64_tr_b16 v[52:53],v9 offset:6144
v_mfma_f32_16x16x32_bf16 a[36:39],v[64:67],v[116:119],a[36:39]
v_add_u32 v8,s54,v8
v_mfma_f32_16x16x32_bf16 a[40:43],v[64:67],v[120:123],a[40:43]
ds_read_b64_tr_b16 v[54:55],v9 offset:7168
v_mfma_f32_16x16x32_bf16 a[44:47],v[64:67],v[124:127],a[44:47]
s_waitcnt vmcnt(23)
s_barrier
s_waitcnt lgkmcnt(6)
v_mfma_f32_16x16x32_bf16 a[60:63],v[68:71],v[124:127],a[60:63]
ds_read_b64_tr_b16 v[56:57],v8 offset:8192
v_mfma_f32_16x16x32_bf16 a[56:59],v[68:71],v[120:123],a[56:59]
buffer_load_dword v25,v0,s[60:63],s65 offen
v_add_u32 v9,s54,v9
v_mfma_f32_16x16x32_bf16 a[52:55],v[68:71],v[116:119],a[52:55]
ds_read_b64_tr_b16 v[58:59],v8 offset:9216
v_mfma_f32_16x16x32_bf16 a[48:51],v[68:71],v[112:115],a[48:51]
v_mfma_f32_16x16x32_bf16 a[64:67],v[72:75],v[112:115],a[64:67]
ds_read_b64_tr_b16 v[60:61],v8 offset:16384
v_mfma_f32_16x16x32_bf16 a[68:71],v[72:75],v[116:119],a[68:71]
buffer_load_dword v45,v44,s[96:99],s72 offen
v_mfma_f32_16x16x32_bf16 a[72:75],v[72:75],v[120:123],a[72:75]
ds_read_b64_tr_b16 v[62:63],v8 offset:17408
v_mfma_f32_16x16x32_bf16 a[76:79],v[72:75],v[124:127],a[76:79]
s_waitcnt lgkmcnt(6)
v_mfma_f32_16x16x32_bf16 a[92:95],v[76:79],v[124:127],a[92:95]
ds_read_b64_tr_b16 v[64:65],v9 offset:8192
v_mfma_f32_16x16x32_bf16 a[88:91],v[76:79],v[120:123],a[88:91]
s_add_u32 s72,s72,s73
s_cmp_eq_u32 s72,s74
s_cselect_b32 s72,s75,s72
v_mfma_f32_16x16x32_bf16 a[84:87],v[76:79],v[116:119],a[84:87]
ds_read_b64_tr_b16 v[66:67],v9 offset:9216
v_mfma_f32_16x16x32_bf16 a[80:83],v[76:79],v[112:115],a[80:83]
v_mfma_f32_16x16x32_bf16 a[96:99],v[48:51],v[112:115],a[96:99]
ds_read_b64_tr_b16 v[68:69],v9 offset:16384
v_mfma_f32_16x16x32_bf16 a[100:103],v[48:51],v[116:119],a[100:103]
s_add_u32 s86,s86,24576
s_cmp_eq_u32 s86,147456
s_cselect_b32 s86,0,s86
v_mfma_f32_16x16x32_bf16 a[104:107],v[48:51],v[120:123],a[104:107]
ds_read_b64_tr_b16 v[70:71],v9 offset:17408
v_mfma_f32_16x16x32_bf16 a[108:111],v[48:51],v[124:127],a[108:111]
s_waitcnt lgkmcnt(8)
v_mfma_f32_16x16x32_bf16 a[124:127],v[52:55],v[124:127],a[124:127]
ds_read_b64_tr_b16 v[72:73],v8 offset:10240
v_mfma_f32_16x16x32_bf16 a[120:123],v[52:55],v[120:123],a[120:123]
v_mfma_f32_16x16x32_bf16 a[116:119],v[52:55],v[116:119],a[116:119]
ds_read_b64_tr_b16 v[74:75],v8 offset:11264
v_mfma_f32_16x16x32_bf16 a[112:115],v[52:55],v[112:115],a[112:115]
s_waitcnt lgkmcnt(8)
v_mfma_f32_16x16x32_bf16 v[144:147],v[56:59],v[128:131],v[144:147]
ds_read_b64_tr_b16 v[76:77],v8 offset:18432
v_mfma_f32_16x16x32_bf16 v[148:151],v[56:59],v[132:135],v[148:151]
v_mfma_f32_16x16x32_bf16 v[152:155],v[56:59],v[136:139],v[152:155]
ds_read_b64_tr_b16 v[78:79],v8 offset:19456
v_mfma_f32_16x16x32_bf16 v[156:159],v[56:59],v[140:143],v[156:159]
s_waitcnt lgkmcnt(6)
v_mfma_f32_16x16x32_bf16 a[140:143],v[60:63],v[140:143],a[140:143]
ds_read_b64_tr_b16 v[48:49],v9 offset:10240
v_mfma_f32_16x16x32_bf16 a[136:139],v[60:63],v[136:139],a[136:139]
buffer_load_dwordx4 v[112:115],v4,s[8:11],s85 offen offset:0 sc1
v_mfma_f32_16x16x32_bf16 a[132:135],v[60:63],v[132:135],a[132:135]
ds_read_b64_tr_b16 v[50:51],v9 offset:11264
v_mfma_f32_16x16x32_bf16 a[128:131],v[60:63],v[128:131],a[128:131]
v_mfma_f32_16x16x32_bf16 v[160:163],v[64:67],v[128:131],v[160:163]
ds_read_b64_tr_b16 v[52:53],v9 offset:18432
v_mfma_f32_16x16x32_bf16 v[164:167],v[64:67],v[132:135],v[164:167]
v_mfma_f32_16x16x32_bf16 v[168:171],v[64:67],v[136:139],v[168:171]
ds_read_b64_tr_b16 v[54:55],v9 offset:19456
v_mfma_f32_16x16x32_bf16 v[172:175],v[64:67],v[140:143],v[172:175]
buffer_load_dwordx4 v[116:119],v4,s[8:11],s85 offen offset:1024 sc1
s_waitcnt lgkmcnt(6)
v_mfma_f32_16x16x32_bf16 a[156:159],v[68:71],v[140:143],a[156:159]
ds_read_b64_tr_b16 v[56:57],v8 offset:12288
v_mfma_f32_16x16x32_bf16 a[152:155],v[68:71],v[136:139],a[152:155]
v_mfma_f32_16x16x32_bf16 a[148:151],v[68:71],v[132:135],a[148:151]
ds_read_b64_tr_b16 v[58:59],v8 offset:13312
v_mfma_f32_16x16x32_bf16 a[144:147],v[68:71],v[128:131],a[144:147]
v_mfma_f32_16x16x32_bf16 v[176:179],v[72:75],v[128:131],v[176:179]
ds_read_b64_tr_b16 v[60:61],v8 offset:20480
v_mfma_f32_16x16x32_bf16 v[180:183],v[72:75],v[132:135],v[180:183]
buffer_load_dwordx4 v[120:123],v4,s[8:11],s85 offen offset:2048 sc1
v_mfma_f32_16x16x32_bf16 v[184:187],v[72:75],v[136:139],v[184:187]
ds_read_b64_tr_b16 v[62:63],v8 offset:21504
v_mfma_f32_16x16x32_bf16 v[188:191],v[72:75],v[140:143],v[188:191]
s_waitcnt lgkmcnt(6)
v_mfma_f32_16x16x32_bf16 a[172:175],v[76:79],v[140:143],a[172:175]
ds_read_b64_tr_b16 v[64:65],v9 offset:12288
v_mfma_f32_16x16x32_bf16 a[168:171],v[76:79],v[136:139],a[168:171]
v_mfma_f32_16x16x32_bf16 a[164:167],v[76:79],v[132:135],a[164:167]
ds_read_b64_tr_b16 v[66:67],v9 offset:13312
v_mfma_f32_16x16x32_bf16 a[160:163],v[76:79],v[128:131],a[160:163]
v_mfma_f32_16x16x32_bf16 v[192:195],v[48:51],v[128:131],v[192:195]
ds_read_b64_tr_b16 v[68:69],v9 offset:20480
v_mfma_f32_16x16x32_bf16 v[196:199],v[48:51],v[132:135],v[196:199]
buffer_load_dwordx4 v[124:127],v4,s[8:11],s85 offen offset:3072 sc1
v_mfma_f32_16x16x32_bf16 v[200:203],v[48:51],v[136:139],v[200:203]
ds_read_b64_tr_b16 v[70:71],v9 offset:21504
s_add_u32 s85,s85,0x20000
v_mfma_f32_16x16x32_bf16 v[204:207],v[48:51],v[140:143],v[204:207]
s_add_u32 s88,s86,s80
s_waitcnt lgkmcnt(6)
v_mfma_f32_16x16x32_bf16 a[188:191],v[52:55],v[140:143],a[188:191]
ds_read_b64_tr_b16 v[72:73],v10 offset:14336
s_add_u32 s89,s86,s81
v_mfma_f32_16x16x32_bf16 a[184:187],v[52:55],v[136:139],a[184:187]
s_add_u32 m0,s88,0
v_mfma_f32_16x16x32_bf16 a[180:183],v[52:55],v[132:135],a[180:183]
ds_read_b64_tr_b16 v[74:75],v10 offset:15360
v_mfma_f32_16x16x32_bf16 a[176:179],v[52:55],v[128:131],a[176:179]
buffer_load_dwordx4 v5,s[12:15],s83 offen offset:0 lds
v_mfma_f32_16x16x32_bf16 v[208:211],v[56:59],v[128:131],v[208:211]
ds_read_b64_tr_b16 v[76:77],v10 offset:22528
s_add_u32 m0,s88,1984
v_mfma_f32_16x16x32_bf16 v[212:215],v[56:59],v[132:135],v[212:215]
v_mfma_f32_16x16x32_bf16 v[216:219],v[56:59],v[136:139],v[216:219]
ds_read_b64_tr_b16 v[78:79],v10 offset:23552
v_mfma_f32_16x16x32_bf16 v[220:223],v[56:59],v[140:143],v[220:223]
s_waitcnt lgkmcnt(6)
v_mfma_f32_16x16x32_bf16 a[204:207],v[60:63],v[140:143],a[204:207]
ds_read_b64_tr_b16 v[48:49],v8 offset:0
v_mfma_f32_16x16x32_bf16 a[200:203],v[60:63],v[136:139],a[200:203]
v_mfma_f32_16x16x32_bf16 a[196:199],v[60:63],v[132:135],a[196:199]
ds_read_b64_tr_b16 v[50:51],v8 offset:1024
v_mfma_f32_16x16x32_bf16 a[192:195],v[60:63],v[128:131],a[192:195]
buffer_load_dwordx4 v5,s[12:15],s83 offen offset:64 lds
v_mfma_f32_16x16x32_bf16 v[224:227],v[64:67],v[128:131],v[224:227]
ds_read_b64_tr_b16 v[52:53],v9 offset:0
s_add_u32 m0,s89,0
v_mfma_f32_16x16x32_bf16 v[228:231],v[64:67],v[132:135],v[228:231]
v_mfma_f32_16x16x32_bf16 v[232:235],v[64:67],v[136:139],v[232:235]
ds_read_b64_tr_b16 v[54:55],v9 offset:1024
v_mfma_f32_16x16x32_bf16 v[236:239],v[64:67],v[140:143],v[236:239]
s_waitcnt lgkmcnt(6)
v_mfma_f32_16x16x32_bf16 a[220:223],v[68:71],v[140:143],a[220:223]
ds_read_b64_tr_b16 v[56:57],v8 offset:2048
v_mfma_f32_16x16x32_bf16 a[216:219],v[68:71],v[136:139],a[216:219]
buffer_load_dwordx4 v6,s[16:19],s84 offen offset:0 lds
v_mfma_f32_16x16x32_bf16 a[212:215],v[68:71],v[132:135],a[212:215]
ds_read_b64_tr_b16 v[58:59],v8 offset:3072
s_add_u32 m0,s89,1984
v_mfma_f32_16x16x32_bf16 a[208:211],v[68:71],v[128:131],a[208:211]
v_mfma_f32_16x16x32_bf16 v[240:243],v[72:75],v[128:131],v[240:243]
ds_read_b64_tr_b16 v[60:61],v9 offset:2048
v_mfma_f32_16x16x32_bf16 v[244:247],v[72:75],v[132:135],v[244:247]
v_mfma_f32_16x16x32_bf16 v[248:251],v[72:75],v[136:139],v[248:251]
ds_read_b64_tr_b16 v[62:63],v9 offset:3072
v_mfma_f32_16x16x32_bf16 v[252:255],v[72:75],v[140:143],v[252:255]
s_waitcnt lgkmcnt(6)
v_mfma_f32_16x16x32_bf16 a[236:239],v[76:79],v[140:143],a[236:239]
ds_read_b64_tr_b16 v[64:65],v8 offset:4096
v_mfma_f32_16x16x32_bf16 a[232:235],v[76:79],v[136:139],a[232:235]
s_add_u32 s87,s87,24576
s_cmp_eq_u32 s87,147456
s_cselect_b32 s87,0,s87
s_cselect_b32 s54,s93,s94
v_mfma_f32_16x16x32_bf16 a[228:231],v[76:79],v[132:135],a[228:231]
ds_read_b64_tr_b16 v[66:67],v8 offset:5120
v_mfma_f32_16x16x32_bf16 a[224:227],v[76:79],v[128:131],a[224:227]
buffer_load_dwordx4 v6,s[16:19],s84 offen offset:64 lds
v_mfma_f32_16x16x32_bf16 a[0:3],v[48:51],v[128:131],a[0:3]
ds_read_b64_tr_b16 v[68:69],v9 offset:4096
s_add_u32 m0,s89,3968
v_mfma_f32_16x16x32_bf16 a[4:7],v[48:51],v[132:135],a[4:7]
v_mfma_f32_16x16x32_bf16 a[8:11],v[48:51],v[136:139],a[8:11]
ds_read_b64_tr_b16 v[70:71],v9 offset:5120
v_mfma_f32_16x16x32_bf16 a[12:15],v[48:51],v[140:143],a[12:15]
buffer_load_dwordx4 v6,s[16:19],s84 offen offset:128 lds
s_waitcnt lgkmcnt(6)
v_mfma_f32_16x16x32_bf16 a[28:31],v[52:55],v[140:143],a[28:31]
ds_read_b64_tr_b16 v[72:73],v8 offset:6144
s_add_u32 m0,s86,s82
v_mfma_f32_16x16x32_bf16 a[24:27],v[52:55],v[136:139],a[24:27]
v_add_u32 v10,s54,v10
v_mfma_f32_16x16x32_bf16 a[20:23],v[52:55],v[132:135],a[20:23]
ds_read_b64_tr_b16 v[74:75],v8 offset:7168
v_mfma_f32_16x16x32_bf16 a[16:19],v[52:55],v[128:131],a[16:19]
v_mfma_f32_16x16x32_bf16 a[32:35],v[56:59],v[128:131],a[32:35]
ds_read_b64_tr_b16 v[76:77],v9 offset:6144
v_mfma_f32_16x16x32_bf16 a[36:39],v[56:59],v[132:135],a[36:39]
v_add_u32 v8,s54,v8
v_mfma_f32_16x16x32_bf16 a[40:43],v[56:59],v[136:139],a[40:43]
ds_read_b64_tr_b16 v[78:79],v9 offset:7168
v_mfma_f32_16x16x32_bf16 a[44:47],v[56:59],v[140:143],a[44:47]
s_waitcnt vmcnt(23)
s_barrier
s_waitcnt lgkmcnt(6)
v_mfma_f32_16x16x32_bf16 a[60:63],v[60:63],v[140:143],a[60:63]
ds_read_b64_tr_b16 v[48:49],v8 offset:8192
v_mfma_f32_16x16x32_bf16 a[56:59],v[60:63],v[136:139],a[56:59]
buffer_load_dwordx4 v7,s[16:19],s84 offen lds
v_add_u32 v9,s54,v9
v_mfma_f32_16x16x32_bf16 a[52:55],v[60:63],v[132:135],a[52:55]
ds_read_b64_tr_b16 v[50:51],v8 offset:9216
s_add_u32 s83,s83,0x40000
v_mfma_f32_16x16x32_bf16 a[48:51],v[60:63],v[128:131],a[48:51]
s_add_u32 s84,s84,0x38000
v_mfma_f32_16x16x32_bf16 a[64:67],v[64:67],v[128:131],a[64:67]
ds_read_b64_tr_b16 v[52:53],v8 offset:16384
v_mfma_f32_16x16x32_bf16 a[68:71],v[64:67],v[132:135],a[68:71]
buffer_load_dword v45,v44,s[96:99],s72 offen
v_mfma_f32_16x16x32_bf16 a[72:75],v[64:67],v[136:139],a[72:75]
ds_read_b64_tr_b16 v[54:55],v8 offset:17408
v_mfma_f32_16x16x32_bf16 a[76:79],v[64:67],v[140:143],a[76:79]
s_waitcnt lgkmcnt(6)
v_mfma_f32_16x16x32_bf16 a[92:95],v[68:71],v[140:143],a[92:95]
ds_read_b64_tr_b16 v[56:57],v9 offset:8192
v_mfma_f32_16x16x32_bf16 a[88:91],v[68:71],v[136:139],a[88:91]
s_add_u32 s72,s72,s73
s_cmp_eq_u32 s72,s74
s_cselect_b32 s72,s75,s72
v_mfma_f32_16x16x32_bf16 a[84:87],v[68:71],v[132:135],a[84:87]
ds_read_b64_tr_b16 v[58:59],v9 offset:9216
v_mfma_f32_16x16x32_bf16 a[80:83],v[68:71],v[128:131],a[80:83]
v_mfma_f32_16x16x32_bf16 a[96:99],v[72:75],v[128:131],a[96:99]
ds_read_b64_tr_b16 v[60:61],v9 offset:16384
v_mfma_f32_16x16x32_bf16 a[100:103],v[72:75],v[132:135],a[100:103]
s_add_u32 s86,s86,24576
s_cmp_eq_u32 s86,147456
s_cselect_b32 s86,0,s86
v_mfma_f32_16x16x32_bf16 a[104:107],v[72:75],v[136:139],a[104:107]
ds_read_b64_tr_b16 v[62:63],v9 offset:17408
v_mfma_f32_16x16x32_bf16 a[108:111],v[72:75],v[140:143],a[108:111]
s_waitcnt lgkmcnt(8)
v_mfma_f32_16x16x32_bf16 a[124:127],v[76:79],v[140:143],a[124:127]
ds_read_b64_tr_b16 v[64:65],v8 offset:10240
v_mfma_f32_16x16x32_bf16 a[120:123],v[76:79],v[136:139],a[120:123]
v_mfma_f32_16x16x32_bf16 a[116:119],v[76:79],v[132:135],a[116:119]
ds_read_b64_tr_b16 v[66:67],v8 offset:11264
s_sub_u32 s55,s55,1
s_cmp_lg_u32 s55,0
v_mfma_f32_16x16x32_bf16 a[112:115],v[76:79],v[128:131],a[112:115]
s_cbranch_scc1 L_kloop
L_glu:
s_waitcnt lgkmcnt(8)
v_mfma_f32_16x16x32_bf16 v[144:147],v[48:51],v[80:83],v[144:147]
ds_read_b64_tr_b16 v[68:69],v8 offset:18432
s_add_u32 s88,s86,s80
v_mfma_f32_16x16x32_bf16 v[148:151],v[48:51],v[84:87],v[148:151]
s_add_u32 s89,s86,s81
s_add_u32 m0,s88,0
v_mfma_f32_16x16x32_bf16 v[152:155],v[48:51],v[88:91],v[152:155]
ds_read_b64_tr_b16 v[70:71],v8 offset:19456
v_subrev_u32 v30,98304,v8
v_mfma_f32_16x16x32_bf16 v[156:159],v[48:51],v[92:95],v[156:159]
buffer_load_dwordx4 v5,s[12:15],s83 offen offset:0 lds
s_waitcnt lgkmcnt(6)
v_mfma_f32_16x16x32_bf16 a[140:143],v[52:55],v[92:95],a[140:143]
ds_read_b64_tr_b16 v[72:73],v9 offset:10240
s_add_u32 m0,s88,1984
v_mfma_f32_16x16x32_bf16 a[136:139],v[52:55],v[88:91],a[136:139]
v_subrev_u32 v31,98304,v9
v_subrev_u32 v47,98304,v10
v_mfma_f32_16x16x32_bf16 a[132:135],v[52:55],v[84:87],a[132:135]
ds_read_b64_tr_b16 v[74:75],v9 offset:11264
v_mfma_f32_16x16x32_bf16 a[128:131],v[52:55],v[80:83],a[128:131]
buffer_load_dwordx4 v5,s[12:15],s83 offen offset:64 lds
v_mfma_f32_16x16x32_bf16 v[160:163],v[56:59],v[80:83],v[160:163]
ds_read_b64_tr_b16 v[76:77],v9 offset:18432
s_add_u32 m0,s89,0
v_mfma_f32_16x16x32_bf16 v[164:167],v[56:59],v[84:87],v[164:167]
s_waitcnt vmcnt(3)
s_barrier
v_mfma_f32_16x16x32_bf16 v[168:171],v[56:59],v[88:91],v[168:171]
ds_read_b64_tr_b16 v[78:79],v9 offset:19456
v_mfma_f32_16x16x32_bf16 v[172:175],v[56:59],v[92:95],v[172:175]
s_waitcnt lgkmcnt(6)
v_mfma_f32_16x16x32_bf16 a[156:159],v[60:63],v[92:95],a[156:159]
ds_read_b64_tr_b16 v[48:49],v8 offset:32768
v_mfma_f32_16x16x32_bf16 a[152:155],v[60:63],v[88:91],a[152:155]
buffer_load_dwordx4 v6,s[16:19],s84 offen offset:0 lds
v_mfma_f32_16x16x32_bf16 a[148:151],v[60:63],v[84:87],a[148:151]
ds_read_b64_tr_b16 v[50:51],v8 offset:33792
s_add_u32 m0,s89,1984
v_mfma_f32_16x16x32_bf16 a[144:147],v[60:63],v[80:83],a[144:147]
v_mfma_f32_16x16x32_bf16 v[176:179],v[64:67],v[80:83],v[176:179]
ds_read_b64_tr_b16 v[52:53],v8 offset:40960
v_mfma_f32_16x16x32_bf16 v[180:183],v[64:67],v[84:87],v[180:183]
buffer_load_dwordx4 v6,s[16:19],s84 offen offset:64 lds
v_mfma_f32_16x16x32_bf16 v[184:187],v[64:67],v[88:91],v[184:187]
ds_read_b64_tr_b16 v[54:55],v8 offset:41984
s_add_u32 m0,s89,3968
v_mfma_f32_16x16x32_bf16 v[188:191],v[64:67],v[92:95],v[188:191]
s_waitcnt lgkmcnt(6)
v_mfma_f32_16x16x32_bf16 a[172:175],v[68:71],v[92:95],a[172:175]
ds_read_b64_tr_b16 v[56:57],v9 offset:32768
v_mfma_f32_16x16x32_bf16 a[168:171],v[68:71],v[88:91],a[168:171]
buffer_load_dwordx4 v6,s[16:19],s84 offen offset:128 lds
v_mfma_f32_16x16x32_bf16 a[164:167],v[68:71],v[84:87],a[164:167]
ds_read_b64_tr_b16 v[58:59],v9 offset:33792
s_add_u32 m0,s86,s82
v_mfma_f32_16x16x32_bf16 a[160:163],v[68:71],v[80:83],a[160:163]
v_mfma_f32_16x16x32_bf16 v[192:195],v[72:75],v[80:83],v[192:195]
ds_read_b64_tr_b16 v[60:61],v9 offset:40960
v_mfma_f32_16x16x32_bf16 v[196:199],v[72:75],v[84:87],v[196:199]
buffer_load_dwordx4 v7,s[16:19],s84 offen lds
v_mfma_f32_16x16x32_bf16 v[200:203],v[72:75],v[88:91],v[200:203]
ds_read_b64_tr_b16 v[62:63],v9 offset:41984
s_add_u32 s83,s83,0x40000
v_mfma_f32_16x16x32_bf16 v[204:207],v[72:75],v[92:95],v[204:207]
s_add_u32 s84,s84,0x38000
s_waitcnt lgkmcnt(6)
v_mfma_f32_16x16x32_bf16 a[188:191],v[76:79],v[92:95],a[188:191]
ds_read_b64_tr_b16 v[64:65],v30 offset:8192
v_mfma_f32_16x16x32_bf16 a[184:187],v[76:79],v[88:91],a[184:187]
v_mfma_f32_16x16x32_bf16 a[180:183],v[76:79],v[84:87],a[180:183]
ds_read_b64_tr_b16 v[66:67],v30 offset:9216
s_lshr_b32 s64,s45,1
v_mfma_f32_16x16x32_bf16 a[176:179],v[76:79],v[80:83],a[176:179]
s_mul_i32 s64,s64,7
v_mfma_f32_16x16x32_bf16 v[144:147],v[48:51],v[96:99],v[144:147]
ds_read_b64_tr_b16 v[68:69],v30 offset:16384
s_lshl_b32 s65,s59,2
v_mfma_f32_16x16x32_bf16 v[148:151],v[48:51],v[100:103],v[148:151]
buffer_load_dwordx4 v[128:131],v4,s[8:11],s85 offen offset:0 sc1
v_mfma_f32_16x16x32_bf16 v[152:155],v[48:51],v[104:107],v[152:155]
ds_read_b64_tr_b16 v[70:71],v30 offset:17408
s_add_u32 s65,s65,s64
v_mfma_f32_16x16x32_bf16 v[156:159],v[48:51],v[108:111],v[156:159]
s_lshr_b32 s56,s65,1
s_waitcnt lgkmcnt(6)
v_mfma_f32_16x16x32_bf16 a[140:143],v[52:55],v[108:111],a[140:143]
ds_read_b64_tr_b16 v[72:73],v31 offset:8192
s_lshl_b32 s56,s56,18
v_mfma_f32_16x16x32_bf16 a[136:139],v[52:55],v[104:107],a[136:139]
buffer_load_dwordx4 v[132:135],v4,s[8:11],s85 offen offset:1024 sc1
v_mfma_f32_16x16x32_bf16 a[132:135],v[52:55],v[100:103],a[132:135]
ds_read_b64_tr_b16 v[74:75],v31 offset:9216
s_and_b32 s57,s65,1
v_mfma_f32_16x16x32_bf16 a[128:131],v[52:55],v[96:99],a[128:131]
s_lshl_b32 s57,s57,11
s_add_u32 s60,s56,s57
v_mfma_f32_16x16x32_bf16 v[160:163],v[56:59],v[96:99],v[160:163]
ds_read_b64_tr_b16 v[76:77],v31 offset:16384
s_add_u32 s60,s60,0x400000
v_mfma_f32_16x16x32_bf16 v[164:167],v[56:59],v[100:103],v[164:167]
s_add_u32 s65,s65,1
s_lshr_b32 s56,s65,1
v_mfma_f32_16x16x32_bf16 v[168:171],v[56:59],v[104:107],v[168:171]
ds_read_b64_tr_b16 v[78:79],v31 offset:17408
s_lshl_b32 s56,s56,18
v_mfma_f32_16x16x32_bf16 v[172:175],v[56:59],v[108:111],v[172:175]
buffer_load_dwordx4 v[136:139],v4,s[8:11],s85 offen offset:2048 sc1
s_waitcnt lgkmcnt(6)
v_mfma_f32_16x16x32_bf16 a[156:159],v[60:63],v[108:111],a[156:159]
ds_read_b64_tr_b16 v[48:49],v8 offset:34816
s_and_b32 s57,s65,1
v_mfma_f32_16x16x32_bf16 a[152:155],v[60:63],v[104:107],a[152:155]
s_lshl_b32 s57,s57,11
s_add_u32 s61,s56,s57
v_mfma_f32_16x16x32_bf16 a[148:151],v[60:63],v[100:103],a[148:151]
ds_read_b64_tr_b16 v[50:51],v8 offset:35840
s_add_u32 s61,s61,0x400000
v_mfma_f32_16x16x32_bf16 a[144:147],v[60:63],v[96:99],a[144:147]
s_add_u32 s65,s65,1
v_mfma_f32_16x16x32_bf16 v[144:147],v[64:67],v[112:115],v[144:147]
ds_read_b64_tr_b16 v[52:53],v8 offset:43008
s_lshr_b32 s56,s65,1
v_mfma_f32_16x16x32_bf16 v[148:151],v[64:67],v[116:119],v[148:151]
buffer_load_dwordx4 v[140:143],v4,s[8:11],s85 offen offset:3072 sc1
v_mfma_f32_16x16x32_bf16 v[152:155],v[64:67],v[120:123],v[152:155]
ds_read_b64_tr_b16 v[54:55],v8 offset:44032
s_add_u32 s85,s85,0x20000
v_mfma_f32_16x16x32_bf16 v[156:159],v[64:67],v[124:127],v[156:159]
s_lshl_b32 s56,s56,18
s_waitcnt lgkmcnt(6)
v_mfma_f32_16x16x32_bf16 a[140:143],v[68:71],v[124:127],a[140:143]
ds_read_b64_tr_b16 v[56:57],v9 offset:34816
s_and_b32 s57,s65,1
v_mfma_f32_16x16x32_bf16 a[136:139],v[68:71],v[120:123],a[136:139]
s_lshl_b32 s57,s57,11
s_add_u32 s62,s56,s57
v_mfma_f32_16x16x32_bf16 a[132:135],v[68:71],v[116:119],a[132:135]
ds_read_b64_tr_b16 v[58:59],v9 offset:35840
s_add_u32 s62,s62,0x400000
v_mfma_f32_16x16x32_bf16 a[128:131],v[68:71],v[112:115],a[128:131]
s_add_u32 s65,s65,1
s_add_u32 s64,s64,3
v_mfma_f32_16x16x32_bf16 v[160:163],v[72:75],v[112:115],v[160:163]
ds_read_b64_tr_b16 v[60:61],v9 offset:43008
s_lshr_b32 s56,s64,1
v_mfma_f32_16x16x32_bf16 v[164:167],v[72:75],v[116:119],v[164:167]
s_waitcnt vmcnt(4)
s_barrier
s_lshl_b32 s56,s56,18
v_mfma_f32_16x16x32_bf16 v[168:171],v[72:75],v[120:123],v[168:171]
ds_read_b64_tr_b16 v[62:63],v9 offset:44032
s_and_b32 s57,s64,1
v_mfma_f32_16x16x32_bf16 v[172:175],v[72:75],v[124:127],v[172:175]
s_lshl_b32 s57,s57,11
s_waitcnt lgkmcnt(6)
v_mfma_f32_16x16x32_bf16 a[156:159],v[76:79],v[124:127],a[156:159]
ds_read_b64_tr_b16 v[64:65],v30 offset:32768
s_add_u32 s63,s56,s57
v_mfma_f32_16x16x32_bf16 a[152:155],v[76:79],v[120:123],a[152:155]
s_add_u32 s63,s63,0x400000
s_lshl_b32 s56,s59,3
v_mfma_f32_16x16x32_bf16 a[148:151],v[76:79],v[116:119],a[148:151]
ds_read_b64_tr_b16 v[66:67],v30 offset:33792
s_add_u32 s63,s63,s56
v_mfma_f32_16x16x32_bf16 a[144:147],v[76:79],v[112:115],a[144:147]
s_mov_b32 s54,0xbfb8aa3b
s_mov_b32 s55,0xbfb8aa3b
v_mfma_f32_16x16x32_bf16 v[176:179],v[48:51],v[96:99],v[176:179]
ds_read_b64_tr_b16 v[68:69],v30 offset:40960
s_mov_b32 s56,1.0
v_mfma_f32_16x16x32_bf16 v[180:183],v[48:51],v[100:103],v[180:183]
s_mov_b32 s57,1.0
v_mfma_f32_16x16x32_bf16 v[184:187],v[48:51],v[104:107],v[184:187]
ds_read_b64_tr_b16 v[70:71],v30 offset:41984
v_mfma_f32_16x16x32_bf16 v[188:191],v[48:51],v[108:111],v[188:191]
s_waitcnt lgkmcnt(6)
v_mfma_f32_16x16x32_bf16 a[172:175],v[52:55],v[108:111],a[172:175]
ds_read_b64_tr_b16 v[72:73],v31 offset:32768
v_mfma_f32_16x16x32_bf16 a[168:171],v[52:55],v[104:107],a[168:171]
v_mfma_f32_16x16x32_bf16 a[164:167],v[52:55],v[100:103],a[164:167]
ds_read_b64_tr_b16 v[74:75],v31 offset:33792
v_mfma_f32_16x16x32_bf16 a[160:163],v[52:55],v[96:99],a[160:163]
v_mfma_f32_16x16x32_bf16 v[192:195],v[56:59],v[96:99],v[192:195]
ds_read_b64_tr_b16 v[76:77],v31 offset:40960
v_mfma_f32_16x16x32_bf16 v[196:199],v[56:59],v[100:103],v[196:199]
v_mfma_f32_16x16x32_bf16 v[200:203],v[56:59],v[104:107],v[200:203]
ds_read_b64_tr_b16 v[78:79],v31 offset:41984
v_mfma_f32_16x16x32_bf16 v[204:207],v[56:59],v[108:111],v[204:207]
s_waitcnt lgkmcnt(6)
v_mfma_f32_16x16x32_bf16 a[188:191],v[60:63],v[108:111],a[188:191]
ds_read_b64_tr_b16 v[48:49],v30 offset:10240
v_mfma_f32_16x16x32_bf16 a[184:187],v[60:63],v[104:107],a[184:187]
v_mfma_f32_16x16x32_bf16 a[180:183],v[60:63],v[100:103],a[180:183]
ds_read_b64_tr_b16 v[50:51],v30 offset:11264
v_mfma_f32_16x16x32_bf16 a[176:179],v[60:63],v[96:99],a[176:179]
s_waitcnt vmcnt(0)
v_mfma_f32_16x16x32_bf16 v[144:147],v[64:67],v[128:131],v[144:147]
ds_read_b64_tr_b16 v[52:53],v30 offset:18432
v_mfma_f32_16x16x32_bf16 v[148:151],v[64:67],v[132:135],v[148:151]
v_mfma_f32_16x16x32_bf16 v[152:155],v[64:67],v[136:139],v[152:155]
ds_read_b64_tr_b16 v[54:55],v30 offset:19456
v_mfma_f32_16x16x32_bf16 v[156:159],v[64:67],v[140:143],v[156:159]
s_waitcnt lgkmcnt(6)
v_mfma_f32_16x16x32_bf16 a[140:143],v[68:71],v[140:143],a[140:143]
ds_read_b64_tr_b16 v[56:57],v31 offset:10240
v_mfma_f32_16x16x32_bf16 a[136:139],v[68:71],v[136:139],a[136:139]
v_mfma_f32_16x16x32_bf16 a[132:135],v[68:71],v[132:135],a[132:135]
ds_read_b64_tr_b16 v[58:59],v31 offset:11264
v_mfma_f32_16x16x32_bf16 a[128:131],v[68:71],v[128:131],a[128:131]
v_mfma_f32_16x16x32_bf16 v[160:163],v[72:75],v[128:131],v[160:163]
ds_read_b64_tr_b16 v[60:61],v31 offset:18432
v_mfma_f32_16x16x32_bf16 v[164:167],v[72:75],v[132:135],v[164:167]
v_mfma_f32_16x16x32_bf16 v[168:171],v[72:75],v[136:139],v[168:171]
ds_read_b64_tr_b16 v[62:63],v31 offset:19456
v_mfma_f32_16x16x32_bf16 v[172:175],v[72:75],v[140:143],v[172:175]
s_waitcnt lgkmcnt(6)
v_mfma_f32_16x16x32_bf16 a[156:159],v[76:79],v[140:143],a[156:159]
ds_read_b64_tr_b16 v[64:65],v30 offset:34816
v_mfma_f32_16x16x32_bf16 a[152:155],v[76:79],v[136:139],a[152:155]
v_mfma_f32_16x16x32_bf16 a[148:151],v[76:79],v[132:135],a[148:151]
ds_read_b64_tr_b16 v[66:67],v30 offset:35840
v_mfma_f32_16x16x32_bf16 a[144:147],v[76:79],v[128:131],a[144:147]
v_mfma_f32_16x16x32_bf16 v[176:179],v[48:51],v[112:115],v[176:179]
ds_read_b64_tr_b16 v[68:69],v30 offset:43008
v_mfma_f32_16x16x32_bf16 v[180:183],v[48:51],v[116:119],v[180:183]
v_mfma_f32_16x16x32_bf16 v[184:187],v[48:51],v[120:123],v[184:187]
ds_read_b64_tr_b16 v[70:71],v30 offset:44032
v_mfma_f32_16x16x32_bf16 v[188:191],v[48:51],v[124:127],v[188:191]
v_mul_f32 v144,s54,v144
s_waitcnt lgkmcnt(6)
v_mfma_f32_16x16x32_bf16 a[172:175],v[52:55],v[124:127],a[172:175]
ds_read_b64_tr_b16 v[72:73],v31 offset:34816
v_mul_f32 v145,s54,v145
v_mfma_f32_16x16x32_bf16 a[168:171],v[52:55],v[120:123],a[168:171]
v_exp_f32 v144,v144
v_mfma_f32_16x16x32_bf16 a[164:167],v[52:55],v[116:119],a[164:167]
ds_read_b64_tr_b16 v[74:75],v31 offset:35840
v_mul_f32 v146,s54,v146
v_mfma_f32_16x16x32_bf16 a[160:163],v[52:55],v[112:115],a[160:163]
v_exp_f32 v145,v145
v_mfma_f32_16x16x32_bf16 v[192:195],v[56:59],v[112:115],v[192:195]
ds_read_b64_tr_b16 v[76:77],v31 offset:43008
v_mul_f32 v147,s54,v147
v_mfma_f32_16x16x32_bf16 v[196:199],v[56:59],v[116:119],v[196:199]
v_exp_f32 v146,v146
v_mfma_f32_16x16x32_bf16 v[200:203],v[56:59],v[120:123],v[200:203]
ds_read_b64_tr_b16 v[78:79],v31 offset:44032
v_add_f32 v144,1.0,v144
v_mfma_f32_16x16x32_bf16 v[204:207],v[56:59],v[124:127],v[204:207]
v_add_f32 v145,1.0,v145
s_waitcnt lgkmcnt(6)
v_mfma_f32_16x16x32_bf16 a[188:191],v[60:63],v[124:127],a[188:191]
ds_read_b64_tr_b16 v[48:49],v8 offset:12288
v_add_f32 v146,1.0,v146
v_mfma_f32_16x16x32_bf16 a[184:187],v[60:63],v[120:123],a[184:187]
v_exp_f32 v147,v147
v_mfma_f32_16x16x32_bf16 a[180:183],v[60:63],v[116:119],a[180:183]
ds_read_b64_tr_b16 v[50:51],v8 offset:13312
v_add_f32 v147,1.0,v147
v_mfma_f32_16x16x32_bf16 a[176:179],v[60:63],v[112:115],a[176:179]
v_rcp_f32 v144,v144
v_mfma_f32_16x16x32_bf16 v[176:179],v[64:67],v[128:131],v[176:179]
ds_read_b64_tr_b16 v[52:53],v8 offset:20480
v_accvgpr_read_b32 v24,a128
v_mfma_f32_16x16x32_bf16 v[180:183],v[64:67],v[132:135],v[180:183]
v_rcp_f32 v145,v145
v_mfma_f32_16x16x32_bf16 v[184:187],v[64:67],v[136:139],v[184:187]
ds_read_b64_tr_b16 v[54:55],v8 offset:21504
v_mul_f32 v144,v144,v24
v_mfma_f32_16x16x32_bf16 v[188:191],v[64:67],v[140:143],v[188:191]
v_accvgpr_read_b32 v25,a129
s_waitcnt lgkmcnt(6)
v_mfma_f32_16x16x32_bf16 a[172:175],v[68:71],v[140:143],a[172:175]
ds_read_b64_tr_b16 v[56:57],v9 offset:12288
v_mul_f32 v145,v145,v25
v_mfma_f32_16x16x32_bf16 a[168:171],v[68:71],v[136:139],a[168:171]
v_rcp_f32 v146,v146
v_mfma_f32_16x16x32_bf16 a[164:167],v[68:71],v[132:135],a[164:167]
ds_read_b64_tr_b16 v[58:59],v9 offset:13312
v_accvgpr_read_b32 v26,a130
v_mfma_f32_16x16x32_bf16 a[160:163],v[68:71],v[128:131],a[160:163]
v_rcp_f32 v147,v147
v_mfma_f32_16x16x32_bf16 v[192:195],v[72:75],v[128:131],v[192:195]
ds_read_b64_tr_b16 v[60:61],v9 offset:20480
v_mul_f32 v146,v146,v26
v_mfma_f32_16x16x32_bf16 v[196:199],v[72:75],v[132:135],v[196:199]
v_accvgpr_read_b32 v27,a131
v_mul_f32 v160,s54,v160
v_mfma_f32_16x16x32_bf16 v[200:203],v[72:75],v[136:139],v[200:203]
ds_read_b64_tr_b16 v[62:63],v9 offset:21504
v_mul_f32 v147,v147,v27
v_mfma_f32_16x16x32_bf16 v[204:207],v[72:75],v[140:143],v[204:207]
v_mul_f32 v161,s54,v161
s_waitcnt lgkmcnt(6)
v_mfma_f32_16x16x32_bf16 a[188:191],v[76:79],v[140:143],a[188:191]
ds_read_b64_tr_b16 v[64:65],v8 offset:36864
v_mul_f32 v162,s54,v162
v_mfma_f32_16x16x32_bf16 a[184:187],v[76:79],v[136:139],a[184:187]
v_exp_f32 v160,v160
v_mfma_f32_16x16x32_bf16 a[180:183],v[76:79],v[132:135],a[180:183]
ds_read_b64_tr_b16 v[66:67],v8 offset:37888
v_mul_f32 v163,s54,v163
v_mfma_f32_16x16x32_bf16 a[176:179],v[76:79],v[128:131],a[176:179]
v_exp_f32 v161,v161
v_mfma_f32_16x16x32_bf16 v[208:211],v[48:51],v[80:83],v[208:211]
ds_read_b64_tr_b16 v[68:69],v8 offset:45056
v_add_f32 v160,1.0,v160
v_mfma_f32_16x16x32_bf16 v[212:215],v[48:51],v[84:87],v[212:215]
v_exp_f32 v162,v162
v_mfma_f32_16x16x32_bf16 v[216:219],v[48:51],v[88:91],v[216:219]
ds_read_b64_tr_b16 v[70:71],v8 offset:46080
v_add_f32 v161,1.0,v161
v_mfma_f32_16x16x32_bf16 v[220:223],v[48:51],v[92:95],v[220:223]
v_add_f32 v162,1.0,v162
s_waitcnt lgkmcnt(6)
v_mfma_f32_16x16x32_bf16 a[204:207],v[52:55],v[92:95],a[204:207]
ds_read_b64_tr_b16 v[72:73],v9 offset:36864
v_accvgpr_read_b32 v24,a144
v_mfma_f32_16x16x32_bf16 a[200:203],v[52:55],v[88:91],a[200:203]
v_exp_f32 v163,v163
v_mfma_f32_16x16x32_bf16 a[196:199],v[52:55],v[84:87],a[196:199]
ds_read_b64_tr_b16 v[74:75],v9 offset:37888
v_add_f32 v163,1.0,v163
v_mfma_f32_16x16x32_bf16 a[192:195],v[52:55],v[80:83],a[192:195]
v_rcp_f32 v160,v160
v_mfma_f32_16x16x32_bf16 v[224:227],v[56:59],v[80:83],v[224:227]
ds_read_b64_tr_b16 v[76:77],v9 offset:45056
v_mul_f32 v160,v160,v24
v_mfma_f32_16x16x32_bf16 v[228:231],v[56:59],v[84:87],v[228:231]
v_rcp_f32 v161,v161
v_mfma_f32_16x16x32_bf16 v[232:235],v[56:59],v[88:91],v[232:235]
ds_read_b64_tr_b16 v[78:79],v9 offset:46080
v_accvgpr_read_b32 v25,a145
v_mfma_f32_16x16x32_bf16 v[236:239],v[56:59],v[92:95],v[236:239]
v_mul_f32 v161,v161,v25
s_waitcnt lgkmcnt(6)
v_mfma_f32_16x16x32_bf16 a[220:223],v[60:63],v[92:95],a[220:223]
ds_read_b64_tr_b16 v[48:49],v30 offset:12288
v_accvgpr_read_b32 v26,a146
v_mfma_f32_16x16x32_bf16 a[216:219],v[60:63],v[88:91],a[216:219]
v_rcp_f32 v162,v162
v_mfma_f32_16x16x32_bf16 a[212:215],v[60:63],v[84:87],a[212:215]
ds_read_b64_tr_b16 v[50:51],v30 offset:13312
v_mul_f32 v162,v162,v26
v_mfma_f32_16x16x32_bf16 a[208:211],v[60:63],v[80:83],a[208:211]
v_rcp_f32 v163,v163
v_mfma_f32_16x16x32_bf16 v[208:211],v[64:67],v[96:99],v[208:211]
ds_read_b64_tr_b16 v[52:53],v30 offset:20480
v_accvgpr_read_b32 v27,a147
v_mfma_f32_16x16x32_bf16 v[212:215],v[64:67],v[100:103],v[212:215]
v_mul_f32 v163,v163,v27
v_cvt_pk_bf16_f32 v144,v144,v145
v_mfma_f32_16x16x32_bf16 v[216:219],v[64:67],v[104:107],v[216:219]
ds_read_b64_tr_b16 v[54:55],v30 offset:21504
v_cvt_pk_bf16_f32 v145,v146,v147
v_mfma_f32_16x16x32_bf16 v[220:223],v[64:67],v[108:111],v[220:223]
v_cvt_pk_bf16_f32 v146,v160,v161
s_waitcnt lgkmcnt(6)
v_mfma_f32_16x16x32_bf16 a[204:207],v[68:71],v[108:111],a[204:207]
ds_read_b64_tr_b16 v[56:57],v31 offset:12288
v_cvt_pk_bf16_f32 v147,v162,v163
v_mfma_f32_16x16x32_bf16 a[200:203],v[68:71],v[104:107],a[200:203]
buffer_store_dwordx4 v[144:147],v20,s[8:11],s60 offen offset:0 sc1
v_mfma_f32_16x16x32_bf16 a[196:199],v[68:71],v[100:103],a[196:199]
ds_read_b64_tr_b16 v[58:59],v31 offset:13312
v_mul_f32 v148,s54,v148
v_mfma_f32_16x16x32_bf16 a[192:195],v[68:71],v[96:99],a[192:195]
v_exp_f32 v148,v148
v_mfma_f32_16x16x32_bf16 v[224:227],v[72:75],v[96:99],v[224:227]
ds_read_b64_tr_b16 v[60:61],v31 offset:20480
v_mul_f32 v149,s54,v149
v_mfma_f32_16x16x32_bf16 v[228:231],v[72:75],v[100:103],v[228:231]
v_exp_f32 v149,v149
v_mfma_f32_16x16x32_bf16 v[232:235],v[72:75],v[104:107],v[232:235]
ds_read_b64_tr_b16 v[62:63],v31 offset:21504
v_mul_f32 v150,s54,v150
v_mfma_f32_16x16x32_bf16 v[236:239],v[72:75],v[108:111],v[236:239]
v_mul_f32 v151,s54,v151
s_waitcnt lgkmcnt(6)
v_mfma_f32_16x16x32_bf16 a[220:223],v[76:79],v[108:111],a[220:223]
ds_read_b64_tr_b16 v[64:65],v30 offset:36864
v_add_f32 v148,1.0,v148
v_mfma_f32_16x16x32_bf16 a[216:219],v[76:79],v[104:107],a[216:219]
v_exp_f32 v150,v150
v_mfma_f32_16x16x32_bf16 a[212:215],v[76:79],v[100:103],a[212:215]
ds_read_b64_tr_b16 v[66:67],v30 offset:37888
v_add_f32 v149,1.0,v149
v_mfma_f32_16x16x32_bf16 a[208:211],v[76:79],v[96:99],a[208:211]
v_exp_f32 v151,v151
v_mfma_f32_16x16x32_bf16 v[208:211],v[48:51],v[112:115],v[208:211]
ds_read_b64_tr_b16 v[68:69],v30 offset:45056
v_add_f32 v150,1.0,v150
v_mfma_f32_16x16x32_bf16 v[212:215],v[48:51],v[116:119],v[212:215]
v_rcp_f32 v148,v148
v_mfma_f32_16x16x32_bf16 v[216:219],v[48:51],v[120:123],v[216:219]
ds_read_b64_tr_b16 v[70:71],v30 offset:46080
v_add_f32 v151,1.0,v151
v_mfma_f32_16x16x32_bf16 v[220:223],v[48:51],v[124:127],v[220:223]
v_accvgpr_read_b32 v24,a132
s_waitcnt lgkmcnt(6)
v_mfma_f32_16x16x32_bf16 a[204:207],v[52:55],v[124:127],a[204:207]
ds_read_b64_tr_b16 v[72:73],v31 offset:36864
v_mul_f32 v148,v148,v24
v_mfma_f32_16x16x32_bf16 a[200:203],v[52:55],v[120:123],a[200:203]
v_rcp_f32 v149,v149
v_mfma_f32_16x16x32_bf16 a[196:199],v[52:55],v[116:119],a[196:199]
ds_read_b64_tr_b16 v[74:75],v31 offset:37888
v_accvgpr_read_b32 v25,a133
v_mfma_f32_16x16x32_bf16 a[192:195],v[52:55],v[112:115],a[192:195]
v_rcp_f32 v150,v150
v_mfma_f32_16x16x32_bf16 v[224:227],v[56:59],v[112:115],v[224:227]
ds_read_b64_tr_b16 v[76:77],v31 offset:45056
v_mul_f32 v149,v149,v25
v_mfma_f32_16x16x32_bf16 v[228:231],v[56:59],v[116:119],v[228:231]
v_rcp_f32 v151,v151
v_mfma_f32_16x16x32_bf16 v[232:235],v[56:59],v[120:123],v[232:235]
ds_read_b64_tr_b16 v[78:79],v31 offset:46080
v_accvgpr_read_b32 v26,a134
v_mfma_f32_16x16x32_bf16 v[236:239],v[56:59],v[124:127],v[236:239]
v_mul_f32 v150,v150,v26
s_waitcnt lgkmcnt(6)
v_mfma_f32_16x16x32_bf16 a[220:223],v[60:63],v[124:127],a[220:223]
ds_read_b64_tr_b16 v[48:49],v10 offset:14336
v_accvgpr_read_b32 v27,a135
v_mfma_f32_16x16x32_bf16 a[216:219],v[60:63],v[120:123],a[216:219]
v_mul_f32 v151,v151,v27
v_mul_f32 v164,s54,v164
v_mfma_f32_16x16x32_bf16 a[212:215],v[60:63],v[116:119],a[212:215]
ds_read_b64_tr_b16 v[50:51],v10 offset:15360
v_mul_f32 v165,s54,v165
v_mfma_f32_16x16x32_bf16 a[208:211],v[60:63],v[112:115],a[208:211]
v_exp_f32 v164,v164
v_mfma_f32_16x16x32_bf16 v[208:211],v[64:67],v[128:131],v[208:211]
ds_read_b64_tr_b16 v[52:53],v10 offset:22528
v_mul_f32 v166,s54,v166
v_mfma_f32_16x16x32_bf16 v[212:215],v[64:67],v[132:135],v[212:215]
v_exp_f32 v165,v165
v_mfma_f32_16x16x32_bf16 v[216:219],v[64:67],v[136:139],v[216:219]
ds_read_b64_tr_b16 v[54:55],v10 offset:23552
v_mul_f32 v167,s54,v167
v_mfma_f32_16x16x32_bf16 v[220:223],v[64:67],v[140:143],v[220:223]
v_add_f32 v164,1.0,v164
s_waitcnt lgkmcnt(6)
v_mfma_f32_16x16x32_bf16 a[204:207],v[68:71],v[140:143],a[204:207]
ds_read_b64_tr_b16 v[56:57],v10 offset:38912
v_add_f32 v165,1.0,v165
v_mfma_f32_16x16x32_bf16 a[200:203],v[68:71],v[136:139],a[200:203]
v_exp_f32 v166,v166
v_mfma_f32_16x16x32_bf16 a[196:199],v[68:71],v[132:135],a[196:199]
ds_read_b64_tr_b16 v[58:59],v10 offset:39936
v_add_f32 v166,1.0,v166
v_mfma_f32_16x16x32_bf16 a[192:195],v[68:71],v[128:131],a[192:195]
v_exp_f32 v167,v167
v_mfma_f32_16x16x32_bf16 v[224:227],v[72:75],v[128:131],v[224:227]
ds_read_b64_tr_b16 v[60:61],v10 offset:47104
v_add_f32 v167,1.0,v167
v_mfma_f32_16x16x32_bf16 v[228:231],v[72:75],v[132:135],v[228:231]
v_rcp_f32 v164,v164
v_mfma_f32_16x16x32_bf16 v[232:235],v[72:75],v[136:139],v[232:235]
ds_read_b64_tr_b16 v[62:63],v10 offset:48128
v_accvgpr_read_b32 v24,a148
v_mfma_f32_16x16x32_bf16 v[236:239],v[72:75],v[140:143],v[236:239]
v_mul_f32 v164,v164,v24
s_waitcnt lgkmcnt(6)
v_mfma_f32_16x16x32_bf16 a[220:223],v[76:79],v[140:143],a[220:223]
ds_read_b64_tr_b16 v[64:65],v47 offset:14336
v_accvgpr_read_b32 v25,a149
v_mfma_f32_16x16x32_bf16 a[216:219],v[76:79],v[136:139],a[216:219]
v_rcp_f32 v165,v165
v_mfma_f32_16x16x32_bf16 a[212:215],v[76:79],v[132:135],a[212:215]
ds_read_b64_tr_b16 v[66:67],v47 offset:15360
v_mul_f32 v165,v165,v25
v_mfma_f32_16x16x32_bf16 a[208:211],v[76:79],v[128:131],a[208:211]
v_rcp_f32 v166,v166
v_mfma_f32_16x16x32_bf16 v[240:243],v[48:51],v[80:83],v[240:243]
ds_read_b64_tr_b16 v[68:69],v47 offset:22528
v_accvgpr_read_b32 v26,a150
v_mfma_f32_16x16x32_bf16 v[244:247],v[48:51],v[84:87],v[244:247]
v_rcp_f32 v167,v167
v_mfma_f32_16x16x32_bf16 v[248:251],v[48:51],v[88:91],v[248:251]
ds_read_b64_tr_b16 v[70:71],v47 offset:23552
v_mul_f32 v166,v166,v26
v_mfma_f32_16x16x32_bf16 v[252:255],v[48:51],v[92:95],v[252:255]
v_accvgpr_read_b32 v27,a151
s_waitcnt lgkmcnt(6)
v_mfma_f32_16x16x32_bf16 a[236:239],v[52:55],v[92:95],a[236:239]
ds_read_b64_tr_b16 v[72:73],v47 offset:38912
v_mul_f32 v167,v167,v27
v_mfma_f32_16x16x32_bf16 a[232:235],v[52:55],v[88:91],a[232:235]
v_cvt_pk_bf16_f32 v148,v148,v149
v_mul_f32 v152,s54,v152
v_mfma_f32_16x16x32_bf16 a[228:231],v[52:55],v[84:87],a[228:231]
ds_read_b64_tr_b16 v[74:75],v47 offset:39936
v_cvt_pk_bf16_f32 v149,v150,v151
v_mfma_f32_16x16x32_bf16 a[224:227],v[52:55],v[80:83],a[224:227]
v_exp_f32 v152,v152
v_mfma_f32_16x16x32_bf16 v[240:243],v[56:59],v[96:99],v[240:243]
ds_read_b64_tr_b16 v[76:77],v47 offset:47104
v_cvt_pk_bf16_f32 v150,v164,v165
v_mfma_f32_16x16x32_bf16 v[244:247],v[56:59],v[100:103],v[244:247]
v_cvt_pk_bf16_f32 v151,v166,v167
v_mul_f32 v153,s54,v153
v_mfma_f32_16x16x32_bf16 v[248:251],v[56:59],v[104:107],v[248:251]
ds_read_b64_tr_b16 v[78:79],v47 offset:48128
v_mul_f32 v154,s54,v154
v_mfma_f32_16x16x32_bf16 v[252:255],v[56:59],v[108:111],v[252:255]
v_mul_f32 v155,s54,v155
s_waitcnt lgkmcnt(6)
v_mfma_f32_16x16x32_bf16 a[236:239],v[60:63],v[108:111],a[236:239]
ds_read_b64_tr_b16 v[48:49],v8 offset:0
v_add_f32 v152,1.0,v152
v_mfma_f32_16x16x32_bf16 a[232:235],v[60:63],v[104:107],a[232:235]
buffer_store_dwordx4 v[148:151],v20,s[8:11],s60 offen offset:1024 sc1
v_mfma_f32_16x16x32_bf16 a[228:231],v[60:63],v[100:103],a[228:231]
ds_read_b64_tr_b16 v[50:51],v8 offset:1024
v_accvgpr_read_b32 v24,a136
v_mfma_f32_16x16x32_bf16 a[224:227],v[60:63],v[96:99],a[224:227]
v_exp_f32 v153,v153
v_mfma_f32_16x16x32_bf16 v[240:243],v[64:67],v[112:115],v[240:243]
ds_read_b64_tr_b16 v[52:53],v8 offset:24576
v_add_f32 v153,1.0,v153
v_mfma_f32_16x16x32_bf16 v[244:247],v[64:67],v[116:119],v[244:247]
v_exp_f32 v154,v154
v_mfma_f32_16x16x32_bf16 v[248:251],v[64:67],v[120:123],v[248:251]
ds_read_b64_tr_b16 v[54:55],v8 offset:25600
v_add_f32 v154,1.0,v154
v_mfma_f32_16x16x32_bf16 v[252:255],v[64:67],v[124:127],v[252:255]
v_accvgpr_read_b32 v25,a137
s_waitcnt lgkmcnt(6)
v_mfma_f32_16x16x32_bf16 a[236:239],v[68:71],v[124:127],a[236:239]
ds_read_b64_tr_b16 v[56:57],v30 offset:0
v_accvgpr_read_b32 v26,a138
v_mfma_f32_16x16x32_bf16 a[232:235],v[68:71],v[120:123],a[232:235]
v_exp_f32 v155,v155
v_mfma_f32_16x16x32_bf16 a[228:231],v[68:71],v[116:119],a[228:231]
ds_read_b64_tr_b16 v[58:59],v30 offset:1024
v_add_f32 v155,1.0,v155
v_mfma_f32_16x16x32_bf16 a[224:227],v[68:71],v[112:115],a[224:227]
v_rcp_f32 v152,v152
v_mfma_f32_16x16x32_bf16 v[240:243],v[72:75],v[128:131],v[240:243]
ds_read_b64_tr_b16 v[60:61],v30 offset:24576
v_mul_f32 v152,v152,v24
v_mfma_f32_16x16x32_bf16 v[244:247],v[72:75],v[132:135],v[244:247]
v_rcp_f32 v153,v153
v_mfma_f32_16x16x32_bf16 v[248:251],v[72:75],v[136:139],v[248:251]
ds_read_b64_tr_b16 v[62:63],v30 offset:25600
v_mul_f32 v153,v153,v25
v_mfma_f32_16x16x32_bf16 v[252:255],v[72:75],v[140:143],v[252:255]
v_accvgpr_read_b32 v27,a139
s_waitcnt lgkmcnt(6)
v_mfma_f32_16x16x32_bf16 a[236:239],v[76:79],v[140:143],a[236:239]
ds_read_b64_tr_b16 v[64:65],v9 offset:0
v_mul_f32 v168,s54,v168
v_mfma_f32_16x16x32_bf16 a[232:235],v[76:79],v[136:139],a[232:235]
v_rcp_f32 v154,v154
v_mfma_f32_16x16x32_bf16 a[228:231],v[76:79],v[132:135],a[228:231]
ds_read_b64_tr_b16 v[66:67],v9 offset:1024
v_mul_f32 v154,v154,v26
v_mfma_f32_16x16x32_bf16 a[224:227],v[76:79],v[128:131],a[224:227]
v_rcp_f32 v155,v155
v_mfma_f32_16x16x32_bf16 a[0:3],v[48:51],v[80:83],a[0:3]
ds_read_b64_tr_b16 v[68:69],v9 offset:24576
v_mul_f32 v155,v155,v27
v_mfma_f32_16x16x32_bf16 a[4:7],v[48:51],v[84:87],a[4:7]
v_exp_f32 v168,v168
v_mfma_f32_16x16x32_bf16 a[8:11],v[48:51],v[88:91],a[8:11]
ds_read_b64_tr_b16 v[70:71],v9 offset:25600
v_mul_f32 v169,s54,v169
v_mfma_f32_16x16x32_bf16 a[12:15],v[48:51],v[92:95],a[12:15]
v_mul_f32 v170,s54,v170
s_waitcnt lgkmcnt(6)
v_mfma_f32_16x16x32_bf16 a[12:15],v[52:55],v[108:111],a[12:15]
ds_read_b64_tr_b16 v[72:73],v31 offset:0
v_mul_f32 v171,s54,v171
v_mfma_f32_16x16x32_bf16 a[8:11],v[52:55],v[104:107],a[8:11]
v_exp_f32 v169,v169
v_mfma_f32_16x16x32_bf16 a[4:7],v[52:55],v[100:103],a[4:7]
ds_read_b64_tr_b16 v[74:75],v31 offset:1024
v_add_f32 v168,1.0,v168
v_mfma_f32_16x16x32_bf16 a[0:3],v[52:55],v[96:99],a[0:3]
v_exp_f32 v170,v170
v_mfma_f32_16x16x32_bf16 a[0:3],v[56:59],v[112:115],a[0:3]
ds_read_b64_tr_b16 v[76:77],v31 offset:24576
v_add_f32 v169,1.0,v169
v_mfma_f32_16x16x32_bf16 a[4:7],v[56:59],v[116:119],a[4:7]
v_exp_f32 v171,v171
v_mfma_f32_16x16x32_bf16 a[8:11],v[56:59],v[120:123],a[8:11]
ds_read_b64_tr_b16 v[78:79],v31 offset:25600
v_add_f32 v170,1.0,v170
v_mfma_f32_16x16x32_bf16 a[12:15],v[56:59],v[124:127],a[12:15]
v_add_f32 v171,1.0,v171
s_waitcnt lgkmcnt(6)
v_mfma_f32_16x16x32_bf16 a[12:15],v[60:63],v[140:143],a[12:15]
ds_read_b64_tr_b16 v[48:49],v8 offset:2048
v_accvgpr_read_b32 v24,a152
v_mfma_f32_16x16x32_bf16 a[8:11],v[60:63],v[136:139],a[8:11]
v_rcp_f32 v168,v168
v_mfma_f32_16x16x32_bf16 a[4:7],v[60:63],v[132:135],a[4:7]
ds_read_b64_tr_b16 v[50:51],v8 offset:3072
v_mul_f32 v168,v168,v24
v_mfma_f32_16x16x32_bf16 a[0:3],v[60:63],v[128:131],a[0:3]
v_rcp_f32 v169,v169
v_mfma_f32_16x16x32_bf16 a[16:19],v[64:67],v[80:83],a[16:19]
ds_read_b64_tr_b16 v[52:53],v8 offset:26624
v_accvgpr_read_b32 v25,a153
v_mfma_f32_16x16x32_bf16 a[20:23],v[64:67],v[84:87],a[20:23]
v_rcp_f32 v170,v170
v_mfma_f32_16x16x32_bf16 a[24:27],v[64:67],v[88:91],a[24:27]
ds_read_b64_tr_b16 v[54:55],v8 offset:27648
v_mul_f32 v169,v169,v25
v_mfma_f32_16x16x32_bf16 a[28:31],v[64:67],v[92:95],a[28:31]
v_accvgpr_read_b32 v26,a154
s_waitcnt lgkmcnt(6)
v_mfma_f32_16x16x32_bf16 a[28:31],v[68:71],v[108:111],a[28:31]
ds_read_b64_tr_b16 v[56:57],v30 offset:2048
v_mul_f32 v170,v170,v26
v_mfma_f32_16x16x32_bf16 a[24:27],v[68:71],v[104:107],a[24:27]
v_rcp_f32 v171,v171
v_mfma_f32_16x16x32_bf16 a[20:23],v[68:71],v[100:103],a[20:23]
ds_read_b64_tr_b16 v[58:59],v30 offset:3072
v_accvgpr_read_b32 v27,a155
v_mfma_f32_16x16x32_bf16 a[16:19],v[68:71],v[96:99],a[16:19]
v_mul_f32 v171,v171,v27
v_cvt_pk_bf16_f32 v152,v152,v153
v_mfma_f32_16x16x32_bf16 a[16:19],v[72:75],v[112:115],a[16:19]
ds_read_b64_tr_b16 v[60:61],v30 offset:26624
v_cvt_pk_bf16_f32 v153,v154,v155
v_mfma_f32_16x16x32_bf16 a[20:23],v[72:75],v[116:119],a[20:23]
v_cvt_pk_bf16_f32 v154,v168,v169
v_cvt_pk_bf16_f32 v155,v170,v171
v_mfma_f32_16x16x32_bf16 a[24:27],v[72:75],v[120:123],a[24:27]
ds_read_b64_tr_b16 v[62:63],v30 offset:27648
v_mul_f32 v156,s54,v156
v_mfma_f32_16x16x32_bf16 a[28:31],v[72:75],v[124:127],a[28:31]
v_mul_f32 v157,s54,v157
s_waitcnt lgkmcnt(6)
v_mfma_f32_16x16x32_bf16 a[28:31],v[76:79],v[140:143],a[28:31]
ds_read_b64_tr_b16 v[64:65],v9 offset:2048
v_mul_f32 v158,s54,v158
v_mfma_f32_16x16x32_bf16 a[24:27],v[76:79],v[136:139],a[24:27]
buffer_store_dwordx4 v[152:155],v21,s[8:11],s60 offen offset:0 sc1
v_mfma_f32_16x16x32_bf16 a[20:23],v[76:79],v[132:135],a[20:23]
ds_read_b64_tr_b16 v[66:67],v9 offset:3072
v_mul_f32 v159,s54,v159
v_mfma_f32_16x16x32_bf16 a[16:19],v[76:79],v[128:131],a[16:19]
v_exp_f32 v156,v156
v_mfma_f32_16x16x32_bf16 a[32:35],v[48:51],v[80:83],a[32:35]
ds_read_b64_tr_b16 v[68:69],v9 offset:26624
v_add_f32 v156,1.0,v156
v_mfma_f32_16x16x32_bf16 a[36:39],v[48:51],v[84:87],a[36:39]
v_exp_f32 v157,v157
v_mfma_f32_16x16x32_bf16 a[40:43],v[48:51],v[88:91],a[40:43]
ds_read_b64_tr_b16 v[70:71],v9 offset:27648
v_add_f32 v157,1.0,v157
v_mfma_f32_16x16x32_bf16 a[44:47],v[48:51],v[92:95],a[44:47]
v_accvgpr_read_b32 v24,a140
s_waitcnt lgkmcnt(6)
v_mfma_f32_16x16x32_bf16 a[44:47],v[52:55],v[108:111],a[44:47]
ds_read_b64_tr_b16 v[72:73],v31 offset:2048
v_accvgpr_read_b32 v25,a141
v_mfma_f32_16x16x32_bf16 a[40:43],v[52:55],v[104:107],a[40:43]
v_exp_f32 v158,v158
v_mfma_f32_16x16x32_bf16 a[36:39],v[52:55],v[100:103],a[36:39]
ds_read_b64_tr_b16 v[74:75],v31 offset:3072
v_add_f32 v158,1.0,v158
v_mfma_f32_16x16x32_bf16 a[32:35],v[52:55],v[96:99],a[32:35]
v_exp_f32 v159,v159
v_mfma_f32_16x16x32_bf16 a[32:35],v[56:59],v[112:115],a[32:35]
ds_read_b64_tr_b16 v[76:77],v31 offset:26624
v_add_f32 v159,1.0,v159
v_mfma_f32_16x16x32_bf16 a[36:39],v[56:59],v[116:119],a[36:39]
v_rcp_f32 v156,v156
v_mfma_f32_16x16x32_bf16 a[40:43],v[56:59],v[120:123],a[40:43]
ds_read_b64_tr_b16 v[78:79],v31 offset:27648
v_mul_f32 v156,v156,v24
v_mfma_f32_16x16x32_bf16 a[44:47],v[56:59],v[124:127],a[44:47]
v_accvgpr_read_b32 v26,a142
s_waitcnt lgkmcnt(6)
v_mfma_f32_16x16x32_bf16 a[44:47],v[60:63],v[140:143],a[44:47]
ds_read_b64_tr_b16 v[48:49],v8 offset:4096
v_accvgpr_read_b32 v27,a143
v_mfma_f32_16x16x32_bf16 a[40:43],v[60:63],v[136:139],a[40:43]
v_rcp_f32 v157,v157
v_mfma_f32_16x16x32_bf16 a[36:39],v[60:63],v[132:135],a[36:39]
ds_read_b64_tr_b16 v[50:51],v8 offset:5120
v_mul_f32 v157,v157,v25
v_mfma_f32_16x16x32_bf16 a[32:35],v[60:63],v[128:131],a[32:35]
v_rcp_f32 v158,v158
v_mfma_f32_16x16x32_bf16 a[48:51],v[64:67],v[80:83],a[48:51]
ds_read_b64_tr_b16 v[52:53],v8 offset:28672
v_mul_f32 v158,v158,v26
v_mfma_f32_16x16x32_bf16 a[52:55],v[64:67],v[84:87],a[52:55]
v_rcp_f32 v159,v159
v_mfma_f32_16x16x32_bf16 a[56:59],v[64:67],v[88:91],a[56:59]
ds_read_b64_tr_b16 v[54:55],v8 offset:29696
v_mul_f32 v159,v159,v27
v_mfma_f32_16x16x32_bf16 a[60:63],v[64:67],v[92:95],a[60:63]
v_mul_f32 v172,s54,v172
s_waitcnt lgkmcnt(6)
v_mfma_f32_16x16x32_bf16 a[60:63],v[68:71],v[108:111],a[60:63]
ds_read_b64_tr_b16 v[56:57],v30 offset:4096
v_mul_f32 v173,s54,v173
v_mfma_f32_16x16x32_bf16 a[56:59],v[68:71],v[104:107],a[56:59]
v_exp_f32 v172,v172
v_mfma_f32_16x16x32_bf16 a[52:55],v[68:71],v[100:103],a[52:55]
ds_read_b64_tr_b16 v[58:59],v30 offset:5120
v_mul_f32 v174,s54,v174
v_mfma_f32_16x16x32_bf16 a[48:51],v[68:71],v[96:99],a[48:51]
v_exp_f32 v173,v173
v_mfma_f32_16x16x32_bf16 a[48:51],v[72:75],v[112:115],a[48:51]
ds_read_b64_tr_b16 v[60:61],v30 offset:28672
v_mul_f32 v175,s54,v175
v_mfma_f32_16x16x32_bf16 a[52:55],v[72:75],v[116:119],a[52:55]
v_exp_f32 v174,v174
v_mfma_f32_16x16x32_bf16 a[56:59],v[72:75],v[120:123],a[56:59]
ds_read_b64_tr_b16 v[62:63],v30 offset:29696
v_add_f32 v172,1.0,v172
v_mfma_f32_16x16x32_bf16 a[60:63],v[72:75],v[124:127],a[60:63]
v_add_f32 v173,1.0,v173
s_waitcnt lgkmcnt(6)
v_mfma_f32_16x16x32_bf16 a[60:63],v[76:79],v[140:143],a[60:63]
ds_read_b64_tr_b16 v[64:65],v9 offset:4096
v_add_f32 v174,1.0,v174
v_mfma_f32_16x16x32_bf16 a[56:59],v[76:79],v[136:139],a[56:59]
v_exp_f32 v175,v175
v_mfma_f32_16x16x32_bf16 a[52:55],v[76:79],v[132:135],a[52:55]
ds_read_b64_tr_b16 v[66:67],v9 offset:5120
v_add_f32 v175,1.0,v175
v_mfma_f32_16x16x32_bf16 a[48:51],v[76:79],v[128:131],a[48:51]
v_rcp_f32 v172,v172
v_mfma_f32_16x16x32_bf16 a[64:67],v[48:51],v[80:83],a[64:67]
ds_read_b64_tr_b16 v[68:69],v9 offset:28672
v_accvgpr_read_b32 v24,a156
v_mfma_f32_16x16x32_bf16 a[68:71],v[48:51],v[84:87],a[68:71]
v_rcp_f32 v173,v173
v_mfma_f32_16x16x32_bf16 a[72:75],v[48:51],v[88:91],a[72:75]
ds_read_b64_tr_b16 v[70:71],v9 offset:29696
v_mul_f32 v172,v172,v24
v_mfma_f32_16x16x32_bf16 a[76:79],v[48:51],v[92:95],a[76:79]
v_accvgpr_read_b32 v25,a157
s_waitcnt lgkmcnt(6)
v_mfma_f32_16x16x32_bf16 a[76:79],v[52:55],v[108:111],a[76:79]
ds_read_b64_tr_b16 v[72:73],v31 offset:4096
v_mul_f32 v173,v173,v25
v_mfma_f32_16x16x32_bf16 a[72:75],v[52:55],v[104:107],a[72:75]
v_rcp_f32 v174,v174
v_mfma_f32_16x16x32_bf16 a[68:71],v[52:55],v[100:103],a[68:71]
ds_read_b64_tr_b16 v[74:75],v31 offset:5120
v_accvgpr_read_b32 v26,a158
v_mfma_f32_16x16x32_bf16 a[64:67],v[52:55],v[96:99],a[64:67]
v_rcp_f32 v175,v175
v_mfma_f32_16x16x32_bf16 a[64:67],v[56:59],v[112:115],a[64:67]
ds_read_b64_tr_b16 v[76:77],v31 offset:28672
v_mul_f32 v174,v174,v26
v_mfma_f32_16x16x32_bf16 a[68:71],v[56:59],v[116:119],a[68:71]
v_accvgpr_read_b32 v27,a159
v_cvt_pk_bf16_f32 v156,v156,v157
v_mfma_f32_16x16x32_bf16 a[72:75],v[56:59],v[120:123],a[72:75]
ds_read_b64_tr_b16 v[78:79],v31 offset:29696
v_mul_f32 v175,v175,v27
v_mfma_f32_16x16x32_bf16 a[76:79],v[56:59],v[124:127],a[76:79]
v_cvt_pk_bf16_f32 v157,v158,v159
s_waitcnt lgkmcnt(6)
v_mfma_f32_16x16x32_bf16 a[76:79],v[60:63],v[140:143],a[76:79]
ds_read_b64_tr_b16 v[48:49],v8 offset:6144
v_cvt_pk_bf16_f32 v158,v172,v173
v_mfma_f32_16x16x32_bf16 a[72:75],v[60:63],v[136:139],a[72:75]
v_cvt_pk_bf16_f32 v159,v174,v175
v_mul_f32 v176,s54,v176
v_mfma_f32_16x16x32_bf16 a[68:71],v[60:63],v[132:135],a[68:71]
ds_read_b64_tr_b16 v[50:51],v8 offset:7168
v_mul_f32 v177,s54,v177
v_mfma_f32_16x16x32_bf16 a[64:67],v[60:63],v[128:131],a[64:67]
buffer_store_dwordx4 v[156:159],v21,s[8:11],s60 offen offset:1024 sc1
v_mfma_f32_16x16x32_bf16 a[80:83],v[64:67],v[80:83],a[80:83]
ds_read_b64_tr_b16 v[52:53],v8 offset:30720
v_mul_f32 v178,s54,v178
v_mfma_f32_16x16x32_bf16 a[84:87],v[64:67],v[84:87],a[84:87]
v_exp_f32 v176,v176
v_mfma_f32_16x16x32_bf16 a[88:91],v[64:67],v[88:91],a[88:91]
ds_read_b64_tr_b16 v[54:55],v8 offset:31744
v_mul_f32 v179,s54,v179
v_mfma_f32_16x16x32_bf16 a[92:95],v[64:67],v[92:95],a[92:95]
v_add_f32 v176,1.0,v176
s_waitcnt lgkmcnt(6)
v_mfma_f32_16x16x32_bf16 a[92:95],v[68:71],v[108:111],a[92:95]
ds_read_b64_tr_b16 v[56:57],v30 offset:6144
v_accvgpr_read_b32 v24,a160
v_mfma_f32_16x16x32_bf16 a[88:91],v[68:71],v[104:107],a[88:91]
v_exp_f32 v177,v177
v_mfma_f32_16x16x32_bf16 a[84:87],v[68:71],v[100:103],a[84:87]
ds_read_b64_tr_b16 v[58:59],v30 offset:7168
v_add_f32 v177,1.0,v177
v_mfma_f32_16x16x32_bf16 a[80:83],v[68:71],v[96:99],a[80:83]
v_exp_f32 v178,v178
v_mfma_f32_16x16x32_bf16 a[80:83],v[72:75],v[112:115],a[80:83]
ds_read_b64_tr_b16 v[60:61],v30 offset:30720
v_add_f32 v178,1.0,v178
v_mfma_f32_16x16x32_bf16 a[84:87],v[72:75],v[116:119],a[84:87]
v_exp_f32 v179,v179
v_mfma_f32_16x16x32_bf16 a[88:91],v[72:75],v[120:123],a[88:91]
ds_read_b64_tr_b16 v[62:63],v30 offset:31744
v_add_f32 v179,1.0,v179
v_mfma_f32_16x16x32_bf16 a[92:95],v[72:75],v[124:127],a[92:95]
v_accvgpr_read_b32 v25,a161
s_waitcnt lgkmcnt(6)
v_mfma_f32_16x16x32_bf16 a[92:95],v[76:79],v[140:143],a[92:95]
ds_read_b64_tr_b16 v[64:65],v9 offset:6144
v_accvgpr_read_b32 v26,a162
v_mfma_f32_16x16x32_bf16 a[88:91],v[76:79],v[136:139],a[88:91]
v_rcp_f32 v176,v176
v_mfma_f32_16x16x32_bf16 a[84:87],v[76:79],v[132:135],a[84:87]
ds_read_b64_tr_b16 v[66:67],v9 offset:7168
v_mul_f32 v176,v176,v24
v_mfma_f32_16x16x32_bf16 a[80:83],v[76:79],v[128:131],a[80:83]
v_rcp_f32 v177,v177
v_mfma_f32_16x16x32_bf16 a[96:99],v[48:51],v[80:83],a[96:99]
ds_read_b64_tr_b16 v[68:69],v9 offset:30720
v_mul_f32 v177,v177,v25
v_mfma_f32_16x16x32_bf16 a[100:103],v[48:51],v[84:87],a[100:103]
v_rcp_f32 v178,v178
v_mfma_f32_16x16x32_bf16 a[104:107],v[48:51],v[88:91],a[104:107]
ds_read_b64_tr_b16 v[70:71],v9 offset:31744
v_mul_f32 v178,v178,v26
v_mfma_f32_16x16x32_bf16 a[108:111],v[48:51],v[92:95],a[108:111]
v_accvgpr_read_b32 v27,a163
s_waitcnt lgkmcnt(6)
v_mfma_f32_16x16x32_bf16 a[108:111],v[52:55],v[108:111],a[108:111]
ds_read_b64_tr_b16 v[72:73],v31 offset:6144
v_mul_f32 v192,s54,v192
v_mfma_f32_16x16x32_bf16 a[104:107],v[52:55],v[104:107],a[104:107]
v_rcp_f32 v179,v179
v_mfma_f32_16x16x32_bf16 a[100:103],v[52:55],v[100:103],a[100:103]
ds_read_b64_tr_b16 v[74:75],v31 offset:7168
v_mul_f32 v179,v179,v27
v_mfma_f32_16x16x32_bf16 a[96:99],v[52:55],v[96:99],a[96:99]
v_exp_f32 v192,v192
v_mfma_f32_16x16x32_bf16 a[96:99],v[56:59],v[112:115],a[96:99]
ds_read_b64_tr_b16 v[76:77],v31 offset:30720
v_mul_f32 v193,s54,v193
v_mfma_f32_16x16x32_bf16 a[100:103],v[56:59],v[116:119],a[100:103]
v_exp_f32 v193,v193
v_mfma_f32_16x16x32_bf16 a[104:107],v[56:59],v[120:123],a[104:107]
ds_read_b64_tr_b16 v[78:79],v31 offset:31744
v_mul_f32 v194,s54,v194
v_mfma_f32_16x16x32_bf16 a[108:111],v[56:59],v[124:127],a[108:111]
v_mul_f32 v195,s54,v195
s_waitcnt lgkmcnt(6)
v_mfma_f32_16x16x32_bf16 a[108:111],v[60:63],v[140:143],a[108:111]
v_exp_f32 v194,v194
v_mfma_f32_16x16x32_bf16 a[104:107],v[60:63],v[136:139],a[104:107]
v_exp_f32 v195,v195
v_mfma_f32_16x16x32_bf16 a[100:103],v[60:63],v[132:135],a[100:103]
v_add_f32 v192,1.0,v192
v_add_f32 v193,1.0,v193
v_mfma_f32_16x16x32_bf16 a[96:99],v[60:63],v[128:131],a[96:99]
v_rcp_f32 v192,v192
v_mfma_f32_16x16x32_bf16 a[112:115],v[64:67],v[80:83],a[112:115]
v_rcp_f32 v193,v193
v_mfma_f32_16x16x32_bf16 a[116:119],v[64:67],v[84:87],a[116:119]
v_add_f32 v194,1.0,v194
v_add_f32 v195,1.0,v195
v_mfma_f32_16x16x32_bf16 a[120:123],v[64:67],v[88:91],a[120:123]
v_rcp_f32 v194,v194
v_mfma_f32_16x16x32_bf16 a[124:127],v[64:67],v[92:95],a[124:127]
v_accvgpr_read_b32 v24,a176
s_waitcnt lgkmcnt(2)
v_mfma_f32_16x16x32_bf16 a[124:127],v[68:71],v[108:111],a[124:127]
v_rcp_f32 v195,v195
v_mfma_f32_16x16x32_bf16 a[120:123],v[68:71],v[104:107],a[120:123]
v_mul_f32 v192,v192,v24
v_accvgpr_read_b32 v25,a177
v_mfma_f32_16x16x32_bf16 a[116:119],v[68:71],v[100:103],a[116:119]
v_mul_f32 v193,v193,v25
v_accvgpr_read_b32 v26,a178
v_mfma_f32_16x16x32_bf16 a[112:115],v[68:71],v[96:99],a[112:115]
v_mul_f32 v194,v194,v26
v_accvgpr_read_b32 v27,a179
v_mfma_f32_16x16x32_bf16 a[112:115],v[72:75],v[112:115],a[112:115]
v_mul_f32 v195,v195,v27
v_cvt_pk_bf16_f32 v176,v176,v177
v_mfma_f32_16x16x32_bf16 a[116:119],v[72:75],v[116:119],a[116:119]
v_cvt_pk_bf16_f32 v177,v178,v179
v_mfma_f32_16x16x32_bf16 a[120:123],v[72:75],v[120:123],a[120:123]
v_cvt_pk_bf16_f32 v178,v192,v193
v_cvt_pk_bf16_f32 v179,v194,v195
v_mfma_f32_16x16x32_bf16 a[124:127],v[72:75],v[124:127],a[124:127]
s_waitcnt lgkmcnt(0)
v_mfma_f32_16x16x32_bf16 a[124:127],v[76:79],v[140:143],a[124:127]
buffer_store_dwordx4 v[176:179],v20,s[8:11],s61 offen offset:0 sc1
v_mfma_f32_16x16x32_bf16 a[120:123],v[76:79],v[136:139],a[120:123]
v_mfma_f32_16x16x32_bf16 a[116:119],v[76:79],v[132:135],a[116:119]
v_mfma_f32_16x16x32_bf16 a[112:115],v[76:79],v[128:131],a[112:115]
s_waitcnt vmcnt(12) lgkmcnt(0)
s_barrier
s_mov_b32 s51,s50
buffer_store_dword v29,v23,s[8:11],s67 offen sc1
v_pk_mul_f32 v[48:49],v[180:181],s[54:55]
v_pk_mul_f32 v[50:51],v[182:183],s[54:55]
v_accvgpr_read_b32 v52,a164
v_accvgpr_read_b32 v53,a165
v_accvgpr_read_b32 v54,a166
v_accvgpr_read_b32 v55,a167
v_pk_mul_f32 v[56:57],v[196:197],s[54:55]
v_pk_mul_f32 v[58:59],v[198:199],s[54:55]
v_accvgpr_read_b32 v60,a180
v_accvgpr_read_b32 v61,a181
v_accvgpr_read_b32 v62,a182
v_accvgpr_read_b32 v63,a183
s_add_u32 m0,s91,0
s_nop 0
buffer_load_dwordx4 v11,s[20:23],s51 offen offset:0 lds
v_exp_f32 v48,v48
v_exp_f32 v49,v49
v_exp_f32 v50,v50
v_exp_f32 v51,v51
v_exp_f32 v56,v56
v_exp_f32 v57,v57
v_exp_f32 v58,v58
v_exp_f32 v59,v59
s_add_u32 m0,s91,4032
s_nop 0
buffer_load_dwordx4 v11,s[20:23],s51 offen offset:64 lds
v_pk_add_f32 v[48:49],v[48:49],s[56:57]
v_pk_add_f32 v[50:51],v[50:51],s[56:57]
v_pk_add_f32 v[56:57],v[56:57],s[56:57]
v_pk_add_f32 v[58:59],v[58:59],s[56:57]
v_rcp_f32 v48,v48
v_rcp_f32 v49,v49
v_rcp_f32 v50,v50
v_rcp_f32 v51,v51
v_rcp_f32 v56,v56
v_rcp_f32 v57,v57
v_rcp_f32 v58,v58
v_rcp_f32 v59,v59
s_add_u32 m0,s91,8064
s_nop 0
buffer_load_dwordx4 v11,s[20:23],s51 offen offset:128 lds
v_pk_mul_f32 v[48:49],v[48:49],v[52:53]
v_pk_mul_f32 v[50:51],v[50:51],v[54:55]
v_pk_mul_f32 v[56:57],v[56:57],v[60:61]
v_pk_mul_f32 v[58:59],v[58:59],v[62:63]
s_add_u32 m0,s91,12096
s_nop 0
buffer_load_dwordx4 v11,s[20:23],s51 offen offset:192 lds
v_cvt_pk_bf16_f32 v180,v48,v49
v_cvt_pk_bf16_f32 v181,v50,v51
v_cvt_pk_bf16_f32 v182,v56,v57
v_cvt_pk_bf16_f32 v183,v58,v59
v_pk_mul_f32 v[64:65],v[184:185],s[54:55]
v_pk_mul_f32 v[66:67],v[186:187],s[54:55]
v_accvgpr_read_b32 v68,a168
v_accvgpr_read_b32 v69,a169
v_accvgpr_read_b32 v70,a170
v_accvgpr_read_b32 v71,a171
v_pk_mul_f32 v[72:73],v[200:201],s[54:55]
v_pk_mul_f32 v[74:75],v[202:203],s[54:55]
v_accvgpr_read_b32 v76,a184
v_accvgpr_read_b32 v77,a185
v_accvgpr_read_b32 v78,a186
v_accvgpr_read_b32 v79,a187
s_add_u32 m0,s91,16384
s_nop 0
buffer_load_dwordx4 v12,s[24:27],s51 offen offset:0 lds
v_exp_f32 v64,v64
v_exp_f32 v65,v65
v_exp_f32 v66,v66
v_exp_f32 v67,v67
v_exp_f32 v72,v72
v_exp_f32 v73,v73
v_exp_f32 v74,v74
v_exp_f32 v75,v75
s_add_u32 m0,s91,20416
s_nop 0
buffer_load_dwordx4 v12,s[24:27],s51 offen offset:64 lds
v_pk_add_f32 v[64:65],v[64:65],s[56:57]
v_pk_add_f32 v[66:67],v[66:67],s[56:57]
v_pk_add_f32 v[72:73],v[72:73],s[56:57]
v_pk_add_f32 v[74:75],v[74:75],s[56:57]
v_rcp_f32 v64,v64
v_rcp_f32 v65,v65
v_rcp_f32 v66,v66
v_rcp_f32 v67,v67
v_rcp_f32 v72,v72
v_rcp_f32 v73,v73
v_rcp_f32 v74,v74
v_rcp_f32 v75,v75
s_add_u32 m0,s91,24448
s_nop 0
buffer_load_dwordx4 v12,s[24:27],s51 offen offset:128 lds
v_pk_mul_f32 v[64:65],v[64:65],v[68:69]
v_pk_mul_f32 v[66:67],v[66:67],v[70:71]
v_pk_mul_f32 v[72:73],v[72:73],v[76:77]
v_pk_mul_f32 v[74:75],v[74:75],v[78:79]
s_add_u32 m0,s91,28480
s_nop 0
buffer_load_dwordx4 v12,s[24:27],s51 offen offset:192 lds
v_cvt_pk_bf16_f32 v184,v64,v65
v_cvt_pk_bf16_f32 v185,v66,v67
v_cvt_pk_bf16_f32 v186,v72,v73
v_cvt_pk_bf16_f32 v187,v74,v75
v_pk_mul_f32 v[48:49],v[188:189],s[54:55]
v_pk_mul_f32 v[50:51],v[190:191],s[54:55]
v_accvgpr_read_b32 v52,a172
v_accvgpr_read_b32 v53,a173
v_accvgpr_read_b32 v54,a174
v_accvgpr_read_b32 v55,a175
v_pk_mul_f32 v[56:57],v[204:205],s[54:55]
v_pk_mul_f32 v[58:59],v[206:207],s[54:55]
v_accvgpr_read_b32 v60,a188
v_accvgpr_read_b32 v61,a189
v_accvgpr_read_b32 v62,a190
v_accvgpr_read_b32 v63,a191
s_add_u32 s51,s51,0x4000
s_add_u32 m0,s91,32768
s_nop 0
buffer_load_dwordx4 v11,s[20:23],s51 offen offset:0 lds
v_exp_f32 v48,v48
v_exp_f32 v49,v49
v_exp_f32 v50,v50
v_exp_f32 v51,v51
v_exp_f32 v56,v56
v_exp_f32 v57,v57
v_exp_f32 v58,v58
v_exp_f32 v59,v59
s_add_u32 m0,s91,36800
s_nop 0
buffer_load_dwordx4 v11,s[20:23],s51 offen offset:64 lds
v_pk_add_f32 v[48:49],v[48:49],s[56:57]
v_pk_add_f32 v[50:51],v[50:51],s[56:57]
v_pk_add_f32 v[56:57],v[56:57],s[56:57]
v_pk_add_f32 v[58:59],v[58:59],s[56:57]
v_rcp_f32 v48,v48
v_rcp_f32 v49,v49
v_rcp_f32 v50,v50
v_rcp_f32 v51,v51
v_rcp_f32 v56,v56
v_rcp_f32 v57,v57
v_rcp_f32 v58,v58
v_rcp_f32 v59,v59
s_add_u32 m0,s91,40832
s_nop 0
buffer_load_dwordx4 v11,s[20:23],s51 offen offset:128 lds
v_pk_mul_f32 v[48:49],v[48:49],v[52:53]
v_pk_mul_f32 v[50:51],v[50:51],v[54:55]
v_pk_mul_f32 v[56:57],v[56:57],v[60:61]
v_pk_mul_f32 v[58:59],v[58:59],v[62:63]
s_add_u32 m0,s91,44864
s_nop 0
buffer_load_dwordx4 v11,s[20:23],s51 offen offset:192 lds
v_cvt_pk_bf16_f32 v188,v48,v49
v_cvt_pk_bf16_f32 v189,v50,v51
v_cvt_pk_bf16_f32 v190,v56,v57
v_cvt_pk_bf16_f32 v191,v58,v59
v_pk_mul_f32 v[64:65],v[208:209],s[54:55]
v_pk_mul_f32 v[66:67],v[210:211],s[54:55]
v_accvgpr_read_b32 v68,a192
v_accvgpr_read_b32 v69,a193
v_accvgpr_read_b32 v70,a194
v_accvgpr_read_b32 v71,a195
v_pk_mul_f32 v[72:73],v[224:225],s[54:55]
v_pk_mul_f32 v[74:75],v[226:227],s[54:55]
v_accvgpr_read_b32 v76,a208
v_accvgpr_read_b32 v77,a209
v_accvgpr_read_b32 v78,a210
v_accvgpr_read_b32 v79,a211
s_add_u32 m0,s91,49152
s_nop 0
buffer_load_dwordx4 v12,s[24:27],s51 offen offset:0 lds
v_exp_f32 v64,v64
v_exp_f32 v65,v65
v_exp_f32 v66,v66
v_exp_f32 v67,v67
v_exp_f32 v72,v72
v_exp_f32 v73,v73
v_exp_f32 v74,v74
v_exp_f32 v75,v75
s_add_u32 m0,s91,53184
s_nop 0
buffer_load_dwordx4 v12,s[24:27],s51 offen offset:64 lds
v_pk_add_f32 v[64:65],v[64:65],s[56:57]
v_pk_add_f32 v[66:67],v[66:67],s[56:57]
v_pk_add_f32 v[72:73],v[72:73],s[56:57]
v_pk_add_f32 v[74:75],v[74:75],s[56:57]
v_rcp_f32 v64,v64
v_rcp_f32 v65,v65
v_rcp_f32 v66,v66
v_rcp_f32 v67,v67
v_rcp_f32 v72,v72
v_rcp_f32 v73,v73
v_rcp_f32 v74,v74
v_rcp_f32 v75,v75
s_add_u32 m0,s91,57216
s_nop 0
buffer_load_dwordx4 v12,s[24:27],s51 offen offset:128 lds
v_pk_mul_f32 v[64:65],v[64:65],v[68:69]
v_pk_mul_f32 v[66:67],v[66:67],v[70:71]
v_pk_mul_f32 v[72:73],v[72:73],v[76:77]
v_pk_mul_f32 v[74:75],v[74:75],v[78:79]
s_add_u32 m0,s91,61248
s_nop 0
buffer_load_dwordx4 v12,s[24:27],s51 offen offset:192 lds
v_cvt_pk_bf16_f32 v208,v64,v65
v_cvt_pk_bf16_f32 v209,v66,v67
v_cvt_pk_bf16_f32 v210,v72,v73
v_cvt_pk_bf16_f32 v211,v74,v75
v_pk_mul_f32 v[48:49],v[212:213],s[54:55]
v_pk_mul_f32 v[50:51],v[214:215],s[54:55]
v_accvgpr_read_b32 v52,a196
v_accvgpr_read_b32 v53,a197
v_accvgpr_read_b32 v54,a198
v_accvgpr_read_b32 v55,a199
v_pk_mul_f32 v[56:57],v[228:229],s[54:55]
v_pk_mul_f32 v[58:59],v[230:231],s[54:55]
v_accvgpr_read_b32 v60,a212
v_accvgpr_read_b32 v61,a213
v_accvgpr_read_b32 v62,a214
v_accvgpr_read_b32 v63,a215
s_add_u32 s51,s51,0x4000
s_add_u32 m0,s91,65536
s_nop 0
buffer_load_dwordx4 v11,s[20:23],s51 offen offset:0 lds
v_exp_f32 v48,v48
v_exp_f32 v49,v49
v_exp_f32 v50,v50
v_exp_f32 v51,v51
v_exp_f32 v56,v56
v_exp_f32 v57,v57
v_exp_f32 v58,v58
v_exp_f32 v59,v59
s_add_u32 m0,s91,69568
s_nop 0
buffer_load_dwordx4 v11,s[20:23],s51 offen offset:64 lds
v_pk_add_f32 v[48:49],v[48:49],s[56:57]
v_pk_add_f32 v[50:51],v[50:51],s[56:57]
v_pk_add_f32 v[56:57],v[56:57],s[56:57]
v_pk_add_f32 v[58:59],v[58:59],s[56:57]
v_rcp_f32 v48,v48
v_rcp_f32 v49,v49
v_rcp_f32 v50,v50
v_rcp_f32 v51,v51
v_rcp_f32 v56,v56
v_rcp_f32 v57,v57
v_rcp_f32 v58,v58
v_rcp_f32 v59,v59
s_add_u32 m0,s91,73600
s_nop 0
buffer_load_dwordx4 v11,s[20:23],s51 offen offset:128 lds
v_pk_mul_f32 v[48:49],v[48:49],v[52:53]
v_pk_mul_f32 v[50:51],v[50:51],v[54:55]
v_pk_mul_f32 v[56:57],v[56:57],v[60:61]
v_pk_mul_f32 v[58:59],v[58:59],v[62:63]
s_add_u32 m0,s91,77632
s_nop 0
buffer_load_dwordx4 v11,s[20:23],s51 offen offset:192 lds
v_cvt_pk_bf16_f32 v212,v48,v49
v_cvt_pk_bf16_f32 v213,v50,v51
v_cvt_pk_bf16_f32 v214,v56,v57
v_cvt_pk_bf16_f32 v215,v58,v59
v_pk_mul_f32 v[64:65],v[216:217],s[54:55]
v_pk_mul_f32 v[66:67],v[218:219],s[54:55]
v_accvgpr_read_b32 v68,a200
v_accvgpr_read_b32 v69,a201
v_accvgpr_read_b32 v70,a202
v_accvgpr_read_b32 v71,a203
v_pk_mul_f32 v[72:73],v[232:233],s[54:55]
v_pk_mul_f32 v[74:75],v[234:235],s[54:55]
v_accvgpr_read_b32 v76,a216
v_accvgpr_read_b32 v77,a217
v_accvgpr_read_b32 v78,a218
v_accvgpr_read_b32 v79,a219
s_add_u32 m0,s91,81920
s_nop 0
buffer_load_dwordx4 v12,s[24:27],s51 offen offset:0 lds
v_exp_f32 v64,v64
v_exp_f32 v65,v65
v_exp_f32 v66,v66
v_exp_f32 v67,v67
v_exp_f32 v72,v72
v_exp_f32 v73,v73
v_exp_f32 v74,v74
v_exp_f32 v75,v75
s_add_u32 m0,s91,85952
s_nop 0
buffer_load_dwordx4 v12,s[24:27],s51 offen offset:64 lds
v_pk_add_f32 v[64:65],v[64:65],s[56:57]
v_pk_add_f32 v[66:67],v[66:67],s[56:57]
v_pk_add_f32 v[72:73],v[72:73],s[56:57]
v_pk_add_f32 v[74:75],v[74:75],s[56:57]
v_rcp_f32 v64,v64
v_rcp_f32 v65,v65
v_rcp_f32 v66,v66
v_rcp_f32 v67,v67
v_rcp_f32 v72,v72
v_rcp_f32 v73,v73
v_rcp_f32 v74,v74
v_rcp_f32 v75,v75
s_add_u32 m0,s91,89984
s_nop 0
buffer_load_dwordx4 v12,s[24:27],s51 offen offset:128 lds
v_pk_mul_f32 v[64:65],v[64:65],v[68:69]
v_pk_mul_f32 v[66:67],v[66:67],v[70:71]
v_pk_mul_f32 v[72:73],v[72:73],v[76:77]
v_pk_mul_f32 v[74:75],v[74:75],v[78:79]
s_add_u32 m0,s91,94016
s_nop 0
buffer_load_dwordx4 v12,s[24:27],s51 offen offset:192 lds
v_cvt_pk_bf16_f32 v216,v64,v65
v_cvt_pk_bf16_f32 v217,v66,v67
v_cvt_pk_bf16_f32 v218,v72,v73
v_cvt_pk_bf16_f32 v219,v74,v75
v_pk_mul_f32 v[48:49],v[220:221],s[54:55]
v_pk_mul_f32 v[50:51],v[222:223],s[54:55]
v_accvgpr_read_b32 v52,a204
v_accvgpr_read_b32 v53,a205
v_accvgpr_read_b32 v54,a206
v_accvgpr_read_b32 v55,a207
v_pk_mul_f32 v[56:57],v[236:237],s[54:55]
v_pk_mul_f32 v[58:59],v[238:239],s[54:55]
v_accvgpr_read_b32 v60,a220
v_accvgpr_read_b32 v61,a221
v_accvgpr_read_b32 v62,a222
v_accvgpr_read_b32 v63,a223
s_add_u32 s51,s51,0x4000
s_add_u32 m0,s91,98304
s_nop 0
buffer_load_dwordx4 v11,s[20:23],s51 offen offset:0 lds
v_exp_f32 v48,v48
v_exp_f32 v49,v49
v_exp_f32 v50,v50
v_exp_f32 v51,v51
v_exp_f32 v56,v56
v_exp_f32 v57,v57
v_exp_f32 v58,v58
v_exp_f32 v59,v59
s_add_u32 m0,s91,102336
s_nop 0
buffer_load_dwordx4 v11,s[20:23],s51 offen offset:64 lds
v_pk_add_f32 v[48:49],v[48:49],s[56:57]
v_pk_add_f32 v[50:51],v[50:51],s[56:57]
v_pk_add_f32 v[56:57],v[56:57],s[56:57]
v_pk_add_f32 v[58:59],v[58:59],s[56:57]
v_rcp_f32 v48,v48
v_rcp_f32 v49,v49
v_rcp_f32 v50,v50
v_rcp_f32 v51,v51
v_rcp_f32 v56,v56
v_rcp_f32 v57,v57
v_rcp_f32 v58,v58
v_rcp_f32 v59,v59
s_add_u32 m0,s91,106368
s_nop 0
buffer_load_dwordx4 v11,s[20:23],s51 offen offset:128 lds
v_pk_mul_f32 v[48:49],v[48:49],v[52:53]
v_pk_mul_f32 v[50:51],v[50:51],v[54:55]
v_pk_mul_f32 v[56:57],v[56:57],v[60:61]
v_pk_mul_f32 v[58:59],v[58:59],v[62:63]
s_add_u32 m0,s91,110400
s_nop 0
buffer_load_dwordx4 v11,s[20:23],s51 offen offset:192 lds
v_cvt_pk_bf16_f32 v220,v48,v49
v_cvt_pk_bf16_f32 v221,v50,v51
v_cvt_pk_bf16_f32 v222,v56,v57
v_cvt_pk_bf16_f32 v223,v58,v59
v_pk_mul_f32 v[64:65],v[240:241],s[54:55]
v_pk_mul_f32 v[66:67],v[242:243],s[54:55]
v_accvgpr_read_b32 v68,a224
v_accvgpr_read_b32 v69,a225
v_accvgpr_read_b32 v70,a226
v_accvgpr_read_b32 v71,a227
s_add_u32 m0,s91,114688
s_nop 0
buffer_load_dwordx4 v12,s[24:27],s51 offen offset:0 lds
v_exp_f32 v64,v64
v_exp_f32 v65,v65
v_exp_f32 v66,v66
v_exp_f32 v67,v67
s_add_u32 m0,s91,118720
s_nop 0
buffer_load_dwordx4 v12,s[24:27],s51 offen offset:64 lds
v_pk_add_f32 v[64:65],v[64:65],s[56:57]
v_pk_add_f32 v[66:67],v[66:67],s[56:57]
v_rcp_f32 v64,v64
v_rcp_f32 v65,v65
v_rcp_f32 v66,v66
v_rcp_f32 v67,v67
s_add_u32 m0,s91,122752
s_nop 0
buffer_load_dwordx4 v12,s[24:27],s51 offen offset:128 lds
v_pk_mul_f32 v[64:65],v[64:65],v[68:69]
v_pk_mul_f32 v[66:67],v[66:67],v[70:71]
s_add_u32 m0,s91,126784
s_nop 0
buffer_load_dwordx4 v12,s[24:27],s51 offen offset:192 lds
s_add_u32 s51,s51,0x4000
v_cvt_pk_bf16_f32 v240,v64,v65
v_cvt_pk_bf16_f32 v241,v66,v67
v_pk_mul_f32 v[48:49],v[244:245],s[54:55]
v_pk_mul_f32 v[50:51],v[246:247],s[54:55]
v_accvgpr_read_b32 v52,a228
v_accvgpr_read_b32 v53,a229
v_accvgpr_read_b32 v54,a230
v_accvgpr_read_b32 v55,a231
v_exp_f32 v48,v48
v_exp_f32 v49,v49
v_exp_f32 v50,v50
v_exp_f32 v51,v51
v_pk_add_f32 v[48:49],v[48:49],s[56:57]
v_pk_add_f32 v[50:51],v[50:51],s[56:57]
buffer_store_dwordx4 v[180:183],v20,s[8:11],s61 offen offset:1024 sc1
v_rcp_f32 v48,v48
v_rcp_f32 v49,v49
v_rcp_f32 v50,v50
v_rcp_f32 v51,v51
v_pk_mul_f32 v[48:49],v[48:49],v[52:53]
v_pk_mul_f32 v[50:51],v[50:51],v[54:55]
v_cvt_pk_bf16_f32 v244,v48,v49
v_cvt_pk_bf16_f32 v245,v50,v51
v_pk_mul_f32 v[64:65],v[248:249],s[54:55]
v_pk_mul_f32 v[66:67],v[250:251],s[54:55]
v_accvgpr_read_b32 v68,a232
v_accvgpr_read_b32 v69,a233
v_accvgpr_read_b32 v70,a234
v_accvgpr_read_b32 v71,a235
v_exp_f32 v64,v64
v_exp_f32 v65,v65
v_exp_f32 v66,v66
v_exp_f32 v67,v67
v_pk_add_f32 v[64:65],v[64:65],s[56:57]
v_pk_add_f32 v[66:67],v[66:67],s[56:57]
buffer_store_dwordx4 v[184:187],v21,s[8:11],s61 offen offset:0 sc1
v_rcp_f32 v64,v64
v_rcp_f32 v65,v65
v_rcp_f32 v66,v66
v_rcp_f32 v67,v67
v_pk_mul_f32 v[64:65],v[64:65],v[68:69]
v_pk_mul_f32 v[66:67],v[66:67],v[70:71]
v_cvt_pk_bf16_f32 v248,v64,v65
v_cvt_pk_bf16_f32 v249,v66,v67
v_pk_mul_f32 v[48:49],v[252:253],s[54:55]
v_pk_mul_f32 v[50:51],v[254:255],s[54:55]
v_accvgpr_read_b32 v52,a236
v_accvgpr_read_b32 v53,a237
v_accvgpr_read_b32 v54,a238
v_accvgpr_read_b32 v55,a239
v_exp_f32 v48,v48
v_exp_f32 v49,v49
v_exp_f32 v50,v50
v_exp_f32 v51,v51
v_pk_add_f32 v[48:49],v[48:49],s[56:57]
v_pk_add_f32 v[50:51],v[50:51],s[56:57]
buffer_store_dwordx4 v[188:191],v21,s[8:11],s61 offen offset:1024 sc1
v_rcp_f32 v48,v48
v_rcp_f32 v49,v49
v_rcp_f32 v50,v50
v_rcp_f32 v51,v51
v_pk_mul_f32 v[48:49],v[48:49],v[52:53]
v_pk_mul_f32 v[50:51],v[50:51],v[54:55]
v_cvt_pk_bf16_f32 v252,v48,v49
v_cvt_pk_bf16_f32 v253,v50,v51
s_mov_b32 s54,0x3e0293ee
s_mov_b32 s55,0x3e0293ee
buffer_store_dwordx4 v[208:211],v20,s[8:11],s62 offen offset:0 sc1
v_accvgpr_read_b32 v48,a0
v_accvgpr_read_b32 v49,a1
v_accvgpr_read_b32 v50,a2
v_accvgpr_read_b32 v51,a3
v_accvgpr_read_b32 v52,a16
v_accvgpr_read_b32 v53,a17
v_accvgpr_read_b32 v54,a18
v_accvgpr_read_b32 v55,a19
v_pk_mul_f32 v[48:49],v[48:49],s[54:55]
v_pk_mul_f32 v[50:51],v[50:51],s[54:55]
v_pk_mul_f32 v[52:53],v[52:53],s[54:55]
v_pk_mul_f32 v[54:55],v[54:55],s[54:55]
v_cvt_pk_bf16_f32 v80,v48,v49
v_cvt_pk_bf16_f32 v81,v50,v51
v_cvt_pk_bf16_f32 v82,v52,v53
v_cvt_pk_bf16_f32 v83,v54,v55
buffer_store_dwordx4 v[212:215],v20,s[8:11],s62 offen offset:1024 sc1
v_accvgpr_read_b32 v56,a32
v_accvgpr_read_b32 v57,a33
v_accvgpr_read_b32 v58,a34
v_accvgpr_read_b32 v59,a35
v_accvgpr_read_b32 v60,a48
v_accvgpr_read_b32 v61,a49
v_accvgpr_read_b32 v62,a50
v_accvgpr_read_b32 v63,a51
v_pk_mul_f32 v[56:57],v[56:57],s[54:55]
v_pk_mul_f32 v[58:59],v[58:59],s[54:55]
v_pk_mul_f32 v[60:61],v[60:61],s[54:55]
v_pk_mul_f32 v[62:63],v[62:63],s[54:55]
v_cvt_pk_bf16_f32 v84,v56,v57
v_cvt_pk_bf16_f32 v85,v58,v59
v_cvt_pk_bf16_f32 v86,v60,v61
v_cvt_pk_bf16_f32 v87,v62,v63
buffer_store_dwordx4 v[216:219],v21,s[8:11],s62 offen offset:0 sc1
v_accvgpr_read_b32 v64,a64
v_accvgpr_read_b32 v65,a65
v_accvgpr_read_b32 v66,a66
v_accvgpr_read_b32 v67,a67
v_accvgpr_read_b32 v68,a80
v_accvgpr_read_b32 v69,a81
v_accvgpr_read_b32 v70,a82
v_accvgpr_read_b32 v71,a83
v_pk_mul_f32 v[64:65],v[64:65],s[54:55]
v_pk_mul_f32 v[66:67],v[66:67],s[54:55]
v_pk_mul_f32 v[68:69],v[68:69],s[54:55]
v_pk_mul_f32 v[70:71],v[70:71],s[54:55]
v_cvt_pk_bf16_f32 v88,v64,v65
v_cvt_pk_bf16_f32 v89,v66,v67
v_cvt_pk_bf16_f32 v90,v68,v69
v_cvt_pk_bf16_f32 v91,v70,v71
buffer_store_dwordx4 v[220:223],v21,s[8:11],s62 offen offset:1024 sc1
v_accvgpr_read_b32 v72,a96
v_accvgpr_read_b32 v73,a97
v_accvgpr_read_b32 v74,a98
v_accvgpr_read_b32 v75,a99
v_accvgpr_read_b32 v76,a112
v_accvgpr_read_b32 v77,a113
v_accvgpr_read_b32 v78,a114
v_accvgpr_read_b32 v79,a115
v_pk_mul_f32 v[72:73],v[72:73],s[54:55]
v_pk_mul_f32 v[74:75],v[74:75],s[54:55]
v_pk_mul_f32 v[76:77],v[76:77],s[54:55]
v_pk_mul_f32 v[78:79],v[78:79],s[54:55]
v_cvt_pk_bf16_f32 v92,v72,v73
v_cvt_pk_bf16_f32 v93,v74,v75
v_cvt_pk_bf16_f32 v94,v76,v77
v_cvt_pk_bf16_f32 v95,v78,v79
buffer_store_dwordx2 v[240:241],v20,s[8:11],s63 offen offset:0 sc1
v_accvgpr_read_b32 v48,a4
v_accvgpr_read_b32 v49,a5
v_accvgpr_read_b32 v50,a6
v_accvgpr_read_b32 v51,a7
v_accvgpr_read_b32 v52,a20
v_accvgpr_read_b32 v53,a21
v_accvgpr_read_b32 v54,a22
v_accvgpr_read_b32 v55,a23
v_pk_mul_f32 v[48:49],v[48:49],s[54:55]
v_pk_mul_f32 v[50:51],v[50:51],s[54:55]
v_pk_mul_f32 v[52:53],v[52:53],s[54:55]
v_pk_mul_f32 v[54:55],v[54:55],s[54:55]
v_cvt_pk_bf16_f32 v96,v48,v49
v_cvt_pk_bf16_f32 v97,v50,v51
v_cvt_pk_bf16_f32 v98,v52,v53
v_cvt_pk_bf16_f32 v99,v54,v55
buffer_store_dwordx2 v[244:245],v20,s[8:11],s63 offen offset:1024 sc1
v_accvgpr_read_b32 v56,a36
v_accvgpr_read_b32 v57,a37
v_accvgpr_read_b32 v58,a38
v_accvgpr_read_b32 v59,a39
v_accvgpr_read_b32 v60,a52
v_accvgpr_read_b32 v61,a53
v_accvgpr_read_b32 v62,a54
v_accvgpr_read_b32 v63,a55
v_pk_mul_f32 v[56:57],v[56:57],s[54:55]
v_pk_mul_f32 v[58:59],v[58:59],s[54:55]
v_pk_mul_f32 v[60:61],v[60:61],s[54:55]
v_pk_mul_f32 v[62:63],v[62:63],s[54:55]
v_cvt_pk_bf16_f32 v100,v56,v57
v_cvt_pk_bf16_f32 v101,v58,v59
v_cvt_pk_bf16_f32 v102,v60,v61
v_cvt_pk_bf16_f32 v103,v62,v63
buffer_store_dwordx2 v[248:249],v21,s[8:11],s63 offen offset:0 sc1
v_accvgpr_read_b32 v64,a68
v_accvgpr_read_b32 v65,a69
v_accvgpr_read_b32 v66,a70
v_accvgpr_read_b32 v67,a71
v_accvgpr_read_b32 v68,a84
v_accvgpr_read_b32 v69,a85
v_accvgpr_read_b32 v70,a86
v_accvgpr_read_b32 v71,a87
v_pk_mul_f32 v[64:65],v[64:65],s[54:55]
v_pk_mul_f32 v[66:67],v[66:67],s[54:55]
v_pk_mul_f32 v[68:69],v[68:69],s[54:55]
v_pk_mul_f32 v[70:71],v[70:71],s[54:55]
v_cvt_pk_bf16_f32 v104,v64,v65
v_cvt_pk_bf16_f32 v105,v66,v67
v_cvt_pk_bf16_f32 v106,v68,v69
v_cvt_pk_bf16_f32 v107,v70,v71
buffer_store_dwordx2 v[252:253],v21,s[8:11],s63 offen offset:1024 sc1
v_accvgpr_read_b32 v72,a100
v_accvgpr_read_b32 v73,a101
v_accvgpr_read_b32 v74,a102
v_accvgpr_read_b32 v75,a103
v_accvgpr_read_b32 v76,a116
v_accvgpr_read_b32 v77,a117
v_accvgpr_read_b32 v78,a118
v_accvgpr_read_b32 v79,a119
v_pk_mul_f32 v[72:73],v[72:73],s[54:55]
v_pk_mul_f32 v[74:75],v[74:75],s[54:55]
v_pk_mul_f32 v[76:77],v[76:77],s[54:55]
v_pk_mul_f32 v[78:79],v[78:79],s[54:55]
v_cvt_pk_bf16_f32 v108,v72,v73
v_cvt_pk_bf16_f32 v109,v74,v75
v_cvt_pk_bf16_f32 v110,v76,v77
v_cvt_pk_bf16_f32 v111,v78,v79
v_accvgpr_read_b32 v48,a8
v_accvgpr_read_b32 v49,a9
v_accvgpr_read_b32 v50,a10
v_accvgpr_read_b32 v51,a11
v_accvgpr_read_b32 v52,a24
v_accvgpr_read_b32 v53,a25
v_accvgpr_read_b32 v54,a26
v_accvgpr_read_b32 v55,a27
v_pk_mul_f32 v[48:49],v[48:49],s[54:55]
v_pk_mul_f32 v[50:51],v[50:51],s[54:55]
v_pk_mul_f32 v[52:53],v[52:53],s[54:55]
v_pk_mul_f32 v[54:55],v[54:55],s[54:55]
v_cvt_pk_bf16_f32 v112,v48,v49
v_cvt_pk_bf16_f32 v113,v50,v51
v_cvt_pk_bf16_f32 v114,v52,v53
v_cvt_pk_bf16_f32 v115,v54,v55
v_accvgpr_read_b32 v56,a40
v_accvgpr_read_b32 v57,a41
v_accvgpr_read_b32 v58,a42
v_accvgpr_read_b32 v59,a43
v_accvgpr_read_b32 v60,a56
v_accvgpr_read_b32 v61,a57
v_accvgpr_read_b32 v62,a58
v_accvgpr_read_b32 v63,a59
v_pk_mul_f32 v[56:57],v[56:57],s[54:55]
v_pk_mul_f32 v[58:59],v[58:59],s[54:55]
v_pk_mul_f32 v[60:61],v[60:61],s[54:55]
v_pk_mul_f32 v[62:63],v[62:63],s[54:55]
v_cvt_pk_bf16_f32 v116,v56,v57
v_cvt_pk_bf16_f32 v117,v58,v59
v_cvt_pk_bf16_f32 v118,v60,v61
v_cvt_pk_bf16_f32 v119,v62,v63
v_accvgpr_read_b32 v64,a72
v_accvgpr_read_b32 v65,a73
v_accvgpr_read_b32 v66,a74
v_accvgpr_read_b32 v67,a75
v_accvgpr_read_b32 v68,a88
v_accvgpr_read_b32 v69,a89
v_accvgpr_read_b32 v70,a90
v_accvgpr_read_b32 v71,a91
v_pk_mul_f32 v[64:65],v[64:65],s[54:55]
v_pk_mul_f32 v[66:67],v[66:67],s[54:55]
v_pk_mul_f32 v[68:69],v[68:69],s[54:55]
v_pk_mul_f32 v[70:71],v[70:71],s[54:55]
v_cvt_pk_bf16_f32 v120,v64,v65
v_cvt_pk_bf16_f32 v121,v66,v67
v_cvt_pk_bf16_f32 v122,v68,v69
v_cvt_pk_bf16_f32 v123,v70,v71
v_accvgpr_read_b32 v72,a104
v_accvgpr_read_b32 v73,a105
v_accvgpr_read_b32 v74,a106
v_accvgpr_read_b32 v75,a107
v_accvgpr_read_b32 v76,a120
v_accvgpr_read_b32 v77,a121
v_accvgpr_read_b32 v78,a122
v_accvgpr_read_b32 v79,a123
v_pk_mul_f32 v[72:73],v[72:73],s[54:55]
v_pk_mul_f32 v[74:75],v[74:75],s[54:55]
v_pk_mul_f32 v[76:77],v[76:77],s[54:55]
v_pk_mul_f32 v[78:79],v[78:79],s[54:55]
v_cvt_pk_bf16_f32 v124,v72,v73
v_cvt_pk_bf16_f32 v125,v74,v75
v_cvt_pk_bf16_f32 v126,v76,v77
v_cvt_pk_bf16_f32 v127,v78,v79
v_accvgpr_read_b32 v48,a12
v_accvgpr_read_b32 v49,a13
v_accvgpr_read_b32 v50,a14
v_accvgpr_read_b32 v51,a15
v_accvgpr_read_b32 v52,a28
v_accvgpr_read_b32 v53,a29
v_accvgpr_read_b32 v54,a30
v_accvgpr_read_b32 v55,a31
v_pk_mul_f32 v[48:49],v[48:49],s[54:55]
v_pk_mul_f32 v[50:51],v[50:51],s[54:55]
v_pk_mul_f32 v[52:53],v[52:53],s[54:55]
v_pk_mul_f32 v[54:55],v[54:55],s[54:55]
v_cvt_pk_bf16_f32 v128,v48,v49
v_cvt_pk_bf16_f32 v129,v50,v51
v_cvt_pk_bf16_f32 v130,v52,v53
v_cvt_pk_bf16_f32 v131,v54,v55
v_accvgpr_read_b32 v56,a44
v_accvgpr_read_b32 v57,a45
v_accvgpr_read_b32 v58,a46
v_accvgpr_read_b32 v59,a47
v_accvgpr_read_b32 v60,a60
v_accvgpr_read_b32 v61,a61
v_accvgpr_read_b32 v62,a62
v_accvgpr_read_b32 v63,a63
v_pk_mul_f32 v[56:57],v[56:57],s[54:55]
v_pk_mul_f32 v[58:59],v[58:59],s[54:55]
v_pk_mul_f32 v[60:61],v[60:61],s[54:55]
v_pk_mul_f32 v[62:63],v[62:63],s[54:55]
v_cvt_pk_bf16_f32 v132,v56,v57
v_cvt_pk_bf16_f32 v133,v58,v59
v_cvt_pk_bf16_f32 v134,v60,v61
v_cvt_pk_bf16_f32 v135,v62,v63
v_accvgpr_read_b32 v64,a76
v_accvgpr_read_b32 v65,a77
v_accvgpr_read_b32 v66,a78
v_accvgpr_read_b32 v67,a79
v_accvgpr_read_b32 v68,a92
v_accvgpr_read_b32 v69,a93
v_accvgpr_read_b32 v70,a94
v_accvgpr_read_b32 v71,a95
v_pk_mul_f32 v[64:65],v[64:65],s[54:55]
v_pk_mul_f32 v[66:67],v[66:67],s[54:55]
v_pk_mul_f32 v[68:69],v[68:69],s[54:55]
v_pk_mul_f32 v[70:71],v[70:71],s[54:55]
v_cvt_pk_bf16_f32 v136,v64,v65
v_cvt_pk_bf16_f32 v137,v66,v67
v_cvt_pk_bf16_f32 v138,v68,v69
v_cvt_pk_bf16_f32 v139,v70,v71
v_accvgpr_read_b32 v72,a108
v_accvgpr_read_b32 v73,a109
v_accvgpr_read_b32 v74,a110
v_accvgpr_read_b32 v75,a111
v_accvgpr_read_b32 v76,a124
v_accvgpr_read_b32 v77,a125
v_accvgpr_read_b32 v78,a126
v_accvgpr_read_b32 v79,a127
v_pk_mul_f32 v[72:73],v[72:73],s[54:55]
v_pk_mul_f32 v[74:75],v[74:75],s[54:55]
v_pk_mul_f32 v[76:77],v[76:77],s[54:55]
v_pk_mul_f32 v[78:79],v[78:79],s[54:55]
v_cvt_pk_bf16_f32 v140,v72,v73
v_cvt_pk_bf16_f32 v141,v74,v75
v_cvt_pk_bf16_f32 v142,v76,v77
v_cvt_pk_bf16_f32 v143,v78,v79
L_att_entry:
v_and_b32 v24,15,v2
v_lshrrev_b32 v25,4,v2
v_bfe_u32 v26,v2,2,2
v_lshrrev_b32 v27,1,v25
v_xor_b32 v27,v27,v26
v_lshlrev_b32 v24,6,v24
v_lshl_add_u32 v24,v27,4,v24
v_and_b32 v27,1,v25
v_lshl_add_u32 v13,v27,3,v24
v_xor_b32 v22,32,v13
s_waitcnt vmcnt(35)
s_barrier
ds_read_b64 a[128:129],v13 offset:0
ds_read_b64 a[130:131],v22 offset:0
ds_read_b64 a[132:133],v13 offset:4096
ds_read_b64 a[134:135],v22 offset:4096
ds_read_b64 a[136:137],v13 offset:8192
ds_read_b64 a[138:139],v22 offset:8192
ds_read_b64 a[140:141],v13 offset:12288
ds_read_b64 a[142:143],v22 offset:12288
ds_read_b64 a[144:145],v13 offset:1024
ds_read_b64 a[146:147],v22 offset:1024
ds_read_b64 a[148:149],v13 offset:5120
ds_read_b64 a[150:151],v22 offset:5120
ds_read_b64 a[152:153],v13 offset:9216
ds_read_b64 a[154:155],v22 offset:9216
v_mov_b32 v208,0
v_mov_b32 v209,0
v_mov_b32 v210,0
v_mov_b32 v211,0
s_nop 1
v_mfma_f32_32x32x16_bf16 a[0:15],v[208:211],v[208:211],0
v_lshl_add_u32 v26,v25,2,v26
v_lshlrev_b32 v26,6,v26
v_and_b32 v27,1,v25
v_lshl_add_u32 v26,v27,5,v26
v_and_b32 v27,3,v2
v_mfma_f32_32x32x16_bf16 a[16:31],v[208:211],v[208:211],0
v_lshl_add_u32 v26,v27,3,v26
v_add_u32 v14,16384,v26
v_xor_b32 v15,32,v14
v_lshlrev_b32 v31,2,v27
v_and_b32 v27,7,v2
v_mfma_f32_32x32x16_bf16 a[32:47],v[208:211],v[208:211],0
v_lshlrev_b32 v30,2,v27
v_mov_b32 v16,0x3f803f80
v_accvgpr_write_b32 a176,v16
v_accvgpr_write_b32 a177,v16
v_accvgpr_write_b32 a178,v16
v_mfma_f32_32x32x16_bf16 a[48:63],v[208:211],v[208:211],0
v_accvgpr_write_b32 a179,v16
v_mfma_f32_32x32x16_bf16 a[64:79],v[208:211],v[208:211],0
s_lshl_b32 s54,s46,2
s_add_u32 s54,s54,s47
s_lshl_b32 s54,s54,7
s_add_u32 s85,s54,0x4202000
s_add_u32 s89,s54,0x4203000
s_lshl_b32 s55,s48,2
v_mfma_f32_32x32x16_bf16 a[80:95],v[208:211],v[208:211],0
s_add_u32 s83,s85,s55
s_add_u32 s84,s89,s55
v_lshrrev_b32 v0,1,v2
v_lshlrev_b32 v0,11,v0
v_and_b32 v27,1,v2
v_lshl_add_u32 v0,v27,7,v0
v_mfma_f32_32x32x16_bf16 a[96:111],v[208:211],v[208:211],0
s_add_u32 s54,s47,0
s_and_b32 s55,s54,1
s_bfe_u32 s54,s54,0x10001
s_lshl_b32 s54,s54,12
s_lshl_b32 s55,s55,10
s_add_u32 s54,s54,s55
v_mfma_f32_32x32x16_bf16 a[112:127],v[208:211],v[208:211],0
v_add_u32 v4,s54,v20
v_mfma_f32_32x32x16_bf16 a[160:175],v[208:211],v[208:211],0
s_add_u32 s54,s47,1
s_and_b32 s55,s54,1
s_bfe_u32 s54,s54,0x10001
s_lshl_b32 s54,s54,12
s_lshl_b32 s55,s55,10
s_add_u32 s54,s54,s55
s_waitcnt lgkmcnt(6)
v_mfma_f32_16x16x32_bf16 v[144:147],a[128:131],v[80:83],0
ds_read_b64 a[156:157],v13 offset:13312
v_add_u32 v5,s54,v20
v_mfma_f32_16x16x32_bf16 v[148:151],a[128:131],v[96:99],0
s_add_u32 s54,s47,2
s_and_b32 s55,s54,1
v_mfma_f32_16x16x32_bf16 v[152:155],a[128:131],v[112:115],0
ds_read_b64 a[158:159],v22 offset:13312
s_bfe_u32 s54,s54,0x10001
v_mfma_f32_16x16x32_bf16 v[156:159],a[128:131],v[128:131],0
s_lshl_b32 s54,s54,12
s_lshl_b32 s55,s55,10
v_mfma_f32_16x16x32_bf16 v[156:159],a[132:135],v[132:135],v[156:159]
ds_read_b64 a[128:129],v13 offset:2048
s_add_u32 s54,s54,s55
v_mfma_f32_16x16x32_bf16 v[152:155],a[132:135],v[116:119],v[152:155]
v_add_u32 v6,s54,v20
v_mfma_f32_16x16x32_bf16 v[148:151],a[132:135],v[100:103],v[148:151]
ds_read_b64 a[130:131],v22 offset:2048
s_add_u32 s54,s47,3
v_mfma_f32_16x16x32_bf16 v[144:147],a[132:135],v[84:87],v[144:147]
s_and_b32 s55,s54,1
s_bfe_u32 s54,s54,0x10001
v_mfma_f32_16x16x32_bf16 v[144:147],a[136:139],v[88:91],v[144:147]
ds_read_b64 a[132:133],v13 offset:6144
s_lshl_b32 s54,s54,12
v_mfma_f32_16x16x32_bf16 v[148:151],a[136:139],v[104:107],v[148:151]
s_lshl_b32 s55,s55,10
s_add_u32 s54,s54,s55
v_mfma_f32_16x16x32_bf16 v[152:155],a[136:139],v[120:123],v[152:155]
ds_read_b64 a[134:135],v22 offset:6144
v_add_u32 v7,s54,v20
v_mfma_f32_16x16x32_bf16 v[156:159],a[136:139],v[136:139],v[156:159]
s_and_b32 s54,s46,3
s_lshl_b32 s55,s44,2
v_mfma_f32_16x16x32_bf16 v[156:159],a[140:143],v[140:143],v[156:159]
ds_read_b64 a[136:137],v13 offset:10240
s_add_u32 s54,s54,s55
v_mfma_f32_16x16x32_bf16 v[152:155],a[140:143],v[124:127],v[152:155]
s_lshl_b32 s54,s54,15
s_lshl_b32 s55,s48,8
v_mfma_f32_16x16x32_bf16 v[148:151],a[140:143],v[108:111],v[148:151]
ds_read_b64 a[138:139],v22 offset:10240
s_add_u32 s54,s54,s55
v_mfma_f32_16x16x32_bf16 v[144:147],a[140:143],v[92:95],v[144:147]
v_add_u32 v0,s54,v0
v_mov_b32 v27,0x7ff00000
s_waitcnt lgkmcnt(6)
v_mfma_f32_16x16x32_bf16 v[160:163],a[144:147],v[80:83],0
ds_read_b64 a[140:141],v13 offset:14336
v_cmp_gt_u32 vcc,32,v2
v_mfma_f32_16x16x32_bf16 v[164:167],a[144:147],v[96:99],0
s_add_u32 s59,s52,0xfffc0000
s_mov_b32 s57,s53
v_mfma_f32_16x16x32_bf16 v[168:171],a[144:147],v[112:115],0
ds_read_b64 a[142:143],v22 offset:14336
v_cndmask_b32 v0,v27,v0,vcc
v_mfma_f32_16x16x32_bf16 v[172:175],a[144:147],v[128:131],0
s_lshl_b32 s87,s46,3
s_add_u32 s87,s87,s48
v_mfma_f32_16x16x32_bf16 v[172:175],a[148:151],v[132:135],v[172:175]
ds_read_b64 a[144:145],v13 offset:3072
s_mul_i32 s80,s47,0x380000
v_mfma_f32_16x16x32_bf16 v[168:171],a[148:151],v[116:119],v[168:171]
s_add_u32 s80,s80,0x400000
s_mov_b32 s86,131072
v_mfma_f32_16x16x32_bf16 v[164:167],a[148:151],v[100:103],v[164:167]
ds_read_b64 a[146:147],v22 offset:3072
s_mov_b32 s93,0xfffe0000
v_mfma_f32_16x16x32_bf16 v[160:163],a[148:151],v[84:87],v[160:163]
s_mov_b32 s94,0x8000
s_mov_b32 s58,s52
v_mfma_f32_16x16x32_bf16 v[160:163],a[152:155],v[88:91],v[160:163]
ds_read_b64 a[148:149],v13 offset:7168
v_mfma_f32_16x16x32_bf16 v[164:167],a[152:155],v[104:107],v[164:167]
v_mfma_f32_16x16x32_bf16 v[168:171],a[152:155],v[120:123],v[168:171]
ds_read_b64 a[150:151],v22 offset:7168
v_mfma_f32_16x16x32_bf16 v[172:175],a[152:155],v[136:139],v[172:175]
v_mfma_f32_16x16x32_bf16 v[172:175],a[156:159],v[140:143],v[172:175]
ds_read_b64 a[152:153],v13 offset:11264
v_mfma_f32_16x16x32_bf16 v[168:171],a[156:159],v[124:127],v[168:171]
v_mfma_f32_16x16x32_bf16 v[164:167],a[156:159],v[108:111],v[164:167]
ds_read_b64 a[154:155],v22 offset:11264
v_mfma_f32_16x16x32_bf16 v[160:163],a[156:159],v[92:95],v[160:163]
s_cmp_lg_u32 s95,0
s_cbranch_scc1 L_havemax
v_max3_f32 v67,v156,v157,v158
v_max3_f32 v66,v152,v153,v154
v_max3_f32 v65,v148,v149,v150
v_max3_f32 v64,v144,v145,v146
v_max3_f32 v67,v67,v159,v172
v_max3_f32 v66,v66,v155,v168
v_max3_f32 v65,v65,v151,v164
v_max3_f32 v64,v64,v147,v160
v_max3_f32 v67,v67,v173,v174
v_max3_f32 v66,v66,v169,v170
v_max3_f32 v65,v65,v165,v166
v_max3_f32 v64,v64,v161,v162
v_max_f32 v67,v67,v175
v_max_f32 v66,v66,v171
v_max_f32 v65,v65,v167
v_max_f32 v64,v64,v163
v_mov_b32 v68,v64
v_mov_b32 v69,v65
v_mov_b32 v70,v66
v_mov_b32 v71,v67
v_permlane16_swap_b32 v64,v68
v_permlane16_swap_b32 v65,v69
v_permlane16_swap_b32 v66,v70
v_permlane16_swap_b32 v67,v71
v_max_f32 v64,v64,v68
v_max_f32 v65,v65,v69
v_max_f32 v66,v66,v70
v_max_f32 v67,v67,v71
v_mov_b32 v68,v64
v_mov_b32 v69,v65
v_mov_b32 v70,v66
v_mov_b32 v71,v67
v_permlane32_swap_b32 v64,v68
v_permlane32_swap_b32 v65,v69
v_permlane32_swap_b32 v66,v70
v_permlane32_swap_b32 v67,v71
v_max_f32 v64,v64,v68
v_max_f32 v65,v65,v69
v_max_f32 v66,v66,v70
v_max_f32 v67,v67,v71
L_havemax:
v_sub_f32 v48,0,v64
v_sub_f32 v49,0,v64
v_sub_f32 v50,0,v64
v_sub_f32 v51,0,v64
v_sub_f32 v52,0,v65
v_sub_f32 v53,0,v65
v_sub_f32 v54,0,v65
v_sub_f32 v55,0,v65
v_sub_f32 v56,0,v66
v_sub_f32 v57,0,v66
v_sub_f32 v58,0,v66
v_sub_f32 v59,0,v66
v_sub_f32 v60,0,v67
v_sub_f32 v61,0,v67
v_sub_f32 v62,0,v67
v_sub_f32 v63,0,v67
s_waitcnt lgkmcnt(6)
v_mfma_f32_16x16x32_bf16 v[176:179],a[128:131],v[80:83],v[48:51]
ds_read_b64 a[156:157],v13 offset:15360
v_add_f32 v156,v156,v60
v_add_f32 v157,v157,v60
v_exp_f32 v156,v156
v_mfma_f32_16x16x32_bf16 v[180:183],a[128:131],v[96:99],v[52:55]
v_add_f32 v158,v158,v60
v_exp_f32 v157,v157
v_mfma_f32_16x16x32_bf16 v[184:187],a[128:131],v[112:115],v[56:59]
ds_read_b64 a[158:159],v22 offset:15360
v_add_f32 v159,v159,v60
v_exp_f32 v158,v158
v_mfma_f32_16x16x32_bf16 v[188:191],a[128:131],v[128:131],v[60:63]
v_add_f32 v152,v152,v56
v_exp_f32 v159,v159
v_cvt_pk_bf16_f32 v220,v156,v157
v_mfma_f32_16x16x32_bf16 v[188:191],a[132:135],v[132:135],v[188:191]
ds_read_b64_tr_b16 a[128:129],v14 offset:0
v_add_f32 v153,v153,v56
v_exp_f32 v152,v152
v_mfma_f32_16x16x32_bf16 v[184:187],a[132:135],v[116:119],v[184:187]
v_add_f32 v154,v154,v56
v_exp_f32 v153,v153
v_cvt_pk_bf16_f32 v221,v158,v159
v_mfma_f32_16x16x32_bf16 v[180:183],a[132:135],v[100:103],v[180:183]
ds_read_b64_tr_b16 a[130:131],v14 offset:1024
v_add_f32 v155,v155,v56
v_exp_f32 v154,v154
v_mfma_f32_16x16x32_bf16 v[176:179],a[132:135],v[84:87],v[176:179]
v_add_f32 v148,v148,v52
v_exp_f32 v155,v155
v_cvt_pk_bf16_f32 v216,v152,v153
v_add_f32 v149,v149,v52
v_exp_f32 v148,v148
v_mfma_f32_16x16x32_bf16 v[176:179],a[136:139],v[88:91],v[176:179]
ds_read_b64_tr_b16 a[132:133],v15 offset:0
v_add_f32 v150,v150,v52
v_exp_f32 v149,v149
v_cvt_pk_bf16_f32 v217,v154,v155
v_mfma_f32_16x16x32_bf16 v[180:183],a[136:139],v[104:107],v[180:183]
v_add_f32 v151,v151,v52
v_exp_f32 v150,v150
v_mfma_f32_16x16x32_bf16 v[184:187],a[136:139],v[120:123],v[184:187]
ds_read_b64_tr_b16 a[134:135],v15 offset:1024
v_add_f32 v144,v144,v48
v_exp_f32 v151,v151
v_cvt_pk_bf16_f32 v212,v148,v149
v_mfma_f32_16x16x32_bf16 v[188:191],a[136:139],v[136:139],v[188:191]
v_add_f32 v145,v145,v48
v_exp_f32 v144,v144
v_mfma_f32_16x16x32_bf16 v[188:191],a[140:143],v[140:143],v[188:191]
ds_read_b64_tr_b16 a[136:137],v14 offset:4096
v_add_f32 v146,v146,v48
v_exp_f32 v145,v145
v_cvt_pk_bf16_f32 v213,v150,v151
v_mfma_f32_16x16x32_bf16 v[184:187],a[140:143],v[124:127],v[184:187]
v_add_f32 v147,v147,v48
v_exp_f32 v146,v146
v_mfma_f32_16x16x32_bf16 v[180:183],a[140:143],v[108:111],v[180:183]
ds_read_b64_tr_b16 a[138:139],v14 offset:5120
v_add_f32 v172,v172,v60
v_exp_f32 v147,v147
v_cvt_pk_bf16_f32 v208,v144,v145
v_mfma_f32_16x16x32_bf16 v[176:179],a[140:143],v[92:95],v[176:179]
v_add_f32 v173,v173,v60
v_exp_f32 v172,v172
v_add_f32 v174,v174,v60
v_exp_f32 v173,v173
v_cvt_pk_bf16_f32 v209,v146,v147
s_waitcnt lgkmcnt(6)
v_mfma_f32_16x16x32_bf16 v[192:195],a[144:147],v[80:83],v[48:51]
ds_read_b64_tr_b16 a[140:141],v15 offset:4096
v_add_f32 v175,v175,v60
v_exp_f32 v174,v174
v_mfma_f32_16x16x32_bf16 v[196:199],a[144:147],v[96:99],v[52:55]
v_add_f32 v168,v168,v56
v_exp_f32 v175,v175
v_cvt_pk_bf16_f32 v222,v172,v173
v_exp_f32 v188,v188
v_mfma_f32_16x16x32_bf16 v[200:203],a[144:147],v[112:115],v[56:59]
ds_read_b64_tr_b16 a[142:143],v15 offset:5120
v_add_f32 v169,v169,v56
v_exp_f32 v168,v168
v_mfma_f32_16x16x32_bf16 v[204:207],a[144:147],v[128:131],v[60:63]
v_add_f32 v170,v170,v56
v_exp_f32 v169,v169
v_cvt_pk_bf16_f32 v223,v174,v175
v_exp_f32 v189,v189
v_mfma_f32_16x16x32_bf16 v[204:207],a[148:151],v[132:135],v[204:207]
ds_read_b64_tr_b16 a[144:145],v14 offset:8192
v_add_f32 v171,v171,v56
v_exp_f32 v170,v170
v_add_u32 v13,0x8000,v13
v_mfma_f32_16x16x32_bf16 v[200:203],a[148:151],v[116:119],v[200:203]
v_add_f32 v164,v164,v52
v_exp_f32 v171,v171
v_cvt_pk_bf16_f32 v218,v168,v169
v_exp_f32 v190,v190
v_mfma_f32_16x16x32_bf16 v[196:199],a[148:151],v[100:103],v[196:199]
ds_read_b64_tr_b16 a[146:147],v14 offset:9216
v_add_f32 v165,v165,v52
v_exp_f32 v164,v164
v_add_f32 v166,v166,v52
v_exp_f32 v165,v165
v_cvt_pk_bf16_f32 v219,v170,v171
v_cvt_pk_bf16_f32 v236,v188,v189
v_mfma_f32_16x16x32_bf16 v[192:195],a[148:151],v[84:87],v[192:195]
v_add_f32 v167,v167,v52
v_exp_f32 v166,v166
v_exp_f32 v191,v191
v_mfma_f32_16x16x32_bf16 v[192:195],a[152:155],v[88:91],v[192:195]
ds_read_b64_tr_b16 a[148:149],v15 offset:8192
s_waitcnt vmcnt(31)
s_barrier
v_add_f32 v160,v160,v48
v_exp_f32 v167,v167
v_cvt_pk_bf16_f32 v214,v164,v165
v_add_u32 v22,0x8000,v22
v_mfma_f32_16x16x32_bf16 v[196:199],a[152:155],v[104:107],v[196:199]
v_add_f32 v161,v161,v48
v_exp_f32 v160,v160
v_exp_f32 v184,v184
v_mfma_f32_16x16x32_bf16 v[200:203],a[152:155],v[120:123],v[200:203]
ds_read_b64_tr_b16 a[150:151],v15 offset:9216
v_add_f32 v162,v162,v48
v_exp_f32 v161,v161
v_cvt_pk_bf16_f32 v215,v166,v167
v_cvt_pk_bf16_f32 v237,v190,v191
v_mfma_f32_16x16x32_bf16 v[204:207],a[152:155],v[136:139],v[204:207]
v_add_f32 v163,v163,v48
v_exp_f32 v162,v162
v_exp_f32 v185,v185
v_mfma_f32_16x16x32_bf16 v[204:207],a[156:159],v[140:143],v[204:207]
ds_read_b64_tr_b16 a[152:153],v14 offset:12288
v_exp_f32 v163,v163
v_cvt_pk_bf16_f32 v210,v160,v161
v_mfma_f32_16x16x32_bf16 v[200:203],a[156:159],v[124:127],v[200:203]
v_cvt_pk_bf16_f32 v211,v162,v163
v_exp_f32 v186,v186
v_mfma_f32_16x16x32_bf16 v[196:199],a[156:159],v[108:111],v[196:199]
ds_read_b64_tr_b16 a[154:155],v14 offset:13312
v_cvt_pk_bf16_f32 v232,v184,v185
v_mfma_f32_16x16x32_bf16 v[192:195],a[156:159],v[92:95],v[192:195]
v_exp_f32 v187,v187
s_mov_b32 s56,4
L_attA:
s_waitcnt lgkmcnt(6)
v_mfma_f32_16x16x32_bf16 a[0:3],a[128:131],v[208:211],a[0:3]
ds_read_b64_tr_b16 a[156:157],v15 offset:12288
v_mfma_f32_16x16x32_bf16 a[32:35],a[128:131],v[212:215],a[32:35]
v_exp_f32 v180,v180
v_mfma_f32_16x16x32_bf16 a[64:67],a[128:131],v[216:219],a[64:67]
ds_read_b64_tr_b16 a[158:159],v15 offset:13312
v_cvt_pk_bf16_f32 v233,v186,v187
v_mfma_f32_16x16x32_bf16 a[96:99],a[128:131],v[220:223],a[96:99]
v_exp_f32 v181,v181
v_mfma_f32_16x16x32_bf16 a[100:103],a[132:135],v[220:223],a[100:103]
ds_read_b64 a[128:129],v13 offset:0
s_add_u32 s88,s86,s91
s_add_u32 m0,s88,0
v_mfma_f32_16x16x32_bf16 a[68:71],a[132:135],v[216:219],a[68:71]
v_exp_f32 v182,v182
v_mfma_f32_16x16x32_bf16 a[36:39],a[132:135],v[212:215],a[36:39]
ds_read_b64 a[130:131],v22 offset:0
v_cvt_pk_bf16_f32 v228,v180,v181
v_mfma_f32_16x16x32_bf16 a[4:7],a[132:135],v[208:211],a[4:7]
v_exp_f32 v183,v183
v_mfma_f32_16x16x32_bf16 a[8:11],a[136:139],v[208:211],a[8:11]
ds_read_b64 a[132:133],v13 offset:4096
buffer_load_dwordx4 v11,s[20:23],s51 offen offset:0 lds
v_mfma_f32_16x16x32_bf16 a[40:43],a[136:139],v[212:215],a[40:43]
v_exp_f32 v176,v176
v_mfma_f32_16x16x32_bf16 a[72:75],a[136:139],v[216:219],a[72:75]
ds_read_b64 a[134:135],v22 offset:4096
v_cvt_pk_bf16_f32 v229,v182,v183
v_mfma_f32_16x16x32_bf16 a[104:107],a[136:139],v[220:223],a[104:107]
v_exp_f32 v177,v177
v_mfma_f32_16x16x32_bf16 a[108:111],a[140:143],v[220:223],a[108:111]
ds_read_b64 a[136:137],v13 offset:8192
s_add_u32 m0,s88,4032
v_mfma_f32_16x16x32_bf16 a[76:79],a[140:143],v[216:219],a[76:79]
v_exp_f32 v178,v178
v_mfma_f32_16x16x32_bf16 a[44:47],a[140:143],v[212:215],a[44:47]
ds_read_b64 a[138:139],v22 offset:8192
v_cvt_pk_bf16_f32 v224,v176,v177
v_mfma_f32_16x16x32_bf16 a[12:15],a[140:143],v[208:211],a[12:15]
v_exp_f32 v179,v179
s_waitcnt lgkmcnt(6)
v_mfma_f32_16x16x32_bf16 a[16:19],a[144:147],v[208:211],a[16:19]
ds_read_b64 a[140:141],v13 offset:12288
buffer_load_dwordx4 v11,s[20:23],s51 offen offset:64 lds
v_mfma_f32_16x16x32_bf16 a[48:51],a[144:147],v[212:215],a[48:51]
v_exp_f32 v204,v204
v_mfma_f32_16x16x32_bf16 a[80:83],a[144:147],v[216:219],a[80:83]
ds_read_b64 a[142:143],v22 offset:12288
v_cvt_pk_bf16_f32 v225,v178,v179
v_mfma_f32_16x16x32_bf16 a[112:115],a[144:147],v[220:223],a[112:115]
v_exp_f32 v205,v205
v_mfma_f32_16x16x32_bf16 a[116:119],a[148:151],v[220:223],a[116:119]
ds_read_b64 a[144:145],v13 offset:1024
v_mfma_f32_16x16x32_bf16 a[84:87],a[148:151],v[216:219],a[84:87]
v_exp_f32 v206,v206
v_mfma_f32_16x16x32_bf16 a[52:55],a[148:151],v[212:215],a[52:55]
ds_read_b64 a[146:147],v22 offset:1024
v_cvt_pk_bf16_f32 v238,v204,v205
v_mfma_f32_16x16x32_bf16 a[20:23],a[148:151],v[208:211],a[20:23]
v_exp_f32 v207,v207
v_mfma_f32_16x16x32_bf16 a[24:27],a[152:155],v[208:211],a[24:27]
ds_read_b64 a[148:149],v13 offset:5120
s_add_u32 m0,s88,8064
v_mfma_f32_16x16x32_bf16 a[56:59],a[152:155],v[212:215],a[56:59]
v_exp_f32 v200,v200
v_mfma_f32_16x16x32_bf16 a[88:91],a[152:155],v[216:219],a[88:91]
ds_read_b64 a[150:151],v22 offset:5120
v_cvt_pk_bf16_f32 v239,v206,v207
v_mfma_f32_16x16x32_bf16 a[120:123],a[152:155],v[220:223],a[120:123]
v_exp_f32 v201,v201
v_mfma_f32_16x16x32_bf16 a[124:127],a[156:159],v[220:223],a[124:127]
ds_read_b64 a[152:153],v13 offset:9216
buffer_load_dwordx4 v11,s[20:23],s51 offen offset:128 lds
v_mfma_f32_16x16x32_bf16 a[92:95],a[156:159],v[216:219],a[92:95]
v_exp_f32 v202,v202
v_mfma_f32_16x16x32_bf16 a[60:63],a[156:159],v[212:215],a[60:63]
ds_read_b64 a[154:155],v22 offset:9216
v_cvt_pk_bf16_f32 v234,v200,v201
v_mfma_f32_16x16x32_bf16 a[28:31],a[156:159],v[208:211],a[28:31]
v_exp_f32 v203,v203
v_mfma_f32_16x16x32_bf16 a[160:163],a[176:179],v[208:211],a[160:163]
s_cmp_le_u32 s56,2
s_cselect_b32 s54,s59,s66
s_add_u32 m0,s88,12096
v_mfma_f32_16x16x32_bf16 a[164:167],a[176:179],v[212:215],a[164:167]
v_exp_f32 v196,v196
v_mfma_f32_16x16x32_bf16 a[168:171],a[176:179],v[216:219],a[168:171]
v_cvt_pk_bf16_f32 v235,v202,v203
v_mfma_f32_16x16x32_bf16 a[172:175],a[176:179],v[220:223],a[172:175]
v_exp_f32 v197,v197
s_waitcnt lgkmcnt(6)
v_mfma_f32_16x16x32_bf16 v[144:147],a[128:131],v[80:83],v[48:51]
ds_read_b64 a[156:157],v13 offset:13312
buffer_load_dwordx4 v11,s[20:23],s51 offen offset:192 lds
v_mfma_f32_16x16x32_bf16 v[148:151],a[128:131],v[96:99],v[52:55]
v_exp_f32 v198,v198
v_mfma_f32_16x16x32_bf16 v[152:155],a[128:131],v[112:115],v[56:59]
ds_read_b64 a[158:159],v22 offset:13312
v_cvt_pk_bf16_f32 v230,v196,v197
v_mfma_f32_16x16x32_bf16 v[156:159],a[128:131],v[128:131],v[60:63]
v_exp_f32 v199,v199
v_mfma_f32_16x16x32_bf16 v[156:159],a[132:135],v[132:135],v[156:159]
ds_read_b64_tr_b16 a[128:129],v14 offset:2048
v_mfma_f32_16x16x32_bf16 v[152:155],a[132:135],v[116:119],v[152:155]
v_exp_f32 v192,v192
v_mfma_f32_16x16x32_bf16 v[148:151],a[132:135],v[100:103],v[148:151]
ds_read_b64_tr_b16 a[130:131],v14 offset:3072
v_cvt_pk_bf16_f32 v231,v198,v199
v_mfma_f32_16x16x32_bf16 v[144:147],a[132:135],v[84:87],v[144:147]
v_exp_f32 v193,v193
v_mfma_f32_16x16x32_bf16 v[144:147],a[136:139],v[88:91],v[144:147]
ds_read_b64_tr_b16 a[132:133],v15 offset:2048
s_add_u32 m0,s88,16384
v_mfma_f32_16x16x32_bf16 v[148:151],a[136:139],v[104:107],v[148:151]
v_exp_f32 v194,v194
v_mfma_f32_16x16x32_bf16 v[152:155],a[136:139],v[120:123],v[152:155]
ds_read_b64_tr_b16 a[134:135],v15 offset:3072
v_cvt_pk_bf16_f32 v226,v192,v193
v_mfma_f32_16x16x32_bf16 v[156:159],a[136:139],v[136:139],v[156:159]
v_exp_f32 v195,v195
v_mfma_f32_16x16x32_bf16 v[156:159],a[140:143],v[140:143],v[156:159]
ds_read_b64_tr_b16 a[136:137],v14 offset:6144
buffer_load_dwordx4 v12,s[24:27],s51 offen offset:0 lds
v_mfma_f32_16x16x32_bf16 v[152:155],a[140:143],v[124:127],v[152:155]
v_mfma_f32_16x16x32_bf16 v[148:151],a[140:143],v[108:111],v[148:151]
ds_read_b64_tr_b16 a[138:139],v14 offset:7168
v_cvt_pk_bf16_f32 v227,v194,v195
v_mfma_f32_16x16x32_bf16 v[144:147],a[140:143],v[92:95],v[144:147]
s_cmp_eq_u32 s56,1
s_cselect_b32 s55,s93,s94
s_waitcnt lgkmcnt(6)
v_mfma_f32_16x16x32_bf16 v[160:163],a[144:147],v[80:83],v[48:51]
ds_read_b64_tr_b16 a[140:141],v15 offset:6144
v_mfma_f32_16x16x32_bf16 v[164:167],a[144:147],v[96:99],v[52:55]
v_exp_f32 v156,v156
v_mfma_f32_16x16x32_bf16 v[168:171],a[144:147],v[112:115],v[56:59]
ds_read_b64_tr_b16 a[142:143],v15 offset:7168
v_mfma_f32_16x16x32_bf16 v[172:175],a[144:147],v[128:131],v[60:63]
v_exp_f32 v157,v157
v_mfma_f32_16x16x32_bf16 v[172:175],a[148:151],v[132:135],v[172:175]
ds_read_b64_tr_b16 a[144:145],v14 offset:10240
s_add_u32 m0,s88,20416
v_mfma_f32_16x16x32_bf16 v[168:171],a[148:151],v[116:119],v[168:171]
v_exp_f32 v158,v158
v_mfma_f32_16x16x32_bf16 v[164:167],a[148:151],v[100:103],v[164:167]
ds_read_b64_tr_b16 a[146:147],v14 offset:11264
v_cvt_pk_bf16_f32 v220,v156,v157
v_mfma_f32_16x16x32_bf16 v[160:163],a[148:151],v[84:87],v[160:163]
v_exp_f32 v159,v159
v_mfma_f32_16x16x32_bf16 v[160:163],a[152:155],v[88:91],v[160:163]
ds_read_b64_tr_b16 a[148:149],v15 offset:10240
buffer_load_dwordx4 v12,s[24:27],s51 offen offset:64 lds
v_mfma_f32_16x16x32_bf16 v[164:167],a[152:155],v[104:107],v[164:167]
v_exp_f32 v152,v152
v_mfma_f32_16x16x32_bf16 v[168:171],a[152:155],v[120:123],v[168:171]
ds_read_b64_tr_b16 a[150:151],v15 offset:11264
v_cvt_pk_bf16_f32 v221,v158,v159
v_mfma_f32_16x16x32_bf16 v[172:175],a[152:155],v[136:139],v[172:175]
v_exp_f32 v153,v153
v_mfma_f32_16x16x32_bf16 v[172:175],a[156:159],v[140:143],v[172:175]
ds_read_b64_tr_b16 a[152:153],v14 offset:14336
s_add_u32 m0,s88,24448
v_mfma_f32_16x16x32_bf16 v[168:171],a[156:159],v[124:127],v[168:171]
v_exp_f32 v154,v154
v_mfma_f32_16x16x32_bf16 v[164:167],a[156:159],v[108:111],v[164:167]
ds_read_b64_tr_b16 a[154:155],v14 offset:15360
v_cvt_pk_bf16_f32 v216,v152,v153
v_mfma_f32_16x16x32_bf16 v[160:163],a[156:159],v[92:95],v[160:163]
v_exp_f32 v155,v155
s_waitcnt lgkmcnt(6)
v_mfma_f32_16x16x32_bf16 a[0:3],a[128:131],v[224:227],a[0:3]
ds_read_b64_tr_b16 a[156:157],v15 offset:14336
buffer_load_dwordx4 v12,s[24:27],s51 offen offset:128 lds
v_mfma_f32_16x16x32_bf16 a[32:35],a[128:131],v[228:231],a[32:35]
v_exp_f32 v148,v148
v_mfma_f32_16x16x32_bf16 a[64:67],a[128:131],v[232:235],a[64:67]
ds_read_b64_tr_b16 a[158:159],v15 offset:15360
v_cvt_pk_bf16_f32 v217,v154,v155
v_mfma_f32_16x16x32_bf16 a[96:99],a[128:131],v[236:239],a[96:99]
v_exp_f32 v149,v149
v_mfma_f32_16x16x32_bf16 a[100:103],a[132:135],v[236:239],a[100:103]
ds_read_b64 a[128:129],v13 offset:2048
v_mfma_f32_16x16x32_bf16 a[68:71],a[132:135],v[232:235],a[68:71]
v_exp_f32 v150,v150
v_mfma_f32_16x16x32_bf16 a[36:39],a[132:135],v[228:231],a[36:39]
ds_read_b64 a[130:131],v22 offset:2048
v_cvt_pk_bf16_f32 v212,v148,v149
v_mfma_f32_16x16x32_bf16 a[4:7],a[132:135],v[224:227],a[4:7]
v_exp_f32 v151,v151
v_mfma_f32_16x16x32_bf16 a[8:11],a[136:139],v[224:227],a[8:11]
ds_read_b64 a[132:133],v13 offset:6144
s_add_u32 m0,s88,28480
v_mfma_f32_16x16x32_bf16 a[40:43],a[136:139],v[228:231],a[40:43]
v_exp_f32 v144,v144
v_mfma_f32_16x16x32_bf16 a[72:75],a[136:139],v[232:235],a[72:75]
ds_read_b64 a[134:135],v22 offset:6144
v_cvt_pk_bf16_f32 v213,v150,v151
v_mfma_f32_16x16x32_bf16 a[104:107],a[136:139],v[236:239],a[104:107]
v_exp_f32 v145,v145
v_mfma_f32_16x16x32_bf16 a[108:111],a[140:143],v[236:239],a[108:111]
ds_read_b64 a[136:137],v13 offset:10240
buffer_load_dwordx4 v12,s[24:27],s51 offen offset:192 lds
v_mfma_f32_16x16x32_bf16 a[76:79],a[140:143],v[232:235],a[76:79]
v_exp_f32 v146,v146
v_mfma_f32_16x16x32_bf16 a[44:47],a[140:143],v[228:231],a[44:47]
ds_read_b64 a[138:139],v22 offset:10240
v_cvt_pk_bf16_f32 v208,v144,v145
v_mfma_f32_16x16x32_bf16 a[12:15],a[140:143],v[224:227],a[12:15]
v_exp_f32 v147,v147
s_waitcnt lgkmcnt(6)
v_mfma_f32_16x16x32_bf16 a[16:19],a[144:147],v[224:227],a[16:19]
ds_read_b64 a[140:141],v13 offset:14336
s_add_u32 s51,s51,0x4000
v_mfma_f32_16x16x32_bf16 a[48:51],a[144:147],v[228:231],a[48:51]
v_exp_f32 v172,v172
v_mfma_f32_16x16x32_bf16 a[80:83],a[144:147],v[232:235],a[80:83]
ds_read_b64 a[142:143],v22 offset:14336
v_cvt_pk_bf16_f32 v209,v146,v147
v_mfma_f32_16x16x32_bf16 a[112:115],a[144:147],v[236:239],a[112:115]
v_exp_f32 v173,v173
v_mfma_f32_16x16x32_bf16 a[116:119],a[148:151],v[236:239],a[116:119]
ds_read_b64 a[144:145],v13 offset:3072
buffer_load_dword v47,v0,s[32:35],s54 offen
v_mfma_f32_16x16x32_bf16 a[84:87],a[148:151],v[232:235],a[84:87]
v_exp_f32 v174,v174
v_mfma_f32_16x16x32_bf16 a[52:55],a[148:151],v[228:231],a[52:55]
ds_read_b64 a[146:147],v22 offset:3072
v_cvt_pk_bf16_f32 v222,v172,v173
v_mfma_f32_16x16x32_bf16 a[20:23],a[148:151],v[224:227],a[20:23]
v_exp_f32 v175,v175
v_mfma_f32_16x16x32_bf16 a[24:27],a[152:155],v[224:227],a[24:27]
ds_read_b64 a[148:149],v13 offset:7168
v_mfma_f32_16x16x32_bf16 a[56:59],a[152:155],v[228:231],a[56:59]
v_exp_f32 v168,v168
v_mfma_f32_16x16x32_bf16 a[88:91],a[152:155],v[232:235],a[88:91]
ds_read_b64 a[150:151],v22 offset:7168
v_cvt_pk_bf16_f32 v223,v174,v175
v_mfma_f32_16x16x32_bf16 a[120:123],a[152:155],v[236:239],a[120:123]
v_exp_f32 v169,v169
v_mfma_f32_16x16x32_bf16 a[124:127],a[156:159],v[236:239],a[124:127]
ds_read_b64 a[152:153],v13 offset:11264
s_add_u32 s59,s59,0x80000
v_mfma_f32_16x16x32_bf16 a[92:95],a[156:159],v[232:235],a[92:95]
v_exp_f32 v170,v170
v_mfma_f32_16x16x32_bf16 a[60:63],a[156:159],v[228:231],a[60:63]
ds_read_b64 a[154:155],v22 offset:11264
v_cvt_pk_bf16_f32 v218,v168,v169
v_mfma_f32_16x16x32_bf16 a[28:31],a[156:159],v[224:227],a[28:31]
v_exp_f32 v171,v171
v_mfma_f32_16x16x32_bf16 a[160:163],a[176:179],v[224:227],a[160:163]
buffer_load_dword v24,v0,s[36:39],s57 offen
v_add_u32 v14,s94,v14
v_mfma_f32_16x16x32_bf16 a[164:167],a[176:179],v[228:231],a[164:167]
v_exp_f32 v164,v164
v_mfma_f32_16x16x32_bf16 a[168:171],a[176:179],v[232:235],a[168:171]
v_cvt_pk_bf16_f32 v219,v170,v171
v_mfma_f32_16x16x32_bf16 a[172:175],a[176:179],v[236:239],a[172:175]
v_exp_f32 v165,v165
s_waitcnt lgkmcnt(6)
v_mfma_f32_16x16x32_bf16 v[176:179],a[128:131],v[80:83],v[48:51]
ds_read_b64 a[156:157],v13 offset:15360
s_add_u32 s57,s57,0x80000
v_add_u32 v15,s94,v15
v_mfma_f32_16x16x32_bf16 v[180:183],a[128:131],v[96:99],v[52:55]
v_exp_f32 v166,v166
v_mfma_f32_16x16x32_bf16 v[184:187],a[128:131],v[112:115],v[56:59]
ds_read_b64 a[158:159],v22 offset:15360
v_cvt_pk_bf16_f32 v214,v164,v165
v_mfma_f32_16x16x32_bf16 v[188:191],a[128:131],v[128:131],v[60:63]
s_waitcnt vmcnt(10)
s_barrier
v_exp_f32 v167,v167
v_mfma_f32_16x16x32_bf16 v[188:191],a[132:135],v[132:135],v[188:191]
ds_read_b64_tr_b16 a[128:129],v14 offset:0
v_mfma_f32_16x16x32_bf16 v[184:187],a[132:135],v[116:119],v[184:187]
v_exp_f32 v160,v160
v_mfma_f32_16x16x32_bf16 v[180:183],a[132:135],v[100:103],v[180:183]
ds_read_b64_tr_b16 a[130:131],v14 offset:1024
v_cvt_pk_bf16_f32 v215,v166,v167
v_mfma_f32_16x16x32_bf16 v[176:179],a[132:135],v[84:87],v[176:179]
v_exp_f32 v161,v161
v_mfma_f32_16x16x32_bf16 v[176:179],a[136:139],v[88:91],v[176:179]
ds_read_b64_tr_b16 a[132:133],v15 offset:0
buffer_store_dword v46,v23,s[8:11],s83 offen sc1
v_mfma_f32_16x16x32_bf16 v[180:183],a[136:139],v[104:107],v[180:183]
v_exp_f32 v162,v162
v_mfma_f32_16x16x32_bf16 v[184:187],a[136:139],v[120:123],v[184:187]
ds_read_b64_tr_b16 a[134:135],v15 offset:1024
v_cvt_pk_bf16_f32 v210,v160,v161
v_mfma_f32_16x16x32_bf16 v[188:191],a[136:139],v[136:139],v[188:191]
v_exp_f32 v163,v163
v_mfma_f32_16x16x32_bf16 v[188:191],a[140:143],v[140:143],v[188:191]
ds_read_b64_tr_b16 a[136:137],v14 offset:4096
v_mfma_f32_16x16x32_bf16 v[184:187],a[140:143],v[124:127],v[184:187]
v_mfma_f32_16x16x32_bf16 v[180:183],a[140:143],v[108:111],v[180:183]
ds_read_b64_tr_b16 a[138:139],v14 offset:5120
v_cvt_pk_bf16_f32 v211,v162,v163
v_mfma_f32_16x16x32_bf16 v[176:179],a[140:143],v[92:95],v[176:179]
s_add_u32 s86,s86,0x8000
s_cmp_eq_u32 s86,163840
s_cselect_b32 s86,0,s86
s_waitcnt lgkmcnt(6)
v_mfma_f32_16x16x32_bf16 v[192:195],a[144:147],v[80:83],v[48:51]
ds_read_b64_tr_b16 a[140:141],v15 offset:4096
v_mfma_f32_16x16x32_bf16 v[196:199],a[144:147],v[96:99],v[52:55]
v_exp_f32 v188,v188
v_mfma_f32_16x16x32_bf16 v[200:203],a[144:147],v[112:115],v[56:59]
ds_read_b64_tr_b16 a[142:143],v15 offset:5120
v_mfma_f32_16x16x32_bf16 v[204:207],a[144:147],v[128:131],v[60:63]
v_exp_f32 v189,v189
v_mfma_f32_16x16x32_bf16 v[204:207],a[148:151],v[132:135],v[204:207]
ds_read_b64_tr_b16 a[144:145],v14 offset:8192
v_add_u32 v13,s55,v13
v_mfma_f32_16x16x32_bf16 v[200:203],a[148:151],v[116:119],v[200:203]
v_exp_f32 v190,v190
v_mfma_f32_16x16x32_bf16 v[196:199],a[148:151],v[100:103],v[196:199]
ds_read_b64_tr_b16 a[146:147],v14 offset:9216
v_cvt_pk_bf16_f32 v236,v188,v189
v_mfma_f32_16x16x32_bf16 v[192:195],a[148:151],v[84:87],v[192:195]
v_exp_f32 v191,v191
v_mfma_f32_16x16x32_bf16 v[192:195],a[152:155],v[88:91],v[192:195]
ds_read_b64_tr_b16 a[148:149],v15 offset:8192
v_add_u32 v22,s55,v22
v_mfma_f32_16x16x32_bf16 v[196:199],a[152:155],v[104:107],v[196:199]
v_exp_f32 v184,v184
v_mfma_f32_16x16x32_bf16 v[200:203],a[152:155],v[120:123],v[200:203]
ds_read_b64_tr_b16 a[150:151],v15 offset:9216
v_cvt_pk_bf16_f32 v237,v190,v191
v_mfma_f32_16x16x32_bf16 v[204:207],a[152:155],v[136:139],v[204:207]
v_exp_f32 v185,v185
v_mfma_f32_16x16x32_bf16 v[204:207],a[156:159],v[140:143],v[204:207]
ds_read_b64_tr_b16 a[152:153],v14 offset:12288
s_sub_u32 s56,s56,1
v_mfma_f32_16x16x32_bf16 v[200:203],a[156:159],v[124:127],v[200:203]
v_exp_f32 v186,v186
v_mfma_f32_16x16x32_bf16 v[196:199],a[156:159],v[108:111],v[196:199]
ds_read_b64_tr_b16 a[154:155],v14 offset:13312
s_cmp_lg_u32 s56,0
v_cvt_pk_bf16_f32 v232,v184,v185
v_mfma_f32_16x16x32_bf16 v[192:195],a[156:159],v[92:95],v[192:195]
v_exp_f32 v187,v187
s_cbranch_scc1 L_attA
v_mov_b32 v25,v28
s_add_u32 s59,s69,L_p2mid-L_pc
s_mov_b32 s56,3
L_attB:
s_waitcnt lgkmcnt(6)
v_mfma_f32_16x16x32_bf16 a[0:3],a[128:131],v[208:211],a[0:3]
ds_read_b64_tr_b16 a[156:157],v15 offset:12288
v_mfma_f32_16x16x32_bf16 a[32:35],a[128:131],v[212:215],a[32:35]
v_exp_f32 v180,v180
v_mfma_f32_16x16x32_bf16 a[64:67],a[128:131],v[216:219],a[64:67]
ds_read_b64_tr_b16 a[158:159],v15 offset:13312
v_cvt_pk_bf16_f32 v233,v186,v187
v_mfma_f32_16x16x32_bf16 a[96:99],a[128:131],v[220:223],a[96:99]
v_exp_f32 v181,v181
v_mfma_f32_16x16x32_bf16 a[100:103],a[132:135],v[220:223],a[100:103]
ds_read_b64 a[128:129],v13 offset:0
s_add_u32 s88,s86,s92
s_add_u32 m0,s88,0
v_mfma_f32_16x16x32_bf16 a[68:71],a[132:135],v[216:219],a[68:71]
v_exp_f32 v182,v182
v_mfma_f32_16x16x32_bf16 a[36:39],a[132:135],v[212:215],a[36:39]
ds_read_b64 a[130:131],v22 offset:0
v_cvt_pk_bf16_f32 v228,v180,v181
v_mfma_f32_16x16x32_bf16 a[4:7],a[132:135],v[208:211],a[4:7]
v_exp_f32 v183,v183
v_mfma_f32_16x16x32_bf16 a[8:11],a[136:139],v[208:211],a[8:11]
ds_read_b64 a[132:133],v13 offset:4096
buffer_load_dwordx4 v32,s[32:35],s58 offen lds
v_mfma_f32_16x16x32_bf16 a[40:43],a[136:139],v[212:215],a[40:43]
v_exp_f32 v176,v176
v_mfma_f32_16x16x32_bf16 a[72:75],a[136:139],v[216:219],a[72:75]
ds_read_b64 a[134:135],v22 offset:4096
v_cvt_pk_bf16_f32 v229,v182,v183
v_mfma_f32_16x16x32_bf16 a[104:107],a[136:139],v[220:223],a[104:107]
v_exp_f32 v177,v177
v_mfma_f32_16x16x32_bf16 a[108:111],a[140:143],v[220:223],a[108:111]
ds_read_b64 a[136:137],v13 offset:8192
v_mfma_f32_16x16x32_bf16 a[76:79],a[140:143],v[216:219],a[76:79]
v_exp_f32 v178,v178
v_mfma_f32_16x16x32_bf16 a[44:47],a[140:143],v[212:215],a[44:47]
ds_read_b64 a[138:139],v22 offset:8192
v_cvt_pk_bf16_f32 v224,v176,v177
v_mfma_f32_16x16x32_bf16 a[12:15],a[140:143],v[208:211],a[12:15]
v_exp_f32 v179,v179
s_waitcnt lgkmcnt(6)
v_mfma_f32_16x16x32_bf16 a[16:19],a[144:147],v[208:211],a[16:19]
ds_read_b64 a[140:141],v13 offset:12288
s_add_u32 m0,s88,1024
v_mfma_f32_16x16x32_bf16 a[48:51],a[144:147],v[212:215],a[48:51]
v_exp_f32 v204,v204
v_mfma_f32_16x16x32_bf16 a[80:83],a[144:147],v[216:219],a[80:83]
ds_read_b64 a[142:143],v22 offset:12288
v_cvt_pk_bf16_f32 v225,v178,v179
v_mfma_f32_16x16x32_bf16 a[112:115],a[144:147],v[220:223],a[112:115]
v_exp_f32 v205,v205
v_mfma_f32_16x16x32_bf16 a[116:119],a[148:151],v[220:223],a[116:119]
ds_read_b64 a[144:145],v13 offset:1024
buffer_load_dwordx4 v33,s[32:35],s58 offen lds
v_mfma_f32_16x16x32_bf16 a[84:87],a[148:151],v[216:219],a[84:87]
v_exp_f32 v206,v206
v_mfma_f32_16x16x32_bf16 a[52:55],a[148:151],v[212:215],a[52:55]
ds_read_b64 a[146:147],v22 offset:1024
v_cvt_pk_bf16_f32 v238,v204,v205
v_mfma_f32_16x16x32_bf16 a[20:23],a[148:151],v[208:211],a[20:23]
v_exp_f32 v207,v207
v_mfma_f32_16x16x32_bf16 a[24:27],a[152:155],v[208:211],a[24:27]
ds_read_b64 a[148:149],v13 offset:5120
s_add_u32 m0,s88,2048
v_mfma_f32_16x16x32_bf16 a[56:59],a[152:155],v[212:215],a[56:59]
v_exp_f32 v200,v200
v_mfma_f32_16x16x32_bf16 a[88:91],a[152:155],v[216:219],a[88:91]
ds_read_b64 a[150:151],v22 offset:5120
v_cvt_pk_bf16_f32 v239,v206,v207
v_mfma_f32_16x16x32_bf16 a[120:123],a[152:155],v[220:223],a[120:123]
v_exp_f32 v201,v201
v_mfma_f32_16x16x32_bf16 a[124:127],a[156:159],v[220:223],a[124:127]
ds_read_b64 a[152:153],v13 offset:9216
buffer_load_dwordx4 v34,s[32:35],s58 offen lds
v_mfma_f32_16x16x32_bf16 a[92:95],a[156:159],v[216:219],a[92:95]
v_exp_f32 v202,v202
v_mfma_f32_16x16x32_bf16 a[60:63],a[156:159],v[212:215],a[60:63]
ds_read_b64 a[154:155],v22 offset:9216
v_cvt_pk_bf16_f32 v234,v200,v201
v_mfma_f32_16x16x32_bf16 a[28:31],a[156:159],v[208:211],a[28:31]
v_exp_f32 v203,v203
v_mfma_f32_16x16x32_bf16 a[160:163],a[176:179],v[208:211],a[160:163]
v_mfma_f32_16x16x32_bf16 a[164:167],a[176:179],v[212:215],a[164:167]
v_exp_f32 v196,v196
v_mfma_f32_16x16x32_bf16 a[168:171],a[176:179],v[216:219],a[168:171]
v_cvt_pk_bf16_f32 v235,v202,v203
v_mfma_f32_16x16x32_bf16 a[172:175],a[176:179],v[220:223],a[172:175]
v_exp_f32 v197,v197
s_waitcnt lgkmcnt(6)
v_mfma_f32_16x16x32_bf16 v[144:147],a[128:131],v[80:83],v[48:51]
ds_read_b64 a[156:157],v13 offset:13312
s_add_u32 m0,s88,3072
v_mfma_f32_16x16x32_bf16 v[148:151],a[128:131],v[96:99],v[52:55]
v_exp_f32 v198,v198
v_mfma_f32_16x16x32_bf16 v[152:155],a[128:131],v[112:115],v[56:59]
ds_read_b64 a[158:159],v22 offset:13312
v_cvt_pk_bf16_f32 v230,v196,v197
v_mfma_f32_16x16x32_bf16 v[156:159],a[128:131],v[128:131],v[60:63]
v_exp_f32 v199,v199
v_mfma_f32_16x16x32_bf16 v[156:159],a[132:135],v[132:135],v[156:159]
ds_read_b64_tr_b16 a[128:129],v14 offset:2048
buffer_load_dwordx4 v35,s[32:35],s58 offen lds
v_mfma_f32_16x16x32_bf16 v[152:155],a[132:135],v[116:119],v[152:155]
v_exp_f32 v192,v192
v_mfma_f32_16x16x32_bf16 v[148:151],a[132:135],v[100:103],v[148:151]
ds_read_b64_tr_b16 a[130:131],v14 offset:3072
v_cvt_pk_bf16_f32 v231,v198,v199
v_mfma_f32_16x16x32_bf16 v[144:147],a[132:135],v[84:87],v[144:147]
v_exp_f32 v193,v193
v_mfma_f32_16x16x32_bf16 v[144:147],a[136:139],v[88:91],v[144:147]
ds_read_b64_tr_b16 a[132:133],v15 offset:2048
v_mfma_f32_16x16x32_bf16 v[148:151],a[136:139],v[104:107],v[148:151]
v_exp_f32 v194,v194
v_mfma_f32_16x16x32_bf16 v[152:155],a[136:139],v[120:123],v[152:155]
ds_read_b64_tr_b16 a[134:135],v15 offset:3072
v_cvt_pk_bf16_f32 v226,v192,v193
v_mfma_f32_16x16x32_bf16 v[156:159],a[136:139],v[136:139],v[156:159]
v_exp_f32 v195,v195
v_mfma_f32_16x16x32_bf16 v[156:159],a[140:143],v[140:143],v[156:159]
ds_read_b64_tr_b16 a[136:137],v14 offset:6144
s_add_u32 s58,s58,0x20000
s_add_u32 m0,s88,16384
v_mfma_f32_16x16x32_bf16 v[152:155],a[140:143],v[124:127],v[152:155]
v_mfma_f32_16x16x32_bf16 v[148:151],a[140:143],v[108:111],v[148:151]
ds_read_b64_tr_b16 a[138:139],v14 offset:7168
v_cvt_pk_bf16_f32 v227,v194,v195
v_mfma_f32_16x16x32_bf16 v[144:147],a[140:143],v[92:95],v[144:147]
s_cmp_eq_u32 s56,3
s_cselect_b32 s55,s93,s94
s_waitcnt lgkmcnt(6)
v_mfma_f32_16x16x32_bf16 v[160:163],a[144:147],v[80:83],v[48:51]
ds_read_b64_tr_b16 a[140:141],v15 offset:6144
buffer_load_dwordx4 v32,s[32:35],s58 offen lds
v_mfma_f32_16x16x32_bf16 v[164:167],a[144:147],v[96:99],v[52:55]
v_exp_f32 v156,v156
v_mfma_f32_16x16x32_bf16 v[168:171],a[144:147],v[112:115],v[56:59]
ds_read_b64_tr_b16 a[142:143],v15 offset:7168
v_mfma_f32_16x16x32_bf16 v[172:175],a[144:147],v[128:131],v[60:63]
v_exp_f32 v157,v157
v_mfma_f32_16x16x32_bf16 v[172:175],a[148:151],v[132:135],v[172:175]
ds_read_b64_tr_b16 a[144:145],v14 offset:10240
v_mfma_f32_16x16x32_bf16 v[168:171],a[148:151],v[116:119],v[168:171]
v_exp_f32 v158,v158
v_mfma_f32_16x16x32_bf16 v[164:167],a[148:151],v[100:103],v[164:167]
ds_read_b64_tr_b16 a[146:147],v14 offset:11264
v_cvt_pk_bf16_f32 v220,v156,v157
v_mfma_f32_16x16x32_bf16 v[160:163],a[148:151],v[84:87],v[160:163]
v_exp_f32 v159,v159
v_mfma_f32_16x16x32_bf16 v[160:163],a[152:155],v[88:91],v[160:163]
ds_read_b64_tr_b16 a[148:149],v15 offset:10240
s_add_u32 m0,s88,17408
v_mfma_f32_16x16x32_bf16 v[164:167],a[152:155],v[104:107],v[164:167]
v_exp_f32 v152,v152
v_mfma_f32_16x16x32_bf16 v[168:171],a[152:155],v[120:123],v[168:171]
ds_read_b64_tr_b16 a[150:151],v15 offset:11264
v_cvt_pk_bf16_f32 v221,v158,v159
v_mfma_f32_16x16x32_bf16 v[172:175],a[152:155],v[136:139],v[172:175]
v_exp_f32 v153,v153
v_mfma_f32_16x16x32_bf16 v[172:175],a[156:159],v[140:143],v[172:175]
ds_read_b64_tr_b16 a[152:153],v14 offset:14336
buffer_load_dwordx4 v33,s[32:35],s58 offen lds
v_mfma_f32_16x16x32_bf16 v[168:171],a[156:159],v[124:127],v[168:171]
v_exp_f32 v154,v154
v_mfma_f32_16x16x32_bf16 v[164:167],a[156:159],v[108:111],v[164:167]
ds_read_b64_tr_b16 a[154:155],v14 offset:15360
v_cvt_pk_bf16_f32 v216,v152,v153
v_mfma_f32_16x16x32_bf16 v[160:163],a[156:159],v[92:95],v[160:163]
v_exp_f32 v155,v155
s_waitcnt lgkmcnt(6)
v_mfma_f32_16x16x32_bf16 a[0:3],a[128:131],v[224:227],a[0:3]
ds_read_b64_tr_b16 a[156:157],v15 offset:14336
v_mfma_f32_16x16x32_bf16 a[32:35],a[128:131],v[228:231],a[32:35]
v_exp_f32 v148,v148
v_mfma_f32_16x16x32_bf16 a[64:67],a[128:131],v[232:235],a[64:67]
ds_read_b64_tr_b16 a[158:159],v15 offset:15360
v_cvt_pk_bf16_f32 v217,v154,v155
v_mfma_f32_16x16x32_bf16 a[96:99],a[128:131],v[236:239],a[96:99]
v_exp_f32 v149,v149
v_mfma_f32_16x16x32_bf16 a[100:103],a[132:135],v[236:239],a[100:103]
ds_read_b64 a[128:129],v13 offset:2048
s_add_u32 m0,s88,18432
v_mfma_f32_16x16x32_bf16 a[68:71],a[132:135],v[232:235],a[68:71]
v_exp_f32 v150,v150
v_mfma_f32_16x16x32_bf16 a[36:39],a[132:135],v[228:231],a[36:39]
ds_read_b64 a[130:131],v22 offset:2048
v_cvt_pk_bf16_f32 v212,v148,v149
v_mfma_f32_16x16x32_bf16 a[4:7],a[132:135],v[224:227],a[4:7]
v_exp_f32 v151,v151
v_mfma_f32_16x16x32_bf16 a[8:11],a[136:139],v[224:227],a[8:11]
ds_read_b64 a[132:133],v13 offset:6144
buffer_load_dwordx4 v34,s[32:35],s58 offen lds
v_mfma_f32_16x16x32_bf16 a[40:43],a[136:139],v[228:231],a[40:43]
v_exp_f32 v144,v144
v_mfma_f32_16x16x32_bf16 a[72:75],a[136:139],v[232:235],a[72:75]
ds_read_b64 a[134:135],v22 offset:6144
v_cvt_pk_bf16_f32 v213,v150,v151
v_mfma_f32_16x16x32_bf16 a[104:107],a[136:139],v[236:239],a[104:107]
v_exp_f32 v145,v145
v_mfma_f32_16x16x32_bf16 a[108:111],a[140:143],v[236:239],a[108:111]
ds_read_b64 a[136:137],v13 offset:10240
v_mfma_f32_16x16x32_bf16 a[76:79],a[140:143],v[232:235],a[76:79]
v_exp_f32 v146,v146
v_mfma_f32_16x16x32_bf16 a[44:47],a[140:143],v[228:231],a[44:47]
ds_read_b64 a[138:139],v22 offset:10240
v_cvt_pk_bf16_f32 v208,v144,v145
v_mfma_f32_16x16x32_bf16 a[12:15],a[140:143],v[224:227],a[12:15]
v_exp_f32 v147,v147
s_waitcnt lgkmcnt(6)
v_mfma_f32_16x16x32_bf16 a[16:19],a[144:147],v[224:227],a[16:19]
ds_read_b64 a[140:141],v13 offset:14336
s_add_u32 m0,s88,19456
v_mfma_f32_16x16x32_bf16 a[48:51],a[144:147],v[228:231],a[48:51]
v_exp_f32 v172,v172
v_mfma_f32_16x16x32_bf16 a[80:83],a[144:147],v[232:235],a[80:83]
ds_read_b64 a[142:143],v22 offset:14336
v_cvt_pk_bf16_f32 v209,v146,v147
v_mfma_f32_16x16x32_bf16 a[112:115],a[144:147],v[236:239],a[112:115]
v_exp_f32 v173,v173
v_mfma_f32_16x16x32_bf16 a[116:119],a[148:151],v[236:239],a[116:119]
ds_read_b64 a[144:145],v13 offset:3072
buffer_load_dwordx4 v35,s[32:35],s58 offen lds
v_mfma_f32_16x16x32_bf16 a[84:87],a[148:151],v[232:235],a[84:87]
v_exp_f32 v174,v174
v_mfma_f32_16x16x32_bf16 a[52:55],a[148:151],v[228:231],a[52:55]
ds_read_b64 a[146:147],v22 offset:3072
v_cvt_pk_bf16_f32 v222,v172,v173
v_mfma_f32_16x16x32_bf16 a[20:23],a[148:151],v[224:227],a[20:23]
v_exp_f32 v175,v175
v_mfma_f32_16x16x32_bf16 a[24:27],a[152:155],v[224:227],a[24:27]
ds_read_b64 a[148:149],v13 offset:7168
v_mfma_f32_16x16x32_bf16 a[56:59],a[152:155],v[228:231],a[56:59]
v_exp_f32 v168,v168
v_mfma_f32_16x16x32_bf16 a[88:91],a[152:155],v[232:235],a[88:91]
ds_read_b64 a[150:151],v22 offset:7168
v_cvt_pk_bf16_f32 v223,v174,v175
v_mfma_f32_16x16x32_bf16 a[120:123],a[152:155],v[236:239],a[120:123]
v_exp_f32 v169,v169
v_mfma_f32_16x16x32_bf16 a[124:127],a[156:159],v[236:239],a[124:127]
ds_read_b64 a[152:153],v13 offset:11264
s_add_u32 s58,s58,0x20000
v_mfma_f32_16x16x32_bf16 a[92:95],a[156:159],v[232:235],a[92:95]
v_exp_f32 v170,v170
v_mfma_f32_16x16x32_bf16 a[60:63],a[156:159],v[228:231],a[60:63]
ds_read_b64 a[154:155],v22 offset:11264
v_cvt_pk_bf16_f32 v218,v168,v169
v_mfma_f32_16x16x32_bf16 a[28:31],a[156:159],v[224:227],a[28:31]
v_exp_f32 v171,v171
v_mfma_f32_16x16x32_bf16 a[160:163],a[176:179],v[224:227],a[160:163]
buffer_load_dword v24,v25,s[4:7],s59 offen
v_add_u32 v14,s55,v14
v_mfma_f32_16x16x32_bf16 a[164:167],a[176:179],v[228:231],a[164:167]
v_exp_f32 v164,v164
v_mfma_f32_16x16x32_bf16 a[168:171],a[176:179],v[232:235],a[168:171]
v_cvt_pk_bf16_f32 v219,v170,v171
v_mfma_f32_16x16x32_bf16 a[172:175],a[176:179],v[236:239],a[172:175]
v_exp_f32 v165,v165
s_waitcnt lgkmcnt(6)
v_mfma_f32_16x16x32_bf16 v[176:179],a[128:131],v[80:83],v[48:51]
ds_read_b64 a[156:157],v13 offset:15360
s_mov_b32 s59,0x7ff00000
v_add_u32 v15,s55,v15
v_mfma_f32_16x16x32_bf16 v[180:183],a[128:131],v[96:99],v[52:55]
v_exp_f32 v166,v166
v_mfma_f32_16x16x32_bf16 v[184:187],a[128:131],v[112:115],v[56:59]
ds_read_b64 a[158:159],v22 offset:15360
v_cvt_pk_bf16_f32 v214,v164,v165
v_mfma_f32_16x16x32_bf16 v[188:191],a[128:131],v[128:131],v[60:63]
s_barrier
v_exp_f32 v167,v167
v_mfma_f32_16x16x32_bf16 v[188:191],a[132:135],v[132:135],v[188:191]
ds_read_b64_tr_b16 a[128:129],v14 offset:0
v_mfma_f32_16x16x32_bf16 v[184:187],a[132:135],v[116:119],v[184:187]
v_exp_f32 v160,v160
v_mfma_f32_16x16x32_bf16 v[180:183],a[132:135],v[100:103],v[180:183]
ds_read_b64_tr_b16 a[130:131],v14 offset:1024
v_cvt_pk_bf16_f32 v215,v166,v167
v_mfma_f32_16x16x32_bf16 v[176:179],a[132:135],v[84:87],v[176:179]
v_exp_f32 v161,v161
v_mfma_f32_16x16x32_bf16 v[176:179],a[136:139],v[88:91],v[176:179]
ds_read_b64_tr_b16 a[132:133],v15 offset:0
s_waitcnt vmcnt(9)
buffer_load_dword v47,v30,s[8:11],s85 offen sc1
v_mfma_f32_16x16x32_bf16 v[180:183],a[136:139],v[104:107],v[180:183]
v_exp_f32 v162,v162
v_mfma_f32_16x16x32_bf16 v[184:187],a[136:139],v[120:123],v[184:187]
ds_read_b64_tr_b16 a[134:135],v15 offset:1024
v_cvt_pk_bf16_f32 v210,v160,v161
v_mfma_f32_16x16x32_bf16 v[188:191],a[136:139],v[136:139],v[188:191]
v_exp_f32 v163,v163
v_mfma_f32_16x16x32_bf16 v[188:191],a[140:143],v[140:143],v[188:191]
ds_read_b64_tr_b16 a[136:137],v14 offset:4096
v_mfma_f32_16x16x32_bf16 v[184:187],a[140:143],v[124:127],v[184:187]
v_mfma_f32_16x16x32_bf16 v[180:183],a[140:143],v[108:111],v[180:183]
ds_read_b64_tr_b16 a[138:139],v14 offset:5120
v_cvt_pk_bf16_f32 v211,v162,v163
v_mfma_f32_16x16x32_bf16 v[176:179],a[140:143],v[92:95],v[176:179]
s_add_u32 s86,s86,0x8000
s_cmp_eq_u32 s86,163840
s_cselect_b32 s86,0,s86
s_waitcnt lgkmcnt(6)
v_mfma_f32_16x16x32_bf16 v[192:195],a[144:147],v[80:83],v[48:51]
ds_read_b64_tr_b16 a[140:141],v15 offset:4096
v_mfma_f32_16x16x32_bf16 v[196:199],a[144:147],v[96:99],v[52:55]
v_exp_f32 v188,v188
v_mfma_f32_16x16x32_bf16 v[200:203],a[144:147],v[112:115],v[56:59]
ds_read_b64_tr_b16 a[142:143],v15 offset:5120
v_mfma_f32_16x16x32_bf16 v[204:207],a[144:147],v[128:131],v[60:63]
v_exp_f32 v189,v189
v_mfma_f32_16x16x32_bf16 v[204:207],a[148:151],v[132:135],v[204:207]
ds_read_b64_tr_b16 a[144:145],v14 offset:8192
v_add_u32 v13,s94,v13
v_mfma_f32_16x16x32_bf16 v[200:203],a[148:151],v[116:119],v[200:203]
v_exp_f32 v190,v190
v_mfma_f32_16x16x32_bf16 v[196:199],a[148:151],v[100:103],v[196:199]
ds_read_b64_tr_b16 a[146:147],v14 offset:9216
v_cvt_pk_bf16_f32 v236,v188,v189
v_mfma_f32_16x16x32_bf16 v[192:195],a[148:151],v[84:87],v[192:195]
v_exp_f32 v191,v191
v_mfma_f32_16x16x32_bf16 v[192:195],a[152:155],v[88:91],v[192:195]
ds_read_b64_tr_b16 a[148:149],v15 offset:8192
v_add_u32 v22,s94,v22
v_mfma_f32_16x16x32_bf16 v[196:199],a[152:155],v[104:107],v[196:199]
v_exp_f32 v184,v184
v_mfma_f32_16x16x32_bf16 v[200:203],a[152:155],v[120:123],v[200:203]
ds_read_b64_tr_b16 a[150:151],v15 offset:9216
v_cvt_pk_bf16_f32 v237,v190,v191
v_mfma_f32_16x16x32_bf16 v[204:207],a[152:155],v[136:139],v[204:207]
v_exp_f32 v185,v185
v_mfma_f32_16x16x32_bf16 v[204:207],a[156:159],v[140:143],v[204:207]
ds_read_b64_tr_b16 a[152:153],v14 offset:12288
s_sub_u32 s56,s56,1
v_mfma_f32_16x16x32_bf16 v[200:203],a[156:159],v[124:127],v[200:203]
v_exp_f32 v186,v186
v_mfma_f32_16x16x32_bf16 v[196:199],a[156:159],v[108:111],v[196:199]
ds_read_b64_tr_b16 a[154:155],v14 offset:13312
s_cmp_lg_u32 s56,0
v_cvt_pk_bf16_f32 v232,v184,v185
v_mfma_f32_16x16x32_bf16 v[192:195],a[156:159],v[92:95],v[192:195]
v_exp_f32 v187,v187
s_cbranch_scc1 L_attB
s_waitcnt lgkmcnt(6)
v_mfma_f32_16x16x32_bf16 a[0:3],a[128:131],v[208:211],a[0:3]
ds_read_b64_tr_b16 a[156:157],v15 offset:12288
v_exp_f32 v180,v180
s_waitcnt vmcnt(0)
v_cmp_ne_u32 vcc,s49,v47
v_mfma_f32_16x16x32_bf16 a[32:35],a[128:131],v[212:215],a[32:35]
v_exp_f32 v181,v181
v_cvt_pk_bf16_f32 v233,v186,v187
v_mfma_f32_16x16x32_bf16 a[64:67],a[128:131],v[216:219],a[64:67]
ds_read_b64_tr_b16 a[158:159],v15 offset:13312
v_exp_f32 v182,v182
v_mfma_f32_16x16x32_bf16 a[96:99],a[128:131],v[220:223],a[96:99]
v_mfma_f32_16x16x32_bf16 a[100:103],a[132:135],v[220:223],a[100:103]
ds_read_b64_tr_b16 a[128:129],v14 offset:2048
s_cbranch_vccnz L_spin_h
L_ok_h:
v_exp_f32 v183,v183
v_cvt_pk_bf16_f32 v228,v180,v181
v_mfma_f32_16x16x32_bf16 a[68:71],a[132:135],v[216:219],a[68:71]
v_exp_f32 v176,v176
v_mfma_f32_16x16x32_bf16 a[36:39],a[132:135],v[212:215],a[36:39]
ds_read_b64_tr_b16 a[130:131],v14 offset:3072
buffer_load_dwordx4 v[48:51],v4,s[8:11],s80 offen offset:0 sc1
v_exp_f32 v177,v177
v_cvt_pk_bf16_f32 v229,v182,v183
v_mfma_f32_16x16x32_bf16 a[4:7],a[132:135],v[208:211],a[4:7]
v_mfma_f32_16x16x32_bf16 a[8:11],a[136:139],v[208:211],a[8:11]
ds_read_b64_tr_b16 a[132:133],v15 offset:2048
v_exp_f32 v178,v178
v_mfma_f32_16x16x32_bf16 a[40:43],a[136:139],v[212:215],a[40:43]
v_exp_f32 v179,v179
v_cvt_pk_bf16_f32 v224,v176,v177
v_mfma_f32_16x16x32_bf16 a[72:75],a[136:139],v[216:219],a[72:75]
ds_read_b64_tr_b16 a[134:135],v15 offset:3072
buffer_load_dwordx4 v[52:55],v5,s[8:11],s80 offen offset:0 sc1
v_exp_f32 v204,v204
v_mfma_f32_16x16x32_bf16 a[104:107],a[136:139],v[220:223],a[104:107]
v_mfma_f32_16x16x32_bf16 a[108:111],a[140:143],v[220:223],a[108:111]
ds_read_b64_tr_b16 a[136:137],v14 offset:6144
v_exp_f32 v205,v205
v_cvt_pk_bf16_f32 v225,v178,v179
v_mfma_f32_16x16x32_bf16 a[76:79],a[140:143],v[216:219],a[76:79]
v_exp_f32 v206,v206
v_mfma_f32_16x16x32_bf16 a[44:47],a[140:143],v[212:215],a[44:47]
ds_read_b64_tr_b16 a[138:139],v14 offset:7168
buffer_load_dwordx4 v[56:59],v6,s[8:11],s80 offen offset:0 sc1
v_exp_f32 v207,v207
v_cvt_pk_bf16_f32 v238,v204,v205
v_mfma_f32_16x16x32_bf16 a[12:15],a[140:143],v[208:211],a[12:15]
s_waitcnt lgkmcnt(6)
v_mfma_f32_16x16x32_bf16 a[16:19],a[144:147],v[208:211],a[16:19]
ds_read_b64_tr_b16 a[140:141],v15 offset:6144
v_exp_f32 v200,v200
v_mfma_f32_16x16x32_bf16 a[48:51],a[144:147],v[212:215],a[48:51]
v_exp_f32 v201,v201
v_cvt_pk_bf16_f32 v239,v206,v207
v_mfma_f32_16x16x32_bf16 a[80:83],a[144:147],v[216:219],a[80:83]
ds_read_b64_tr_b16 a[142:143],v15 offset:7168
buffer_load_dwordx4 v[60:63],v7,s[8:11],s80 offen offset:0 sc1
v_mfma_f32_16x16x32_bf16 a[112:115],a[144:147],v[220:223],a[112:115]
v_exp_f32 v202,v202
v_mfma_f32_16x16x32_bf16 a[116:119],a[148:151],v[220:223],a[116:119]
ds_read_b64_tr_b16 a[144:145],v14 offset:10240
v_exp_f32 v203,v203
v_cvt_pk_bf16_f32 v234,v200,v201
v_mfma_f32_16x16x32_bf16 a[84:87],a[148:151],v[216:219],a[84:87]
v_exp_f32 v196,v196
v_mfma_f32_16x16x32_bf16 a[52:55],a[148:151],v[212:215],a[52:55]
ds_read_b64_tr_b16 a[146:147],v14 offset:11264
buffer_load_dwordx4 v[64:67],v4,s[8:11],s80 offen offset:2048 sc1
v_mfma_f32_16x16x32_bf16 a[20:23],a[148:151],v[208:211],a[20:23]
v_exp_f32 v197,v197
v_cvt_pk_bf16_f32 v235,v202,v203
v_mfma_f32_16x16x32_bf16 a[24:27],a[152:155],v[208:211],a[24:27]
ds_read_b64_tr_b16 a[148:149],v15 offset:10240
v_exp_f32 v198,v198
v_mfma_f32_16x16x32_bf16 a[56:59],a[152:155],v[212:215],a[56:59]
v_exp_f32 v199,v199
v_cvt_pk_bf16_f32 v230,v196,v197
v_mfma_f32_16x16x32_bf16 a[88:91],a[152:155],v[216:219],a[88:91]
ds_read_b64_tr_b16 a[150:151],v15 offset:11264
buffer_load_dwordx4 v[68:71],v5,s[8:11],s80 offen offset:2048 sc1
v_mfma_f32_16x16x32_bf16 a[120:123],a[152:155],v[220:223],a[120:123]
v_exp_f32 v192,v192
v_mfma_f32_16x16x32_bf16 a[124:127],a[156:159],v[220:223],a[124:127]
ds_read_b64_tr_b16 a[152:153],v14 offset:14336
v_exp_f32 v193,v193
v_cvt_pk_bf16_f32 v231,v198,v199
v_mfma_f32_16x16x32_bf16 a[92:95],a[156:159],v[216:219],a[92:95]
v_exp_f32 v194,v194
v_mfma_f32_16x16x32_bf16 a[60:63],a[156:159],v[212:215],a[60:63]
ds_read_b64_tr_b16 a[154:155],v14 offset:15360
buffer_load_dwordx4 v[72:75],v6,s[8:11],s80 offen offset:2048 sc1
v_mfma_f32_16x16x32_bf16 a[28:31],a[156:159],v[208:211],a[28:31]
v_exp_f32 v195,v195
v_cvt_pk_bf16_f32 v226,v192,v193
v_mfma_f32_16x16x32_bf16 a[160:163],a[176:179],v[208:211],a[160:163]
v_cvt_pk_bf16_f32 v227,v194,v195
v_mfma_f32_16x16x32_bf16 a[164:167],a[176:179],v[212:215],a[164:167]
v_mfma_f32_16x16x32_bf16 a[168:171],a[176:179],v[216:219],a[168:171]
buffer_load_dwordx4 v[76:79],v7,s[8:11],s80 offen offset:2048 sc1
v_mfma_f32_16x16x32_bf16 a[172:175],a[176:179],v[220:223],a[172:175]
v_mfma_f32_16x16x32_bf16 a[160:163],a[176:179],v[224:227],a[160:163]
v_mfma_f32_16x16x32_bf16 a[164:167],a[176:179],v[228:231],a[164:167]
v_mfma_f32_16x16x32_bf16 a[168:171],a[176:179],v[232:235],a[168:171]
s_add_u32 s80,s80,0x40000
v_mfma_f32_16x16x32_bf16 a[172:175],a[176:179],v[236:239],a[172:175]
s_waitcnt lgkmcnt(6)
v_mfma_f32_16x16x32_bf16 a[0:3],a[128:131],v[224:227],a[0:3]
ds_read_b64_tr_b16 a[156:157],v15 offset:14336
buffer_load_dwordx4 v[144:147],v4,s[8:11],s80 offen offset:0 sc1
v_mfma_f32_16x16x32_bf16 a[32:35],a[128:131],v[228:231],a[32:35]
v_mfma_f32_16x16x32_bf16 a[64:67],a[128:131],v[232:235],a[64:67]
ds_read_b64_tr_b16 a[158:159],v15 offset:15360
v_mov_b32 v26,0x53800000
v_mfma_f32_16x16x32_bf16 a[96:99],a[128:131],v[236:239],a[96:99]
v_mov_b32 v27,65536
v_accvgpr_read_b32 v16,a160
v_mfma_f32_16x16x32_bf16 a[100:103],a[132:135],v[236:239],a[100:103]
buffer_load_dwordx4 v[148:151],v5,s[8:11],s80 offen offset:0 sc1
v_accvgpr_read_b32 v17,a164
v_mfma_f32_16x16x32_bf16 a[68:71],a[132:135],v[232:235],a[68:71]
v_accvgpr_read_b32 v18,a168
v_accvgpr_read_b32 v19,a172
v_mfma_f32_16x16x32_bf16 a[36:39],a[132:135],v[228:231],a[36:39]
v_add_f32 v24,v16,v17
v_add_f32 v25,v18,v19
v_mfma_f32_16x16x32_bf16 a[4:7],a[132:135],v[224:227],a[4:7]
v_add_f32 v25,v24,v25
v_cmp_nlt_f32 vcc,v25,v26
v_mfma_f32_16x16x32_bf16 a[8:11],a[136:139],v[224:227],a[8:11]
buffer_load_dwordx4 v[152:155],v6,s[8:11],s80 offen offset:0 sc1
v_add_u32 v25,s91,v27
v_mfma_f32_16x16x32_bf16 a[40:43],a[136:139],v[228:231],a[40:43]
v_mfma_f32_16x16x32_bf16 a[72:75],a[136:139],v[232:235],a[72:75]
v_mfma_f32_16x16x32_bf16 a[104:107],a[136:139],v[236:239],a[104:107]
v_mfma_f32_16x16x32_bf16 a[108:111],a[140:143],v[236:239],a[108:111]
buffer_load_dwordx4 v[156:159],v7,s[8:11],s80 offen offset:0 sc1
s_cmp_lg_u64 vcc,0
s_cselect_b32 s54,1,0
v_mfma_f32_16x16x32_bf16 a[76:79],a[140:143],v[232:235],a[76:79]
v_mov_b32 v24,s54
v_mfma_f32_16x16x32_bf16 a[44:47],a[140:143],v[228:231],a[44:47]
ds_write_b32 v25,v24
v_mfma_f32_16x16x32_bf16 a[12:15],a[140:143],v[224:227],a[12:15]
v_rcp_f32 v16,v16
s_waitcnt lgkmcnt(1)
v_mfma_f32_16x16x32_bf16 a[16:19],a[144:147],v[224:227],a[16:19]
buffer_load_dwordx4 v[160:163],v4,s[8:11],s80 offen offset:2048 sc1
v_mfma_f32_16x16x32_bf16 a[48:51],a[144:147],v[228:231],a[48:51]
v_rcp_f32 v17,v17
v_mfma_f32_16x16x32_bf16 a[80:83],a[144:147],v[232:235],a[80:83]
s_waitcnt lgkmcnt(0)
s_barrier
v_mfma_f32_16x16x32_bf16 a[112:115],a[144:147],v[236:239],a[112:115]
ds_read_b32 v24,v27 offset:0
v_mfma_f32_16x16x32_bf16 a[116:119],a[148:151],v[236:239],a[116:119]
buffer_load_dwordx4 v[164:167],v5,s[8:11],s80 offen offset:2048 sc1
ds_read_b32 v25,v27 offset:1024
v_mfma_f32_16x16x32_bf16 a[84:87],a[148:151],v[232:235],a[84:87]
ds_read_b32 v26,v27 offset:2048
v_mfma_f32_16x16x32_bf16 a[52:55],a[148:151],v[228:231],a[52:55]
ds_read_b32 v28,v27 offset:3072
v_mfma_f32_16x16x32_bf16 a[20:23],a[148:151],v[224:227],a[20:23]
ds_read_b64_tr_b16 v[176:177],v36 offset:0
v_mfma_f32_16x16x32_bf16 a[24:27],a[152:155],v[224:227],a[24:27]
buffer_load_dwordx4 v[168:171],v6,s[8:11],s80 offen offset:2048 sc1
ds_read_b64_tr_b16 v[178:179],v36 offset:4096
v_mfma_f32_16x16x32_bf16 a[56:59],a[152:155],v[228:231],a[56:59]
ds_read_b64_tr_b16 v[180:181],v37 offset:0
v_mfma_f32_16x16x32_bf16 a[88:91],a[152:155],v[232:235],a[88:91]
ds_read_b64_tr_b16 v[182:183],v37 offset:4096
v_mfma_f32_16x16x32_bf16 a[120:123],a[152:155],v[236:239],a[120:123]
ds_read_b64_tr_b16 v[184:185],v38 offset:0
v_mfma_f32_16x16x32_bf16 a[124:127],a[156:159],v[236:239],a[124:127]
buffer_load_dwordx4 v[172:175],v7,s[8:11],s80 offen offset:2048 sc1
ds_read_b64_tr_b16 v[186:187],v38 offset:4096
s_add_u32 s80,s80,0x40000
v_mfma_f32_16x16x32_bf16 a[92:95],a[156:159],v[232:235],a[92:95]
ds_read_b64_tr_b16 v[188:189],v39 offset:0
v_mfma_f32_16x16x32_bf16 a[60:63],a[156:159],v[228:231],a[60:63]
ds_read_b64_tr_b16 v[190:191],v39 offset:4096
v_mfma_f32_16x16x32_bf16 a[28:31],a[156:159],v[224:227],a[28:31]
v_rcp_f32 v18,v18
v_rcp_f32 v19,v19
s_waitcnt lgkmcnt(9)
v_or3_b32 v24,v24,v25,v26
s_waitcnt lgkmcnt(8)
v_or_b32 v24,v24,v28
s_nop 0
v_readfirstlane_b32 s54,v24
s_nop 0
s_andn2_b32 s54,s54,s95
s_cbranch_scc1 L_fallback
s_waitcnt vmcnt(8) lgkmcnt(6)
v_mfma_f32_16x16x32_bf16 a[128:131],v[176:179],v[48:51],0
ds_read_b64_tr_b16 v[192:193],v40 offset:0
s_lshl_b32 s54,s45,19
v_mfma_f32_16x16x32_bf16 a[160:163],v[176:179],v[52:55],0
s_add_u32 s54,s54,0x1200000
s_add_u32 s55,s54,0x40000
v_mfma_f32_16x16x32_bf16 a[192:195],v[176:179],v[56:59],0
ds_read_b64_tr_b16 v[194:195],v40 offset:4096
v_accvgpr_read_b32 v208,a0
v_mfma_f32_16x16x32_bf16 a[224:227],v[176:179],v[60:63],0
buffer_load_dwordx4 v[80:83],v4,s[8:11],s80 offen offset:0 sc1
s_waitcnt lgkmcnt(4)
v_mfma_f32_16x16x32_bf16 a[228:231],v[180:183],v[60:63],0
ds_read_b64_tr_b16 v[196:197],v41 offset:0
v_accvgpr_read_b32 v209,a1
v_mfma_f32_16x16x32_bf16 a[196:199],v[180:183],v[56:59],0
v_accvgpr_read_b32 v210,a2
v_accvgpr_read_b32 v211,a3
v_mfma_f32_16x16x32_bf16 a[164:167],v[180:183],v[52:55],0
ds_read_b64_tr_b16 v[198:199],v41 offset:4096
v_accvgpr_read_b32 v212,a4
v_mfma_f32_16x16x32_bf16 a[132:135],v[180:183],v[48:51],0
buffer_load_dwordx4 v[84:87],v5,s[8:11],s80 offen offset:0 sc1
v_mfma_f32_16x16x32_bf16 a[136:139],v[184:187],v[48:51],0
ds_read_b64_tr_b16 v[200:201],v42 offset:0
v_accvgpr_read_b32 v213,a5
v_mfma_f32_16x16x32_bf16 a[168:171],v[184:187],v[52:55],0
v_accvgpr_read_b32 v214,a6
v_accvgpr_read_b32 v215,a7
v_mfma_f32_16x16x32_bf16 a[200:203],v[184:187],v[56:59],0
ds_read_b64_tr_b16 v[202:203],v42 offset:4096
v_mul_f32 v208,v208,v16
v_mfma_f32_16x16x32_bf16 a[232:235],v[184:187],v[60:63],0
v_mul_f32 v209,v209,v16
s_waitcnt lgkmcnt(4)
v_mfma_f32_16x16x32_bf16 a[236:239],v[188:191],v[60:63],0
ds_read_b64_tr_b16 v[204:205],v43 offset:0
v_mul_f32 v210,v210,v16
v_mfma_f32_16x16x32_bf16 a[204:207],v[188:191],v[56:59],0
buffer_load_dwordx4 v[88:91],v6,s[8:11],s80 offen offset:0 sc1
v_mfma_f32_16x16x32_bf16 a[172:175],v[188:191],v[52:55],0
ds_read_b64_tr_b16 v[206:207],v43 offset:4096
v_mul_f32 v211,v211,v16
v_mfma_f32_16x16x32_bf16 a[140:143],v[188:191],v[48:51],0
v_mul_f32 v212,v212,v16
v_mul_f32 v213,v213,v16
v_mfma_f32_16x16x32_bf16 a[144:147],v[192:195],v[48:51],0
ds_read_b64_tr_b16 v[176:177],v36 offset:8192
v_mul_f32 v214,v214,v16
v_mfma_f32_16x16x32_bf16 a[176:179],v[192:195],v[52:55],0
v_mul_f32 v215,v215,v16
v_cvt_pk_bf16_f32 v240,v208,v209
v_mfma_f32_16x16x32_bf16 a[208:211],v[192:195],v[56:59],0
ds_read_b64_tr_b16 v[178:179],v36 offset:12288
v_add_u32 v36,0x4000,v36
v_mfma_f32_16x16x32_bf16 a[240:243],v[192:195],v[60:63],0
buffer_load_dwordx4 v[92:95],v7,s[8:11],s80 offen offset:0 sc1
s_waitcnt lgkmcnt(4)
v_mfma_f32_16x16x32_bf16 a[244:247],v[196:199],v[60:63],0
ds_read_b64_tr_b16 v[180:181],v37 offset:8192
v_cvt_pk_bf16_f32 v241,v210,v211
v_mfma_f32_16x16x32_bf16 a[212:215],v[196:199],v[56:59],0
v_cvt_pk_bf16_f32 v242,v212,v213
v_cvt_pk_bf16_f32 v243,v214,v215
v_mfma_f32_16x16x32_bf16 a[180:183],v[196:199],v[52:55],0
ds_read_b64_tr_b16 v[182:183],v37 offset:12288
v_accvgpr_read_b32 v216,a8
v_mfma_f32_16x16x32_bf16 a[148:151],v[196:199],v[48:51],0
v_add_u32 v37,0x4000,v37
v_accvgpr_read_b32 v217,a9
v_mfma_f32_16x16x32_bf16 a[152:155],v[200:203],v[48:51],0
ds_read_b64_tr_b16 v[184:185],v38 offset:8192
v_accvgpr_read_b32 v218,a10
v_mfma_f32_16x16x32_bf16 a[184:187],v[200:203],v[52:55],0
buffer_load_dwordx4 v[96:99],v4,s[8:11],s80 offen offset:2048 sc1
v_mfma_f32_16x16x32_bf16 a[216:219],v[200:203],v[56:59],0
ds_read_b64_tr_b16 v[186:187],v38 offset:12288
v_add_u32 v38,0x4000,v38
v_mfma_f32_16x16x32_bf16 a[248:251],v[200:203],v[60:63],0
v_accvgpr_read_b32 v219,a11
s_waitcnt lgkmcnt(4)
v_mfma_f32_16x16x32_bf16 a[252:255],v[204:207],v[60:63],0
ds_read_b64_tr_b16 v[188:189],v39 offset:8192
v_accvgpr_read_b32 v220,a12
v_mfma_f32_16x16x32_bf16 a[220:223],v[204:207],v[56:59],0
buffer_load_dwordx4 v[100:103],v5,s[8:11],s80 offen offset:2048 sc1
v_mfma_f32_16x16x32_bf16 a[188:191],v[204:207],v[52:55],0
ds_read_b64_tr_b16 v[190:191],v39 offset:12288
v_accvgpr_read_b32 v221,a13
v_mfma_f32_16x16x32_bf16 a[156:159],v[204:207],v[48:51],0
v_add_u32 v39,0x4000,v39
v_accvgpr_read_b32 v222,a14
v_mfma_f32_16x16x32_bf16 a[128:131],v[176:179],v[64:67],a[128:131]
ds_read_b64_tr_b16 v[192:193],v40 offset:8192
v_accvgpr_read_b32 v223,a15
v_mfma_f32_16x16x32_bf16 a[160:163],v[176:179],v[68:71],a[160:163]
buffer_load_dwordx4 v[104:107],v6,s[8:11],s80 offen offset:2048 sc1
v_mfma_f32_16x16x32_bf16 a[192:195],v[176:179],v[72:75],a[192:195]
ds_read_b64_tr_b16 v[194:195],v40 offset:12288
v_add_u32 v40,0x4000,v40
v_mfma_f32_16x16x32_bf16 a[224:227],v[176:179],v[76:79],a[224:227]
v_mul_f32 v216,v216,v16
s_waitcnt lgkmcnt(4)
v_mfma_f32_16x16x32_bf16 a[228:231],v[180:183],v[76:79],a[228:231]
ds_read_b64_tr_b16 v[196:197],v41 offset:8192
v_mul_f32 v217,v217,v16
v_mfma_f32_16x16x32_bf16 a[196:199],v[180:183],v[72:75],a[196:199]
buffer_store_dwordx4 v[240:243],v20,s[8:11],s54 offen offset:0 sc1
v_mfma_f32_16x16x32_bf16 a[164:167],v[180:183],v[68:71],a[164:167]
ds_read_b64_tr_b16 v[198:199],v41 offset:12288
v_mul_f32 v218,v218,v16
v_mfma_f32_16x16x32_bf16 a[132:135],v[180:183],v[64:67],a[132:135]
buffer_load_dwordx4 v[108:111],v7,s[8:11],s80 offen offset:2048 sc1
v_add_u32 v41,0x4000,v41
v_mfma_f32_16x16x32_bf16 a[136:139],v[184:187],v[64:67],a[136:139]
ds_read_b64_tr_b16 v[200:201],v42 offset:8192
s_add_u32 s80,s80,0x40000
v_mfma_f32_16x16x32_bf16 a[168:171],v[184:187],v[68:71],a[168:171]
v_mul_f32 v219,v219,v16
v_mul_f32 v220,v220,v16
v_mfma_f32_16x16x32_bf16 a[200:203],v[184:187],v[72:75],a[200:203]
ds_read_b64_tr_b16 v[202:203],v42 offset:12288
v_add_u32 v42,0x4000,v42
v_mfma_f32_16x16x32_bf16 a[232:235],v[184:187],v[76:79],a[232:235]
v_mul_f32 v221,v221,v16
s_waitcnt lgkmcnt(4)
v_mfma_f32_16x16x32_bf16 a[236:239],v[188:191],v[76:79],a[236:239]
ds_read_b64_tr_b16 v[204:205],v43 offset:8192
v_mul_f32 v222,v222,v16
v_mfma_f32_16x16x32_bf16 a[204:207],v[188:191],v[72:75],a[204:207]
buffer_load_dwordx4 v[112:115],v4,s[8:11],s80 offen offset:0 sc1
v_mfma_f32_16x16x32_bf16 a[172:175],v[188:191],v[68:71],a[172:175]
ds_read_b64_tr_b16 v[206:207],v43 offset:12288
v_mul_f32 v223,v223,v16
v_mfma_f32_16x16x32_bf16 a[140:143],v[188:191],v[64:67],a[140:143]
s_barrier
v_add_u32 v43,0x4000,v43
v_mfma_f32_16x16x32_bf16 a[144:147],v[192:195],v[64:67],a[144:147]
ds_read_b64_tr_b16 v[176:177],v36 offset:0
v_cvt_pk_bf16_f32 v244,v216,v217
v_mfma_f32_16x16x32_bf16 a[176:179],v[192:195],v[68:71],a[176:179]
buffer_load_dwordx4 v[116:119],v5,s[8:11],s80 offen offset:0 sc1
v_mfma_f32_16x16x32_bf16 a[208:211],v[192:195],v[72:75],a[208:211]
ds_read_b64_tr_b16 v[178:179],v36 offset:4096
v_cvt_pk_bf16_f32 v245,v218,v219
v_mfma_f32_16x16x32_bf16 a[240:243],v[192:195],v[76:79],a[240:243]
v_cvt_pk_bf16_f32 v246,v220,v221
s_waitcnt lgkmcnt(4)
v_mfma_f32_16x16x32_bf16 a[244:247],v[196:199],v[76:79],a[244:247]
ds_read_b64_tr_b16 v[180:181],v37 offset:0
v_cvt_pk_bf16_f32 v247,v222,v223
v_mfma_f32_16x16x32_bf16 a[212:215],v[196:199],v[72:75],a[212:215]
buffer_store_dwordx4 v[244:247],v20,s[8:11],s54 offen offset:2048 sc1
v_mfma_f32_16x16x32_bf16 a[180:183],v[196:199],v[68:71],a[180:183]
ds_read_b64_tr_b16 v[182:183],v37 offset:4096
v_accvgpr_read_b32 v224,a16
v_mfma_f32_16x16x32_bf16 a[148:151],v[196:199],v[64:67],a[148:151]
buffer_load_dwordx4 v[120:123],v6,s[8:11],s80 offen offset:0 sc1
v_mfma_f32_16x16x32_bf16 a[152:155],v[200:203],v[64:67],a[152:155]
ds_read_b64_tr_b16 v[184:185],v38 offset:0
v_accvgpr_read_b32 v225,a17
v_mfma_f32_16x16x32_bf16 a[184:187],v[200:203],v[68:71],a[184:187]
v_accvgpr_read_b32 v226,a18
v_accvgpr_read_b32 v227,a19
v_mfma_f32_16x16x32_bf16 a[216:219],v[200:203],v[72:75],a[216:219]
ds_read_b64_tr_b16 v[186:187],v38 offset:4096
v_accvgpr_read_b32 v228,a20
v_mfma_f32_16x16x32_bf16 a[248:251],v[200:203],v[76:79],a[248:251]
v_accvgpr_read_b32 v229,a21
s_waitcnt lgkmcnt(6)
v_mfma_f32_16x16x32_bf16 a[252:255],v[204:207],v[76:79],a[252:255]
ds_read_b64_tr_b16 v[188:189],v39 offset:0
v_accvgpr_read_b32 v230,a22
v_mfma_f32_16x16x32_bf16 a[220:223],v[204:207],v[72:75],a[220:223]
buffer_load_dwordx4 v[124:127],v7,s[8:11],s80 offen offset:0 sc1
v_mfma_f32_16x16x32_bf16 a[188:191],v[204:207],v[68:71],a[188:191]
ds_read_b64_tr_b16 v[190:191],v39 offset:4096
v_accvgpr_read_b32 v231,a23
v_mfma_f32_16x16x32_bf16 a[156:159],v[204:207],v[64:67],a[156:159]
s_waitcnt vmcnt(14) lgkmcnt(6)
v_mfma_f32_16x16x32_bf16 a[128:131],v[176:179],v[144:147],a[128:131]
ds_read_b64_tr_b16 v[192:193],v40 offset:0
v_mul_f32 v224,v224,v16
v_mfma_f32_16x16x32_bf16 a[160:163],v[176:179],v[148:151],a[160:163]
v_mul_f32 v225,v225,v16
v_mul_f32 v226,v226,v16
v_mfma_f32_16x16x32_bf16 a[192:195],v[176:179],v[152:155],a[192:195]
ds_read_b64_tr_b16 v[194:195],v40 offset:4096
v_mul_f32 v227,v227,v16
v_mfma_f32_16x16x32_bf16 a[224:227],v[176:179],v[156:159],a[224:227]
buffer_load_dwordx4 v[128:131],v4,s[8:11],s80 offen offset:2048 sc1
s_waitcnt lgkmcnt(4)
v_mfma_f32_16x16x32_bf16 a[228:231],v[180:183],v[156:159],a[228:231]
ds_read_b64_tr_b16 v[196:197],v41 offset:0
v_mul_f32 v228,v228,v16
v_mfma_f32_16x16x32_bf16 a[196:199],v[180:183],v[152:155],a[196:199]
v_mul_f32 v229,v229,v16
v_mul_f32 v230,v230,v16
v_mfma_f32_16x16x32_bf16 a[164:167],v[180:183],v[148:151],a[164:167]
ds_read_b64_tr_b16 v[198:199],v41 offset:4096
v_mul_f32 v231,v231,v16
v_mfma_f32_16x16x32_bf16 a[132:135],v[180:183],v[144:147],a[132:135]
buffer_load_dwordx4 v[132:135],v5,s[8:11],s80 offen offset:2048 sc1
v_mfma_f32_16x16x32_bf16 a[136:139],v[184:187],v[144:147],a[136:139]
ds_read_b64_tr_b16 v[200:201],v42 offset:0
v_cvt_pk_bf16_f32 v248,v224,v225
v_mfma_f32_16x16x32_bf16 a[168:171],v[184:187],v[148:151],a[168:171]
v_cvt_pk_bf16_f32 v249,v226,v227
v_cvt_pk_bf16_f32 v250,v228,v229
v_mfma_f32_16x16x32_bf16 a[200:203],v[184:187],v[152:155],a[200:203]
ds_read_b64_tr_b16 v[202:203],v42 offset:4096
v_cvt_pk_bf16_f32 v251,v230,v231
v_mfma_f32_16x16x32_bf16 a[232:235],v[184:187],v[156:159],a[232:235]
v_accvgpr_read_b32 v232,a24
s_waitcnt lgkmcnt(4)
v_mfma_f32_16x16x32_bf16 a[236:239],v[188:191],v[156:159],a[236:239]
ds_read_b64_tr_b16 v[204:205],v43 offset:0
v_accvgpr_read_b32 v233,a25
v_mfma_f32_16x16x32_bf16 a[204:207],v[188:191],v[152:155],a[204:207]
buffer_load_dwordx4 v[136:139],v6,s[8:11],s80 offen offset:2048 sc1
v_mfma_f32_16x16x32_bf16 a[172:175],v[188:191],v[148:151],a[172:175]
ds_read_b64_tr_b16 v[206:207],v43 offset:4096
v_accvgpr_read_b32 v234,a26
v_mfma_f32_16x16x32_bf16 a[140:143],v[188:191],v[144:147],a[140:143]
buffer_store_dwordx4 v[248:251],v20,s[8:11],s55 offen offset:0 sc1
v_mfma_f32_16x16x32_bf16 a[144:147],v[192:195],v[144:147],a[144:147]
ds_read_b64_tr_b16 v[176:177],v36 offset:8192
v_accvgpr_read_b32 v235,a27
v_mfma_f32_16x16x32_bf16 a[176:179],v[192:195],v[148:151],a[176:179]
v_accvgpr_read_b32 v236,a28
v_accvgpr_read_b32 v237,a29
v_mfma_f32_16x16x32_bf16 a[208:211],v[192:195],v[152:155],a[208:211]
ds_read_b64_tr_b16 v[178:179],v36 offset:12288
v_add_u32 v36,0x4000,v36
v_mfma_f32_16x16x32_bf16 a[240:243],v[192:195],v[156:159],a[240:243]
buffer_load_dwordx4 v[140:143],v7,s[8:11],s80 offen offset:2048 sc1
s_waitcnt lgkmcnt(4)
v_mfma_f32_16x16x32_bf16 a[244:247],v[196:199],v[156:159],a[244:247]
ds_read_b64_tr_b16 v[180:181],v37 offset:8192
s_add_u32 s80,s80,0x40000
v_mfma_f32_16x16x32_bf16 a[212:215],v[196:199],v[152:155],a[212:215]
v_accvgpr_read_b32 v238,a30
v_accvgpr_read_b32 v239,a31
v_mfma_f32_16x16x32_bf16 a[180:183],v[196:199],v[148:151],a[180:183]
ds_read_b64_tr_b16 v[182:183],v37 offset:12288
v_mul_f32 v232,v232,v16
v_mfma_f32_16x16x32_bf16 a[148:151],v[196:199],v[144:147],a[148:151]
v_add_u32 v37,0x4000,v37
v_mul_f32 v233,v233,v16
v_mfma_f32_16x16x32_bf16 a[152:155],v[200:203],v[144:147],a[152:155]
ds_read_b64_tr_b16 v[184:185],v38 offset:8192
v_mul_f32 v234,v234,v16
v_mfma_f32_16x16x32_bf16 a[184:187],v[200:203],v[148:151],a[184:187]
buffer_load_dwordx4 v[48:51],v4,s[8:11],s80 offen offset:0 sc1
v_mfma_f32_16x16x32_bf16 a[216:219],v[200:203],v[152:155],a[216:219]
ds_read_b64_tr_b16 v[186:187],v38 offset:12288
v_add_u32 v38,0x4000,v38
v_mfma_f32_16x16x32_bf16 a[248:251],v[200:203],v[156:159],a[248:251]
v_mul_f32 v235,v235,v16
s_waitcnt lgkmcnt(4)
v_mfma_f32_16x16x32_bf16 a[252:255],v[204:207],v[156:159],a[252:255]
ds_read_b64_tr_b16 v[188:189],v39 offset:8192
v_mul_f32 v236,v236,v16
v_mfma_f32_16x16x32_bf16 a[220:223],v[204:207],v[152:155],a[220:223]
buffer_load_dwordx4 v[52:55],v5,s[8:11],s80 offen offset:0 sc1
v_mfma_f32_16x16x32_bf16 a[188:191],v[204:207],v[148:151],a[188:191]
ds_read_b64_tr_b16 v[190:191],v39 offset:12288
v_mul_f32 v237,v237,v16
v_mfma_f32_16x16x32_bf16 a[156:159],v[204:207],v[144:147],a[156:159]
v_add_u32 v39,0x4000,v39
v_mul_f32 v238,v238,v16
v_mfma_f32_16x16x32_bf16 a[128:131],v[176:179],v[160:163],a[128:131]
ds_read_b64_tr_b16 v[192:193],v40 offset:8192
v_mul_f32 v239,v239,v16
v_mfma_f32_16x16x32_bf16 a[160:163],v[176:179],v[164:167],a[160:163]
buffer_load_dwordx4 v[56:59],v6,s[8:11],s80 offen offset:0 sc1
v_mfma_f32_16x16x32_bf16 a[192:195],v[176:179],v[168:171],a[192:195]
ds_read_b64_tr_b16 v[194:195],v40 offset:12288
v_add_u32 v40,0x4000,v40
v_mfma_f32_16x16x32_bf16 a[224:227],v[176:179],v[172:175],a[224:227]
v_cvt_pk_bf16_f32 v252,v232,v233
s_waitcnt lgkmcnt(4)
v_mfma_f32_16x16x32_bf16 a[228:231],v[180:183],v[172:175],a[228:231]
ds_read_b64_tr_b16 v[196:197],v41 offset:8192
v_cvt_pk_bf16_f32 v253,v234,v235
v_mfma_f32_16x16x32_bf16 a[196:199],v[180:183],v[168:171],a[196:199]
v_cvt_pk_bf16_f32 v254,v236,v237
v_cvt_pk_bf16_f32 v255,v238,v239
v_mfma_f32_16x16x32_bf16 a[164:167],v[180:183],v[164:167],a[164:167]
ds_read_b64_tr_b16 v[198:199],v41 offset:12288
v_accvgpr_read_b32 v208,a32
v_mfma_f32_16x16x32_bf16 a[132:135],v[180:183],v[160:163],a[132:135]
buffer_load_dwordx4 v[60:63],v7,s[8:11],s80 offen offset:0 sc1
v_add_u32 v41,0x4000,v41
v_mfma_f32_16x16x32_bf16 a[136:139],v[184:187],v[160:163],a[136:139]
ds_read_b64_tr_b16 v[200:201],v42 offset:8192
v_accvgpr_read_b32 v209,a33
v_mfma_f32_16x16x32_bf16 a[168:171],v[184:187],v[164:167],a[168:171]
buffer_store_dwordx4 v[252:255],v20,s[8:11],s55 offen offset:2048 sc1
v_mfma_f32_16x16x32_bf16 a[200:203],v[184:187],v[168:171],a[200:203]
ds_read_b64_tr_b16 v[202:203],v42 offset:12288
v_add_u32 v42,0x4000,v42
v_mfma_f32_16x16x32_bf16 a[232:235],v[184:187],v[172:175],a[232:235]
v_accvgpr_read_b32 v210,a34
s_waitcnt lgkmcnt(4)
v_mfma_f32_16x16x32_bf16 a[236:239],v[188:191],v[172:175],a[236:239]
ds_read_b64_tr_b16 v[204:205],v43 offset:8192
v_accvgpr_read_b32 v211,a35
v_mfma_f32_16x16x32_bf16 a[204:207],v[188:191],v[168:171],a[204:207]
buffer_load_dwordx4 v[64:67],v4,s[8:11],s80 offen offset:2048 sc1
v_mfma_f32_16x16x32_bf16 a[172:175],v[188:191],v[164:167],a[172:175]
ds_read_b64_tr_b16 v[206:207],v43 offset:12288
v_accvgpr_read_b32 v212,a36
v_mfma_f32_16x16x32_bf16 a[140:143],v[188:191],v[160:163],a[140:143]
s_barrier
v_add_u32 v43,0x4000,v43
v_mfma_f32_16x16x32_bf16 a[144:147],v[192:195],v[160:163],a[144:147]
ds_read_b64_tr_b16 v[176:177],v36 offset:0
v_accvgpr_read_b32 v213,a37
v_mfma_f32_16x16x32_bf16 a[176:179],v[192:195],v[164:167],a[176:179]
buffer_load_dwordx4 v[68:71],v5,s[8:11],s80 offen offset:2048 sc1
v_mfma_f32_16x16x32_bf16 a[208:211],v[192:195],v[168:171],a[208:211]
ds_read_b64_tr_b16 v[178:179],v36 offset:4096
v_accvgpr_read_b32 v214,a38
v_mfma_f32_16x16x32_bf16 a[240:243],v[192:195],v[172:175],a[240:243]
v_accvgpr_read_b32 v215,a39
s_waitcnt lgkmcnt(4)
v_mfma_f32_16x16x32_bf16 a[244:247],v[196:199],v[172:175],a[244:247]
ds_read_b64_tr_b16 v[180:181],v37 offset:0
v_mul_f32 v208,v208,v17
v_mfma_f32_16x16x32_bf16 a[212:215],v[196:199],v[168:171],a[212:215]
v_mul_f32 v209,v209,v17
v_mul_f32 v210,v210,v17
v_mfma_f32_16x16x32_bf16 a[180:183],v[196:199],v[164:167],a[180:183]
ds_read_b64_tr_b16 v[182:183],v37 offset:4096
v_mul_f32 v211,v211,v17
v_mfma_f32_16x16x32_bf16 a[148:151],v[196:199],v[160:163],a[148:151]
buffer_load_dwordx4 v[72:75],v6,s[8:11],s80 offen offset:2048 sc1
v_mfma_f32_16x16x32_bf16 a[152:155],v[200:203],v[160:163],a[152:155]
ds_read_b64_tr_b16 v[184:185],v38 offset:0
v_mul_f32 v212,v212,v17
v_mfma_f32_16x16x32_bf16 a[184:187],v[200:203],v[164:167],a[184:187]
v_mul_f32 v213,v213,v17
v_mul_f32 v214,v214,v17
v_mfma_f32_16x16x32_bf16 a[216:219],v[200:203],v[168:171],a[216:219]
ds_read_b64_tr_b16 v[186:187],v38 offset:4096
v_mul_f32 v215,v215,v17
v_mfma_f32_16x16x32_bf16 a[248:251],v[200:203],v[172:175],a[248:251]
v_cvt_pk_bf16_f32 v240,v208,v209
s_waitcnt lgkmcnt(6)
v_mfma_f32_16x16x32_bf16 a[252:255],v[204:207],v[172:175],a[252:255]
ds_read_b64_tr_b16 v[188:189],v39 offset:0
v_cvt_pk_bf16_f32 v241,v210,v211
v_mfma_f32_16x16x32_bf16 a[220:223],v[204:207],v[168:171],a[220:223]
buffer_load_dwordx4 v[76:79],v7,s[8:11],s80 offen offset:2048 sc1
v_mfma_f32_16x16x32_bf16 a[188:191],v[204:207],v[164:167],a[188:191]
ds_read_b64_tr_b16 v[190:191],v39 offset:4096
s_add_u32 s80,s80,0x40000
v_mfma_f32_16x16x32_bf16 a[156:159],v[204:207],v[160:163],a[156:159]
s_waitcnt vmcnt(19) lgkmcnt(6)
v_mfma_f32_16x16x32_bf16 a[128:131],v[176:179],v[80:83],a[128:131]
ds_read_b64_tr_b16 v[192:193],v40 offset:0
v_cvt_pk_bf16_f32 v242,v212,v213
v_mfma_f32_16x16x32_bf16 a[160:163],v[176:179],v[84:87],a[160:163]
v_cvt_pk_bf16_f32 v243,v214,v215
v_accvgpr_read_b32 v216,a40
v_mfma_f32_16x16x32_bf16 a[192:195],v[176:179],v[88:91],a[192:195]
ds_read_b64_tr_b16 v[194:195],v40 offset:4096
v_accvgpr_read_b32 v217,a41
v_mfma_f32_16x16x32_bf16 a[224:227],v[176:179],v[92:95],a[224:227]
v_accvgpr_read_b32 v218,a42
s_waitcnt lgkmcnt(4)
v_mfma_f32_16x16x32_bf16 a[228:231],v[180:183],v[92:95],a[228:231]
ds_read_b64_tr_b16 v[196:197],v41 offset:0
v_accvgpr_read_b32 v219,a43
v_mfma_f32_16x16x32_bf16 a[196:199],v[180:183],v[88:91],a[196:199]
buffer_load_dwordx4 v[144:147],v4,s[8:11],s80 offen offset:0 sc1
v_mfma_f32_16x16x32_bf16 a[164:167],v[180:183],v[84:87],a[164:167]
ds_read_b64_tr_b16 v[198:199],v41 offset:4096
v_accvgpr_read_b32 v220,a44
v_mfma_f32_16x16x32_bf16 a[132:135],v[180:183],v[80:83],a[132:135]
buffer_store_dwordx4 v[240:243],v20,s[8:11],s54 offen offset:1024 sc1
v_mfma_f32_16x16x32_bf16 a[136:139],v[184:187],v[80:83],a[136:139]
ds_read_b64_tr_b16 v[200:201],v42 offset:0
v_accvgpr_read_b32 v221,a45
v_mfma_f32_16x16x32_bf16 a[168:171],v[184:187],v[84:87],a[168:171]
v_accvgpr_read_b32 v222,a46
v_accvgpr_read_b32 v223,a47
v_mfma_f32_16x16x32_bf16 a[200:203],v[184:187],v[88:91],a[200:203]
ds_read_b64_tr_b16 v[202:203],v42 offset:4096
v_mul_f32 v216,v216,v17
v_mfma_f32_16x16x32_bf16 a[232:235],v[184:187],v[92:95],a[232:235]
v_mul_f32 v217,v217,v17
s_waitcnt lgkmcnt(4)
v_mfma_f32_16x16x32_bf16 a[236:239],v[188:191],v[92:95],a[236:239]
ds_read_b64_tr_b16 v[204:205],v43 offset:0
v_mul_f32 v218,v218,v17
v_mfma_f32_16x16x32_bf16 a[204:207],v[188:191],v[88:91],a[204:207]
buffer_load_dwordx4 v[148:151],v5,s[8:11],s80 offen offset:0 sc1
v_mfma_f32_16x16x32_bf16 a[172:175],v[188:191],v[84:87],a[172:175]
ds_read_b64_tr_b16 v[206:207],v43 offset:4096
v_mul_f32 v219,v219,v17
v_mfma_f32_16x16x32_bf16 a[140:143],v[188:191],v[80:83],a[140:143]
v_mul_f32 v220,v220,v17
v_mul_f32 v221,v221,v17
v_mfma_f32_16x16x32_bf16 a[144:147],v[192:195],v[80:83],a[144:147]
ds_read_b64_tr_b16 v[176:177],v36 offset:8192
v_mul_f32 v222,v222,v17
v_mfma_f32_16x16x32_bf16 a[176:179],v[192:195],v[84:87],a[176:179]
v_mul_f32 v223,v223,v17
v_cvt_pk_bf16_f32 v244,v216,v217
v_mfma_f32_16x16x32_bf16 a[208:211],v[192:195],v[88:91],a[208:211]
ds_read_b64_tr_b16 v[178:179],v36 offset:12288
v_add_u32 v36,0x4000,v36
v_mfma_f32_16x16x32_bf16 a[240:243],v[192:195],v[92:95],a[240:243]
v_cvt_pk_bf16_f32 v245,v218,v219
s_waitcnt lgkmcnt(4)
v_mfma_f32_16x16x32_bf16 a[244:247],v[196:199],v[92:95],a[244:247]
ds_read_b64_tr_b16 v[180:181],v37 offset:8192
v_cvt_pk_bf16_f32 v246,v220,v221
v_mfma_f32_16x16x32_bf16 a[212:215],v[196:199],v[88:91],a[212:215]
buffer_load_dwordx4 v[152:155],v6,s[8:11],s80 offen offset:0 sc1
v_mfma_f32_16x16x32_bf16 a[180:183],v[196:199],v[84:87],a[180:183]
ds_read_b64_tr_b16 v[182:183],v37 offset:12288
v_cvt_pk_bf16_f32 v247,v222,v223
v_mfma_f32_16x16x32_bf16 a[148:151],v[196:199],v[80:83],a[148:151]
v_add_u32 v37,0x4000,v37
v_accvgpr_read_b32 v224,a48
v_mfma_f32_16x16x32_bf16 a[152:155],v[200:203],v[80:83],a[152:155]
ds_read_b64_tr_b16 v[184:185],v38 offset:8192
v_accvgpr_read_b32 v225,a49
v_mfma_f32_16x16x32_bf16 a[184:187],v[200:203],v[84:87],a[184:187]
buffer_store_dwordx4 v[244:247],v20,s[8:11],s54 offen offset:3072 sc1
v_mfma_f32_16x16x32_bf16 a[216:219],v[200:203],v[88:91],a[216:219]
ds_read_b64_tr_b16 v[186:187],v38 offset:12288
v_add_u32 v38,0x4000,v38
v_mfma_f32_16x16x32_bf16 a[248:251],v[200:203],v[92:95],a[248:251]
v_accvgpr_read_b32 v226,a50
s_waitcnt lgkmcnt(4)
v_mfma_f32_16x16x32_bf16 a[252:255],v[204:207],v[92:95],a[252:255]
ds_read_b64_tr_b16 v[188:189],v39 offset:8192
v_accvgpr_read_b32 v227,a51
v_mfma_f32_16x16x32_bf16 a[220:223],v[204:207],v[88:91],a[220:223]
buffer_load_dwordx4 v[156:159],v7,s[8:11],s80 offen offset:0 sc1
v_mfma_f32_16x16x32_bf16 a[188:191],v[204:207],v[84:87],a[188:191]
ds_read_b64_tr_b16 v[190:191],v39 offset:12288
v_accvgpr_read_b32 v228,a52
v_mfma_f32_16x16x32_bf16 a[156:159],v[204:207],v[80:83],a[156:159]
v_add_u32 v39,0x4000,v39
v_accvgpr_read_b32 v229,a53
v_mfma_f32_16x16x32_bf16 a[128:131],v[176:179],v[96:99],a[128:131]
ds_read_b64_tr_b16 v[192:193],v40 offset:8192
v_accvgpr_read_b32 v230,a54
v_mfma_f32_16x16x32_bf16 a[160:163],v[176:179],v[100:103],a[160:163]
v_accvgpr_read_b32 v231,a55
v_mul_f32 v224,v224,v17
v_mfma_f32_16x16x32_bf16 a[192:195],v[176:179],v[104:107],a[192:195]
ds_read_b64_tr_b16 v[194:195],v40 offset:12288
v_add_u32 v40,0x4000,v40
v_mfma_f32_16x16x32_bf16 a[224:227],v[176:179],v[108:111],a[224:227]
buffer_load_dwordx4 v[160:163],v4,s[8:11],s80 offen offset:2048 sc1
s_waitcnt lgkmcnt(4)
v_mfma_f32_16x16x32_bf16 a[228:231],v[180:183],v[108:111],a[228:231]
ds_read_b64_tr_b16 v[196:197],v41 offset:8192
v_mul_f32 v225,v225,v17
v_mfma_f32_16x16x32_bf16 a[196:199],v[180:183],v[104:107],a[196:199]
v_mul_f32 v226,v226,v17
v_mul_f32 v227,v227,v17
v_mfma_f32_16x16x32_bf16 a[164:167],v[180:183],v[100:103],a[164:167]
ds_read_b64_tr_b16 v[198:199],v41 offset:12288
v_mul_f32 v228,v228,v17
v_mfma_f32_16x16x32_bf16 a[132:135],v[180:183],v[96:99],a[132:135]
v_add_u32 v41,0x4000,v41
v_mul_f32 v229,v229,v17
v_mfma_f32_16x16x32_bf16 a[136:139],v[184:187],v[96:99],a[136:139]
ds_read_b64_tr_b16 v[200:201],v42 offset:8192
v_mul_f32 v230,v230,v17
v_mfma_f32_16x16x32_bf16 a[168:171],v[184:187],v[100:103],a[168:171]
v_mul_f32 v231,v231,v17
v_cvt_pk_bf16_f32 v248,v224,v225
v_mfma_f32_16x16x32_bf16 a[200:203],v[184:187],v[104:107],a[200:203]
ds_read_b64_tr_b16 v[202:203],v42 offset:12288
v_add_u32 v42,0x4000,v42
v_mfma_f32_16x16x32_bf16 a[232:235],v[184:187],v[108:111],a[232:235]
buffer_load_dwordx4 v[164:167],v5,s[8:11],s80 offen offset:2048 sc1
s_waitcnt lgkmcnt(4)
v_mfma_f32_16x16x32_bf16 a[236:239],v[188:191],v[108:111],a[236:239]
ds_read_b64_tr_b16 v[204:205],v43 offset:8192
v_cvt_pk_bf16_f32 v249,v226,v227
v_mfma_f32_16x16x32_bf16 a[204:207],v[188:191],v[104:107],a[204:207]
v_cvt_pk_bf16_f32 v250,v228,v229
v_cvt_pk_bf16_f32 v251,v230,v231
v_mfma_f32_16x16x32_bf16 a[172:175],v[188:191],v[100:103],a[172:175]
ds_read_b64_tr_b16 v[206:207],v43 offset:12288
v_accvgpr_read_b32 v232,a56
v_mfma_f32_16x16x32_bf16 a[140:143],v[188:191],v[96:99],a[140:143]
s_barrier
v_add_u32 v43,0x4000,v43
v_mfma_f32_16x16x32_bf16 a[144:147],v[192:195],v[96:99],a[144:147]
ds_read_b64_tr_b16 v[176:177],v36 offset:0
v_accvgpr_read_b32 v233,a57
v_mfma_f32_16x16x32_bf16 a[176:179],v[192:195],v[100:103],a[176:179]
buffer_store_dwordx4 v[248:251],v20,s[8:11],s55 offen offset:1024 sc1
v_mfma_f32_16x16x32_bf16 a[208:211],v[192:195],v[104:107],a[208:211]
ds_read_b64_tr_b16 v[178:179],v36 offset:4096
v_accvgpr_read_b32 v234,a58
v_mfma_f32_16x16x32_bf16 a[240:243],v[192:195],v[108:111],a[240:243]
buffer_load_dwordx4 v[168:171],v6,s[8:11],s80 offen offset:2048 sc1
s_waitcnt lgkmcnt(4)
v_mfma_f32_16x16x32_bf16 a[244:247],v[196:199],v[108:111],a[244:247]
ds_read_b64_tr_b16 v[180:181],v37 offset:0
v_accvgpr_read_b32 v235,a59
v_mfma_f32_16x16x32_bf16 a[212:215],v[196:199],v[104:107],a[212:215]
v_accvgpr_read_b32 v236,a60
v_accvgpr_read_b32 v237,a61
v_mfma_f32_16x16x32_bf16 a[180:183],v[196:199],v[100:103],a[180:183]
ds_read_b64_tr_b16 v[182:183],v37 offset:4096
v_accvgpr_read_b32 v238,a62
v_mfma_f32_16x16x32_bf16 a[148:151],v[196:199],v[96:99],a[148:151]
v_accvgpr_read_b32 v239,a63
v_mul_f32 v232,v232,v17
v_mfma_f32_16x16x32_bf16 a[152:155],v[200:203],v[96:99],a[152:155]
ds_read_b64_tr_b16 v[184:185],v38 offset:0
v_mul_f32 v233,v233,v17
v_mfma_f32_16x16x32_bf16 a[184:187],v[200:203],v[100:103],a[184:187]
v_mul_f32 v234,v234,v17
v_mul_f32 v235,v235,v17
v_mfma_f32_16x16x32_bf16 a[216:219],v[200:203],v[104:107],a[216:219]
ds_read_b64_tr_b16 v[186:187],v38 offset:4096
v_mul_f32 v236,v236,v17
v_mfma_f32_16x16x32_bf16 a[248:251],v[200:203],v[108:111],a[248:251]
buffer_load_dwordx4 v[172:175],v7,s[8:11],s80 offen offset:2048 sc1
s_waitcnt lgkmcnt(6)
v_mfma_f32_16x16x32_bf16 a[252:255],v[204:207],v[108:111],a[252:255]
ds_read_b64_tr_b16 v[188:189],v39 offset:0
s_add_u32 s80,s80,0x40000
v_mfma_f32_16x16x32_bf16 a[220:223],v[204:207],v[104:107],a[220:223]
v_mul_f32 v237,v237,v17
v_mul_f32 v238,v238,v17
v_mfma_f32_16x16x32_bf16 a[188:191],v[204:207],v[100:103],a[188:191]
ds_read_b64_tr_b16 v[190:191],v39 offset:4096
v_mul_f32 v239,v239,v17
v_mfma_f32_16x16x32_bf16 a[156:159],v[204:207],v[96:99],a[156:159]
s_waitcnt vmcnt(20) lgkmcnt(6)
v_mfma_f32_16x16x32_bf16 a[128:131],v[176:179],v[112:115],a[128:131]
ds_read_b64_tr_b16 v[192:193],v40 offset:0
v_cvt_pk_bf16_f32 v252,v232,v233
v_mfma_f32_16x16x32_bf16 a[160:163],v[176:179],v[116:119],a[160:163]
v_cvt_pk_bf16_f32 v253,v234,v235
v_cvt_pk_bf16_f32 v254,v236,v237
v_mfma_f32_16x16x32_bf16 a[192:195],v[176:179],v[120:123],a[192:195]
ds_read_b64_tr_b16 v[194:195],v40 offset:4096
v_cvt_pk_bf16_f32 v255,v238,v239
v_mfma_f32_16x16x32_bf16 a[224:227],v[176:179],v[124:127],a[224:227]
v_accvgpr_read_b32 v208,a64
s_waitcnt lgkmcnt(4)
v_mfma_f32_16x16x32_bf16 a[228:231],v[180:183],v[124:127],a[228:231]
ds_read_b64_tr_b16 v[196:197],v41 offset:0
v_accvgpr_read_b32 v209,a65
v_mfma_f32_16x16x32_bf16 a[196:199],v[180:183],v[120:123],a[196:199]
buffer_load_dwordx4 v[80:83],v4,s[8:11],s80 offen offset:0 sc1
v_mfma_f32_16x16x32_bf16 a[164:167],v[180:183],v[116:119],a[164:167]
ds_read_b64_tr_b16 v[198:199],v41 offset:4096
v_accvgpr_read_b32 v210,a66
v_mfma_f32_16x16x32_bf16 a[132:135],v[180:183],v[112:115],a[132:135]
buffer_store_dwordx4 v[252:255],v20,s[8:11],s55 offen offset:3072 sc1
v_mfma_f32_16x16x32_bf16 a[136:139],v[184:187],v[112:115],a[136:139]
ds_read_b64_tr_b16 v[200:201],v42 offset:0
v_accvgpr_read_b32 v211,a67
v_mfma_f32_16x16x32_bf16 a[168:171],v[184:187],v[116:119],a[168:171]
v_accvgpr_read_b32 v212,a68
v_accvgpr_read_b32 v213,a69
v_mfma_f32_16x16x32_bf16 a[200:203],v[184:187],v[120:123],a[200:203]
ds_read_b64_tr_b16 v[202:203],v42 offset:4096
v_accvgpr_read_b32 v214,a70
v_mfma_f32_16x16x32_bf16 a[232:235],v[184:187],v[124:127],a[232:235]
v_accvgpr_read_b32 v215,a71
s_waitcnt lgkmcnt(4)
v_mfma_f32_16x16x32_bf16 a[236:239],v[188:191],v[124:127],a[236:239]
ds_read_b64_tr_b16 v[204:205],v43 offset:0
v_mul_f32 v208,v208,v18
v_mfma_f32_16x16x32_bf16 a[204:207],v[188:191],v[120:123],a[204:207]
buffer_load_dwordx4 v[84:87],v5,s[8:11],s80 offen offset:0 sc1
v_mfma_f32_16x16x32_bf16 a[172:175],v[188:191],v[116:119],a[172:175]
ds_read_b64_tr_b16 v[206:207],v43 offset:4096
v_mul_f32 v209,v209,v18
v_mfma_f32_16x16x32_bf16 a[140:143],v[188:191],v[112:115],a[140:143]
v_mul_f32 v210,v210,v18
v_mul_f32 v211,v211,v18
v_mfma_f32_16x16x32_bf16 a[144:147],v[192:195],v[112:115],a[144:147]
ds_read_b64_tr_b16 v[176:177],v36 offset:8192
v_mul_f32 v212,v212,v18
v_mfma_f32_16x16x32_bf16 a[176:179],v[192:195],v[116:119],a[176:179]
v_mul_f32 v213,v213,v18
v_mul_f32 v214,v214,v18
v_mfma_f32_16x16x32_bf16 a[208:211],v[192:195],v[120:123],a[208:211]
ds_read_b64_tr_b16 v[178:179],v36 offset:12288
v_add_u32 v36,0xfffdc000,v36
v_mfma_f32_16x16x32_bf16 a[240:243],v[192:195],v[124:127],a[240:243]
v_mul_f32 v215,v215,v18
s_waitcnt lgkmcnt(4)
v_mfma_f32_16x16x32_bf16 a[244:247],v[196:199],v[124:127],a[244:247]
ds_read_b64_tr_b16 v[180:181],v37 offset:8192
v_cvt_pk_bf16_f32 v240,v208,v209
v_mfma_f32_16x16x32_bf16 a[212:215],v[196:199],v[120:123],a[212:215]
buffer_load_dwordx4 v[88:91],v6,s[8:11],s80 offen offset:0 sc1
v_mfma_f32_16x16x32_bf16 a[180:183],v[196:199],v[116:119],a[180:183]
ds_read_b64_tr_b16 v[182:183],v37 offset:12288
v_cvt_pk_bf16_f32 v241,v210,v211
v_mfma_f32_16x16x32_bf16 a[148:151],v[196:199],v[112:115],a[148:151]
v_add_u32 v37,0xfffdc000,v37
v_cvt_pk_bf16_f32 v242,v212,v213
v_mfma_f32_16x16x32_bf16 a[152:155],v[200:203],v[112:115],a[152:155]
ds_read_b64_tr_b16 v[184:185],v38 offset:8192
v_cvt_pk_bf16_f32 v243,v214,v215
v_mfma_f32_16x16x32_bf16 a[184:187],v[200:203],v[116:119],a[184:187]
buffer_store_dwordx4 v[240:243],v21,s[8:11],s54 offen offset:0 sc1
v_mfma_f32_16x16x32_bf16 a[216:219],v[200:203],v[120:123],a[216:219]
ds_read_b64_tr_b16 v[186:187],v38 offset:12288
v_add_u32 v38,0xfffdc000,v38
v_mfma_f32_16x16x32_bf16 a[248:251],v[200:203],v[124:127],a[248:251]
v_accvgpr_read_b32 v216,a72
s_waitcnt lgkmcnt(4)
v_mfma_f32_16x16x32_bf16 a[252:255],v[204:207],v[124:127],a[252:255]
ds_read_b64_tr_b16 v[188:189],v39 offset:8192
v_accvgpr_read_b32 v217,a73
v_mfma_f32_16x16x32_bf16 a[220:223],v[204:207],v[120:123],a[220:223]
buffer_load_dwordx4 v[92:95],v7,s[8:11],s80 offen offset:0 sc1
v_mfma_f32_16x16x32_bf16 a[188:191],v[204:207],v[116:119],a[188:191]
ds_read_b64_tr_b16 v[190:191],v39 offset:12288
v_accvgpr_read_b32 v218,a74
v_mfma_f32_16x16x32_bf16 a[156:159],v[204:207],v[112:115],a[156:159]
v_add_u32 v39,0xfffdc000,v39
v_accvgpr_read_b32 v219,a75
v_mfma_f32_16x16x32_bf16 a[128:131],v[176:179],v[128:131],a[128:131]
ds_read_b64_tr_b16 v[192:193],v40 offset:8192
v_accvgpr_read_b32 v220,a76
v_mfma_f32_16x16x32_bf16 a[160:163],v[176:179],v[132:135],a[160:163]
v_accvgpr_read_b32 v221,a77
v_accvgpr_read_b32 v222,a78
v_mfma_f32_16x16x32_bf16 a[192:195],v[176:179],v[136:139],a[192:195]
ds_read_b64_tr_b16 v[194:195],v40 offset:12288
v_add_u32 v40,0xfffdc000,v40
v_mfma_f32_16x16x32_bf16 a[224:227],v[176:179],v[140:143],a[224:227]
buffer_load_dwordx4 v[96:99],v4,s[8:11],s80 offen offset:2048 sc1
s_waitcnt lgkmcnt(4)
v_mfma_f32_16x16x32_bf16 a[228:231],v[180:183],v[140:143],a[228:231]
ds_read_b64_tr_b16 v[196:197],v41 offset:8192
v_accvgpr_read_b32 v223,a79
v_mfma_f32_16x16x32_bf16 a[196:199],v[180:183],v[136:139],a[196:199]
v_mul_f32 v216,v216,v18
v_mul_f32 v217,v217,v18
v_mfma_f32_16x16x32_bf16 a[164:167],v[180:183],v[132:135],a[164:167]
ds_read_b64_tr_b16 v[198:199],v41 offset:12288
v_mul_f32 v218,v218,v18
v_mfma_f32_16x16x32_bf16 a[132:135],v[180:183],v[128:131],a[132:135]
v_add_u32 v41,0xfffdc000,v41
v_mul_f32 v219,v219,v18
v_mfma_f32_16x16x32_bf16 a[136:139],v[184:187],v[128:131],a[136:139]
ds_read_b64_tr_b16 v[200:201],v42 offset:8192
v_mul_f32 v220,v220,v18
v_mfma_f32_16x16x32_bf16 a[168:171],v[184:187],v[132:135],a[168:171]
v_mul_f32 v221,v221,v18
v_mul_f32 v222,v222,v18
v_mfma_f32_16x16x32_bf16 a[200:203],v[184:187],v[136:139],a[200:203]
ds_read_b64_tr_b16 v[202:203],v42 offset:12288
v_add_u32 v42,0xfffdc000,v42
v_mfma_f32_16x16x32_bf16 a[232:235],v[184:187],v[140:143],a[232:235]
buffer_load_dwordx4 v[100:103],v5,s[8:11],s80 offen offset:2048 sc1
s_waitcnt lgkmcnt(4)
v_mfma_f32_16x16x32_bf16 a[236:239],v[188:191],v[140:143],a[236:239]
ds_read_b64_tr_b16 v[204:205],v43 offset:8192
v_mul_f32 v223,v223,v18
v_mfma_f32_16x16x32_bf16 a[204:207],v[188:191],v[136:139],a[204:207]
v_cvt_pk_bf16_f32 v244,v216,v217
v_cvt_pk_bf16_f32 v245,v218,v219
v_mfma_f32_16x16x32_bf16 a[172:175],v[188:191],v[132:135],a[172:175]
ds_read_b64_tr_b16 v[206:207],v43 offset:12288
v_cvt_pk_bf16_f32 v246,v220,v221
v_mfma_f32_16x16x32_bf16 a[140:143],v[188:191],v[128:131],a[140:143]
s_barrier
v_add_u32 v43,0xfffdc000,v43
v_mfma_f32_16x16x32_bf16 a[144:147],v[192:195],v[128:131],a[144:147]
ds_read_b64_tr_b16 v[176:177],v36 offset:0
v_cvt_pk_bf16_f32 v247,v222,v223
v_mfma_f32_16x16x32_bf16 a[176:179],v[192:195],v[132:135],a[176:179]
buffer_store_dwordx4 v[244:247],v21,s[8:11],s54 offen offset:2048 sc1
v_mfma_f32_16x16x32_bf16 a[208:211],v[192:195],v[136:139],a[208:211]
ds_read_b64_tr_b16 v[178:179],v36 offset:4096
v_accvgpr_read_b32 v224,a80
v_mfma_f32_16x16x32_bf16 a[240:243],v[192:195],v[140:143],a[240:243]
buffer_load_dwordx4 v[104:107],v6,s[8:11],s80 offen offset:2048 sc1
s_waitcnt lgkmcnt(4)
v_mfma_f32_16x16x32_bf16 a[244:247],v[196:199],v[140:143],a[244:247]
ds_read_b64_tr_b16 v[180:181],v37 offset:0
v_accvgpr_read_b32 v225,a81
v_mfma_f32_16x16x32_bf16 a[212:215],v[196:199],v[136:139],a[212:215]
v_accvgpr_read_b32 v226,a82
v_accvgpr_read_b32 v227,a83
v_mfma_f32_16x16x32_bf16 a[180:183],v[196:199],v[132:135],a[180:183]
ds_read_b64_tr_b16 v[182:183],v37 offset:4096
v_accvgpr_read_b32 v228,a84
v_mfma_f32_16x16x32_bf16 a[148:151],v[196:199],v[128:131],a[148:151]
v_accvgpr_read_b32 v229,a85
v_accvgpr_read_b32 v230,a86
v_mfma_f32_16x16x32_bf16 a[152:155],v[200:203],v[128:131],a[152:155]
ds_read_b64_tr_b16 v[184:185],v38 offset:0
v_accvgpr_read_b32 v231,a87
v_mfma_f32_16x16x32_bf16 a[184:187],v[200:203],v[132:135],a[184:187]
v_mul_f32 v224,v224,v18
v_mul_f32 v225,v225,v18
v_mfma_f32_16x16x32_bf16 a[216:219],v[200:203],v[136:139],a[216:219]
ds_read_b64_tr_b16 v[186:187],v38 offset:4096
v_mul_f32 v226,v226,v18
v_mfma_f32_16x16x32_bf16 a[248:251],v[200:203],v[140:143],a[248:251]
buffer_load_dwordx4 v[108:111],v7,s[8:11],s80 offen offset:2048 sc1
s_waitcnt lgkmcnt(6)
v_mfma_f32_16x16x32_bf16 a[252:255],v[204:207],v[140:143],a[252:255]
ds_read_b64_tr_b16 v[188:189],v39 offset:0
s_add_u32 s80,s80,0x40000
v_mfma_f32_16x16x32_bf16 a[220:223],v[204:207],v[136:139],a[220:223]
v_mul_f32 v227,v227,v18
v_mul_f32 v228,v228,v18
v_mfma_f32_16x16x32_bf16 a[188:191],v[204:207],v[132:135],a[188:191]
ds_read_b64_tr_b16 v[190:191],v39 offset:4096
v_mul_f32 v229,v229,v18
v_mfma_f32_16x16x32_bf16 a[156:159],v[204:207],v[128:131],a[156:159]
s_waitcnt vmcnt(22) lgkmcnt(6)
v_mfma_f32_16x16x32_bf16 a[128:131],v[176:179],v[48:51],a[128:131]
ds_read_b64_tr_b16 v[192:193],v40 offset:0
v_mul_f32 v230,v230,v18
v_mfma_f32_16x16x32_bf16 a[160:163],v[176:179],v[52:55],a[160:163]
v_mul_f32 v231,v231,v18
v_cvt_pk_bf16_f32 v248,v224,v225
v_mfma_f32_16x16x32_bf16 a[192:195],v[176:179],v[56:59],a[192:195]
ds_read_b64_tr_b16 v[194:195],v40 offset:4096
v_cvt_pk_bf16_f32 v249,v226,v227
v_mfma_f32_16x16x32_bf16 a[224:227],v[176:179],v[60:63],a[224:227]
buffer_load_dwordx4 v[112:115],v4,s[8:11],s80 offen offset:0 sc1
s_waitcnt lgkmcnt(4)
v_mfma_f32_16x16x32_bf16 a[228:231],v[180:183],v[60:63],a[228:231]
ds_read_b64_tr_b16 v[196:197],v41 offset:0
v_cvt_pk_bf16_f32 v250,v228,v229
v_mfma_f32_16x16x32_bf16 a[196:199],v[180:183],v[56:59],a[196:199]
v_cvt_pk_bf16_f32 v251,v230,v231
v_accvgpr_read_b32 v232,a88
v_mfma_f32_16x16x32_bf16 a[164:167],v[180:183],v[52:55],a[164:167]
ds_read_b64_tr_b16 v[198:199],v41 offset:4096
v_accvgpr_read_b32 v233,a89
v_mfma_f32_16x16x32_bf16 a[132:135],v[180:183],v[48:51],a[132:135]
buffer_load_dwordx4 v[116:119],v5,s[8:11],s80 offen offset:0 sc1
v_mfma_f32_16x16x32_bf16 a[136:139],v[184:187],v[48:51],a[136:139]
ds_read_b64_tr_b16 v[200:201],v42 offset:0
s_add_u32 m0,s92,32768
v_mfma_f32_16x16x32_bf16 a[168:171],v[184:187],v[52:55],a[168:171]
buffer_store_dwordx4 v[248:251],v21,s[8:11],s55 offen offset:0 sc1
v_mfma_f32_16x16x32_bf16 a[200:203],v[184:187],v[56:59],a[200:203]
ds_read_b64_tr_b16 v[202:203],v42 offset:4096
v_accvgpr_read_b32 v234,a90
v_mfma_f32_16x16x32_bf16 a[232:235],v[184:187],v[60:63],a[232:235]
v_accvgpr_read_b32 v235,a91
s_waitcnt lgkmcnt(4)
v_mfma_f32_16x16x32_bf16 a[236:239],v[188:191],v[60:63],a[236:239]
ds_read_b64_tr_b16 v[204:205],v43 offset:0
v_accvgpr_read_b32 v236,a92
v_mfma_f32_16x16x32_bf16 a[204:207],v[188:191],v[56:59],a[204:207]
buffer_load_dwordx4 v32,s[32:35],s58 offen lds
v_mfma_f32_16x16x32_bf16 a[172:175],v[188:191],v[52:55],a[172:175]
ds_read_b64_tr_b16 v[206:207],v43 offset:4096
v_accvgpr_read_b32 v237,a93
v_mfma_f32_16x16x32_bf16 a[140:143],v[188:191],v[48:51],a[140:143]
v_accvgpr_read_b32 v238,a94
v_accvgpr_read_b32 v239,a95
v_mfma_f32_16x16x32_bf16 a[144:147],v[192:195],v[48:51],a[144:147]
ds_read_b64_tr_b16 v[176:177],v36 offset:8192
v_mul_f32 v232,v232,v18
v_mfma_f32_16x16x32_bf16 a[176:179],v[192:195],v[52:55],a[176:179]
v_mul_f32 v233,v233,v18
v_mul_f32 v234,v234,v18
v_mfma_f32_16x16x32_bf16 a[208:211],v[192:195],v[56:59],a[208:211]
ds_read_b64_tr_b16 v[178:179],v36 offset:12288
v_add_u32 v36,0x4000,v36
v_mfma_f32_16x16x32_bf16 a[240:243],v[192:195],v[60:63],a[240:243]
buffer_load_dwordx4 v[120:123],v6,s[8:11],s80 offen offset:0 sc1
s_waitcnt lgkmcnt(4)
v_mfma_f32_16x16x32_bf16 a[244:247],v[196:199],v[60:63],a[244:247]
ds_read_b64_tr_b16 v[180:181],v37 offset:8192
v_mul_f32 v235,v235,v18
v_mfma_f32_16x16x32_bf16 a[212:215],v[196:199],v[56:59],a[212:215]
v_mul_f32 v236,v236,v18
v_mul_f32 v237,v237,v18
v_mfma_f32_16x16x32_bf16 a[180:183],v[196:199],v[52:55],a[180:183]
ds_read_b64_tr_b16 v[182:183],v37 offset:12288
v_mul_f32 v238,v238,v18
v_mfma_f32_16x16x32_bf16 a[148:151],v[196:199],v[48:51],a[148:151]
v_add_u32 v37,0x4000,v37
v_mul_f32 v239,v239,v18
v_mfma_f32_16x16x32_bf16 a[152:155],v[200:203],v[48:51],a[152:155]
ds_read_b64_tr_b16 v[184:185],v38 offset:8192
v_cvt_pk_bf16_f32 v252,v232,v233
v_mfma_f32_16x16x32_bf16 a[184:187],v[200:203],v[52:55],a[184:187]
buffer_load_dwordx4 v[124:127],v7,s[8:11],s80 offen offset:0 sc1
v_mfma_f32_16x16x32_bf16 a[216:219],v[200:203],v[56:59],a[216:219]
ds_read_b64_tr_b16 v[186:187],v38 offset:12288
v_add_u32 v38,0x4000,v38
v_mfma_f32_16x16x32_bf16 a[248:251],v[200:203],v[60:63],a[248:251]
s_add_u32 m0,s92,33792
s_waitcnt lgkmcnt(4)
v_mfma_f32_16x16x32_bf16 a[252:255],v[204:207],v[60:63],a[252:255]
ds_read_b64_tr_b16 v[188:189],v39 offset:8192
v_cvt_pk_bf16_f32 v253,v234,v235
v_mfma_f32_16x16x32_bf16 a[220:223],v[204:207],v[56:59],a[220:223]
buffer_load_dwordx4 v33,s[32:35],s58 offen lds
v_mfma_f32_16x16x32_bf16 a[188:191],v[204:207],v[52:55],a[188:191]
ds_read_b64_tr_b16 v[190:191],v39 offset:12288
v_cvt_pk_bf16_f32 v254,v236,v237
v_mfma_f32_16x16x32_bf16 a[156:159],v[204:207],v[48:51],a[156:159]
v_add_u32 v39,0x4000,v39
v_cvt_pk_bf16_f32 v255,v238,v239
v_mfma_f32_16x16x32_bf16 a[128:131],v[176:179],v[64:67],a[128:131]
ds_read_b64_tr_b16 v[192:193],v40 offset:8192
v_accvgpr_read_b32 v208,a96
v_mfma_f32_16x16x32_bf16 a[160:163],v[176:179],v[68:71],a[160:163]
buffer_load_dwordx4 v[128:131],v4,s[8:11],s80 offen offset:2048 sc1
v_mfma_f32_16x16x32_bf16 a[192:195],v[176:179],v[72:75],a[192:195]
ds_read_b64_tr_b16 v[194:195],v40 offset:12288
v_add_u32 v40,0x4000,v40
v_mfma_f32_16x16x32_bf16 a[224:227],v[176:179],v[76:79],a[224:227]
v_accvgpr_read_b32 v209,a97
s_waitcnt lgkmcnt(4)
v_mfma_f32_16x16x32_bf16 a[228:231],v[180:183],v[76:79],a[228:231]
ds_read_b64_tr_b16 v[196:197],v41 offset:8192
v_accvgpr_read_b32 v210,a98
v_mfma_f32_16x16x32_bf16 a[196:199],v[180:183],v[72:75],a[196:199]
buffer_store_dwordx4 v[252:255],v21,s[8:11],s55 offen offset:2048 sc1
v_mfma_f32_16x16x32_bf16 a[164:167],v[180:183],v[68:71],a[164:167]
ds_read_b64_tr_b16 v[198:199],v41 offset:12288
v_accvgpr_read_b32 v211,a99
v_mfma_f32_16x16x32_bf16 a[132:135],v[180:183],v[64:67],a[132:135]
buffer_load_dwordx4 v[132:135],v5,s[8:11],s80 offen offset:2048 sc1
v_add_u32 v41,0x4000,v41
v_mfma_f32_16x16x32_bf16 a[136:139],v[184:187],v[64:67],a[136:139]
ds_read_b64_tr_b16 v[200:201],v42 offset:8192
s_add_u32 m0,s92,34816
v_mfma_f32_16x16x32_bf16 a[168:171],v[184:187],v[68:71],a[168:171]
v_accvgpr_read_b32 v212,a100
v_accvgpr_read_b32 v213,a101
v_mfma_f32_16x16x32_bf16 a[200:203],v[184:187],v[72:75],a[200:203]
ds_read_b64_tr_b16 v[202:203],v42 offset:12288
v_add_u32 v42,0x4000,v42
v_mfma_f32_16x16x32_bf16 a[232:235],v[184:187],v[76:79],a[232:235]
v_accvgpr_read_b32 v214,a102
s_waitcnt lgkmcnt(4)
v_mfma_f32_16x16x32_bf16 a[236:239],v[188:191],v[76:79],a[236:239]
ds_read_b64_tr_b16 v[204:205],v43 offset:8192
v_accvgpr_read_b32 v215,a103
v_mfma_f32_16x16x32_bf16 a[204:207],v[188:191],v[72:75],a[204:207]
buffer_load_dwordx4 v34,s[32:35],s58 offen lds
v_mfma_f32_16x16x32_bf16 a[172:175],v[188:191],v[68:71],a[172:175]
ds_read_b64_tr_b16 v[206:207],v43 offset:12288
v_mul_f32 v208,v208,v19
v_mfma_f32_16x16x32_bf16 a[140:143],v[188:191],v[64:67],a[140:143]
s_barrier
v_add_u32 v43,0x4000,v43
v_mfma_f32_16x16x32_bf16 a[144:147],v[192:195],v[64:67],a[144:147]
ds_read_b64_tr_b16 v[176:177],v36 offset:0
v_mul_f32 v209,v209,v19
v_mfma_f32_16x16x32_bf16 a[176:179],v[192:195],v[68:71],a[176:179]
buffer_load_dwordx4 v[136:139],v6,s[8:11],s80 offen offset:2048 sc1
v_mfma_f32_16x16x32_bf16 a[208:211],v[192:195],v[72:75],a[208:211]
ds_read_b64_tr_b16 v[178:179],v36 offset:4096
v_mul_f32 v210,v210,v19
v_mfma_f32_16x16x32_bf16 a[240:243],v[192:195],v[76:79],a[240:243]
v_mul_f32 v211,v211,v19
s_waitcnt lgkmcnt(4)
v_mfma_f32_16x16x32_bf16 a[244:247],v[196:199],v[76:79],a[244:247]
ds_read_b64_tr_b16 v[180:181],v37 offset:0
v_mul_f32 v212,v212,v19
v_mfma_f32_16x16x32_bf16 a[212:215],v[196:199],v[72:75],a[212:215]
v_mul_f32 v213,v213,v19
v_mul_f32 v214,v214,v19
v_mfma_f32_16x16x32_bf16 a[180:183],v[196:199],v[68:71],a[180:183]
ds_read_b64_tr_b16 v[182:183],v37 offset:4096
v_mul_f32 v215,v215,v19
v_mfma_f32_16x16x32_bf16 a[148:151],v[196:199],v[64:67],a[148:151]
buffer_load_dwordx4 v[140:143],v7,s[8:11],s80 offen offset:2048 sc1
v_mfma_f32_16x16x32_bf16 a[152:155],v[200:203],v[64:67],a[152:155]
ds_read_b64_tr_b16 v[184:185],v38 offset:0
s_add_u32 s80,s80,0x40000
v_mfma_f32_16x16x32_bf16 a[184:187],v[200:203],v[68:71],a[184:187]
s_add_u32 m0,s92,35840
v_cvt_pk_bf16_f32 v240,v208,v209
v_mfma_f32_16x16x32_bf16 a[216:219],v[200:203],v[72:75],a[216:219]
ds_read_b64_tr_b16 v[186:187],v38 offset:4096
v_cvt_pk_bf16_f32 v241,v210,v211
v_mfma_f32_16x16x32_bf16 a[248:251],v[200:203],v[76:79],a[248:251]
v_cvt_pk_bf16_f32 v242,v212,v213
s_waitcnt lgkmcnt(6)
v_mfma_f32_16x16x32_bf16 a[252:255],v[204:207],v[76:79],a[252:255]
ds_read_b64_tr_b16 v[188:189],v39 offset:0
v_cvt_pk_bf16_f32 v243,v214,v215
v_mfma_f32_16x16x32_bf16 a[220:223],v[204:207],v[72:75],a[220:223]
buffer_load_dwordx4 v35,s[32:35],s58 offen lds
v_mfma_f32_16x16x32_bf16 a[188:191],v[204:207],v[68:71],a[188:191]
ds_read_b64_tr_b16 v[190:191],v39 offset:4096
v_mfma_f32_16x16x32_bf16 a[156:159],v[204:207],v[64:67],a[156:159]
s_waitcnt vmcnt(25) lgkmcnt(6)
v_mfma_f32_16x16x32_bf16 a[128:131],v[176:179],v[144:147],a[128:131]
ds_read_b64_tr_b16 v[192:193],v40 offset:0
v_accvgpr_read_b32 v216,a104
v_mfma_f32_16x16x32_bf16 a[160:163],v[176:179],v[148:151],a[160:163]
buffer_store_dwordx4 v[240:243],v21,s[8:11],s54 offen offset:1024 sc1
v_mfma_f32_16x16x32_bf16 a[192:195],v[176:179],v[152:155],a[192:195]
ds_read_b64_tr_b16 v[194:195],v40 offset:4096
v_accvgpr_read_b32 v217,a105
v_mfma_f32_16x16x32_bf16 a[224:227],v[176:179],v[156:159],a[224:227]
buffer_load_dwordx4 v[48:51],v4,s[8:11],s80 offen offset:0 sc1
s_waitcnt lgkmcnt(4)
v_mfma_f32_16x16x32_bf16 a[228:231],v[180:183],v[156:159],a[228:231]
ds_read_b64_tr_b16 v[196:197],v41 offset:0
v_accvgpr_read_b32 v218,a106
v_mfma_f32_16x16x32_bf16 a[196:199],v[180:183],v[152:155],a[196:199]
v_accvgpr_read_b32 v219,a107
v_accvgpr_read_b32 v220,a108
v_mfma_f32_16x16x32_bf16 a[164:167],v[180:183],v[148:151],a[164:167]
ds_read_b64_tr_b16 v[198:199],v41 offset:4096
v_accvgpr_read_b32 v221,a109
v_mfma_f32_16x16x32_bf16 a[132:135],v[180:183],v[144:147],a[132:135]
buffer_load_dwordx4 v[52:55],v5,s[8:11],s80 offen offset:0 sc1
v_mfma_f32_16x16x32_bf16 a[136:139],v[184:187],v[144:147],a[136:139]
ds_read_b64_tr_b16 v[200:201],v42 offset:0
s_add_u32 s58,s58,0x20000
v_mfma_f32_16x16x32_bf16 a[168:171],v[184:187],v[148:151],a[168:171]
s_add_u32 m0,s92,49152
v_accvgpr_read_b32 v222,a110
v_mfma_f32_16x16x32_bf16 a[200:203],v[184:187],v[152:155],a[200:203]
ds_read_b64_tr_b16 v[202:203],v42 offset:4096
v_accvgpr_read_b32 v223,a111
v_mfma_f32_16x16x32_bf16 a[232:235],v[184:187],v[156:159],a[232:235]
v_mul_f32 v216,v216,v19
s_waitcnt lgkmcnt(4)
v_mfma_f32_16x16x32_bf16 a[236:239],v[188:191],v[156:159],a[236:239]
ds_read_b64_tr_b16 v[204:205],v43 offset:0
v_mul_f32 v217,v217,v19
v_mfma_f32_16x16x32_bf16 a[204:207],v[188:191],v[152:155],a[204:207]
buffer_load_dwordx4 v32,s[32:35],s58 offen lds
v_mfma_f32_16x16x32_bf16 a[172:175],v[188:191],v[148:151],a[172:175]
ds_read_b64_tr_b16 v[206:207],v43 offset:4096
v_mul_f32 v218,v218,v19
v_mfma_f32_16x16x32_bf16 a[140:143],v[188:191],v[144:147],a[140:143]
v_mul_f32 v219,v219,v19
v_mul_f32 v220,v220,v19
v_mfma_f32_16x16x32_bf16 a[144:147],v[192:195],v[144:147],a[144:147]
ds_read_b64_tr_b16 v[176:177],v36 offset:8192
v_mul_f32 v221,v221,v19
v_mfma_f32_16x16x32_bf16 a[176:179],v[192:195],v[148:151],a[176:179]
v_mul_f32 v222,v222,v19
v_mul_f32 v223,v223,v19
v_mfma_f32_16x16x32_bf16 a[208:211],v[192:195],v[152:155],a[208:211]
ds_read_b64_tr_b16 v[178:179],v36 offset:12288
v_add_u32 v36,0x4000,v36
v_mfma_f32_16x16x32_bf16 a[240:243],v[192:195],v[156:159],a[240:243]
buffer_load_dwordx4 v[56:59],v6,s[8:11],s80 offen offset:0 sc1
s_waitcnt lgkmcnt(4)
v_mfma_f32_16x16x32_bf16 a[244:247],v[196:199],v[156:159],a[244:247]
ds_read_b64_tr_b16 v[180:181],v37 offset:8192
v_cvt_pk_bf16_f32 v244,v216,v217
v_mfma_f32_16x16x32_bf16 a[212:215],v[196:199],v[152:155],a[212:215]
v_cvt_pk_bf16_f32 v245,v218,v219
v_cvt_pk_bf16_f32 v246,v220,v221
v_mfma_f32_16x16x32_bf16 a[180:183],v[196:199],v[148:151],a[180:183]
ds_read_b64_tr_b16 v[182:183],v37 offset:12288
v_cvt_pk_bf16_f32 v247,v222,v223
v_mfma_f32_16x16x32_bf16 a[148:151],v[196:199],v[144:147],a[148:151]
v_add_u32 v37,0x4000,v37
v_mfma_f32_16x16x32_bf16 a[152:155],v[200:203],v[144:147],a[152:155]
ds_read_b64_tr_b16 v[184:185],v38 offset:8192
v_mfma_f32_16x16x32_bf16 a[184:187],v[200:203],v[148:151],a[184:187]
buffer_load_dwordx4 v[60:63],v7,s[8:11],s80 offen offset:0 sc1
v_mfma_f32_16x16x32_bf16 a[216:219],v[200:203],v[152:155],a[216:219]
ds_read_b64_tr_b16 v[186:187],v38 offset:12288
v_add_u32 v38,0x4000,v38
v_mfma_f32_16x16x32_bf16 a[248:251],v[200:203],v[156:159],a[248:251]
s_add_u32 m0,s92,50176
s_waitcnt lgkmcnt(4)
v_mfma_f32_16x16x32_bf16 a[252:255],v[204:207],v[156:159],a[252:255]
ds_read_b64_tr_b16 v[188:189],v39 offset:8192
v_mfma_f32_16x16x32_bf16 a[220:223],v[204:207],v[152:155],a[220:223]
buffer_load_dwordx4 v33,s[32:35],s58 offen lds
v_mfma_f32_16x16x32_bf16 a[188:191],v[204:207],v[148:151],a[188:191]
ds_read_b64_tr_b16 v[190:191],v39 offset:12288
v_mfma_f32_16x16x32_bf16 a[156:159],v[204:207],v[144:147],a[156:159]
v_add_u32 v39,0x4000,v39
v_mfma_f32_16x16x32_bf16 a[128:131],v[176:179],v[160:163],a[128:131]
ds_read_b64_tr_b16 v[192:193],v40 offset:8192
v_accvgpr_read_b32 v224,a112
v_mfma_f32_16x16x32_bf16 a[160:163],v[176:179],v[164:167],a[160:163]
buffer_load_dwordx4 v[64:67],v4,s[8:11],s80 offen offset:2048 sc1
v_mfma_f32_16x16x32_bf16 a[192:195],v[176:179],v[168:171],a[192:195]
ds_read_b64_tr_b16 v[194:195],v40 offset:12288
v_add_u32 v40,0x4000,v40
v_mfma_f32_16x16x32_bf16 a[224:227],v[176:179],v[172:175],a[224:227]
v_accvgpr_read_b32 v225,a113
s_waitcnt lgkmcnt(4)
v_mfma_f32_16x16x32_bf16 a[228:231],v[180:183],v[172:175],a[228:231]
ds_read_b64_tr_b16 v[196:197],v41 offset:8192
v_accvgpr_read_b32 v226,a114
v_mfma_f32_16x16x32_bf16 a[196:199],v[180:183],v[168:171],a[196:199]
buffer_store_dwordx4 v[244:247],v21,s[8:11],s54 offen offset:3072 sc1
v_mfma_f32_16x16x32_bf16 a[164:167],v[180:183],v[164:167],a[164:167]
ds_read_b64_tr_b16 v[198:199],v41 offset:12288
v_accvgpr_read_b32 v227,a115
v_mfma_f32_16x16x32_bf16 a[132:135],v[180:183],v[160:163],a[132:135]
buffer_load_dwordx4 v[68:71],v5,s[8:11],s80 offen offset:2048 sc1
v_add_u32 v41,0x4000,v41
v_mfma_f32_16x16x32_bf16 a[136:139],v[184:187],v[160:163],a[136:139]
ds_read_b64_tr_b16 v[200:201],v42 offset:8192
s_add_u32 m0,s92,51200
v_mfma_f32_16x16x32_bf16 a[168:171],v[184:187],v[164:167],a[168:171]
v_accvgpr_read_b32 v228,a116
v_accvgpr_read_b32 v229,a117
v_mfma_f32_16x16x32_bf16 a[200:203],v[184:187],v[168:171],a[200:203]
ds_read_b64_tr_b16 v[202:203],v42 offset:12288
v_add_u32 v42,0x4000,v42
v_mfma_f32_16x16x32_bf16 a[232:235],v[184:187],v[172:175],a[232:235]
v_accvgpr_read_b32 v230,a118
s_waitcnt lgkmcnt(4)
v_mfma_f32_16x16x32_bf16 a[236:239],v[188:191],v[172:175],a[236:239]
ds_read_b64_tr_b16 v[204:205],v43 offset:8192
v_accvgpr_read_b32 v231,a119
v_mfma_f32_16x16x32_bf16 a[204:207],v[188:191],v[168:171],a[204:207]
buffer_load_dwordx4 v34,s[32:35],s58 offen lds
v_mfma_f32_16x16x32_bf16 a[172:175],v[188:191],v[164:167],a[172:175]
ds_read_b64_tr_b16 v[206:207],v43 offset:12288
v_mul_f32 v224,v224,v19
v_mfma_f32_16x16x32_bf16 a[140:143],v[188:191],v[160:163],a[140:143]
s_waitcnt vmcnt(11)
s_barrier
v_add_u32 v43,0x4000,v43
v_mfma_f32_16x16x32_bf16 a[144:147],v[192:195],v[160:163],a[144:147]
ds_read_b64_tr_b16 v[176:177],v36 offset:0
v_mul_f32 v225,v225,v19
v_mfma_f32_16x16x32_bf16 a[176:179],v[192:195],v[164:167],a[176:179]
buffer_load_dwordx4 v[72:75],v6,s[8:11],s80 offen offset:2048 sc1
v_mfma_f32_16x16x32_bf16 a[208:211],v[192:195],v[168:171],a[208:211]
ds_read_b64_tr_b16 v[178:179],v36 offset:4096
v_mul_f32 v226,v226,v19
v_mfma_f32_16x16x32_bf16 a[240:243],v[192:195],v[172:175],a[240:243]
v_mul_f32 v227,v227,v19
s_waitcnt lgkmcnt(4)
v_mfma_f32_16x16x32_bf16 a[244:247],v[196:199],v[172:175],a[244:247]
ds_read_b64_tr_b16 v[180:181],v37 offset:0
v_mul_f32 v228,v228,v19
v_mfma_f32_16x16x32_bf16 a[212:215],v[196:199],v[168:171],a[212:215]
v_mul_f32 v229,v229,v19
v_mul_f32 v230,v230,v19
v_mfma_f32_16x16x32_bf16 a[180:183],v[196:199],v[164:167],a[180:183]
ds_read_b64_tr_b16 v[182:183],v37 offset:4096
v_mul_f32 v231,v231,v19
v_mfma_f32_16x16x32_bf16 a[148:151],v[196:199],v[160:163],a[148:151]
buffer_load_dwordx4 v[76:79],v7,s[8:11],s80 offen offset:2048 sc1
v_mfma_f32_16x16x32_bf16 a[152:155],v[200:203],v[160:163],a[152:155]
ds_read_b64_tr_b16 v[184:185],v38 offset:0
s_add_u32 s80,s80,0x40000
v_mfma_f32_16x16x32_bf16 a[184:187],v[200:203],v[164:167],a[184:187]
s_add_u32 m0,s92,52224
v_cvt_pk_bf16_f32 v248,v224,v225
v_mfma_f32_16x16x32_bf16 a[216:219],v[200:203],v[168:171],a[216:219]
ds_read_b64_tr_b16 v[186:187],v38 offset:4096
v_cvt_pk_bf16_f32 v249,v226,v227
v_mfma_f32_16x16x32_bf16 a[248:251],v[200:203],v[172:175],a[248:251]
v_cvt_pk_bf16_f32 v250,v228,v229
s_waitcnt lgkmcnt(6)
v_mfma_f32_16x16x32_bf16 a[252:255],v[204:207],v[172:175],a[252:255]
ds_read_b64_tr_b16 v[188:189],v39 offset:0
v_cvt_pk_bf16_f32 v251,v230,v231
v_mfma_f32_16x16x32_bf16 a[220:223],v[204:207],v[168:171],a[220:223]
buffer_load_dwordx4 v35,s[32:35],s58 offen lds
v_mfma_f32_16x16x32_bf16 a[188:191],v[204:207],v[164:167],a[188:191]
ds_read_b64_tr_b16 v[190:191],v39 offset:4096
v_mfma_f32_16x16x32_bf16 a[156:159],v[204:207],v[160:163],a[156:159]
L_p2mid:
s_waitcnt lgkmcnt(6)
v_mfma_f32_16x16x32_bf16 a[128:131],v[176:179],v[80:83],a[128:131]
ds_read_b64_tr_b16 v[192:193],v40 offset:0
v_accvgpr_read_b32 v232,a120
v_mfma_f32_16x16x32_bf16 a[160:163],v[176:179],v[84:87],a[160:163]
buffer_store_dwordx4 v[248:251],v21,s[8:11],s55 offen offset:1024 sc1
v_mfma_f32_16x16x32_bf16 a[192:195],v[176:179],v[88:91],a[192:195]
ds_read_b64_tr_b16 v[194:195],v40 offset:4096
v_accvgpr_read_b32 v233,a121
v_mfma_f32_16x16x32_bf16 a[224:227],v[176:179],v[92:95],a[224:227]
buffer_load_dwordx4 v[144:147],v4,s[8:11],s80 offen offset:0 sc1
s_waitcnt lgkmcnt(4)
v_mfma_f32_16x16x32_bf16 a[228:231],v[180:183],v[92:95],a[228:231]
ds_read_b64_tr_b16 v[196:197],v41 offset:0
v_accvgpr_read_b32 v234,a122
v_mfma_f32_16x16x32_bf16 a[196:199],v[180:183],v[88:91],a[196:199]
v_accvgpr_read_b32 v235,a123
v_accvgpr_read_b32 v236,a124
v_mfma_f32_16x16x32_bf16 a[164:167],v[180:183],v[84:87],a[164:167]
ds_read_b64_tr_b16 v[198:199],v41 offset:4096
v_accvgpr_read_b32 v237,a125
v_mfma_f32_16x16x32_bf16 a[132:135],v[180:183],v[80:83],a[132:135]
buffer_load_dwordx4 v[148:151],v5,s[8:11],s80 offen offset:0 sc1
v_mfma_f32_16x16x32_bf16 a[136:139],v[184:187],v[80:83],a[136:139]
ds_read_b64_tr_b16 v[200:201],v42 offset:0
s_add_u32 s58,s58,0x20000
v_mfma_f32_16x16x32_bf16 a[168:171],v[184:187],v[84:87],a[168:171]
s_add_u32 m0,s92,65536
v_accvgpr_read_b32 v238,a126
v_mfma_f32_16x16x32_bf16 a[200:203],v[184:187],v[88:91],a[200:203]
ds_read_b64_tr_b16 v[202:203],v42 offset:4096
v_accvgpr_read_b32 v239,a127
v_mfma_f32_16x16x32_bf16 a[232:235],v[184:187],v[92:95],a[232:235]
v_mul_f32 v232,v232,v19
s_waitcnt lgkmcnt(4)
v_mfma_f32_16x16x32_bf16 a[236:239],v[188:191],v[92:95],a[236:239]
ds_read_b64_tr_b16 v[204:205],v43 offset:0
v_mul_f32 v233,v233,v19
v_mfma_f32_16x16x32_bf16 a[204:207],v[188:191],v[88:91],a[204:207]
buffer_load_dwordx4 v32,s[32:35],s58 offen lds
v_mfma_f32_16x16x32_bf16 a[172:175],v[188:191],v[84:87],a[172:175]
ds_read_b64_tr_b16 v[206:207],v43 offset:4096
v_mul_f32 v234,v234,v19
v_mfma_f32_16x16x32_bf16 a[140:143],v[188:191],v[80:83],a[140:143]
v_mul_f32 v235,v235,v19
v_mul_f32 v236,v236,v19
v_mfma_f32_16x16x32_bf16 a[144:147],v[192:195],v[80:83],a[144:147]
ds_read_b64_tr_b16 v[176:177],v36 offset:8192
v_mul_f32 v237,v237,v19
v_mfma_f32_16x16x32_bf16 a[176:179],v[192:195],v[84:87],a[176:179]
v_mul_f32 v238,v238,v19
v_mul_f32 v239,v239,v19
v_mfma_f32_16x16x32_bf16 a[208:211],v[192:195],v[88:91],a[208:211]
ds_read_b64_tr_b16 v[178:179],v36 offset:12288
v_add_u32 v36,0x4000,v36
v_mfma_f32_16x16x32_bf16 a[240:243],v[192:195],v[92:95],a[240:243]
buffer_load_dwordx4 v[152:155],v6,s[8:11],s80 offen offset:0 sc1
s_waitcnt lgkmcnt(4)
v_mfma_f32_16x16x32_bf16 a[244:247],v[196:199],v[92:95],a[244:247]
ds_read_b64_tr_b16 v[180:181],v37 offset:8192
v_cvt_pk_bf16_f32 v252,v232,v233
v_mfma_f32_16x16x32_bf16 a[212:215],v[196:199],v[88:91],a[212:215]
v_cvt_pk_bf16_f32 v253,v234,v235
v_cvt_pk_bf16_f32 v254,v236,v237
v_mfma_f32_16x16x32_bf16 a[180:183],v[196:199],v[84:87],a[180:183]
ds_read_b64_tr_b16 v[182:183],v37 offset:12288
v_cvt_pk_bf16_f32 v255,v238,v239
v_mfma_f32_16x16x32_bf16 a[148:151],v[196:199],v[80:83],a[148:151]
v_add_u32 v37,0x4000,v37
v_mfma_f32_16x16x32_bf16 a[152:155],v[200:203],v[80:83],a[152:155]
ds_read_b64_tr_b16 v[184:185],v38 offset:8192
v_mfma_f32_16x16x32_bf16 a[184:187],v[200:203],v[84:87],a[184:187]
buffer_load_dwordx4 v[156:159],v7,s[8:11],s80 offen offset:0 sc1
v_mfma_f32_16x16x32_bf16 a[216:219],v[200:203],v[88:91],a[216:219]
ds_read_b64_tr_b16 v[186:187],v38 offset:12288
v_add_u32 v38,0x4000,v38
v_mfma_f32_16x16x32_bf16 a[248:251],v[200:203],v[92:95],a[248:251]
s_add_u32 m0,s92,66560
s_waitcnt lgkmcnt(4)
v_mfma_f32_16x16x32_bf16 a[252:255],v[204:207],v[92:95],a[252:255]
ds_read_b64_tr_b16 v[188:189],v39 offset:8192
v_mfma_f32_16x16x32_bf16 a[220:223],v[204:207],v[88:91],a[220:223]
buffer_load_dwordx4 v33,s[32:35],s58 offen lds
v_mfma_f32_16x16x32_bf16 a[188:191],v[204:207],v[84:87],a[188:191]
ds_read_b64_tr_b16 v[190:191],v39 offset:12288
v_mfma_f32_16x16x32_bf16 a[156:159],v[204:207],v[80:83],a[156:159]
v_add_u32 v39,0x4000,v39
v_mfma_f32_16x16x32_bf16 a[128:131],v[176:179],v[96:99],a[128:131]
ds_read_b64_tr_b16 v[192:193],v40 offset:8192
v_mfma_f32_16x16x32_bf16 a[160:163],v[176:179],v[100:103],a[160:163]
buffer_load_dwordx4 v[160:163],v4,s[8:11],s80 offen offset:2048 sc1
v_mfma_f32_16x16x32_bf16 a[192:195],v[176:179],v[104:107],a[192:195]
ds_read_b64_tr_b16 v[194:195],v40 offset:12288
v_add_u32 v40,0x4000,v40
v_mfma_f32_16x16x32_bf16 a[224:227],v[176:179],v[108:111],a[224:227]
s_waitcnt lgkmcnt(4)
v_mfma_f32_16x16x32_bf16 a[228:231],v[180:183],v[108:111],a[228:231]
ds_read_b64_tr_b16 v[196:197],v41 offset:8192
v_mfma_f32_16x16x32_bf16 a[196:199],v[180:183],v[104:107],a[196:199]
v_mfma_f32_16x16x32_bf16 a[164:167],v[180:183],v[100:103],a[164:167]
ds_read_b64_tr_b16 v[198:199],v41 offset:12288
v_mfma_f32_16x16x32_bf16 a[132:135],v[180:183],v[96:99],a[132:135]
buffer_load_dwordx4 v[164:167],v5,s[8:11],s80 offen offset:2048 sc1
v_add_u32 v41,0x4000,v41
v_mfma_f32_16x16x32_bf16 a[136:139],v[184:187],v[96:99],a[136:139]
ds_read_b64_tr_b16 v[200:201],v42 offset:8192
s_add_u32 m0,s92,67584
v_mfma_f32_16x16x32_bf16 a[168:171],v[184:187],v[100:103],a[168:171]
v_mfma_f32_16x16x32_bf16 a[200:203],v[184:187],v[104:107],a[200:203]
ds_read_b64_tr_b16 v[202:203],v42 offset:12288
v_add_u32 v42,0x4000,v42
v_mfma_f32_16x16x32_bf16 a[232:235],v[184:187],v[108:111],a[232:235]
s_waitcnt lgkmcnt(4)
v_mfma_f32_16x16x32_bf16 a[236:239],v[188:191],v[108:111],a[236:239]
ds_read_b64_tr_b16 v[204:205],v43 offset:8192
v_mfma_f32_16x16x32_bf16 a[204:207],v[188:191],v[104:107],a[204:207]
buffer_load_dwordx4 v34,s[32:35],s58 offen lds
v_mfma_f32_16x16x32_bf16 a[172:175],v[188:191],v[100:103],a[172:175]
ds_read_b64_tr_b16 v[206:207],v43 offset:12288
v_mfma_f32_16x16x32_bf16 a[140:143],v[188:191],v[96:99],a[140:143]
s_waitcnt vmcnt(10)
s_barrier
v_add_u32 v43,0x4000,v43
v_mfma_f32_16x16x32_bf16 a[144:147],v[192:195],v[96:99],a[144:147]
ds_read_b64_tr_b16 v[176:177],v36 offset:0
v_mfma_f32_16x16x32_bf16 a[176:179],v[192:195],v[100:103],a[176:179]
buffer_load_dwordx4 v[168:171],v6,s[8:11],s80 offen offset:2048 sc1
v_mfma_f32_16x16x32_bf16 a[208:211],v[192:195],v[104:107],a[208:211]
ds_read_b64_tr_b16 v[178:179],v36 offset:4096
v_mfma_f32_16x16x32_bf16 a[240:243],v[192:195],v[108:111],a[240:243]
s_waitcnt lgkmcnt(4)
v_mfma_f32_16x16x32_bf16 a[244:247],v[196:199],v[108:111],a[244:247]
ds_read_b64_tr_b16 v[180:181],v37 offset:0
v_mfma_f32_16x16x32_bf16 a[212:215],v[196:199],v[104:107],a[212:215]
v_mfma_f32_16x16x32_bf16 a[180:183],v[196:199],v[100:103],a[180:183]
ds_read_b64_tr_b16 v[182:183],v37 offset:4096
v_mfma_f32_16x16x32_bf16 a[148:151],v[196:199],v[96:99],a[148:151]
buffer_load_dwordx4 v[172:175],v7,s[8:11],s80 offen offset:2048 sc1
v_mfma_f32_16x16x32_bf16 a[152:155],v[200:203],v[96:99],a[152:155]
ds_read_b64_tr_b16 v[184:185],v38 offset:0
s_add_u32 s80,s80,0x40000
v_mfma_f32_16x16x32_bf16 a[184:187],v[200:203],v[100:103],a[184:187]
s_add_u32 m0,s92,68608
v_mfma_f32_16x16x32_bf16 a[216:219],v[200:203],v[104:107],a[216:219]
ds_read_b64_tr_b16 v[186:187],v38 offset:4096
v_mfma_f32_16x16x32_bf16 a[248:251],v[200:203],v[108:111],a[248:251]
s_waitcnt lgkmcnt(6)
v_mfma_f32_16x16x32_bf16 a[252:255],v[204:207],v[108:111],a[252:255]
ds_read_b64_tr_b16 v[188:189],v39 offset:0
v_mfma_f32_16x16x32_bf16 a[220:223],v[204:207],v[104:107],a[220:223]
buffer_load_dwordx4 v35,s[32:35],s58 offen lds
v_mfma_f32_16x16x32_bf16 a[188:191],v[204:207],v[100:103],a[188:191]
ds_read_b64_tr_b16 v[190:191],v39 offset:4096
v_mfma_f32_16x16x32_bf16 a[156:159],v[204:207],v[96:99],a[156:159]
s_waitcnt lgkmcnt(6)
v_mfma_f32_16x16x32_bf16 a[128:131],v[176:179],v[112:115],a[128:131]
ds_read_b64_tr_b16 v[192:193],v40 offset:0
v_mfma_f32_16x16x32_bf16 a[160:163],v[176:179],v[116:119],a[160:163]
buffer_store_dwordx4 v[252:255],v21,s[8:11],s55 offen offset:3072 sc1
v_mfma_f32_16x16x32_bf16 a[192:195],v[176:179],v[120:123],a[192:195]
ds_read_b64_tr_b16 v[194:195],v40 offset:4096
v_mfma_f32_16x16x32_bf16 a[224:227],v[176:179],v[124:127],a[224:227]
buffer_load_dwordx4 v[80:83],v4,s[8:11],s80 offen offset:0 sc1
s_waitcnt lgkmcnt(4)
v_mfma_f32_16x16x32_bf16 a[228:231],v[180:183],v[124:127],a[228:231]
ds_read_b64_tr_b16 v[196:197],v41 offset:0
v_mfma_f32_16x16x32_bf16 a[196:199],v[180:183],v[120:123],a[196:199]
v_mfma_f32_16x16x32_bf16 a[164:167],v[180:183],v[116:119],a[164:167]
ds_read_b64_tr_b16 v[198:199],v41 offset:4096
v_mfma_f32_16x16x32_bf16 a[132:135],v[180:183],v[112:115],a[132:135]
buffer_load_dwordx4 v[84:87],v5,s[8:11],s80 offen offset:0 sc1
v_mfma_f32_16x16x32_bf16 a[136:139],v[184:187],v[112:115],a[136:139]
ds_read_b64_tr_b16 v[200:201],v42 offset:0
s_add_u32 s58,s58,0x20000
v_mfma_f32_16x16x32_bf16 a[168:171],v[184:187],v[116:119],a[168:171]
s_add_u32 m0,s92,81920
v_mfma_f32_16x16x32_bf16 a[200:203],v[184:187],v[120:123],a[200:203]
ds_read_b64_tr_b16 v[202:203],v42 offset:4096
v_mfma_f32_16x16x32_bf16 a[232:235],v[184:187],v[124:127],a[232:235]
s_waitcnt lgkmcnt(4)
v_mfma_f32_16x16x32_bf16 a[236:239],v[188:191],v[124:127],a[236:239]
ds_read_b64_tr_b16 v[204:205],v43 offset:0
v_mfma_f32_16x16x32_bf16 a[204:207],v[188:191],v[120:123],a[204:207]
buffer_load_dwordx4 v32,s[32:35],s58 offen lds
v_mfma_f32_16x16x32_bf16 a[172:175],v[188:191],v[116:119],a[172:175]
ds_read_b64_tr_b16 v[206:207],v43 offset:4096
v_mfma_f32_16x16x32_bf16 a[140:143],v[188:191],v[112:115],a[140:143]
v_mfma_f32_16x16x32_bf16 a[144:147],v[192:195],v[112:115],a[144:147]
ds_read_b64_tr_b16 v[176:177],v36 offset:8192
v_mfma_f32_16x16x32_bf16 a[176:179],v[192:195],v[116:119],a[176:179]
v_mfma_f32_16x16x32_bf16 a[208:211],v[192:195],v[120:123],a[208:211]
ds_read_b64_tr_b16 v[178:179],v36 offset:12288
v_add_u32 v36,0x4000,v36
v_mfma_f32_16x16x32_bf16 a[240:243],v[192:195],v[124:127],a[240:243]
buffer_load_dwordx4 v[88:91],v6,s[8:11],s80 offen offset:0 sc1
s_waitcnt lgkmcnt(4)
v_mfma_f32_16x16x32_bf16 a[244:247],v[196:199],v[124:127],a[244:247]
ds_read_b64_tr_b16 v[180:181],v37 offset:8192
v_mfma_f32_16x16x32_bf16 a[212:215],v[196:199],v[120:123],a[212:215]
v_mfma_f32_16x16x32_bf16 a[180:183],v[196:199],v[116:119],a[180:183]
ds_read_b64_tr_b16 v[182:183],v37 offset:12288
v_mfma_f32_16x16x32_bf16 a[148:151],v[196:199],v[112:115],a[148:151]
v_add_u32 v37,0x4000,v37
v_mfma_f32_16x16x32_bf16 a[152:155],v[200:203],v[112:115],a[152:155]
ds_read_b64_tr_b16 v[184:185],v38 offset:8192
v_mfma_f32_16x16x32_bf16 a[184:187],v[200:203],v[116:119],a[184:187]
buffer_load_dwordx4 v[92:95],v7,s[8:11],s80 offen offset:0 sc1
v_mfma_f32_16x16x32_bf16 a[216:219],v[200:203],v[120:123],a[216:219]
ds_read_b64_tr_b16 v[186:187],v38 offset:12288
v_add_u32 v38,0x4000,v38
v_mfma_f32_16x16x32_bf16 a[248:251],v[200:203],v[124:127],a[248:251]
s_add_u32 m0,s92,82944
s_waitcnt lgkmcnt(4)
v_mfma_f32_16x16x32_bf16 a[252:255],v[204:207],v[124:127],a[252:255]
ds_read_b64_tr_b16 v[188:189],v39 offset:8192
v_mfma_f32_16x16x32_bf16 a[220:223],v[204:207],v[120:123],a[220:223]
buffer_load_dwordx4 v33,s[32:35],s58 offen lds
v_mfma_f32_16x16x32_bf16 a[188:191],v[204:207],v[116:119],a[188:191]
ds_read_b64_tr_b16 v[190:191],v39 offset:12288
v_mfma_f32_16x16x32_bf16 a[156:159],v[204:207],v[112:115],a[156:159]
v_add_u32 v39,0x4000,v39
v_mfma_f32_16x16x32_bf16 a[128:131],v[176:179],v[128:131],a[128:131]
ds_read_b64_tr_b16 v[192:193],v40 offset:8192
v_mfma_f32_16x16x32_bf16 a[160:163],v[176:179],v[132:135],a[160:163]
buffer_load_dwordx4 v[96:99],v4,s[8:11],s80 offen offset:2048 sc1
v_mfma_f32_16x16x32_bf16 a[192:195],v[176:179],v[136:139],a[192:195]
ds_read_b64_tr_b16 v[194:195],v40 offset:12288
v_add_u32 v40,0x4000,v40
v_mfma_f32_16x16x32_bf16 a[224:227],v[176:179],v[140:143],a[224:227]
s_waitcnt lgkmcnt(4)
v_mfma_f32_16x16x32_bf16 a[228:231],v[180:183],v[140:143],a[228:231]
ds_read_b64_tr_b16 v[196:197],v41 offset:8192
v_mfma_f32_16x16x32_bf16 a[196:199],v[180:183],v[136:139],a[196:199]
v_mfma_f32_16x16x32_bf16 a[164:167],v[180:183],v[132:135],a[164:167]
ds_read_b64_tr_b16 v[198:199],v41 offset:12288
v_mfma_f32_16x16x32_bf16 a[132:135],v[180:183],v[128:131],a[132:135]
buffer_load_dwordx4 v[100:103],v5,s[8:11],s80 offen offset:2048 sc1
v_add_u32 v41,0x4000,v41
v_mfma_f32_16x16x32_bf16 a[136:139],v[184:187],v[128:131],a[136:139]
ds_read_b64_tr_b16 v[200:201],v42 offset:8192
s_add_u32 m0,s92,83968
v_mfma_f32_16x16x32_bf16 a[168:171],v[184:187],v[132:135],a[168:171]
v_mfma_f32_16x16x32_bf16 a[200:203],v[184:187],v[136:139],a[200:203]
ds_read_b64_tr_b16 v[202:203],v42 offset:12288
v_add_u32 v42,0x4000,v42
v_mfma_f32_16x16x32_bf16 a[232:235],v[184:187],v[140:143],a[232:235]
s_waitcnt lgkmcnt(4)
v_mfma_f32_16x16x32_bf16 a[236:239],v[188:191],v[140:143],a[236:239]
ds_read_b64_tr_b16 v[204:205],v43 offset:8192
v_mfma_f32_16x16x32_bf16 a[204:207],v[188:191],v[136:139],a[204:207]
buffer_load_dwordx4 v34,s[32:35],s58 offen lds
v_mfma_f32_16x16x32_bf16 a[172:175],v[188:191],v[132:135],a[172:175]
ds_read_b64_tr_b16 v[206:207],v43 offset:12288
v_mfma_f32_16x16x32_bf16 a[140:143],v[188:191],v[128:131],a[140:143]
s_waitcnt vmcnt(10)
s_barrier
v_add_u32 v43,0x4000,v43
v_mfma_f32_16x16x32_bf16 a[144:147],v[192:195],v[128:131],a[144:147]
ds_read_b64_tr_b16 v[176:177],v36 offset:0
v_mfma_f32_16x16x32_bf16 a[176:179],v[192:195],v[132:135],a[176:179]
buffer_load_dwordx4 v[104:107],v6,s[8:11],s80 offen offset:2048 sc1
v_mfma_f32_16x16x32_bf16 a[208:211],v[192:195],v[136:139],a[208:211]
ds_read_b64_tr_b16 v[178:179],v36 offset:4096
v_mfma_f32_16x16x32_bf16 a[240:243],v[192:195],v[140:143],a[240:243]
s_waitcnt lgkmcnt(4)
v_mfma_f32_16x16x32_bf16 a[244:247],v[196:199],v[140:143],a[244:247]
ds_read_b64_tr_b16 v[180:181],v37 offset:0
v_mfma_f32_16x16x32_bf16 a[212:215],v[196:199],v[136:139],a[212:215]
v_mfma_f32_16x16x32_bf16 a[180:183],v[196:199],v[132:135],a[180:183]
ds_read_b64_tr_b16 v[182:183],v37 offset:4096
v_mfma_f32_16x16x32_bf16 a[148:151],v[196:199],v[128:131],a[148:151]
buffer_load_dwordx4 v[108:111],v7,s[8:11],s80 offen offset:2048 sc1
v_mfma_f32_16x16x32_bf16 a[152:155],v[200:203],v[128:131],a[152:155]
ds_read_b64_tr_b16 v[184:185],v38 offset:0
s_add_u32 s80,s80,0x40000
v_mfma_f32_16x16x32_bf16 a[184:187],v[200:203],v[132:135],a[184:187]
s_add_u32 m0,s92,84992
v_mfma_f32_16x16x32_bf16 a[216:219],v[200:203],v[136:139],a[216:219]
ds_read_b64_tr_b16 v[186:187],v38 offset:4096
v_mfma_f32_16x16x32_bf16 a[248:251],v[200:203],v[140:143],a[248:251]
s_waitcnt lgkmcnt(6)
v_mfma_f32_16x16x32_bf16 a[252:255],v[204:207],v[140:143],a[252:255]
ds_read_b64_tr_b16 v[188:189],v39 offset:0
v_mfma_f32_16x16x32_bf16 a[220:223],v[204:207],v[136:139],a[220:223]
buffer_load_dwordx4 v35,s[32:35],s58 offen lds
v_mfma_f32_16x16x32_bf16 a[188:191],v[204:207],v[132:135],a[188:191]
ds_read_b64_tr_b16 v[190:191],v39 offset:4096
v_mfma_f32_16x16x32_bf16 a[156:159],v[204:207],v[128:131],a[156:159]
s_waitcnt lgkmcnt(6)
v_mfma_f32_16x16x32_bf16 a[128:131],v[176:179],v[48:51],a[128:131]
ds_read_b64_tr_b16 v[192:193],v40 offset:0
v_mfma_f32_16x16x32_bf16 a[160:163],v[176:179],v[52:55],a[160:163]
v_mfma_f32_16x16x32_bf16 a[192:195],v[176:179],v[56:59],a[192:195]
ds_read_b64_tr_b16 v[194:195],v40 offset:4096
v_mfma_f32_16x16x32_bf16 a[224:227],v[176:179],v[60:63],a[224:227]
buffer_load_dwordx4 v[112:115],v4,s[8:11],s80 offen offset:0 sc1
s_waitcnt lgkmcnt(4)
v_mfma_f32_16x16x32_bf16 a[228:231],v[180:183],v[60:63],a[228:231]
ds_read_b64_tr_b16 v[196:197],v41 offset:0
v_mfma_f32_16x16x32_bf16 a[196:199],v[180:183],v[56:59],a[196:199]
v_mfma_f32_16x16x32_bf16 a[164:167],v[180:183],v[52:55],a[164:167]
ds_read_b64_tr_b16 v[198:199],v41 offset:4096
v_mfma_f32_16x16x32_bf16 a[132:135],v[180:183],v[48:51],a[132:135]
buffer_load_dwordx4 v[116:119],v5,s[8:11],s80 offen offset:0 sc1
v_mfma_f32_16x16x32_bf16 a[136:139],v[184:187],v[48:51],a[136:139]
ds_read_b64_tr_b16 v[200:201],v42 offset:0
s_add_u32 s58,s58,0x20000
v_mfma_f32_16x16x32_bf16 a[168:171],v[184:187],v[52:55],a[168:171]
s_add_u32 m0,s92,98304
v_mfma_f32_16x16x32_bf16 a[200:203],v[184:187],v[56:59],a[200:203]
ds_read_b64_tr_b16 v[202:203],v42 offset:4096
v_mfma_f32_16x16x32_bf16 a[232:235],v[184:187],v[60:63],a[232:235]
s_waitcnt lgkmcnt(4)
v_mfma_f32_16x16x32_bf16 a[236:239],v[188:191],v[60:63],a[236:239]
ds_read_b64_tr_b16 v[204:205],v43 offset:0
v_mfma_f32_16x16x32_bf16 a[204:207],v[188:191],v[56:59],a[204:207]
buffer_load_dwordx4 v32,s[32:35],s58 offen lds
v_mfma_f32_16x16x32_bf16 a[172:175],v[188:191],v[52:55],a[172:175]
ds_read_b64_tr_b16 v[206:207],v43 offset:4096
v_mfma_f32_16x16x32_bf16 a[140:143],v[188:191],v[48:51],a[140:143]
v_mfma_f32_16x16x32_bf16 a[144:147],v[192:195],v[48:51],a[144:147]
ds_read_b64_tr_b16 v[176:177],v36 offset:8192
v_mfma_f32_16x16x32_bf16 a[176:179],v[192:195],v[52:55],a[176:179]
v_mfma_f32_16x16x32_bf16 a[208:211],v[192:195],v[56:59],a[208:211]
ds_read_b64_tr_b16 v[178:179],v36 offset:12288
v_add_u32 v36,0x4000,v36
v_mfma_f32_16x16x32_bf16 a[240:243],v[192:195],v[60:63],a[240:243]
buffer_load_dwordx4 v[120:123],v6,s[8:11],s80 offen offset:0 sc1
s_waitcnt lgkmcnt(4)
v_mfma_f32_16x16x32_bf16 a[244:247],v[196:199],v[60:63],a[244:247]
ds_read_b64_tr_b16 v[180:181],v37 offset:8192
v_mfma_f32_16x16x32_bf16 a[212:215],v[196:199],v[56:59],a[212:215]
v_mfma_f32_16x16x32_bf16 a[180:183],v[196:199],v[52:55],a[180:183]
ds_read_b64_tr_b16 v[182:183],v37 offset:12288
v_mfma_f32_16x16x32_bf16 a[148:151],v[196:199],v[48:51],a[148:151]
v_add_u32 v37,0x4000,v37
v_mfma_f32_16x16x32_bf16 a[152:155],v[200:203],v[48:51],a[152:155]
ds_read_b64_tr_b16 v[184:185],v38 offset:8192
v_mfma_f32_16x16x32_bf16 a[184:187],v[200:203],v[52:55],a[184:187]
buffer_load_dwordx4 v[124:127],v7,s[8:11],s80 offen offset:0 sc1
v_mfma_f32_16x16x32_bf16 a[216:219],v[200:203],v[56:59],a[216:219]
ds_read_b64_tr_b16 v[186:187],v38 offset:12288
v_add_u32 v38,0x4000,v38
v_mfma_f32_16x16x32_bf16 a[248:251],v[200:203],v[60:63],a[248:251]
s_add_u32 m0,s92,99328
s_waitcnt lgkmcnt(4)
v_mfma_f32_16x16x32_bf16 a[252:255],v[204:207],v[60:63],a[252:255]
ds_read_b64_tr_b16 v[188:189],v39 offset:8192
v_mfma_f32_16x16x32_bf16 a[220:223],v[204:207],v[56:59],a[220:223]
buffer_load_dwordx4 v33,s[32:35],s58 offen lds
v_mfma_f32_16x16x32_bf16 a[188:191],v[204:207],v[52:55],a[188:191]
ds_read_b64_tr_b16 v[190:191],v39 offset:12288
v_mfma_f32_16x16x32_bf16 a[156:159],v[204:207],v[48:51],a[156:159]
v_add_u32 v39,0x4000,v39
v_mfma_f32_16x16x32_bf16 a[128:131],v[176:179],v[64:67],a[128:131]
ds_read_b64_tr_b16 v[192:193],v40 offset:8192
v_mfma_f32_16x16x32_bf16 a[160:163],v[176:179],v[68:71],a[160:163]
buffer_load_dwordx4 v[128:131],v4,s[8:11],s80 offen offset:2048 sc1
v_mfma_f32_16x16x32_bf16 a[192:195],v[176:179],v[72:75],a[192:195]
ds_read_b64_tr_b16 v[194:195],v40 offset:12288
v_add_u32 v40,0x4000,v40
v_mfma_f32_16x16x32_bf16 a[224:227],v[176:179],v[76:79],a[224:227]
s_waitcnt lgkmcnt(4)
v_mfma_f32_16x16x32_bf16 a[228:231],v[180:183],v[76:79],a[228:231]
ds_read_b64_tr_b16 v[196:197],v41 offset:8192
v_mfma_f32_16x16x32_bf16 a[196:199],v[180:183],v[72:75],a[196:199]
v_mfma_f32_16x16x32_bf16 a[164:167],v[180:183],v[68:71],a[164:167]
ds_read_b64_tr_b16 v[198:199],v41 offset:12288
v_mfma_f32_16x16x32_bf16 a[132:135],v[180:183],v[64:67],a[132:135]
buffer_load_dwordx4 v[132:135],v5,s[8:11],s80 offen offset:2048 sc1
v_add_u32 v41,0x4000,v41
v_mfma_f32_16x16x32_bf16 a[136:139],v[184:187],v[64:67],a[136:139]
ds_read_b64_tr_b16 v[200:201],v42 offset:8192
s_add_u32 m0,s92,100352
v_mfma_f32_16x16x32_bf16 a[168:171],v[184:187],v[68:71],a[168:171]
v_mfma_f32_16x16x32_bf16 a[200:203],v[184:187],v[72:75],a[200:203]
ds_read_b64_tr_b16 v[202:203],v42 offset:12288
v_add_u32 v42,0x4000,v42
v_mfma_f32_16x16x32_bf16 a[232:235],v[184:187],v[76:79],a[232:235]
s_waitcnt lgkmcnt(4)
v_mfma_f32_16x16x32_bf16 a[236:239],v[188:191],v[76:79],a[236:239]
ds_read_b64_tr_b16 v[204:205],v43 offset:8192
v_mfma_f32_16x16x32_bf16 a[204:207],v[188:191],v[72:75],a[204:207]
buffer_load_dwordx4 v34,s[32:35],s58 offen lds
v_mfma_f32_16x16x32_bf16 a[172:175],v[188:191],v[68:71],a[172:175]
ds_read_b64_tr_b16 v[206:207],v43 offset:12288
v_mfma_f32_16x16x32_bf16 a[140:143],v[188:191],v[64:67],a[140:143]
s_waitcnt vmcnt(9)
s_barrier
v_add_u32 v43,0x4000,v43
v_mfma_f32_16x16x32_bf16 a[144:147],v[192:195],v[64:67],a[144:147]
ds_read_b64_tr_b16 v[176:177],v36 offset:0
v_mfma_f32_16x16x32_bf16 a[176:179],v[192:195],v[68:71],a[176:179]
buffer_store_dword v46,v23,s[8:11],s84 offen sc1
v_mfma_f32_16x16x32_bf16 a[208:211],v[192:195],v[72:75],a[208:211]
ds_read_b64_tr_b16 v[178:179],v36 offset:4096
v_mfma_f32_16x16x32_bf16 a[240:243],v[192:195],v[76:79],a[240:243]
buffer_load_dwordx4 v[136:139],v6,s[8:11],s80 offen offset:2048 sc1
s_waitcnt lgkmcnt(4)
v_mfma_f32_16x16x32_bf16 a[244:247],v[196:199],v[76:79],a[244:247]
ds_read_b64_tr_b16 v[180:181],v37 offset:0
v_mfma_f32_16x16x32_bf16 a[212:215],v[196:199],v[72:75],a[212:215]
v_mfma_f32_16x16x32_bf16 a[180:183],v[196:199],v[68:71],a[180:183]
ds_read_b64_tr_b16 v[182:183],v37 offset:4096
v_mfma_f32_16x16x32_bf16 a[148:151],v[196:199],v[64:67],a[148:151]
buffer_load_dwordx4 v[140:143],v7,s[8:11],s80 offen offset:2048 sc1
v_mfma_f32_16x16x32_bf16 a[152:155],v[200:203],v[64:67],a[152:155]
ds_read_b64_tr_b16 v[184:185],v38 offset:0
s_add_u32 s80,s80,0x40000
v_mfma_f32_16x16x32_bf16 a[184:187],v[200:203],v[68:71],a[184:187]
s_add_u32 m0,s92,101376
v_mfma_f32_16x16x32_bf16 a[216:219],v[200:203],v[72:75],a[216:219]
ds_read_b64_tr_b16 v[186:187],v38 offset:4096
v_mfma_f32_16x16x32_bf16 a[248:251],v[200:203],v[76:79],a[248:251]
s_waitcnt lgkmcnt(6)
v_mfma_f32_16x16x32_bf16 a[252:255],v[204:207],v[76:79],a[252:255]
ds_read_b64_tr_b16 v[188:189],v39 offset:0
v_mfma_f32_16x16x32_bf16 a[220:223],v[204:207],v[72:75],a[220:223]
buffer_load_dwordx4 v35,s[32:35],s58 offen lds
v_mfma_f32_16x16x32_bf16 a[188:191],v[204:207],v[68:71],a[188:191]
ds_read_b64_tr_b16 v[190:191],v39 offset:4096
v_mfma_f32_16x16x32_bf16 a[156:159],v[204:207],v[64:67],a[156:159]
s_waitcnt lgkmcnt(6)
v_mfma_f32_16x16x32_bf16 a[128:131],v[176:179],v[144:147],a[128:131]
ds_read_b64_tr_b16 v[192:193],v40 offset:0
s_mul_i32 s86,s87,196608
v_mfma_f32_16x16x32_bf16 a[160:163],v[176:179],v[148:151],a[160:163]
s_mul_i32 s82,s44,12288
s_add_u32 s86,s86,s82
v_mfma_f32_16x16x32_bf16 a[192:195],v[176:179],v[152:155],a[192:195]
ds_read_b64_tr_b16 v[194:195],v40 offset:4096
s_add_u32 s82,s47,1
v_mfma_f32_16x16x32_bf16 a[224:227],v[176:179],v[156:159],a[224:227]
buffer_load_dwordx4 v[48:51],v4,s[8:11],s80 offen offset:0 sc1
s_waitcnt lgkmcnt(4)
v_mfma_f32_16x16x32_bf16 a[228:231],v[180:183],v[156:159],a[228:231]
ds_read_b64_tr_b16 v[196:197],v41 offset:0
s_and_b32 s82,s82,3
v_mfma_f32_16x16x32_bf16 a[196:199],v[180:183],v[152:155],a[196:199]
s_mul_i32 s82,s82,49152
s_add_u32 s93,s86,s82
v_mfma_f32_16x16x32_bf16 a[164:167],v[180:183],v[148:151],a[164:167]
ds_read_b64_tr_b16 v[198:199],v41 offset:4096
s_add_u32 s93,s93,0x2200000
v_mfma_f32_16x16x32_bf16 a[132:135],v[180:183],v[144:147],a[132:135]
buffer_load_dwordx4 v[52:55],v5,s[8:11],s80 offen offset:0 sc1
v_mfma_f32_16x16x32_bf16 a[136:139],v[184:187],v[144:147],a[136:139]
ds_read_b64_tr_b16 v[200:201],v42 offset:0
s_add_u32 s58,s58,0x20000
v_mfma_f32_16x16x32_bf16 a[168:171],v[184:187],v[148:151],a[168:171]
s_add_u32 m0,s92,114688
s_add_u32 s82,s47,2
v_mfma_f32_16x16x32_bf16 a[200:203],v[184:187],v[152:155],a[200:203]
ds_read_b64_tr_b16 v[202:203],v42 offset:4096
s_and_b32 s82,s82,3
v_mfma_f32_16x16x32_bf16 a[232:235],v[184:187],v[156:159],a[232:235]
s_mul_i32 s82,s82,49152
s_waitcnt lgkmcnt(4)
v_mfma_f32_16x16x32_bf16 a[236:239],v[188:191],v[156:159],a[236:239]
ds_read_b64_tr_b16 v[204:205],v43 offset:0
s_add_u32 s94,s86,s82
v_mfma_f32_16x16x32_bf16 a[204:207],v[188:191],v[152:155],a[204:207]
buffer_load_dwordx4 v32,s[32:35],s58 offen lds
v_mfma_f32_16x16x32_bf16 a[172:175],v[188:191],v[148:151],a[172:175]
ds_read_b64_tr_b16 v[206:207],v43 offset:4096
s_add_u32 s94,s94,0x2201000
v_mfma_f32_16x16x32_bf16 a[140:143],v[188:191],v[144:147],a[140:143]
s_add_u32 s82,s47,3
s_and_b32 s82,s82,3
v_mfma_f32_16x16x32_bf16 a[144:147],v[192:195],v[144:147],a[144:147]
ds_read_b64_tr_b16 v[176:177],v36 offset:8192
s_mul_i32 s82,s82,49152
v_mfma_f32_16x16x32_bf16 a[176:179],v[192:195],v[148:151],a[176:179]
s_add_u32 s81,s86,s82
s_add_u32 s81,s81,0x2202000
v_mfma_f32_16x16x32_bf16 a[208:211],v[192:195],v[152:155],a[208:211]
ds_read_b64_tr_b16 v[178:179],v36 offset:12288
v_add_u32 v36,0x4000,v36
v_mfma_f32_16x16x32_bf16 a[240:243],v[192:195],v[156:159],a[240:243]
buffer_load_dwordx4 v[56:59],v6,s[8:11],s80 offen offset:0 sc1
s_waitcnt lgkmcnt(4)
v_mfma_f32_16x16x32_bf16 a[244:247],v[196:199],v[156:159],a[244:247]
ds_read_b64_tr_b16 v[180:181],v37 offset:8192
s_mul_i32 s82,s47,49152
v_mfma_f32_16x16x32_bf16 a[212:215],v[196:199],v[152:155],a[212:215]
s_add_u32 s82,s82,s86
s_lshl_b32 s87,s87,7
v_mfma_f32_16x16x32_bf16 a[180:183],v[196:199],v[148:151],a[180:183]
ds_read_b64_tr_b16 v[182:183],v37 offset:12288
s_lshl_b32 s83,s47,2
v_mfma_f32_16x16x32_bf16 a[148:151],v[196:199],v[144:147],a[148:151]
s_add_u32 s83,s83,s87
v_add_u32 v37,0x4000,v37
v_mfma_f32_16x16x32_bf16 a[152:155],v[200:203],v[144:147],a[152:155]
ds_read_b64_tr_b16 v[184:185],v38 offset:8192
s_mov_b32 s59,0xbfb8aa3b
v_mfma_f32_16x16x32_bf16 a[184:187],v[200:203],v[148:151],a[184:187]
buffer_load_dwordx4 v[60:63],v7,s[8:11],s80 offen offset:0 sc1
v_mfma_f32_16x16x32_bf16 a[216:219],v[200:203],v[152:155],a[216:219]
ds_read_b64_tr_b16 v[186:187],v38 offset:12288
v_add_u32 v38,0x4000,v38
v_mfma_f32_16x16x32_bf16 a[248:251],v[200:203],v[156:159],a[248:251]
s_add_u32 m0,s92,115712
s_waitcnt lgkmcnt(4)
v_mfma_f32_16x16x32_bf16 a[252:255],v[204:207],v[156:159],a[252:255]
ds_read_b64_tr_b16 v[188:189],v39 offset:8192
v_mfma_f32_16x16x32_bf16 a[220:223],v[204:207],v[152:155],a[220:223]
buffer_load_dwordx4 v33,s[32:35],s58 offen lds
v_mfma_f32_16x16x32_bf16 a[188:191],v[204:207],v[148:151],a[188:191]
ds_read_b64_tr_b16 v[190:191],v39 offset:12288
v_mfma_f32_16x16x32_bf16 a[156:159],v[204:207],v[144:147],a[156:159]
v_add_u32 v39,0x4000,v39
v_mfma_f32_16x16x32_bf16 a[128:131],v[176:179],v[160:163],a[128:131]
ds_read_b64_tr_b16 v[192:193],v40 offset:8192
v_mfma_f32_16x16x32_bf16 a[160:163],v[176:179],v[164:167],a[160:163]
buffer_load_dwordx4 v[64:67],v4,s[8:11],s80 offen offset:2048 sc1
v_mfma_f32_16x16x32_bf16 a[192:195],v[176:179],v[168:171],a[192:195]
ds_read_b64_tr_b16 v[194:195],v40 offset:12288
v_add_u32 v40,0x4000,v40
v_mfma_f32_16x16x32_bf16 a[224:227],v[176:179],v[172:175],a[224:227]
s_waitcnt lgkmcnt(4)
v_mfma_f32_16x16x32_bf16 a[228:231],v[180:183],v[172:175],a[228:231]
ds_read_b64_tr_b16 v[196:197],v41 offset:8192
v_mfma_f32_16x16x32_bf16 a[196:199],v[180:183],v[168:171],a[196:199]
v_mfma_f32_16x16x32_bf16 a[164:167],v[180:183],v[164:167],a[164:167]
ds_read_b64_tr_b16 v[198:199],v41 offset:12288
v_mfma_f32_16x16x32_bf16 a[132:135],v[180:183],v[160:163],a[132:135]
buffer_load_dwordx4 v[68:71],v5,s[8:11],s80 offen offset:2048 sc1
v_add_u32 v41,0x4000,v41
v_mfma_f32_16x16x32_bf16 a[136:139],v[184:187],v[160:163],a[136:139]
ds_read_b64_tr_b16 v[200:201],v42 offset:8192
s_add_u32 m0,s92,116736
v_mfma_f32_16x16x32_bf16 a[168:171],v[184:187],v[164:167],a[168:171]
v_mfma_f32_16x16x32_bf16 a[200:203],v[184:187],v[168:171],a[200:203]
ds_read_b64_tr_b16 v[202:203],v42 offset:12288
v_add_u32 v42,0x4000,v42
v_mfma_f32_16x16x32_bf16 a[232:235],v[184:187],v[172:175],a[232:235]
s_waitcnt lgkmcnt(4)
v_mfma_f32_16x16x32_bf16 a[236:239],v[188:191],v[172:175],a[236:239]
ds_read_b64_tr_b16 v[204:205],v43 offset:8192
v_mfma_f32_16x16x32_bf16 a[204:207],v[188:191],v[168:171],a[204:207]
buffer_load_dwordx4 v34,s[32:35],s58 offen lds
v_mfma_f32_16x16x32_bf16 a[172:175],v[188:191],v[164:167],a[172:175]
ds_read_b64_tr_b16 v[206:207],v43 offset:12288
v_mfma_f32_16x16x32_bf16 a[140:143],v[188:191],v[160:163],a[140:143]
s_waitcnt vmcnt(9)
s_barrier
v_add_u32 v43,0x4000,v43
v_mfma_f32_16x16x32_bf16 a[144:147],v[192:195],v[160:163],a[144:147]
ds_read_b64_tr_b16 v[176:177],v36 offset:0
v_mfma_f32_16x16x32_bf16 a[176:179],v[192:195],v[164:167],a[176:179]
buffer_load_dwordx4 v[72:75],v6,s[8:11],s80 offen offset:2048 sc1
v_mfma_f32_16x16x32_bf16 a[208:211],v[192:195],v[168:171],a[208:211]
ds_read_b64_tr_b16 v[178:179],v36 offset:4096
v_mfma_f32_16x16x32_bf16 a[240:243],v[192:195],v[172:175],a[240:243]
s_waitcnt lgkmcnt(4)
v_mfma_f32_16x16x32_bf16 a[244:247],v[196:199],v[172:175],a[244:247]
ds_read_b64_tr_b16 v[180:181],v37 offset:0
v_mfma_f32_16x16x32_bf16 a[212:215],v[196:199],v[168:171],a[212:215]
v_mfma_f32_16x16x32_bf16 a[180:183],v[196:199],v[164:167],a[180:183]
ds_read_b64_tr_b16 v[182:183],v37 offset:4096
v_mfma_f32_16x16x32_bf16 a[148:151],v[196:199],v[160:163],a[148:151]
buffer_load_dwordx4 v[76:79],v7,s[8:11],s80 offen offset:2048 sc1
v_mfma_f32_16x16x32_bf16 a[152:155],v[200:203],v[160:163],a[152:155]
ds_read_b64_tr_b16 v[184:185],v38 offset:0
s_add_u32 s80,s80,0x40000
v_mfma_f32_16x16x32_bf16 a[184:187],v[200:203],v[164:167],a[184:187]
s_add_u32 m0,s92,117760
v_mfma_f32_16x16x32_bf16 a[216:219],v[200:203],v[168:171],a[216:219]
ds_read_b64_tr_b16 v[186:187],v38 offset:4096
v_mfma_f32_16x16x32_bf16 a[248:251],v[200:203],v[172:175],a[248:251]
s_waitcnt lgkmcnt(6)
v_mfma_f32_16x16x32_bf16 a[252:255],v[204:207],v[172:175],a[252:255]
ds_read_b64_tr_b16 v[188:189],v39 offset:0
v_mfma_f32_16x16x32_bf16 a[220:223],v[204:207],v[168:171],a[220:223]
buffer_load_dwordx4 v35,s[32:35],s58 offen lds
v_mfma_f32_16x16x32_bf16 a[188:191],v[204:207],v[164:167],a[188:191]
ds_read_b64_tr_b16 v[190:191],v39 offset:4096
v_mfma_f32_16x16x32_bf16 a[156:159],v[204:207],v[160:163],a[156:159]
s_waitcnt lgkmcnt(6)
v_mfma_f32_16x16x32_bf16 a[128:131],v[176:179],v[80:83],a[128:131]
ds_read_b64_tr_b16 v[192:193],v40 offset:0
v_mfma_f32_16x16x32_bf16 a[160:163],v[176:179],v[84:87],a[160:163]
v_mfma_f32_16x16x32_bf16 a[192:195],v[176:179],v[88:91],a[192:195]
ds_read_b64_tr_b16 v[194:195],v40 offset:4096
v_mfma_f32_16x16x32_bf16 a[224:227],v[176:179],v[92:95],a[224:227]
buffer_load_dwordx4 v[144:147],v4,s[8:11],s80 offen offset:0 sc1
s_waitcnt lgkmcnt(4)
v_mfma_f32_16x16x32_bf16 a[228:231],v[180:183],v[92:95],a[228:231]
ds_read_b64_tr_b16 v[196:197],v41 offset:0
v_mfma_f32_16x16x32_bf16 a[196:199],v[180:183],v[88:91],a[196:199]
v_mfma_f32_16x16x32_bf16 a[164:167],v[180:183],v[84:87],a[164:167]
ds_read_b64_tr_b16 v[198:199],v41 offset:4096
v_mfma_f32_16x16x32_bf16 a[132:135],v[180:183],v[80:83],a[132:135]
buffer_load_dwordx4 v[148:151],v5,s[8:11],s80 offen offset:0 sc1
v_mfma_f32_16x16x32_bf16 a[136:139],v[184:187],v[80:83],a[136:139]
ds_read_b64_tr_b16 v[200:201],v42 offset:0
s_add_u32 s58,s58,0x20000
v_mfma_f32_16x16x32_bf16 a[168:171],v[184:187],v[84:87],a[168:171]
s_add_u32 m0,s92,131072
v_mfma_f32_16x16x32_bf16 a[200:203],v[184:187],v[88:91],a[200:203]
ds_read_b64_tr_b16 v[202:203],v42 offset:4096
v_mfma_f32_16x16x32_bf16 a[232:235],v[184:187],v[92:95],a[232:235]
s_waitcnt lgkmcnt(4)
v_mfma_f32_16x16x32_bf16 a[236:239],v[188:191],v[92:95],a[236:239]
ds_read_b64_tr_b16 v[204:205],v43 offset:0
v_mfma_f32_16x16x32_bf16 a[204:207],v[188:191],v[88:91],a[204:207]
buffer_load_dwordx4 v32,s[32:35],s58 offen lds
v_mfma_f32_16x16x32_bf16 a[172:175],v[188:191],v[84:87],a[172:175]
ds_read_b64_tr_b16 v[206:207],v43 offset:4096
v_mfma_f32_16x16x32_bf16 a[140:143],v[188:191],v[80:83],a[140:143]
v_mfma_f32_16x16x32_bf16 a[144:147],v[192:195],v[80:83],a[144:147]
ds_read_b64_tr_b16 v[176:177],v36 offset:8192
v_mfma_f32_16x16x32_bf16 a[176:179],v[192:195],v[84:87],a[176:179]
v_mfma_f32_16x16x32_bf16 a[208:211],v[192:195],v[88:91],a[208:211]
ds_read_b64_tr_b16 v[178:179],v36 offset:12288
v_add_u32 v36,0x4000,v36
v_mfma_f32_16x16x32_bf16 a[240:243],v[192:195],v[92:95],a[240:243]
buffer_load_dwordx4 v[152:155],v6,s[8:11],s80 offen offset:0 sc1
s_waitcnt lgkmcnt(4)
v_mfma_f32_16x16x32_bf16 a[244:247],v[196:199],v[92:95],a[244:247]
ds_read_b64_tr_b16 v[180:181],v37 offset:8192
v_mfma_f32_16x16x32_bf16 a[212:215],v[196:199],v[88:91],a[212:215]
v_mfma_f32_16x16x32_bf16 a[180:183],v[196:199],v[84:87],a[180:183]
ds_read_b64_tr_b16 v[182:183],v37 offset:12288
v_mfma_f32_16x16x32_bf16 a[148:151],v[196:199],v[80:83],a[148:151]
v_add_u32 v37,0x4000,v37
v_mfma_f32_16x16x32_bf16 a[152:155],v[200:203],v[80:83],a[152:155]
ds_read_b64_tr_b16 v[184:185],v38 offset:8192
v_mfma_f32_16x16x32_bf16 a[184:187],v[200:203],v[84:87],a[184:187]
buffer_load_dwordx4 v[156:159],v7,s[8:11],s80 offen offset:0 sc1
v_mfma_f32_16x16x32_bf16 a[216:219],v[200:203],v[88:91],a[216:219]
ds_read_b64_tr_b16 v[186:187],v38 offset:12288
v_add_u32 v38,0x4000,v38
v_mfma_f32_16x16x32_bf16 a[248:251],v[200:203],v[92:95],a[248:251]
s_add_u32 m0,s92,132096
s_waitcnt lgkmcnt(4)
v_mfma_f32_16x16x32_bf16 a[252:255],v[204:207],v[92:95],a[252:255]
ds_read_b64_tr_b16 v[188:189],v39 offset:8192
v_mfma_f32_16x16x32_bf16 a[220:223],v[204:207],v[88:91],a[220:223]
buffer_load_dwordx4 v33,s[32:35],s58 offen lds
v_mfma_f32_16x16x32_bf16 a[188:191],v[204:207],v[84:87],a[188:191]
ds_read_b64_tr_b16 v[190:191],v39 offset:12288
v_mfma_f32_16x16x32_bf16 a[156:159],v[204:207],v[80:83],a[156:159]
v_add_u32 v39,0x4000,v39
v_mfma_f32_16x16x32_bf16 a[128:131],v[176:179],v[96:99],a[128:131]
ds_read_b64_tr_b16 v[192:193],v40 offset:8192
v_mfma_f32_16x16x32_bf16 a[160:163],v[176:179],v[100:103],a[160:163]
buffer_load_dwordx4 v[160:163],v4,s[8:11],s80 offen offset:2048 sc1
v_mfma_f32_16x16x32_bf16 a[192:195],v[176:179],v[104:107],a[192:195]
ds_read_b64_tr_b16 v[194:195],v40 offset:12288
v_add_u32 v40,0x4000,v40
v_mfma_f32_16x16x32_bf16 a[224:227],v[176:179],v[108:111],a[224:227]
s_waitcnt lgkmcnt(4)
v_mfma_f32_16x16x32_bf16 a[228:231],v[180:183],v[108:111],a[228:231]
ds_read_b64_tr_b16 v[196:197],v41 offset:8192
v_mfma_f32_16x16x32_bf16 a[196:199],v[180:183],v[104:107],a[196:199]
v_mfma_f32_16x16x32_bf16 a[164:167],v[180:183],v[100:103],a[164:167]
ds_read_b64_tr_b16 v[198:199],v41 offset:12288
v_mfma_f32_16x16x32_bf16 a[132:135],v[180:183],v[96:99],a[132:135]
buffer_load_dwordx4 v[164:167],v5,s[8:11],s80 offen offset:2048 sc1
v_add_u32 v41,0x4000,v41
v_mfma_f32_16x16x32_bf16 a[136:139],v[184:187],v[96:99],a[136:139]
ds_read_b64_tr_b16 v[200:201],v42 offset:8192
s_add_u32 m0,s92,133120
v_mfma_f32_16x16x32_bf16 a[168:171],v[184:187],v[100:103],a[168:171]
v_mfma_f32_16x16x32_bf16 a[200:203],v[184:187],v[104:107],a[200:203]
ds_read_b64_tr_b16 v[202:203],v42 offset:12288
v_add_u32 v42,0x4000,v42
v_mfma_f32_16x16x32_bf16 a[232:235],v[184:187],v[108:111],a[232:235]
buffer_load_dwordx4 v34,s[32:35],s58 offen lds
s_waitcnt lgkmcnt(4)
v_mfma_f32_16x16x32_bf16 a[236:239],v[188:191],v[108:111],a[236:239]
ds_read_b64_tr_b16 v[204:205],v43 offset:8192
v_mfma_f32_16x16x32_bf16 a[204:207],v[188:191],v[104:107],a[204:207]
buffer_load_dword v47,v30,s[8:11],s89 offen sc1
v_mfma_f32_16x16x32_bf16 a[172:175],v[188:191],v[100:103],a[172:175]
ds_read_b64_tr_b16 v[206:207],v43 offset:12288
v_mfma_f32_16x16x32_bf16 a[140:143],v[188:191],v[96:99],a[140:143]
s_waitcnt vmcnt(10)
s_barrier
v_add_u32 v43,0x4000,v43
v_mfma_f32_16x16x32_bf16 a[144:147],v[192:195],v[96:99],a[144:147]
ds_read_b64_tr_b16 v[176:177],v36 offset:0
v_mfma_f32_16x16x32_bf16 a[176:179],v[192:195],v[100:103],a[176:179]
buffer_load_dwordx4 v[168:171],v6,s[8:11],s80 offen offset:2048 sc1
v_mfma_f32_16x16x32_bf16 a[208:211],v[192:195],v[104:107],a[208:211]
ds_read_b64_tr_b16 v[178:179],v36 offset:4096
v_mfma_f32_16x16x32_bf16 a[240:243],v[192:195],v[108:111],a[240:243]
s_waitcnt lgkmcnt(4)
v_mfma_f32_16x16x32_bf16 a[244:247],v[196:199],v[108:111],a[244:247]
ds_read_b64_tr_b16 v[180:181],v37 offset:0
v_mfma_f32_16x16x32_bf16 a[212:215],v[196:199],v[104:107],a[212:215]
v_mfma_f32_16x16x32_bf16 a[180:183],v[196:199],v[100:103],a[180:183]
ds_read_b64_tr_b16 v[182:183],v37 offset:4096
v_mfma_f32_16x16x32_bf16 a[148:151],v[196:199],v[96:99],a[148:151]
buffer_load_dwordx4 v[172:175],v7,s[8:11],s80 offen offset:2048 sc1
v_mfma_f32_16x16x32_bf16 a[152:155],v[200:203],v[96:99],a[152:155]
ds_read_b64_tr_b16 v[184:185],v38 offset:0
s_lshl_b32 s80,s47,22
v_mfma_f32_16x16x32_bf16 a[184:187],v[200:203],v[100:103],a[184:187]
s_add_u32 s80,s80,0x1200000
s_add_u32 m0,s92,134144
v_mfma_f32_16x16x32_bf16 a[216:219],v[200:203],v[104:107],a[216:219]
ds_read_b64_tr_b16 v[186:187],v38 offset:4096
v_mfma_f32_16x16x32_bf16 a[248:251],v[200:203],v[108:111],a[248:251]
s_waitcnt lgkmcnt(6)
v_mfma_f32_16x16x32_bf16 a[252:255],v[204:207],v[108:111],a[252:255]
ds_read_b64_tr_b16 v[188:189],v39 offset:0
v_mfma_f32_16x16x32_bf16 a[220:223],v[204:207],v[104:107],a[220:223]
buffer_load_dwordx4 v35,s[32:35],s58 offen lds
v_mfma_f32_16x16x32_bf16 a[188:191],v[204:207],v[100:103],a[188:191]
ds_read_b64_tr_b16 v[190:191],v39 offset:4096
v_mfma_f32_16x16x32_bf16 a[156:159],v[204:207],v[96:99],a[156:159]
s_waitcnt lgkmcnt(6)
v_mfma_f32_16x16x32_bf16 a[128:131],v[176:179],v[112:115],a[128:131]
ds_read_b64_tr_b16 v[192:193],v40 offset:0
s_add_u32 s58,s58,0x20000
v_mfma_f32_16x16x32_bf16 a[160:163],v[176:179],v[116:119],a[160:163]
s_add_u32 m0,s92,147456
v_mfma_f32_16x16x32_bf16 a[192:195],v[176:179],v[120:123],a[192:195]
ds_read_b64_tr_b16 v[194:195],v40 offset:4096
v_mfma_f32_16x16x32_bf16 a[224:227],v[176:179],v[124:127],a[224:227]
buffer_load_dwordx4 v32,s[32:35],s58 offen lds
s_waitcnt lgkmcnt(4)
v_mfma_f32_16x16x32_bf16 a[228:231],v[180:183],v[124:127],a[228:231]
ds_read_b64_tr_b16 v[196:197],v41 offset:0
s_add_u32 m0,s92,148480
v_mfma_f32_16x16x32_bf16 a[196:199],v[180:183],v[120:123],a[196:199]
v_mfma_f32_16x16x32_bf16 a[164:167],v[180:183],v[116:119],a[164:167]
ds_read_b64_tr_b16 v[198:199],v41 offset:4096
v_mfma_f32_16x16x32_bf16 a[132:135],v[180:183],v[112:115],a[132:135]
buffer_load_dwordx4 v33,s[32:35],s58 offen lds
v_mfma_f32_16x16x32_bf16 a[136:139],v[184:187],v[112:115],a[136:139]
ds_read_b64_tr_b16 v[200:201],v42 offset:0
s_add_u32 m0,s92,149504
v_mfma_f32_16x16x32_bf16 a[168:171],v[184:187],v[116:119],a[168:171]
v_mfma_f32_16x16x32_bf16 a[200:203],v[184:187],v[120:123],a[200:203]
ds_read_b64_tr_b16 v[202:203],v42 offset:4096
v_mfma_f32_16x16x32_bf16 a[232:235],v[184:187],v[124:127],a[232:235]
buffer_load_dwordx4 v34,s[32:35],s58 offen lds
s_waitcnt lgkmcnt(4)
v_mfma_f32_16x16x32_bf16 a[236:239],v[188:191],v[124:127],a[236:239]
ds_read_b64_tr_b16 v[204:205],v43 offset:0
s_add_u32 m0,s92,150528
v_mfma_f32_16x16x32_bf16 a[204:207],v[188:191],v[120:123],a[204:207]
v_mfma_f32_16x16x32_bf16 a[172:175],v[188:191],v[116:119],a[172:175]
ds_read_b64_tr_b16 v[206:207],v43 offset:4096
v_mfma_f32_16x16x32_bf16 a[140:143],v[188:191],v[112:115],a[140:143]
buffer_load_dwordx4 v35,s[32:35],s58 offen lds
v_mfma_f32_16x16x32_bf16 a[144:147],v[192:195],v[112:115],a[144:147]
ds_read_b64_tr_b16 v[176:177],v36 offset:8192
v_mfma_f32_16x16x32_bf16 a[176:179],v[192:195],v[116:119],a[176:179]
s_waitcnt vmcnt(7)
v_cmp_ne_u32 vcc,s49,v47
v_mfma_f32_16x16x32_bf16 a[208:211],v[192:195],v[120:123],a[208:211]
ds_read_b64_tr_b16 v[178:179],v36 offset:12288
v_add_u32 v36,0x4000,v36
v_mfma_f32_16x16x32_bf16 a[240:243],v[192:195],v[124:127],a[240:243]
s_waitcnt lgkmcnt(4)
v_mfma_f32_16x16x32_bf16 a[244:247],v[196:199],v[124:127],a[244:247]
ds_read_b64_tr_b16 v[180:181],v37 offset:8192
v_mfma_f32_16x16x32_bf16 a[212:215],v[196:199],v[120:123],a[212:215]
s_cbranch_vccnz L_spin_o
L_ok_o:
v_mfma_f32_16x16x32_bf16 a[180:183],v[196:199],v[116:119],a[180:183]
ds_read_b64_tr_b16 v[182:183],v37 offset:12288
v_mfma_f32_16x16x32_bf16 a[148:151],v[196:199],v[112:115],a[148:151]
v_add_u32 v37,0x4000,v37
v_mfma_f32_16x16x32_bf16 a[152:155],v[200:203],v[112:115],a[152:155]
ds_read_b64_tr_b16 v[184:185],v38 offset:8192
v_mfma_f32_16x16x32_bf16 a[184:187],v[200:203],v[116:119],a[184:187]
buffer_load_dwordx4 v[80:83],v4,s[8:11],s80 offen offset:0 sc1
v_mfma_f32_16x16x32_bf16 a[216:219],v[200:203],v[120:123],a[216:219]
ds_read_b64_tr_b16 v[186:187],v38 offset:12288
v_add_u32 v38,0x4000,v38
v_mfma_f32_16x16x32_bf16 a[248:251],v[200:203],v[124:127],a[248:251]
s_waitcnt lgkmcnt(4)
v_mfma_f32_16x16x32_bf16 a[252:255],v[204:207],v[124:127],a[252:255]
ds_read_b64_tr_b16 v[188:189],v39 offset:8192
v_mfma_f32_16x16x32_bf16 a[220:223],v[204:207],v[120:123],a[220:223]
buffer_load_dwordx4 v[84:87],v5,s[8:11],s80 offen offset:0 sc1
v_mfma_f32_16x16x32_bf16 a[188:191],v[204:207],v[116:119],a[188:191]
ds_read_b64_tr_b16 v[190:191],v39 offset:12288
v_mfma_f32_16x16x32_bf16 a[156:159],v[204:207],v[112:115],a[156:159]
v_add_u32 v39,0x4000,v39
v_mfma_f32_16x16x32_bf16 a[128:131],v[176:179],v[128:131],a[128:131]
ds_read_b64_tr_b16 v[192:193],v40 offset:8192
v_mfma_f32_16x16x32_bf16 a[160:163],v[176:179],v[132:135],a[160:163]
v_mfma_f32_16x16x32_bf16 a[192:195],v[176:179],v[136:139],a[192:195]
ds_read_b64_tr_b16 v[194:195],v40 offset:12288
v_add_u32 v40,0x4000,v40
v_mfma_f32_16x16x32_bf16 a[224:227],v[176:179],v[140:143],a[224:227]
buffer_load_dwordx4 v[88:91],v6,s[8:11],s80 offen offset:0 sc1
s_waitcnt lgkmcnt(4)
v_mfma_f32_16x16x32_bf16 a[228:231],v[180:183],v[140:143],a[228:231]
ds_read_b64_tr_b16 v[196:197],v41 offset:8192
v_mfma_f32_16x16x32_bf16 a[196:199],v[180:183],v[136:139],a[196:199]
v_mfma_f32_16x16x32_bf16 a[164:167],v[180:183],v[132:135],a[164:167]
ds_read_b64_tr_b16 v[198:199],v41 offset:12288
v_mfma_f32_16x16x32_bf16 a[132:135],v[180:183],v[128:131],a[132:135]
v_add_u32 v41,0x4000,v41
v_mfma_f32_16x16x32_bf16 a[136:139],v[184:187],v[128:131],a[136:139]
ds_read_b64_tr_b16 v[200:201],v42 offset:8192
v_mfma_f32_16x16x32_bf16 a[168:171],v[184:187],v[132:135],a[168:171]
buffer_load_dwordx4 v[92:95],v7,s[8:11],s80 offen offset:0 sc1
v_mfma_f32_16x16x32_bf16 a[200:203],v[184:187],v[136:139],a[200:203]
ds_read_b64_tr_b16 v[202:203],v42 offset:12288
v_add_u32 v42,0x4000,v42
v_mfma_f32_16x16x32_bf16 a[232:235],v[184:187],v[140:143],a[232:235]
s_waitcnt lgkmcnt(4)
v_mfma_f32_16x16x32_bf16 a[236:239],v[188:191],v[140:143],a[236:239]
ds_read_b64_tr_b16 v[204:205],v43 offset:8192
v_mfma_f32_16x16x32_bf16 a[204:207],v[188:191],v[136:139],a[204:207]
buffer_load_dwordx4 v[96:99],v4,s[8:11],s80 offen offset:2048 sc1
v_mfma_f32_16x16x32_bf16 a[172:175],v[188:191],v[132:135],a[172:175]
ds_read_b64_tr_b16 v[206:207],v43 offset:12288
v_mfma_f32_16x16x32_bf16 a[140:143],v[188:191],v[128:131],a[140:143]
s_waitcnt vmcnt(9)
s_barrier
v_add_u32 v43,0x4000,v43
v_mfma_f32_16x16x32_bf16 a[144:147],v[192:195],v[128:131],a[144:147]
ds_read_b64_tr_b16 v[176:177],v36 offset:0
v_mfma_f32_16x16x32_bf16 a[176:179],v[192:195],v[132:135],a[176:179]
buffer_load_dwordx4 v[100:103],v5,s[8:11],s80 offen offset:2048 sc1
v_mfma_f32_16x16x32_bf16 a[208:211],v[192:195],v[136:139],a[208:211]
ds_read_b64_tr_b16 v[178:179],v36 offset:4096
v_mfma_f32_16x16x32_bf16 a[240:243],v[192:195],v[140:143],a[240:243]
s_waitcnt lgkmcnt(4)
v_mfma_f32_16x16x32_bf16 a[244:247],v[196:199],v[140:143],a[244:247]
ds_read_b64_tr_b16 v[180:181],v37 offset:0
v_mfma_f32_16x16x32_bf16 a[212:215],v[196:199],v[136:139],a[212:215]
v_mfma_f32_16x16x32_bf16 a[180:183],v[196:199],v[132:135],a[180:183]
ds_read_b64_tr_b16 v[182:183],v37 offset:4096
v_mfma_f32_16x16x32_bf16 a[148:151],v[196:199],v[128:131],a[148:151]
buffer_load_dwordx4 v[104:107],v6,s[8:11],s80 offen offset:2048 sc1
v_mfma_f32_16x16x32_bf16 a[152:155],v[200:203],v[128:131],a[152:155]
ds_read_b64_tr_b16 v[184:185],v38 offset:0
v_mfma_f32_16x16x32_bf16 a[184:187],v[200:203],v[132:135],a[184:187]
v_mfma_f32_16x16x32_bf16 a[216:219],v[200:203],v[136:139],a[216:219]
ds_read_b64_tr_b16 v[186:187],v38 offset:4096
v_mfma_f32_16x16x32_bf16 a[248:251],v[200:203],v[140:143],a[248:251]
s_waitcnt lgkmcnt(6)
v_mfma_f32_16x16x32_bf16 a[252:255],v[204:207],v[140:143],a[252:255]
ds_read_b64_tr_b16 v[188:189],v39 offset:0
v_mfma_f32_16x16x32_bf16 a[220:223],v[204:207],v[136:139],a[220:223]
buffer_load_dwordx4 v[108:111],v7,s[8:11],s80 offen offset:2048 sc1
v_mfma_f32_16x16x32_bf16 a[188:191],v[204:207],v[132:135],a[188:191]
ds_read_b64_tr_b16 v[190:191],v39 offset:4096
s_add_u32 s80,s80,0x40000
v_mfma_f32_16x16x32_bf16 a[156:159],v[204:207],v[128:131],a[156:159]
s_waitcnt lgkmcnt(6)
v_mfma_f32_16x16x32_bf16 a[128:131],v[176:179],v[48:51],a[128:131]
ds_read_b64_tr_b16 v[192:193],v40 offset:0
v_mfma_f32_16x16x32_bf16 a[160:163],v[176:179],v[52:55],a[160:163]
v_mfma_f32_16x16x32_bf16 a[192:195],v[176:179],v[56:59],a[192:195]
ds_read_b64_tr_b16 v[194:195],v40 offset:4096
v_mfma_f32_16x16x32_bf16 a[224:227],v[176:179],v[60:63],a[224:227]
buffer_load_dwordx4 v[112:115],v4,s[8:11],s80 offen offset:0 sc1
s_waitcnt lgkmcnt(4)
v_mfma_f32_16x16x32_bf16 a[228:231],v[180:183],v[60:63],a[228:231]
ds_read_b64_tr_b16 v[196:197],v41 offset:0
v_mfma_f32_16x16x32_bf16 a[196:199],v[180:183],v[56:59],a[196:199]
v_mfma_f32_16x16x32_bf16 a[164:167],v[180:183],v[52:55],a[164:167]
ds_read_b64_tr_b16 v[198:199],v41 offset:4096
v_mfma_f32_16x16x32_bf16 a[132:135],v[180:183],v[48:51],a[132:135]
buffer_load_dwordx4 v[116:119],v5,s[8:11],s80 offen offset:0 sc1
v_mfma_f32_16x16x32_bf16 a[136:139],v[184:187],v[48:51],a[136:139]
ds_read_b64_tr_b16 v[200:201],v42 offset:0
s_mov_b32 s58,s53
v_mfma_f32_16x16x32_bf16 a[168:171],v[184:187],v[52:55],a[168:171]
s_add_u32 m0,s92,0
v_mfma_f32_16x16x32_bf16 a[200:203],v[184:187],v[56:59],a[200:203]
ds_read_b64_tr_b16 v[202:203],v42 offset:4096
v_mfma_f32_16x16x32_bf16 a[232:235],v[184:187],v[60:63],a[232:235]
s_waitcnt lgkmcnt(4)
v_mfma_f32_16x16x32_bf16 a[236:239],v[188:191],v[60:63],a[236:239]
ds_read_b64_tr_b16 v[204:205],v43 offset:0
v_mfma_f32_16x16x32_bf16 a[204:207],v[188:191],v[56:59],a[204:207]
buffer_load_dwordx4 v32,s[36:39],s58 offen lds
v_mfma_f32_16x16x32_bf16 a[172:175],v[188:191],v[52:55],a[172:175]
ds_read_b64_tr_b16 v[206:207],v43 offset:4096
v_mfma_f32_16x16x32_bf16 a[140:143],v[188:191],v[48:51],a[140:143]
v_mfma_f32_16x16x32_bf16 a[144:147],v[192:195],v[48:51],a[144:147]
ds_read_b64_tr_b16 v[176:177],v36 offset:8192
v_mfma_f32_16x16x32_bf16 a[176:179],v[192:195],v[52:55],a[176:179]
v_mfma_f32_16x16x32_bf16 a[208:211],v[192:195],v[56:59],a[208:211]
ds_read_b64_tr_b16 v[178:179],v36 offset:12288
v_add_u32 v36,0x4000,v36
v_mfma_f32_16x16x32_bf16 a[240:243],v[192:195],v[60:63],a[240:243]
buffer_load_dwordx4 v[120:123],v6,s[8:11],s80 offen offset:0 sc1
s_waitcnt lgkmcnt(4)
v_mfma_f32_16x16x32_bf16 a[244:247],v[196:199],v[60:63],a[244:247]
ds_read_b64_tr_b16 v[180:181],v37 offset:8192
v_mfma_f32_16x16x32_bf16 a[212:215],v[196:199],v[56:59],a[212:215]
v_mfma_f32_16x16x32_bf16 a[180:183],v[196:199],v[52:55],a[180:183]
ds_read_b64_tr_b16 v[182:183],v37 offset:12288
v_mfma_f32_16x16x32_bf16 a[148:151],v[196:199],v[48:51],a[148:151]
v_add_u32 v37,0x4000,v37
v_mfma_f32_16x16x32_bf16 a[152:155],v[200:203],v[48:51],a[152:155]
ds_read_b64_tr_b16 v[184:185],v38 offset:8192
v_mfma_f32_16x16x32_bf16 a[184:187],v[200:203],v[52:55],a[184:187]
buffer_load_dwordx4 v[124:127],v7,s[8:11],s80 offen offset:0 sc1
v_mfma_f32_16x16x32_bf16 a[216:219],v[200:203],v[56:59],a[216:219]
ds_read_b64_tr_b16 v[186:187],v38 offset:12288
v_add_u32 v38,0x4000,v38
v_mfma_f32_16x16x32_bf16 a[248:251],v[200:203],v[60:63],a[248:251]
s_add_u32 m0,s92,1024
s_waitcnt lgkmcnt(4)
v_mfma_f32_16x16x32_bf16 a[252:255],v[204:207],v[60:63],a[252:255]
ds_read_b64_tr_b16 v[188:189],v39 offset:8192
v_mfma_f32_16x16x32_bf16 a[220:223],v[204:207],v[56:59],a[220:223]
buffer_load_dwordx4 v33,s[36:39],s58 offen lds
v_mfma_f32_16x16x32_bf16 a[188:191],v[204:207],v[52:55],a[188:191]
ds_read_b64_tr_b16 v[190:191],v39 offset:12288
v_mfma_f32_16x16x32_bf16 a[156:159],v[204:207],v[48:51],a[156:159]
v_add_u32 v39,0x4000,v39
v_mfma_f32_16x16x32_bf16 a[128:131],v[176:179],v[64:67],a[128:131]
ds_read_b64_tr_b16 v[192:193],v40 offset:8192
v_mfma_f32_16x16x32_bf16 a[160:163],v[176:179],v[68:71],a[160:163]
buffer_load_dwordx4 v[128:131],v4,s[8:11],s80 offen offset:2048 sc1
v_mfma_f32_16x16x32_bf16 a[192:195],v[176:179],v[72:75],a[192:195]
ds_read_b64_tr_b16 v[194:195],v40 offset:12288
v_add_u32 v40,0x4000,v40
v_mfma_f32_16x16x32_bf16 a[224:227],v[176:179],v[76:79],a[224:227]
s_waitcnt lgkmcnt(4)
v_mfma_f32_16x16x32_bf16 a[228:231],v[180:183],v[76:79],a[228:231]
ds_read_b64_tr_b16 v[196:197],v41 offset:8192
v_mfma_f32_16x16x32_bf16 a[196:199],v[180:183],v[72:75],a[196:199]
v_mfma_f32_16x16x32_bf16 a[164:167],v[180:183],v[68:71],a[164:167]
ds_read_b64_tr_b16 v[198:199],v41 offset:12288
v_mfma_f32_16x16x32_bf16 a[132:135],v[180:183],v[64:67],a[132:135]
buffer_load_dwordx4 v[132:135],v5,s[8:11],s80 offen offset:2048 sc1
v_add_u32 v41,0x4000,v41
v_mfma_f32_16x16x32_bf16 a[136:139],v[184:187],v[64:67],a[136:139]
ds_read_b64_tr_b16 v[200:201],v42 offset:8192
s_add_u32 m0,s92,2048
v_mfma_f32_16x16x32_bf16 a[168:171],v[184:187],v[68:71],a[168:171]
v_mfma_f32_16x16x32_bf16 a[200:203],v[184:187],v[72:75],a[200:203]
ds_read_b64_tr_b16 v[202:203],v42 offset:12288
v_add_u32 v42,0x4000,v42
v_mfma_f32_16x16x32_bf16 a[232:235],v[184:187],v[76:79],a[232:235]
s_waitcnt lgkmcnt(4)
v_mfma_f32_16x16x32_bf16 a[236:239],v[188:191],v[76:79],a[236:239]
ds_read_b64_tr_b16 v[204:205],v43 offset:8192
v_mfma_f32_16x16x32_bf16 a[204:207],v[188:191],v[72:75],a[204:207]
buffer_load_dwordx4 v34,s[36:39],s58 offen lds
v_mfma_f32_16x16x32_bf16 a[172:175],v[188:191],v[68:71],a[172:175]
ds_read_b64_tr_b16 v[206:207],v43 offset:12288
v_mfma_f32_16x16x32_bf16 a[140:143],v[188:191],v[64:67],a[140:143]
s_waitcnt vmcnt(17)
s_barrier
v_add_u32 v43,0x4000,v43
v_mfma_f32_16x16x32_bf16 a[144:147],v[192:195],v[64:67],a[144:147]
ds_read_b64_tr_b16 v[176:177],v36 offset:0
v_mfma_f32_16x16x32_bf16 a[176:179],v[192:195],v[68:71],a[176:179]
buffer_load_dwordx4 v[136:139],v6,s[8:11],s80 offen offset:2048 sc1
v_mfma_f32_16x16x32_bf16 a[208:211],v[192:195],v[72:75],a[208:211]
ds_read_b64_tr_b16 v[178:179],v36 offset:4096
v_mfma_f32_16x16x32_bf16 a[240:243],v[192:195],v[76:79],a[240:243]
s_waitcnt lgkmcnt(4)
v_mfma_f32_16x16x32_bf16 a[244:247],v[196:199],v[76:79],a[244:247]
ds_read_b64_tr_b16 v[180:181],v37 offset:0
v_mfma_f32_16x16x32_bf16 a[212:215],v[196:199],v[72:75],a[212:215]
v_mfma_f32_16x16x32_bf16 a[180:183],v[196:199],v[68:71],a[180:183]
ds_read_b64_tr_b16 v[182:183],v37 offset:4096
v_mfma_f32_16x16x32_bf16 a[148:151],v[196:199],v[64:67],a[148:151]
buffer_load_dwordx4 v[140:143],v7,s[8:11],s80 offen offset:2048 sc1
v_mfma_f32_16x16x32_bf16 a[152:155],v[200:203],v[64:67],a[152:155]
ds_read_b64_tr_b16 v[184:185],v38 offset:0
s_add_u32 s80,s80,0x40000
v_mfma_f32_16x16x32_bf16 a[184:187],v[200:203],v[68:71],a[184:187]
s_add_u32 m0,s92,3072
v_mfma_f32_16x16x32_bf16 a[216:219],v[200:203],v[72:75],a[216:219]
ds_read_b64_tr_b16 v[186:187],v38 offset:4096
v_mfma_f32_16x16x32_bf16 a[248:251],v[200:203],v[76:79],a[248:251]
s_waitcnt lgkmcnt(6)
v_mfma_f32_16x16x32_bf16 a[252:255],v[204:207],v[76:79],a[252:255]
ds_read_b64_tr_b16 v[188:189],v39 offset:0
v_mfma_f32_16x16x32_bf16 a[220:223],v[204:207],v[72:75],a[220:223]
buffer_load_dwordx4 v35,s[36:39],s58 offen lds
v_mfma_f32_16x16x32_bf16 a[188:191],v[204:207],v[68:71],a[188:191]
ds_read_b64_tr_b16 v[190:191],v39 offset:4096
v_mfma_f32_16x16x32_bf16 a[156:159],v[204:207],v[64:67],a[156:159]
s_waitcnt lgkmcnt(6)
v_mfma_f32_16x16x32_bf16 a[128:131],v[176:179],v[144:147],a[128:131]
ds_read_b64_tr_b16 v[192:193],v40 offset:0
v_mfma_f32_16x16x32_bf16 a[160:163],v[176:179],v[148:151],a[160:163]
v_mfma_f32_16x16x32_bf16 a[192:195],v[176:179],v[152:155],a[192:195]
ds_read_b64_tr_b16 v[194:195],v40 offset:4096
v_mfma_f32_16x16x32_bf16 a[224:227],v[176:179],v[156:159],a[224:227]
buffer_load_dwordx4 v[48:51],v4,s[8:11],s80 offen offset:0 sc1
s_waitcnt lgkmcnt(4)
v_mfma_f32_16x16x32_bf16 a[228:231],v[180:183],v[156:159],a[228:231]
ds_read_b64_tr_b16 v[196:197],v41 offset:0
v_mfma_f32_16x16x32_bf16 a[196:199],v[180:183],v[152:155],a[196:199]
v_mfma_f32_16x16x32_bf16 a[164:167],v[180:183],v[148:151],a[164:167]
ds_read_b64_tr_b16 v[198:199],v41 offset:4096
v_mfma_f32_16x16x32_bf16 a[132:135],v[180:183],v[144:147],a[132:135]
buffer_load_dwordx4 v[52:55],v5,s[8:11],s80 offen offset:0 sc1
v_mfma_f32_16x16x32_bf16 a[136:139],v[184:187],v[144:147],a[136:139]
ds_read_b64_tr_b16 v[200:201],v42 offset:0
s_add_u32 s58,s58,0x20000
v_mfma_f32_16x16x32_bf16 a[168:171],v[184:187],v[148:151],a[168:171]
s_add_u32 m0,s92,16384
v_mfma_f32_16x16x32_bf16 a[200:203],v[184:187],v[152:155],a[200:203]
ds_read_b64_tr_b16 v[202:203],v42 offset:4096
v_mfma_f32_16x16x32_bf16 a[232:235],v[184:187],v[156:159],a[232:235]
s_waitcnt lgkmcnt(4)
v_mfma_f32_16x16x32_bf16 a[236:239],v[188:191],v[156:159],a[236:239]
ds_read_b64_tr_b16 v[204:205],v43 offset:0
v_mfma_f32_16x16x32_bf16 a[204:207],v[188:191],v[152:155],a[204:207]
buffer_load_dwordx4 v32,s[36:39],s58 offen lds
v_mfma_f32_16x16x32_bf16 a[172:175],v[188:191],v[148:151],a[172:175]
ds_read_b64_tr_b16 v[206:207],v43 offset:4096
v_mfma_f32_16x16x32_bf16 a[140:143],v[188:191],v[144:147],a[140:143]
v_mfma_f32_16x16x32_bf16 a[144:147],v[192:195],v[144:147],a[144:147]
ds_read_b64_tr_b16 v[176:177],v36 offset:8192
v_mfma_f32_16x16x32_bf16 a[176:179],v[192:195],v[148:151],a[176:179]
v_mfma_f32_16x16x32_bf16 a[208:211],v[192:195],v[152:155],a[208:211]
ds_read_b64_tr_b16 v[178:179],v36 offset:12288
v_add_u32 v36,0xfffdc000,v36
v_mfma_f32_16x16x32_bf16 a[240:243],v[192:195],v[156:159],a[240:243]
buffer_load_dwordx4 v[56:59],v6,s[8:11],s80 offen offset:0 sc1
s_waitcnt lgkmcnt(4)
v_mfma_f32_16x16x32_bf16 a[244:247],v[196:199],v[156:159],a[244:247]
ds_read_b64_tr_b16 v[180:181],v37 offset:8192
v_mfma_f32_16x16x32_bf16 a[212:215],v[196:199],v[152:155],a[212:215]
v_mfma_f32_16x16x32_bf16 a[180:183],v[196:199],v[148:151],a[180:183]
ds_read_b64_tr_b16 v[182:183],v37 offset:12288
v_mfma_f32_16x16x32_bf16 a[148:151],v[196:199],v[144:147],a[148:151]
v_add_u32 v37,0xfffdc000,v37
v_mfma_f32_16x16x32_bf16 a[152:155],v[200:203],v[144:147],a[152:155]
ds_read_b64_tr_b16 v[184:185],v38 offset:8192
v_mfma_f32_16x16x32_bf16 a[184:187],v[200:203],v[148:151],a[184:187]
buffer_load_dwordx4 v[60:63],v7,s[8:11],s80 offen offset:0 sc1
v_mfma_f32_16x16x32_bf16 a[216:219],v[200:203],v[152:155],a[216:219]
ds_read_b64_tr_b16 v[186:187],v38 offset:12288
v_add_u32 v38,0xfffdc000,v38
v_mfma_f32_16x16x32_bf16 a[248:251],v[200:203],v[156:159],a[248:251]
s_add_u32 m0,s92,17408
s_waitcnt lgkmcnt(4)
v_mfma_f32_16x16x32_bf16 a[252:255],v[204:207],v[156:159],a[252:255]
ds_read_b64_tr_b16 v[188:189],v39 offset:8192
v_mfma_f32_16x16x32_bf16 a[220:223],v[204:207],v[152:155],a[220:223]
buffer_load_dwordx4 v33,s[36:39],s58 offen lds
v_mfma_f32_16x16x32_bf16 a[188:191],v[204:207],v[148:151],a[188:191]
ds_read_b64_tr_b16 v[190:191],v39 offset:12288
v_mfma_f32_16x16x32_bf16 a[156:159],v[204:207],v[144:147],a[156:159]
v_add_u32 v39,0xfffdc000,v39
v_mfma_f32_16x16x32_bf16 a[128:131],v[176:179],v[160:163],a[128:131]
ds_read_b64_tr_b16 v[192:193],v40 offset:8192
v_mfma_f32_16x16x32_bf16 a[160:163],v[176:179],v[164:167],a[160:163]
buffer_load_dwordx4 v[64:67],v4,s[8:11],s80 offen offset:2048 sc1
v_mfma_f32_16x16x32_bf16 a[192:195],v[176:179],v[168:171],a[192:195]
ds_read_b64_tr_b16 v[194:195],v40 offset:12288
v_add_u32 v40,0xfffdc000,v40
v_mfma_f32_16x16x32_bf16 a[224:227],v[176:179],v[172:175],a[224:227]
s_waitcnt lgkmcnt(4)
v_mfma_f32_16x16x32_bf16 a[228:231],v[180:183],v[172:175],a[228:231]
ds_read_b64_tr_b16 v[196:197],v41 offset:8192
v_mfma_f32_16x16x32_bf16 a[196:199],v[180:183],v[168:171],a[196:199]
v_mfma_f32_16x16x32_bf16 a[164:167],v[180:183],v[164:167],a[164:167]
ds_read_b64_tr_b16 v[198:199],v41 offset:12288
v_mfma_f32_16x16x32_bf16 a[132:135],v[180:183],v[160:163],a[132:135]
buffer_load_dwordx4 v[68:71],v5,s[8:11],s80 offen offset:2048 sc1
v_add_u32 v41,0xfffdc000,v41
v_mfma_f32_16x16x32_bf16 a[136:139],v[184:187],v[160:163],a[136:139]
ds_read_b64_tr_b16 v[200:201],v42 offset:8192
s_add_u32 m0,s92,18432
v_mfma_f32_16x16x32_bf16 a[168:171],v[184:187],v[164:167],a[168:171]
v_mfma_f32_16x16x32_bf16 a[200:203],v[184:187],v[168:171],a[200:203]
ds_read_b64_tr_b16 v[202:203],v42 offset:12288
v_add_u32 v42,0xfffdc000,v42
v_mfma_f32_16x16x32_bf16 a[232:235],v[184:187],v[172:175],a[232:235]
s_waitcnt lgkmcnt(4)
v_mfma_f32_16x16x32_bf16 a[236:239],v[188:191],v[172:175],a[236:239]
ds_read_b64_tr_b16 v[204:205],v43 offset:8192
v_mfma_f32_16x16x32_bf16 a[204:207],v[188:191],v[168:171],a[204:207]
buffer_load_dwordx4 v34,s[36:39],s58 offen lds
v_mfma_f32_16x16x32_bf16 a[172:175],v[188:191],v[164:167],a[172:175]
ds_read_b64_tr_b16 v[206:207],v43 offset:12288
v_mfma_f32_16x16x32_bf16 a[140:143],v[188:191],v[160:163],a[140:143]
s_waitcnt vmcnt(9)
s_barrier
v_add_u32 v43,0xfffdc000,v43
v_mfma_f32_16x16x32_bf16 a[144:147],v[192:195],v[160:163],a[144:147]
ds_read_b64_tr_b16 v[176:177],v36 offset:0
v_mfma_f32_16x16x32_bf16 a[176:179],v[192:195],v[164:167],a[176:179]
buffer_load_dwordx4 v[72:75],v6,s[8:11],s80 offen offset:2048 sc1
v_mfma_f32_16x16x32_bf16 a[208:211],v[192:195],v[168:171],a[208:211]
ds_read_b64_tr_b16 v[178:179],v36 offset:4096
v_mfma_f32_16x16x32_bf16 a[240:243],v[192:195],v[172:175],a[240:243]
s_waitcnt lgkmcnt(4)
v_mfma_f32_16x16x32_bf16 a[244:247],v[196:199],v[172:175],a[244:247]
ds_read_b64_tr_b16 v[180:181],v37 offset:0
v_mfma_f32_16x16x32_bf16 a[212:215],v[196:199],v[168:171],a[212:215]
v_mfma_f32_16x16x32_bf16 a[180:183],v[196:199],v[164:167],a[180:183]
ds_read_b64_tr_b16 v[182:183],v37 offset:4096
v_mfma_f32_16x16x32_bf16 a[148:151],v[196:199],v[160:163],a[148:151]
buffer_load_dwordx4 v[76:79],v7,s[8:11],s80 offen offset:2048 sc1
v_mfma_f32_16x16x32_bf16 a[152:155],v[200:203],v[160:163],a[152:155]
ds_read_b64_tr_b16 v[184:185],v38 offset:0
s_add_u32 s80,s80,0x40000
v_mfma_f32_16x16x32_bf16 a[184:187],v[200:203],v[164:167],a[184:187]
s_add_u32 m0,s92,19456
v_mfma_f32_16x16x32_bf16 a[216:219],v[200:203],v[168:171],a[216:219]
ds_read_b64_tr_b16 v[186:187],v38 offset:4096
v_mfma_f32_16x16x32_bf16 a[248:251],v[200:203],v[172:175],a[248:251]
s_waitcnt lgkmcnt(6)
v_mfma_f32_16x16x32_bf16 a[252:255],v[204:207],v[172:175],a[252:255]
ds_read_b64_tr_b16 v[188:189],v39 offset:0
v_mfma_f32_16x16x32_bf16 a[220:223],v[204:207],v[168:171],a[220:223]
buffer_load_dwordx4 v35,s[36:39],s58 offen lds
v_mfma_f32_16x16x32_bf16 a[188:191],v[204:207],v[164:167],a[188:191]
ds_read_b64_tr_b16 v[190:191],v39 offset:4096
v_mfma_f32_16x16x32_bf16 a[156:159],v[204:207],v[160:163],a[156:159]
s_waitcnt lgkmcnt(6)
v_mfma_f32_16x16x32_bf16 a[0:3],v[176:179],v[80:83],0
ds_read_b64_tr_b16 v[192:193],v40 offset:0
v_accvgpr_read_b32 v208,a160
v_mfma_f32_16x16x32_bf16 a[32:35],v[176:179],v[84:87],0
v_accvgpr_read_b32 v209,a161
v_accvgpr_read_b32 v210,a162
v_mfma_f32_16x16x32_bf16 a[64:67],v[176:179],v[88:91],0
ds_read_b64_tr_b16 v[194:195],v40 offset:4096
v_accvgpr_read_b32 v211,a163
v_mfma_f32_16x16x32_bf16 a[96:99],v[176:179],v[92:95],0
buffer_load_dwordx4 v[144:147],v4,s[8:11],s80 offen offset:0 sc1
s_waitcnt lgkmcnt(4)
v_mfma_f32_16x16x32_bf16 a[100:103],v[180:183],v[92:95],0
ds_read_b64_tr_b16 v[196:197],v41 offset:0
v_accvgpr_read_b32 v212,a164
v_mfma_f32_16x16x32_bf16 a[68:71],v[180:183],v[88:91],0
v_accvgpr_read_b32 v213,a165
v_accvgpr_read_b32 v214,a166
v_mfma_f32_16x16x32_bf16 a[36:39],v[180:183],v[84:87],0
ds_read_b64_tr_b16 v[198:199],v41 offset:4096
v_accvgpr_read_b32 v215,a167
v_mfma_f32_16x16x32_bf16 a[4:7],v[180:183],v[80:83],0
buffer_load_dwordx4 v[148:151],v5,s[8:11],s80 offen offset:0 sc1
v_mfma_f32_16x16x32_bf16 a[8:11],v[184:187],v[80:83],0
ds_read_b64_tr_b16 v[200:201],v42 offset:0
s_add_u32 s58,s58,0x20000
v_mfma_f32_16x16x32_bf16 a[40:43],v[184:187],v[84:87],0
s_add_u32 m0,s92,32768
v_cvt_pk_bf16_f32 v224,v208,v209
v_mfma_f32_16x16x32_bf16 a[72:75],v[184:187],v[88:91],0
ds_read_b64_tr_b16 v[202:203],v42 offset:4096
v_cvt_pk_bf16_f32 v225,v210,v211
v_mfma_f32_16x16x32_bf16 a[104:107],v[184:187],v[92:95],0
v_cvt_pk_bf16_f32 v226,v212,v213
s_waitcnt lgkmcnt(4)
v_mfma_f32_16x16x32_bf16 a[108:111],v[188:191],v[92:95],0
ds_read_b64_tr_b16 v[204:205],v43 offset:0
v_cvt_pk_bf16_f32 v227,v214,v215
v_mfma_f32_16x16x32_bf16 a[76:79],v[188:191],v[88:91],0
buffer_load_dwordx4 v32,s[36:39],s58 offen lds
v_mfma_f32_16x16x32_bf16 a[44:47],v[188:191],v[84:87],0
ds_read_b64_tr_b16 v[206:207],v43 offset:4096
v_accvgpr_read_b32 v216,a168
v_mfma_f32_16x16x32_bf16 a[12:15],v[188:191],v[80:83],0
buffer_store_dwordx4 v[224:227],v1,s[8:11],s93 offen offset:0 sc1
v_mfma_f32_16x16x32_bf16 a[16:19],v[192:195],v[80:83],0
ds_read_b64_tr_b16 v[176:177],v36 offset:8192
v_accvgpr_read_b32 v217,a169
v_mfma_f32_16x16x32_bf16 a[48:51],v[192:195],v[84:87],0
v_accvgpr_read_b32 v218,a170
v_accvgpr_read_b32 v219,a171
v_mfma_f32_16x16x32_bf16 a[80:83],v[192:195],v[88:91],0
ds_read_b64_tr_b16 v[178:179],v36 offset:12288
v_add_u32 v36,0x4000,v36
v_mfma_f32_16x16x32_bf16 a[112:115],v[192:195],v[92:95],0
buffer_load_dwordx4 v[152:155],v6,s[8:11],s80 offen offset:0 sc1
s_waitcnt lgkmcnt(4)
v_mfma_f32_16x16x32_bf16 a[116:119],v[196:199],v[92:95],0
ds_read_b64_tr_b16 v[180:181],v37 offset:8192
v_accvgpr_read_b32 v220,a172
v_mfma_f32_16x16x32_bf16 a[84:87],v[196:199],v[88:91],0
v_accvgpr_read_b32 v221,a173
v_accvgpr_read_b32 v222,a174
v_mfma_f32_16x16x32_bf16 a[52:55],v[196:199],v[84:87],0
ds_read_b64_tr_b16 v[182:183],v37 offset:12288
v_accvgpr_read_b32 v223,a175
v_mfma_f32_16x16x32_bf16 a[20:23],v[196:199],v[80:83],0
v_add_u32 v37,0x4000,v37
v_cvt_pk_bf16_f32 v228,v216,v217
v_mfma_f32_16x16x32_bf16 a[24:27],v[200:203],v[80:83],0
ds_read_b64_tr_b16 v[184:185],v38 offset:8192
v_cvt_pk_bf16_f32 v229,v218,v219
v_mfma_f32_16x16x32_bf16 a[56:59],v[200:203],v[84:87],0
buffer_load_dwordx4 v[156:159],v7,s[8:11],s80 offen offset:0 sc1
v_mfma_f32_16x16x32_bf16 a[88:91],v[200:203],v[88:91],0
ds_read_b64_tr_b16 v[186:187],v38 offset:12288
v_add_u32 v38,0x4000,v38
v_mfma_f32_16x16x32_bf16 a[120:123],v[200:203],v[92:95],0
s_add_u32 m0,s92,33792
s_waitcnt lgkmcnt(4)
v_mfma_f32_16x16x32_bf16 a[124:127],v[204:207],v[92:95],0
ds_read_b64_tr_b16 v[188:189],v39 offset:8192
v_cvt_pk_bf16_f32 v230,v220,v221
v_mfma_f32_16x16x32_bf16 a[92:95],v[204:207],v[88:91],0
buffer_load_dwordx4 v33,s[36:39],s58 offen lds
v_mfma_f32_16x16x32_bf16 a[60:63],v[204:207],v[84:87],0
ds_read_b64_tr_b16 v[190:191],v39 offset:12288
v_cvt_pk_bf16_f32 v231,v222,v223
v_mfma_f32_16x16x32_bf16 a[28:31],v[204:207],v[80:83],0
v_add_u32 v39,0x4000,v39
v_accvgpr_read_b32 v208,a176
v_mfma_f32_16x16x32_bf16 a[0:3],v[176:179],v[96:99],a[0:3]
ds_read_b64_tr_b16 v[192:193],v40 offset:8192
v_accvgpr_read_b32 v209,a177
v_mfma_f32_16x16x32_bf16 a[32:35],v[176:179],v[100:103],a[32:35]
buffer_load_dwordx4 v[160:163],v4,s[8:11],s80 offen offset:2048 sc1
v_mfma_f32_16x16x32_bf16 a[64:67],v[176:179],v[104:107],a[64:67]
ds_read_b64_tr_b16 v[194:195],v40 offset:12288
v_add_u32 v40,0x4000,v40
v_mfma_f32_16x16x32_bf16 a[96:99],v[176:179],v[108:111],a[96:99]
v_accvgpr_read_b32 v210,a178
s_waitcnt lgkmcnt(4)
v_mfma_f32_16x16x32_bf16 a[100:103],v[180:183],v[108:111],a[100:103]
ds_read_b64_tr_b16 v[196:197],v41 offset:8192
v_accvgpr_read_b32 v211,a179
v_mfma_f32_16x16x32_bf16 a[68:71],v[180:183],v[104:107],a[68:71]
buffer_store_dwordx4 v[228:231],v1,s[8:11],s93 offen offset:1024 sc1
v_mfma_f32_16x16x32_bf16 a[36:39],v[180:183],v[100:103],a[36:39]
ds_read_b64_tr_b16 v[198:199],v41 offset:12288
v_accvgpr_read_b32 v212,a180
v_mfma_f32_16x16x32_bf16 a[4:7],v[180:183],v[96:99],a[4:7]
buffer_load_dwordx4 v[164:167],v5,s[8:11],s80 offen offset:2048 sc1
v_add_u32 v41,0x4000,v41
v_mfma_f32_16x16x32_bf16 a[8:11],v[184:187],v[96:99],a[8:11]
ds_read_b64_tr_b16 v[200:201],v42 offset:8192
s_add_u32 m0,s92,34816
v_mfma_f32_16x16x32_bf16 a[40:43],v[184:187],v[100:103],a[40:43]
v_accvgpr_read_b32 v213,a181
v_accvgpr_read_b32 v214,a182
v_mfma_f32_16x16x32_bf16 a[72:75],v[184:187],v[104:107],a[72:75]
ds_read_b64_tr_b16 v[202:203],v42 offset:12288
v_add_u32 v42,0x4000,v42
v_mfma_f32_16x16x32_bf16 a[104:107],v[184:187],v[108:111],a[104:107]
v_accvgpr_read_b32 v215,a183
s_waitcnt lgkmcnt(4)
v_mfma_f32_16x16x32_bf16 a[108:111],v[188:191],v[108:111],a[108:111]
ds_read_b64_tr_b16 v[204:205],v43 offset:8192
v_cvt_pk_bf16_f32 v224,v208,v209
v_mfma_f32_16x16x32_bf16 a[76:79],v[188:191],v[104:107],a[76:79]
buffer_load_dwordx4 v34,s[36:39],s58 offen lds
v_mfma_f32_16x16x32_bf16 a[44:47],v[188:191],v[100:103],a[44:47]
ds_read_b64_tr_b16 v[206:207],v43 offset:12288
v_cvt_pk_bf16_f32 v225,v210,v211
v_mfma_f32_16x16x32_bf16 a[12:15],v[188:191],v[96:99],a[12:15]
s_waitcnt vmcnt(11)
s_barrier
v_add_u32 v43,0x4000,v43
v_mfma_f32_16x16x32_bf16 a[16:19],v[192:195],v[96:99],a[16:19]
ds_read_b64_tr_b16 v[176:177],v36 offset:0
v_cvt_pk_bf16_f32 v226,v212,v213
v_mfma_f32_16x16x32_bf16 a[48:51],v[192:195],v[100:103],a[48:51]
buffer_load_dwordx4 v[168:171],v6,s[8:11],s80 offen offset:2048 sc1
v_mfma_f32_16x16x32_bf16 a[80:83],v[192:195],v[104:107],a[80:83]
ds_read_b64_tr_b16 v[178:179],v36 offset:4096
v_cvt_pk_bf16_f32 v227,v214,v215
v_mfma_f32_16x16x32_bf16 a[112:115],v[192:195],v[108:111],a[112:115]
v_accvgpr_read_b32 v216,a184
s_waitcnt lgkmcnt(4)
v_mfma_f32_16x16x32_bf16 a[116:119],v[196:199],v[108:111],a[116:119]
ds_read_b64_tr_b16 v[180:181],v37 offset:0
v_accvgpr_read_b32 v217,a185
v_mfma_f32_16x16x32_bf16 a[84:87],v[196:199],v[104:107],a[84:87]
buffer_store_dwordx4 v[224:227],v1,s[8:11],s93 offen offset:2048 sc1
v_mfma_f32_16x16x32_bf16 a[52:55],v[196:199],v[100:103],a[52:55]
ds_read_b64_tr_b16 v[182:183],v37 offset:4096
v_accvgpr_read_b32 v218,a186
v_mfma_f32_16x16x32_bf16 a[20:23],v[196:199],v[96:99],a[20:23]
buffer_load_dwordx4 v[172:175],v7,s[8:11],s80 offen offset:2048 sc1
v_mfma_f32_16x16x32_bf16 a[24:27],v[200:203],v[96:99],a[24:27]
ds_read_b64_tr_b16 v[184:185],v38 offset:0
s_add_u32 s80,s80,0x40000
v_mfma_f32_16x16x32_bf16 a[56:59],v[200:203],v[100:103],a[56:59]
s_add_u32 m0,s92,35840
v_accvgpr_read_b32 v219,a187
v_mfma_f32_16x16x32_bf16 a[88:91],v[200:203],v[104:107],a[88:91]
ds_read_b64_tr_b16 v[186:187],v38 offset:4096
v_accvgpr_read_b32 v220,a188
v_mfma_f32_16x16x32_bf16 a[120:123],v[200:203],v[108:111],a[120:123]
v_accvgpr_read_b32 v221,a189
s_waitcnt lgkmcnt(6)
v_mfma_f32_16x16x32_bf16 a[124:127],v[204:207],v[108:111],a[124:127]
ds_read_b64_tr_b16 v[188:189],v39 offset:0
v_accvgpr_read_b32 v222,a190
v_mfma_f32_16x16x32_bf16 a[92:95],v[204:207],v[104:107],a[92:95]
buffer_load_dwordx4 v35,s[36:39],s58 offen lds
v_mfma_f32_16x16x32_bf16 a[60:63],v[204:207],v[100:103],a[60:63]
ds_read_b64_tr_b16 v[190:191],v39 offset:4096
v_accvgpr_read_b32 v223,a191
v_mfma_f32_16x16x32_bf16 a[28:31],v[204:207],v[96:99],a[28:31]
s_waitcnt lgkmcnt(6)
v_mfma_f32_16x16x32_bf16 a[0:3],v[176:179],v[112:115],a[0:3]
ds_read_b64_tr_b16 v[192:193],v40 offset:0
v_cvt_pk_bf16_f32 v228,v216,v217
v_mfma_f32_16x16x32_bf16 a[32:35],v[176:179],v[116:119],a[32:35]
v_cvt_pk_bf16_f32 v229,v218,v219
v_cvt_pk_bf16_f32 v230,v220,v221
v_mfma_f32_16x16x32_bf16 a[64:67],v[176:179],v[120:123],a[64:67]
ds_read_b64_tr_b16 v[194:195],v40 offset:4096
v_cvt_pk_bf16_f32 v231,v222,v223
v_mfma_f32_16x16x32_bf16 a[96:99],v[176:179],v[124:127],a[96:99]
buffer_load_dwordx4 v[80:83],v4,s[8:11],s80 offen offset:0 sc1
s_waitcnt lgkmcnt(4)
v_mfma_f32_16x16x32_bf16 a[100:103],v[180:183],v[124:127],a[100:103]
ds_read_b64_tr_b16 v[196:197],v41 offset:0
v_accvgpr_read_b32 v208,a192
v_mfma_f32_16x16x32_bf16 a[68:71],v[180:183],v[120:123],a[68:71]
buffer_store_dwordx4 v[228:231],v1,s[8:11],s93 offen offset:3072 sc1
v_mfma_f32_16x16x32_bf16 a[36:39],v[180:183],v[116:119],a[36:39]
ds_read_b64_tr_b16 v[198:199],v41 offset:4096
v_accvgpr_read_b32 v209,a193
v_mfma_f32_16x16x32_bf16 a[4:7],v[180:183],v[112:115],a[4:7]
buffer_load_dwordx4 v[84:87],v5,s[8:11],s80 offen offset:0 sc1
v_mfma_f32_16x16x32_bf16 a[8:11],v[184:187],v[112:115],a[8:11]
ds_read_b64_tr_b16 v[200:201],v42 offset:0
s_add_u32 s58,s58,0x20000
v_mfma_f32_16x16x32_bf16 a[40:43],v[184:187],v[116:119],a[40:43]
s_add_u32 m0,s92,49152
v_accvgpr_read_b32 v210,a194
v_mfma_f32_16x16x32_bf16 a[72:75],v[184:187],v[120:123],a[72:75]
ds_read_b64_tr_b16 v[202:203],v42 offset:4096
v_accvgpr_read_b32 v211,a195
v_mfma_f32_16x16x32_bf16 a[104:107],v[184:187],v[124:127],a[104:107]
v_accvgpr_read_b32 v212,a196
s_waitcnt lgkmcnt(4)
v_mfma_f32_16x16x32_bf16 a[108:111],v[188:191],v[124:127],a[108:111]
ds_read_b64_tr_b16 v[204:205],v43 offset:0
v_accvgpr_read_b32 v213,a197
v_mfma_f32_16x16x32_bf16 a[76:79],v[188:191],v[120:123],a[76:79]
buffer_load_dwordx4 v32,s[36:39],s58 offen lds
v_mfma_f32_16x16x32_bf16 a[44:47],v[188:191],v[116:119],a[44:47]
ds_read_b64_tr_b16 v[206:207],v43 offset:4096
v_accvgpr_read_b32 v214,a198
v_mfma_f32_16x16x32_bf16 a[12:15],v[188:191],v[112:115],a[12:15]
v_accvgpr_read_b32 v215,a199
v_cvt_pk_bf16_f32 v224,v208,v209
v_mfma_f32_16x16x32_bf16 a[16:19],v[192:195],v[112:115],a[16:19]
ds_read_b64_tr_b16 v[176:177],v36 offset:8192
v_cvt_pk_bf16_f32 v225,v210,v211
v_mfma_f32_16x16x32_bf16 a[48:51],v[192:195],v[116:119],a[48:51]
v_cvt_pk_bf16_f32 v226,v212,v213
v_cvt_pk_bf16_f32 v227,v214,v215
v_mfma_f32_16x16x32_bf16 a[80:83],v[192:195],v[120:123],a[80:83]
ds_read_b64_tr_b16 v[178:179],v36 offset:12288
v_add_u32 v36,0x4000,v36
v_mfma_f32_16x16x32_bf16 a[112:115],v[192:195],v[124:127],a[112:115]
buffer_load_dwordx4 v[88:91],v6,s[8:11],s80 offen offset:0 sc1
s_waitcnt lgkmcnt(4)
v_mfma_f32_16x16x32_bf16 a[116:119],v[196:199],v[124:127],a[116:119]
ds_read_b64_tr_b16 v[180:181],v37 offset:8192
v_mfma_f32_16x16x32_bf16 a[84:87],v[196:199],v[120:123],a[84:87]
buffer_store_dwordx4 v[224:227],v1,s[8:11],s94 offen offset:0 sc1
v_mfma_f32_16x16x32_bf16 a[52:55],v[196:199],v[116:119],a[52:55]
ds_read_b64_tr_b16 v[182:183],v37 offset:12288
v_accvgpr_read_b32 v216,a200
v_mfma_f32_16x16x32_bf16 a[20:23],v[196:199],v[112:115],a[20:23]
v_add_u32 v37,0x4000,v37
v_accvgpr_read_b32 v217,a201
v_mfma_f32_16x16x32_bf16 a[24:27],v[200:203],v[112:115],a[24:27]
ds_read_b64_tr_b16 v[184:185],v38 offset:8192
v_accvgpr_read_b32 v218,a202
v_mfma_f32_16x16x32_bf16 a[56:59],v[200:203],v[116:119],a[56:59]
buffer_load_dwordx4 v[92:95],v7,s[8:11],s80 offen offset:0 sc1
v_mfma_f32_16x16x32_bf16 a[88:91],v[200:203],v[120:123],a[88:91]
ds_read_b64_tr_b16 v[186:187],v38 offset:12288
v_add_u32 v38,0x4000,v38
v_mfma_f32_16x16x32_bf16 a[120:123],v[200:203],v[124:127],a[120:123]
s_add_u32 m0,s92,50176
s_waitcnt lgkmcnt(4)
v_mfma_f32_16x16x32_bf16 a[124:127],v[204:207],v[124:127],a[124:127]
ds_read_b64_tr_b16 v[188:189],v39 offset:8192
v_accvgpr_read_b32 v219,a203
v_mfma_f32_16x16x32_bf16 a[92:95],v[204:207],v[120:123],a[92:95]
buffer_load_dwordx4 v33,s[36:39],s58 offen lds
v_mfma_f32_16x16x32_bf16 a[60:63],v[204:207],v[116:119],a[60:63]
ds_read_b64_tr_b16 v[190:191],v39 offset:12288
v_accvgpr_read_b32 v220,a204
v_mfma_f32_16x16x32_bf16 a[28:31],v[204:207],v[112:115],a[28:31]
v_add_u32 v39,0x4000,v39
v_accvgpr_read_b32 v221,a205
v_mfma_f32_16x16x32_bf16 a[0:3],v[176:179],v[128:131],a[0:3]
ds_read_b64_tr_b16 v[192:193],v40 offset:8192
v_accvgpr_read_b32 v222,a206
v_mfma_f32_16x16x32_bf16 a[32:35],v[176:179],v[132:135],a[32:35]
buffer_load_dwordx4 v[96:99],v4,s[8:11],s80 offen offset:2048 sc1
v_mfma_f32_16x16x32_bf16 a[64:67],v[176:179],v[136:139],a[64:67]
ds_read_b64_tr_b16 v[194:195],v40 offset:12288
v_add_u32 v40,0x4000,v40
v_mfma_f32_16x16x32_bf16 a[96:99],v[176:179],v[140:143],a[96:99]
v_accvgpr_read_b32 v223,a207
s_waitcnt lgkmcnt(4)
v_mfma_f32_16x16x32_bf16 a[100:103],v[180:183],v[140:143],a[100:103]
ds_read_b64_tr_b16 v[196:197],v41 offset:8192
v_cvt_pk_bf16_f32 v228,v216,v217
v_mfma_f32_16x16x32_bf16 a[68:71],v[180:183],v[136:139],a[68:71]
v_cvt_pk_bf16_f32 v229,v218,v219
v_cvt_pk_bf16_f32 v230,v220,v221
v_mfma_f32_16x16x32_bf16 a[36:39],v[180:183],v[132:135],a[36:39]
ds_read_b64_tr_b16 v[198:199],v41 offset:12288
v_cvt_pk_bf16_f32 v231,v222,v223
v_mfma_f32_16x16x32_bf16 a[4:7],v[180:183],v[128:131],a[4:7]
buffer_load_dwordx4 v[100:103],v5,s[8:11],s80 offen offset:2048 sc1
v_add_u32 v41,0x4000,v41
v_mfma_f32_16x16x32_bf16 a[8:11],v[184:187],v[128:131],a[8:11]
ds_read_b64_tr_b16 v[200:201],v42 offset:8192
s_add_u32 m0,s92,51200
v_mfma_f32_16x16x32_bf16 a[40:43],v[184:187],v[132:135],a[40:43]
v_mfma_f32_16x16x32_bf16 a[72:75],v[184:187],v[136:139],a[72:75]
ds_read_b64_tr_b16 v[202:203],v42 offset:12288
v_add_u32 v42,0x4000,v42
v_mfma_f32_16x16x32_bf16 a[104:107],v[184:187],v[140:143],a[104:107]
v_accvgpr_read_b32 v208,a208
s_waitcnt lgkmcnt(4)
v_mfma_f32_16x16x32_bf16 a[108:111],v[188:191],v[140:143],a[108:111]
ds_read_b64_tr_b16 v[204:205],v43 offset:8192
v_accvgpr_read_b32 v209,a209
v_mfma_f32_16x16x32_bf16 a[76:79],v[188:191],v[136:139],a[76:79]
buffer_load_dwordx4 v34,s[36:39],s58 offen lds
v_mfma_f32_16x16x32_bf16 a[44:47],v[188:191],v[132:135],a[44:47]
ds_read_b64_tr_b16 v[206:207],v43 offset:12288
v_accvgpr_read_b32 v210,a210
v_mfma_f32_16x16x32_bf16 a[12:15],v[188:191],v[128:131],a[12:15]
s_waitcnt vmcnt(11)
s_barrier
v_add_u32 v43,0x4000,v43
v_mfma_f32_16x16x32_bf16 a[16:19],v[192:195],v[128:131],a[16:19]
ds_read_b64_tr_b16 v[176:177],v36 offset:0
v_accvgpr_read_b32 v211,a211
v_mfma_f32_16x16x32_bf16 a[48:51],v[192:195],v[132:135],a[48:51]
buffer_load_dwordx4 v[104:107],v6,s[8:11],s80 offen offset:2048 sc1
v_mfma_f32_16x16x32_bf16 a[80:83],v[192:195],v[136:139],a[80:83]
ds_read_b64_tr_b16 v[178:179],v36 offset:4096
v_accvgpr_read_b32 v212,a212
v_mfma_f32_16x16x32_bf16 a[112:115],v[192:195],v[140:143],a[112:115]
v_accvgpr_read_b32 v213,a213
s_waitcnt lgkmcnt(4)
v_mfma_f32_16x16x32_bf16 a[116:119],v[196:199],v[140:143],a[116:119]
ds_read_b64_tr_b16 v[180:181],v37 offset:0
v_accvgpr_read_b32 v214,a214
v_mfma_f32_16x16x32_bf16 a[84:87],v[196:199],v[136:139],a[84:87]
buffer_store_dwordx4 v[228:231],v1,s[8:11],s94 offen offset:1024 sc1
v_mfma_f32_16x16x32_bf16 a[52:55],v[196:199],v[132:135],a[52:55]
ds_read_b64_tr_b16 v[182:183],v37 offset:4096
v_accvgpr_read_b32 v215,a215
v_mfma_f32_16x16x32_bf16 a[20:23],v[196:199],v[128:131],a[20:23]
buffer_load_dwordx4 v[108:111],v7,s[8:11],s80 offen offset:2048 sc1
v_mfma_f32_16x16x32_bf16 a[24:27],v[200:203],v[128:131],a[24:27]
ds_read_b64_tr_b16 v[184:185],v38 offset:0
s_add_u32 s80,s80,0x40000
v_mfma_f32_16x16x32_bf16 a[56:59],v[200:203],v[132:135],a[56:59]
s_add_u32 m0,s92,52224
v_cvt_pk_bf16_f32 v224,v208,v209
v_mfma_f32_16x16x32_bf16 a[88:91],v[200:203],v[136:139],a[88:91]
ds_read_b64_tr_b16 v[186:187],v38 offset:4096
v_cvt_pk_bf16_f32 v225,v210,v211
v_mfma_f32_16x16x32_bf16 a[120:123],v[200:203],v[140:143],a[120:123]
v_cvt_pk_bf16_f32 v226,v212,v213
s_waitcnt lgkmcnt(6)
v_mfma_f32_16x16x32_bf16 a[124:127],v[204:207],v[140:143],a[124:127]
ds_read_b64_tr_b16 v[188:189],v39 offset:0
v_cvt_pk_bf16_f32 v227,v214,v215
v_mfma_f32_16x16x32_bf16 a[92:95],v[204:207],v[136:139],a[92:95]
buffer_load_dwordx4 v35,s[36:39],s58 offen lds
v_mfma_f32_16x16x32_bf16 a[60:63],v[204:207],v[132:135],a[60:63]
ds_read_b64_tr_b16 v[190:191],v39 offset:4096
v_mfma_f32_16x16x32_bf16 a[28:31],v[204:207],v[128:131],a[28:31]
s_waitcnt lgkmcnt(6)
v_mfma_f32_16x16x32_bf16 a[0:3],v[176:179],v[48:51],a[0:3]
ds_read_b64_tr_b16 v[192:193],v40 offset:0
v_accvgpr_read_b32 v216,a216
v_mfma_f32_16x16x32_bf16 a[32:35],v[176:179],v[52:55],a[32:35]
buffer_store_dwordx4 v[224:227],v1,s[8:11],s94 offen offset:2048 sc1
v_mfma_f32_16x16x32_bf16 a[64:67],v[176:179],v[56:59],a[64:67]
ds_read_b64_tr_b16 v[194:195],v40 offset:4096
v_accvgpr_read_b32 v217,a217
v_mfma_f32_16x16x32_bf16 a[96:99],v[176:179],v[60:63],a[96:99]
buffer_load_dwordx4 v[112:115],v4,s[8:11],s80 offen offset:0 sc1
s_waitcnt lgkmcnt(4)
v_mfma_f32_16x16x32_bf16 a[100:103],v[180:183],v[60:63],a[100:103]
ds_read_b64_tr_b16 v[196:197],v41 offset:0
v_accvgpr_read_b32 v218,a218
v_mfma_f32_16x16x32_bf16 a[68:71],v[180:183],v[56:59],a[68:71]
v_accvgpr_read_b32 v219,a219
v_accvgpr_read_b32 v220,a220
v_mfma_f32_16x16x32_bf16 a[36:39],v[180:183],v[52:55],a[36:39]
ds_read_b64_tr_b16 v[198:199],v41 offset:4096
v_accvgpr_read_b32 v221,a221
v_mfma_f32_16x16x32_bf16 a[4:7],v[180:183],v[48:51],a[4:7]
buffer_load_dwordx4 v[116:119],v5,s[8:11],s80 offen offset:0 sc1
v_mfma_f32_16x16x32_bf16 a[8:11],v[184:187],v[48:51],a[8:11]
ds_read_b64_tr_b16 v[200:201],v42 offset:0
s_add_u32 s58,s58,0x20000
v_mfma_f32_16x16x32_bf16 a[40:43],v[184:187],v[52:55],a[40:43]
s_add_u32 m0,s92,65536
v_accvgpr_read_b32 v222,a222
v_mfma_f32_16x16x32_bf16 a[72:75],v[184:187],v[56:59],a[72:75]
ds_read_b64_tr_b16 v[202:203],v42 offset:4096
v_accvgpr_read_b32 v223,a223
v_mfma_f32_16x16x32_bf16 a[104:107],v[184:187],v[60:63],a[104:107]
v_cvt_pk_bf16_f32 v228,v216,v217
s_waitcnt lgkmcnt(4)
v_mfma_f32_16x16x32_bf16 a[108:111],v[188:191],v[60:63],a[108:111]
ds_read_b64_tr_b16 v[204:205],v43 offset:0
v_cvt_pk_bf16_f32 v229,v218,v219
v_mfma_f32_16x16x32_bf16 a[76:79],v[188:191],v[56:59],a[76:79]
buffer_load_dwordx4 v32,s[36:39],s58 offen lds
v_mfma_f32_16x16x32_bf16 a[44:47],v[188:191],v[52:55],a[44:47]
ds_read_b64_tr_b16 v[206:207],v43 offset:4096
v_cvt_pk_bf16_f32 v230,v220,v221
v_mfma_f32_16x16x32_bf16 a[12:15],v[188:191],v[48:51],a[12:15]
v_cvt_pk_bf16_f32 v231,v222,v223
v_mfma_f32_16x16x32_bf16 a[16:19],v[192:195],v[48:51],a[16:19]
ds_read_b64_tr_b16 v[176:177],v36 offset:8192
v_mfma_f32_16x16x32_bf16 a[48:51],v[192:195],v[52:55],a[48:51]
v_mfma_f32_16x16x32_bf16 a[80:83],v[192:195],v[56:59],a[80:83]
ds_read_b64_tr_b16 v[178:179],v36 offset:12288
v_add_u32 v36,0x4000,v36
v_mfma_f32_16x16x32_bf16 a[112:115],v[192:195],v[60:63],a[112:115]
buffer_load_dwordx4 v[120:123],v6,s[8:11],s80 offen offset:0 sc1
s_waitcnt lgkmcnt(4)
v_mfma_f32_16x16x32_bf16 a[116:119],v[196:199],v[60:63],a[116:119]
ds_read_b64_tr_b16 v[180:181],v37 offset:8192
v_mfma_f32_16x16x32_bf16 a[84:87],v[196:199],v[56:59],a[84:87]
buffer_store_dwordx4 v[228:231],v1,s[8:11],s94 offen offset:3072 sc1
v_mfma_f32_16x16x32_bf16 a[52:55],v[196:199],v[52:55],a[52:55]
ds_read_b64_tr_b16 v[182:183],v37 offset:12288
v_accvgpr_read_b32 v208,a224
v_mfma_f32_16x16x32_bf16 a[20:23],v[196:199],v[48:51],a[20:23]
v_add_u32 v37,0x4000,v37
v_accvgpr_read_b32 v209,a225
v_mfma_f32_16x16x32_bf16 a[24:27],v[200:203],v[48:51],a[24:27]
ds_read_b64_tr_b16 v[184:185],v38 offset:8192
v_accvgpr_read_b32 v210,a226
v_mfma_f32_16x16x32_bf16 a[56:59],v[200:203],v[52:55],a[56:59]
buffer_load_dwordx4 v[124:127],v7,s[8:11],s80 offen offset:0 sc1
v_mfma_f32_16x16x32_bf16 a[88:91],v[200:203],v[56:59],a[88:91]
ds_read_b64_tr_b16 v[186:187],v38 offset:12288
v_add_u32 v38,0x4000,v38
v_mfma_f32_16x16x32_bf16 a[120:123],v[200:203],v[60:63],a[120:123]
s_add_u32 m0,s92,66560
s_waitcnt lgkmcnt(4)
v_mfma_f32_16x16x32_bf16 a[124:127],v[204:207],v[60:63],a[124:127]
ds_read_b64_tr_b16 v[188:189],v39 offset:8192
v_accvgpr_read_b32 v211,a227
v_mfma_f32_16x16x32_bf16 a[92:95],v[204:207],v[56:59],a[92:95]
buffer_load_dwordx4 v33,s[36:39],s58 offen lds
v_mfma_f32_16x16x32_bf16 a[60:63],v[204:207],v[52:55],a[60:63]
ds_read_b64_tr_b16 v[190:191],v39 offset:12288
v_accvgpr_read_b32 v212,a228
v_mfma_f32_16x16x32_bf16 a[28:31],v[204:207],v[48:51],a[28:31]
v_add_u32 v39,0x4000,v39
v_accvgpr_read_b32 v213,a229
v_mfma_f32_16x16x32_bf16 a[0:3],v[176:179],v[64:67],a[0:3]
ds_read_b64_tr_b16 v[192:193],v40 offset:8192
v_accvgpr_read_b32 v214,a230
v_mfma_f32_16x16x32_bf16 a[32:35],v[176:179],v[68:71],a[32:35]
buffer_load_dwordx4 v[128:131],v4,s[8:11],s80 offen offset:2048 sc1
v_mfma_f32_16x16x32_bf16 a[64:67],v[176:179],v[72:75],a[64:67]
ds_read_b64_tr_b16 v[194:195],v40 offset:12288
v_add_u32 v40,0x4000,v40
v_mfma_f32_16x16x32_bf16 a[96:99],v[176:179],v[76:79],a[96:99]
v_accvgpr_read_b32 v215,a231
s_waitcnt lgkmcnt(4)
v_mfma_f32_16x16x32_bf16 a[100:103],v[180:183],v[76:79],a[100:103]
ds_read_b64_tr_b16 v[196:197],v41 offset:8192
v_cvt_pk_bf16_f32 v224,v208,v209
v_mfma_f32_16x16x32_bf16 a[68:71],v[180:183],v[72:75],a[68:71]
v_cvt_pk_bf16_f32 v225,v210,v211
v_cvt_pk_bf16_f32 v226,v212,v213
v_mfma_f32_16x16x32_bf16 a[36:39],v[180:183],v[68:71],a[36:39]
ds_read_b64_tr_b16 v[198:199],v41 offset:12288
v_cvt_pk_bf16_f32 v227,v214,v215
v_mfma_f32_16x16x32_bf16 a[4:7],v[180:183],v[64:67],a[4:7]
buffer_load_dwordx4 v[132:135],v5,s[8:11],s80 offen offset:2048 sc1
v_add_u32 v41,0x4000,v41
v_mfma_f32_16x16x32_bf16 a[8:11],v[184:187],v[64:67],a[8:11]
ds_read_b64_tr_b16 v[200:201],v42 offset:8192
s_add_u32 m0,s92,67584
v_mfma_f32_16x16x32_bf16 a[40:43],v[184:187],v[68:71],a[40:43]
v_mfma_f32_16x16x32_bf16 a[72:75],v[184:187],v[72:75],a[72:75]
ds_read_b64_tr_b16 v[202:203],v42 offset:12288
v_add_u32 v42,0x4000,v42
v_mfma_f32_16x16x32_bf16 a[104:107],v[184:187],v[76:79],a[104:107]
v_accvgpr_read_b32 v216,a232
s_waitcnt lgkmcnt(4)
v_mfma_f32_16x16x32_bf16 a[108:111],v[188:191],v[76:79],a[108:111]
ds_read_b64_tr_b16 v[204:205],v43 offset:8192
v_accvgpr_read_b32 v217,a233
v_mfma_f32_16x16x32_bf16 a[76:79],v[188:191],v[72:75],a[76:79]
buffer_load_dwordx4 v34,s[36:39],s58 offen lds
v_mfma_f32_16x16x32_bf16 a[44:47],v[188:191],v[68:71],a[44:47]
ds_read_b64_tr_b16 v[206:207],v43 offset:12288
v_accvgpr_read_b32 v218,a234
v_mfma_f32_16x16x32_bf16 a[12:15],v[188:191],v[64:67],a[12:15]
s_waitcnt vmcnt(11)
s_barrier
v_add_u32 v43,0x4000,v43
v_mfma_f32_16x16x32_bf16 a[16:19],v[192:195],v[64:67],a[16:19]
ds_read_b64_tr_b16 v[176:177],v36 offset:0
v_accvgpr_read_b32 v219,a235
v_mfma_f32_16x16x32_bf16 a[48:51],v[192:195],v[68:71],a[48:51]
buffer_load_dwordx4 v[136:139],v6,s[8:11],s80 offen offset:2048 sc1
v_mfma_f32_16x16x32_bf16 a[80:83],v[192:195],v[72:75],a[80:83]
ds_read_b64_tr_b16 v[178:179],v36 offset:4096
v_accvgpr_read_b32 v220,a236
v_mfma_f32_16x16x32_bf16 a[112:115],v[192:195],v[76:79],a[112:115]
v_accvgpr_read_b32 v221,a237
s_waitcnt lgkmcnt(4)
v_mfma_f32_16x16x32_bf16 a[116:119],v[196:199],v[76:79],a[116:119]
ds_read_b64_tr_b16 v[180:181],v37 offset:0
v_accvgpr_read_b32 v222,a238
v_mfma_f32_16x16x32_bf16 a[84:87],v[196:199],v[72:75],a[84:87]
buffer_store_dwordx4 v[224:227],v1,s[8:11],s81 offen offset:0 sc1
v_mfma_f32_16x16x32_bf16 a[52:55],v[196:199],v[68:71],a[52:55]
ds_read_b64_tr_b16 v[182:183],v37 offset:4096
v_accvgpr_read_b32 v223,a239
v_mfma_f32_16x16x32_bf16 a[20:23],v[196:199],v[64:67],a[20:23]
buffer_load_dwordx4 v[140:143],v7,s[8:11],s80 offen offset:2048 sc1
v_mfma_f32_16x16x32_bf16 a[24:27],v[200:203],v[64:67],a[24:27]
ds_read_b64_tr_b16 v[184:185],v38 offset:0
s_add_u32 s80,s80,0x40000
v_mfma_f32_16x16x32_bf16 a[56:59],v[200:203],v[68:71],a[56:59]
s_add_u32 m0,s92,68608
v_cvt_pk_bf16_f32 v228,v216,v217
v_mfma_f32_16x16x32_bf16 a[88:91],v[200:203],v[72:75],a[88:91]
ds_read_b64_tr_b16 v[186:187],v38 offset:4096
v_cvt_pk_bf16_f32 v229,v218,v219
v_mfma_f32_16x16x32_bf16 a[120:123],v[200:203],v[76:79],a[120:123]
v_cvt_pk_bf16_f32 v230,v220,v221
s_waitcnt lgkmcnt(6)
v_mfma_f32_16x16x32_bf16 a[124:127],v[204:207],v[76:79],a[124:127]
ds_read_b64_tr_b16 v[188:189],v39 offset:0
v_cvt_pk_bf16_f32 v231,v222,v223
v_mfma_f32_16x16x32_bf16 a[92:95],v[204:207],v[72:75],a[92:95]
buffer_load_dwordx4 v35,s[36:39],s58 offen lds
v_mfma_f32_16x16x32_bf16 a[60:63],v[204:207],v[68:71],a[60:63]
ds_read_b64_tr_b16 v[190:191],v39 offset:4096
v_mfma_f32_16x16x32_bf16 a[28:31],v[204:207],v[64:67],a[28:31]
s_waitcnt lgkmcnt(6)
v_mfma_f32_16x16x32_bf16 a[0:3],v[176:179],v[144:147],a[0:3]
ds_read_b64_tr_b16 v[192:193],v40 offset:0
v_accvgpr_read_b32 v208,a240
v_mfma_f32_16x16x32_bf16 a[32:35],v[176:179],v[148:151],a[32:35]
buffer_store_dwordx4 v[228:231],v1,s[8:11],s81 offen offset:1024 sc1
v_mfma_f32_16x16x32_bf16 a[64:67],v[176:179],v[152:155],a[64:67]
ds_read_b64_tr_b16 v[194:195],v40 offset:4096
v_accvgpr_read_b32 v209,a241
v_mfma_f32_16x16x32_bf16 a[96:99],v[176:179],v[156:159],a[96:99]
buffer_load_dwordx4 v[48:51],v4,s[8:11],s80 offen offset:0 sc1
s_waitcnt lgkmcnt(4)
v_mfma_f32_16x16x32_bf16 a[100:103],v[180:183],v[156:159],a[100:103]
ds_read_b64_tr_b16 v[196:197],v41 offset:0
v_accvgpr_read_b32 v210,a242
v_mfma_f32_16x16x32_bf16 a[68:71],v[180:183],v[152:155],a[68:71]
v_accvgpr_read_b32 v211,a243
v_accvgpr_read_b32 v212,a244
v_mfma_f32_16x16x32_bf16 a[36:39],v[180:183],v[148:151],a[36:39]
ds_read_b64_tr_b16 v[198:199],v41 offset:4096
v_accvgpr_read_b32 v213,a245
v_mfma_f32_16x16x32_bf16 a[4:7],v[180:183],v[144:147],a[4:7]
buffer_load_dwordx4 v[52:55],v5,s[8:11],s80 offen offset:0 sc1
v_mfma_f32_16x16x32_bf16 a[8:11],v[184:187],v[144:147],a[8:11]
ds_read_b64_tr_b16 v[200:201],v42 offset:0
s_add_u32 s58,s58,0x20000
v_mfma_f32_16x16x32_bf16 a[40:43],v[184:187],v[148:151],a[40:43]
s_add_u32 m0,s92,81920
v_accvgpr_read_b32 v214,a246
v_mfma_f32_16x16x32_bf16 a[72:75],v[184:187],v[152:155],a[72:75]
ds_read_b64_tr_b16 v[202:203],v42 offset:4096
v_accvgpr_read_b32 v215,a247
v_mfma_f32_16x16x32_bf16 a[104:107],v[184:187],v[156:159],a[104:107]
v_cvt_pk_bf16_f32 v224,v208,v209
s_waitcnt lgkmcnt(4)
v_mfma_f32_16x16x32_bf16 a[108:111],v[188:191],v[156:159],a[108:111]
ds_read_b64_tr_b16 v[204:205],v43 offset:0
v_cvt_pk_bf16_f32 v225,v210,v211
v_mfma_f32_16x16x32_bf16 a[76:79],v[188:191],v[152:155],a[76:79]
buffer_load_dwordx4 v32,s[36:39],s58 offen lds
v_mfma_f32_16x16x32_bf16 a[44:47],v[188:191],v[148:151],a[44:47]
ds_read_b64_tr_b16 v[206:207],v43 offset:4096
v_cvt_pk_bf16_f32 v226,v212,v213
v_mfma_f32_16x16x32_bf16 a[12:15],v[188:191],v[144:147],a[12:15]
v_cvt_pk_bf16_f32 v227,v214,v215
v_mfma_f32_16x16x32_bf16 a[16:19],v[192:195],v[144:147],a[16:19]
ds_read_b64_tr_b16 v[176:177],v36 offset:8192
v_mfma_f32_16x16x32_bf16 a[48:51],v[192:195],v[148:151],a[48:51]
v_mfma_f32_16x16x32_bf16 a[80:83],v[192:195],v[152:155],a[80:83]
ds_read_b64_tr_b16 v[178:179],v36 offset:12288
v_add_u32 v36,0x4000,v36
v_mfma_f32_16x16x32_bf16 a[112:115],v[192:195],v[156:159],a[112:115]
buffer_load_dwordx4 v[56:59],v6,s[8:11],s80 offen offset:0 sc1
s_waitcnt lgkmcnt(4)
v_mfma_f32_16x16x32_bf16 a[116:119],v[196:199],v[156:159],a[116:119]
ds_read_b64_tr_b16 v[180:181],v37 offset:8192
v_mfma_f32_16x16x32_bf16 a[84:87],v[196:199],v[152:155],a[84:87]
buffer_store_dwordx4 v[224:227],v1,s[8:11],s81 offen offset:2048 sc1
v_mfma_f32_16x16x32_bf16 a[52:55],v[196:199],v[148:151],a[52:55]
ds_read_b64_tr_b16 v[182:183],v37 offset:12288
v_accvgpr_read_b32 v216,a248
v_mfma_f32_16x16x32_bf16 a[20:23],v[196:199],v[144:147],a[20:23]
v_add_u32 v37,0x4000,v37
v_accvgpr_read_b32 v217,a249
v_mfma_f32_16x16x32_bf16 a[24:27],v[200:203],v[144:147],a[24:27]
ds_read_b64_tr_b16 v[184:185],v38 offset:8192
v_accvgpr_read_b32 v218,a250
v_mfma_f32_16x16x32_bf16 a[56:59],v[200:203],v[148:151],a[56:59]
buffer_load_dwordx4 v[60:63],v7,s[8:11],s80 offen offset:0 sc1
v_mfma_f32_16x16x32_bf16 a[88:91],v[200:203],v[152:155],a[88:91]
ds_read_b64_tr_b16 v[186:187],v38 offset:12288
v_add_u32 v38,0x4000,v38
v_mfma_f32_16x16x32_bf16 a[120:123],v[200:203],v[156:159],a[120:123]
s_add_u32 m0,s92,82944
s_waitcnt lgkmcnt(4)
v_mfma_f32_16x16x32_bf16 a[124:127],v[204:207],v[156:159],a[124:127]
ds_read_b64_tr_b16 v[188:189],v39 offset:8192
v_accvgpr_read_b32 v219,a251
v_mfma_f32_16x16x32_bf16 a[92:95],v[204:207],v[152:155],a[92:95]
buffer_load_dwordx4 v33,s[36:39],s58 offen lds
v_mfma_f32_16x16x32_bf16 a[60:63],v[204:207],v[148:151],a[60:63]
ds_read_b64_tr_b16 v[190:191],v39 offset:12288
v_accvgpr_read_b32 v220,a252
v_mfma_f32_16x16x32_bf16 a[28:31],v[204:207],v[144:147],a[28:31]
v_add_u32 v39,0x4000,v39
v_accvgpr_read_b32 v221,a253
v_mfma_f32_16x16x32_bf16 a[0:3],v[176:179],v[160:163],a[0:3]
ds_read_b64_tr_b16 v[192:193],v40 offset:8192
v_accvgpr_read_b32 v222,a254
v_mfma_f32_16x16x32_bf16 a[32:35],v[176:179],v[164:167],a[32:35]
buffer_load_dwordx4 v[64:67],v4,s[8:11],s80 offen offset:2048 sc1
v_mfma_f32_16x16x32_bf16 a[64:67],v[176:179],v[168:171],a[64:67]
ds_read_b64_tr_b16 v[194:195],v40 offset:12288
v_add_u32 v40,0x4000,v40
v_mfma_f32_16x16x32_bf16 a[96:99],v[176:179],v[172:175],a[96:99]
v_accvgpr_read_b32 v223,a255
s_waitcnt lgkmcnt(4)
v_mfma_f32_16x16x32_bf16 a[100:103],v[180:183],v[172:175],a[100:103]
ds_read_b64_tr_b16 v[196:197],v41 offset:8192
v_cvt_pk_bf16_f32 v228,v216,v217
v_mfma_f32_16x16x32_bf16 a[68:71],v[180:183],v[168:171],a[68:71]
v_cvt_pk_bf16_f32 v229,v218,v219
v_cvt_pk_bf16_f32 v230,v220,v221
v_mfma_f32_16x16x32_bf16 a[36:39],v[180:183],v[164:167],a[36:39]
ds_read_b64_tr_b16 v[198:199],v41 offset:12288
v_cvt_pk_bf16_f32 v231,v222,v223
v_mfma_f32_16x16x32_bf16 a[4:7],v[180:183],v[160:163],a[4:7]
buffer_load_dwordx4 v[68:71],v5,s[8:11],s80 offen offset:2048 sc1
v_add_u32 v41,0x4000,v41
v_mfma_f32_16x16x32_bf16 a[8:11],v[184:187],v[160:163],a[8:11]
ds_read_b64_tr_b16 v[200:201],v42 offset:8192
s_add_u32 m0,s92,83968
v_mfma_f32_16x16x32_bf16 a[40:43],v[184:187],v[164:167],a[40:43]
v_mfma_f32_16x16x32_bf16 a[72:75],v[184:187],v[168:171],a[72:75]
ds_read_b64_tr_b16 v[202:203],v42 offset:12288
v_add_u32 v42,0x4000,v42
v_mfma_f32_16x16x32_bf16 a[104:107],v[184:187],v[172:175],a[104:107]
s_waitcnt lgkmcnt(4)
v_mfma_f32_16x16x32_bf16 a[108:111],v[188:191],v[172:175],a[108:111]
ds_read_b64_tr_b16 v[204:205],v43 offset:8192
v_mfma_f32_16x16x32_bf16 a[76:79],v[188:191],v[168:171],a[76:79]
buffer_load_dwordx4 v34,s[36:39],s58 offen lds
v_mfma_f32_16x16x32_bf16 a[44:47],v[188:191],v[164:167],a[44:47]
ds_read_b64_tr_b16 v[206:207],v43 offset:12288
v_mfma_f32_16x16x32_bf16 a[12:15],v[188:191],v[160:163],a[12:15]
s_waitcnt vmcnt(11)
s_barrier
v_add_u32 v43,0x4000,v43
v_mfma_f32_16x16x32_bf16 a[16:19],v[192:195],v[160:163],a[16:19]
ds_read_b64_tr_b16 v[176:177],v36 offset:0
v_mfma_f32_16x16x32_bf16 a[48:51],v[192:195],v[164:167],a[48:51]
buffer_load_dwordx4 v[72:75],v6,s[8:11],s80 offen offset:2048 sc1
v_mfma_f32_16x16x32_bf16 a[80:83],v[192:195],v[168:171],a[80:83]
ds_read_b64_tr_b16 v[178:179],v36 offset:4096
v_mfma_f32_16x16x32_bf16 a[112:115],v[192:195],v[172:175],a[112:115]
s_waitcnt lgkmcnt(4)
v_mfma_f32_16x16x32_bf16 a[116:119],v[196:199],v[172:175],a[116:119]
ds_read_b64_tr_b16 v[180:181],v37 offset:0
v_mfma_f32_16x16x32_bf16 a[84:87],v[196:199],v[168:171],a[84:87]
buffer_store_dwordx4 v[228:231],v1,s[8:11],s81 offen offset:3072 sc1
v_mfma_f32_16x16x32_bf16 a[52:55],v[196:199],v[164:167],a[52:55]
ds_read_b64_tr_b16 v[182:183],v37 offset:4096
v_mfma_f32_16x16x32_bf16 a[20:23],v[196:199],v[160:163],a[20:23]
buffer_load_dwordx4 v[76:79],v7,s[8:11],s80 offen offset:2048 sc1
v_mfma_f32_16x16x32_bf16 a[24:27],v[200:203],v[160:163],a[24:27]
ds_read_b64_tr_b16 v[184:185],v38 offset:0
s_add_u32 s80,s80,0x40000
v_mfma_f32_16x16x32_bf16 a[56:59],v[200:203],v[164:167],a[56:59]
s_add_u32 m0,s92,84992
v_mfma_f32_16x16x32_bf16 a[88:91],v[200:203],v[168:171],a[88:91]
ds_read_b64_tr_b16 v[186:187],v38 offset:4096
v_mfma_f32_16x16x32_bf16 a[120:123],v[200:203],v[172:175],a[120:123]
s_waitcnt lgkmcnt(6)
v_mfma_f32_16x16x32_bf16 a[124:127],v[204:207],v[172:175],a[124:127]
ds_read_b64_tr_b16 v[188:189],v39 offset:0
v_mfma_f32_16x16x32_bf16 a[92:95],v[204:207],v[168:171],a[92:95]
buffer_load_dwordx4 v35,s[36:39],s58 offen lds
v_mfma_f32_16x16x32_bf16 a[60:63],v[204:207],v[164:167],a[60:63]
ds_read_b64_tr_b16 v[190:191],v39 offset:4096
v_mfma_f32_16x16x32_bf16 a[28:31],v[204:207],v[160:163],a[28:31]
s_waitcnt lgkmcnt(6)
v_mfma_f32_16x16x32_bf16 a[0:3],v[176:179],v[80:83],a[0:3]
ds_read_b64_tr_b16 v[192:193],v40 offset:0
v_mfma_f32_16x16x32_bf16 a[32:35],v[176:179],v[84:87],a[32:35]
v_mfma_f32_16x16x32_bf16 a[64:67],v[176:179],v[88:91],a[64:67]
ds_read_b64_tr_b16 v[194:195],v40 offset:4096
v_mfma_f32_16x16x32_bf16 a[96:99],v[176:179],v[92:95],a[96:99]
buffer_load_dwordx4 v[144:147],v4,s[8:11],s80 offen offset:0 sc1
s_waitcnt lgkmcnt(4)
v_mfma_f32_16x16x32_bf16 a[100:103],v[180:183],v[92:95],a[100:103]
ds_read_b64_tr_b16 v[196:197],v41 offset:0
v_mfma_f32_16x16x32_bf16 a[68:71],v[180:183],v[88:91],a[68:71]
v_mfma_f32_16x16x32_bf16 a[36:39],v[180:183],v[84:87],a[36:39]
ds_read_b64_tr_b16 v[198:199],v41 offset:4096
v_mfma_f32_16x16x32_bf16 a[4:7],v[180:183],v[80:83],a[4:7]
buffer_load_dwordx4 v[148:151],v5,s[8:11],s80 offen offset:0 sc1
v_mfma_f32_16x16x32_bf16 a[8:11],v[184:187],v[80:83],a[8:11]
ds_read_b64_tr_b16 v[200:201],v42 offset:0
s_add_u32 s58,s58,0x20000
v_mfma_f32_16x16x32_bf16 a[40:43],v[184:187],v[84:87],a[40:43]
s_add_u32 m0,s92,98304
v_mfma_f32_16x16x32_bf16 a[72:75],v[184:187],v[88:91],a[72:75]
ds_read_b64_tr_b16 v[202:203],v42 offset:4096
v_mfma_f32_16x16x32_bf16 a[104:107],v[184:187],v[92:95],a[104:107]
s_waitcnt lgkmcnt(4)
v_mfma_f32_16x16x32_bf16 a[108:111],v[188:191],v[92:95],a[108:111]
ds_read_b64_tr_b16 v[204:205],v43 offset:0
v_mfma_f32_16x16x32_bf16 a[76:79],v[188:191],v[88:91],a[76:79]
buffer_load_dwordx4 v32,s[36:39],s58 offen lds
v_mfma_f32_16x16x32_bf16 a[44:47],v[188:191],v[84:87],a[44:47]
ds_read_b64_tr_b16 v[206:207],v43 offset:4096
v_mfma_f32_16x16x32_bf16 a[12:15],v[188:191],v[80:83],a[12:15]
v_mfma_f32_16x16x32_bf16 a[16:19],v[192:195],v[80:83],a[16:19]
ds_read_b64_tr_b16 v[176:177],v36 offset:8192
v_mfma_f32_16x16x32_bf16 a[48:51],v[192:195],v[84:87],a[48:51]
v_mfma_f32_16x16x32_bf16 a[80:83],v[192:195],v[88:91],a[80:83]
ds_read_b64_tr_b16 v[178:179],v36 offset:12288
v_add_u32 v36,0x4000,v36
v_mfma_f32_16x16x32_bf16 a[112:115],v[192:195],v[92:95],a[112:115]
buffer_load_dwordx4 v[152:155],v6,s[8:11],s80 offen offset:0 sc1
s_waitcnt lgkmcnt(4)
v_mfma_f32_16x16x32_bf16 a[116:119],v[196:199],v[92:95],a[116:119]
ds_read_b64_tr_b16 v[180:181],v37 offset:8192
v_mfma_f32_16x16x32_bf16 a[84:87],v[196:199],v[88:91],a[84:87]
v_mfma_f32_16x16x32_bf16 a[52:55],v[196:199],v[84:87],a[52:55]
ds_read_b64_tr_b16 v[182:183],v37 offset:12288
v_mfma_f32_16x16x32_bf16 a[20:23],v[196:199],v[80:83],a[20:23]
v_add_u32 v37,0x4000,v37
v_mfma_f32_16x16x32_bf16 a[24:27],v[200:203],v[80:83],a[24:27]
ds_read_b64_tr_b16 v[184:185],v38 offset:8192
v_mfma_f32_16x16x32_bf16 a[56:59],v[200:203],v[84:87],a[56:59]
buffer_load_dwordx4 v[156:159],v7,s[8:11],s80 offen offset:0 sc1
v_mfma_f32_16x16x32_bf16 a[88:91],v[200:203],v[88:91],a[88:91]
ds_read_b64_tr_b16 v[186:187],v38 offset:12288
v_add_u32 v38,0x4000,v38
v_mfma_f32_16x16x32_bf16 a[120:123],v[200:203],v[92:95],a[120:123]
s_add_u32 m0,s92,99328
s_waitcnt lgkmcnt(4)
v_mfma_f32_16x16x32_bf16 a[124:127],v[204:207],v[92:95],a[124:127]
ds_read_b64_tr_b16 v[188:189],v39 offset:8192
v_mfma_f32_16x16x32_bf16 a[92:95],v[204:207],v[88:91],a[92:95]
buffer_load_dwordx4 v33,s[36:39],s58 offen lds
v_mfma_f32_16x16x32_bf16 a[60:63],v[204:207],v[84:87],a[60:63]
ds_read_b64_tr_b16 v[190:191],v39 offset:12288
v_mfma_f32_16x16x32_bf16 a[28:31],v[204:207],v[80:83],a[28:31]
v_add_u32 v39,0x4000,v39
v_mfma_f32_16x16x32_bf16 a[0:3],v[176:179],v[96:99],a[0:3]
ds_read_b64_tr_b16 v[192:193],v40 offset:8192
v_mfma_f32_16x16x32_bf16 a[32:35],v[176:179],v[100:103],a[32:35]
buffer_load_dwordx4 v[160:163],v4,s[8:11],s80 offen offset:2048 sc1
v_mfma_f32_16x16x32_bf16 a[64:67],v[176:179],v[104:107],a[64:67]
ds_read_b64_tr_b16 v[194:195],v40 offset:12288
v_add_u32 v40,0x4000,v40
v_mfma_f32_16x16x32_bf16 a[96:99],v[176:179],v[108:111],a[96:99]
s_waitcnt lgkmcnt(4)
v_mfma_f32_16x16x32_bf16 a[100:103],v[180:183],v[108:111],a[100:103]
ds_read_b64_tr_b16 v[196:197],v41 offset:8192
v_mfma_f32_16x16x32_bf16 a[68:71],v[180:183],v[104:107],a[68:71]
v_mfma_f32_16x16x32_bf16 a[36:39],v[180:183],v[100:103],a[36:39]
ds_read_b64_tr_b16 v[198:199],v41 offset:12288
v_mfma_f32_16x16x32_bf16 a[4:7],v[180:183],v[96:99],a[4:7]
buffer_load_dwordx4 v[164:167],v5,s[8:11],s80 offen offset:2048 sc1
v_add_u32 v41,0x4000,v41
v_mfma_f32_16x16x32_bf16 a[8:11],v[184:187],v[96:99],a[8:11]
ds_read_b64_tr_b16 v[200:201],v42 offset:8192
s_add_u32 m0,s92,100352
v_mfma_f32_16x16x32_bf16 a[40:43],v[184:187],v[100:103],a[40:43]
v_mfma_f32_16x16x32_bf16 a[72:75],v[184:187],v[104:107],a[72:75]
ds_read_b64_tr_b16 v[202:203],v42 offset:12288
v_add_u32 v42,0x4000,v42
v_mfma_f32_16x16x32_bf16 a[104:107],v[184:187],v[108:111],a[104:107]
buffer_load_dwordx4 v34,s[36:39],s58 offen lds
s_waitcnt lgkmcnt(4)
v_mfma_f32_16x16x32_bf16 a[108:111],v[188:191],v[108:111],a[108:111]
ds_read_b64_tr_b16 v[204:205],v43 offset:8192
v_mfma_f32_16x16x32_bf16 a[76:79],v[188:191],v[104:107],a[76:79]
s_add_u32 s86,s83,0x4204000
v_mfma_f32_16x16x32_bf16 a[44:47],v[188:191],v[100:103],a[44:47]
ds_read_b64_tr_b16 v[206:207],v43 offset:12288
v_mfma_f32_16x16x32_bf16 a[12:15],v[188:191],v[96:99],a[12:15]
s_waitcnt vmcnt(9)
s_barrier
v_add_u32 v43,0x4000,v43
v_mfma_f32_16x16x32_bf16 a[16:19],v[192:195],v[96:99],a[16:19]
ds_read_b64_tr_b16 v[176:177],v36 offset:0
v_mfma_f32_16x16x32_bf16 a[48:51],v[192:195],v[100:103],a[48:51]
buffer_store_dword v46,v23,s[8:11],s86 offen sc1
v_mfma_f32_16x16x32_bf16 a[80:83],v[192:195],v[104:107],a[80:83]
ds_read_b64_tr_b16 v[178:179],v36 offset:4096
v_mfma_f32_16x16x32_bf16 a[112:115],v[192:195],v[108:111],a[112:115]
buffer_load_dwordx4 v[168:171],v6,s[8:11],s80 offen offset:2048 sc1
s_waitcnt lgkmcnt(4)
v_mfma_f32_16x16x32_bf16 a[116:119],v[196:199],v[108:111],a[116:119]
ds_read_b64_tr_b16 v[180:181],v37 offset:0
v_mfma_f32_16x16x32_bf16 a[84:87],v[196:199],v[104:107],a[84:87]
s_add_u32 s93,s93,0x1000000
v_mfma_f32_16x16x32_bf16 a[52:55],v[196:199],v[100:103],a[52:55]
ds_read_b64_tr_b16 v[182:183],v37 offset:4096
v_mfma_f32_16x16x32_bf16 a[20:23],v[196:199],v[96:99],a[20:23]
buffer_load_dwordx4 v[172:175],v7,s[8:11],s80 offen offset:2048 sc1
v_mfma_f32_16x16x32_bf16 a[24:27],v[200:203],v[96:99],a[24:27]
ds_read_b64_tr_b16 v[184:185],v38 offset:0
s_add_u32 s80,s80,0x40000
v_mfma_f32_16x16x32_bf16 a[56:59],v[200:203],v[100:103],a[56:59]
s_add_u32 s94,s94,0x1000000
s_add_u32 m0,s92,101376
v_mfma_f32_16x16x32_bf16 a[88:91],v[200:203],v[104:107],a[88:91]
ds_read_b64_tr_b16 v[186:187],v38 offset:4096
v_mfma_f32_16x16x32_bf16 a[120:123],v[200:203],v[108:111],a[120:123]
buffer_load_dwordx4 v35,s[36:39],s58 offen lds
s_waitcnt lgkmcnt(6)
v_mfma_f32_16x16x32_bf16 a[124:127],v[204:207],v[108:111],a[124:127]
ds_read_b64_tr_b16 v[188:189],v39 offset:0
v_mfma_f32_16x16x32_bf16 a[92:95],v[204:207],v[104:107],a[92:95]
s_add_u32 s81,s81,0x1000000
v_mfma_f32_16x16x32_bf16 a[60:63],v[204:207],v[100:103],a[60:63]
ds_read_b64_tr_b16 v[190:191],v39 offset:4096
v_mfma_f32_16x16x32_bf16 a[28:31],v[204:207],v[96:99],a[28:31]
s_waitcnt lgkmcnt(6)
v_mfma_f32_16x16x32_bf16 a[0:3],v[176:179],v[112:115],a[0:3]
ds_read_b64_tr_b16 v[192:193],v40 offset:0
v_mfma_f32_16x16x32_bf16 a[32:35],v[176:179],v[116:119],a[32:35]
v_mfma_f32_16x16x32_bf16 a[64:67],v[176:179],v[120:123],a[64:67]
ds_read_b64_tr_b16 v[194:195],v40 offset:4096
v_mfma_f32_16x16x32_bf16 a[96:99],v[176:179],v[124:127],a[96:99]
buffer_load_dwordx4 v[80:83],v4,s[8:11],s80 offen offset:0 sc1
s_waitcnt lgkmcnt(4)
v_mfma_f32_16x16x32_bf16 a[100:103],v[180:183],v[124:127],a[100:103]
ds_read_b64_tr_b16 v[196:197],v41 offset:0
v_mfma_f32_16x16x32_bf16 a[68:71],v[180:183],v[120:123],a[68:71]
v_mfma_f32_16x16x32_bf16 a[36:39],v[180:183],v[116:119],a[36:39]
ds_read_b64_tr_b16 v[198:199],v41 offset:4096
v_mfma_f32_16x16x32_bf16 a[4:7],v[180:183],v[112:115],a[4:7]
buffer_load_dwordx4 v[84:87],v5,s[8:11],s80 offen offset:0 sc1
v_mfma_f32_16x16x32_bf16 a[8:11],v[184:187],v[112:115],a[8:11]
ds_read_b64_tr_b16 v[200:201],v42 offset:0
s_add_u32 s58,s58,0x20000
v_mfma_f32_16x16x32_bf16 a[40:43],v[184:187],v[116:119],a[40:43]
s_add_u32 m0,s92,114688
v_mfma_f32_16x16x32_bf16 a[72:75],v[184:187],v[120:123],a[72:75]
ds_read_b64_tr_b16 v[202:203],v42 offset:4096
v_mfma_f32_16x16x32_bf16 a[104:107],v[184:187],v[124:127],a[104:107]
s_waitcnt lgkmcnt(4)
v_mfma_f32_16x16x32_bf16 a[108:111],v[188:191],v[124:127],a[108:111]
ds_read_b64_tr_b16 v[204:205],v43 offset:0
v_mfma_f32_16x16x32_bf16 a[76:79],v[188:191],v[120:123],a[76:79]
buffer_load_dwordx4 v32,s[36:39],s58 offen lds
v_mfma_f32_16x16x32_bf16 a[44:47],v[188:191],v[116:119],a[44:47]
ds_read_b64_tr_b16 v[206:207],v43 offset:4096
v_mfma_f32_16x16x32_bf16 a[12:15],v[188:191],v[112:115],a[12:15]
v_mfma_f32_16x16x32_bf16 a[16:19],v[192:195],v[112:115],a[16:19]
ds_read_b64_tr_b16 v[176:177],v36 offset:8192
v_mfma_f32_16x16x32_bf16 a[48:51],v[192:195],v[116:119],a[48:51]
v_mfma_f32_16x16x32_bf16 a[80:83],v[192:195],v[120:123],a[80:83]
ds_read_b64_tr_b16 v[178:179],v36 offset:12288
v_add_u32 v36,0x4000,v36
v_mfma_f32_16x16x32_bf16 a[112:115],v[192:195],v[124:127],a[112:115]
buffer_load_dwordx4 v[88:91],v6,s[8:11],s80 offen offset:0 sc1
s_waitcnt lgkmcnt(4)
v_mfma_f32_16x16x32_bf16 a[116:119],v[196:199],v[124:127],a[116:119]
ds_read_b64_tr_b16 v[180:181],v37 offset:8192
v_mfma_f32_16x16x32_bf16 a[84:87],v[196:199],v[120:123],a[84:87]
v_mfma_f32_16x16x32_bf16 a[52:55],v[196:199],v[116:119],a[52:55]
ds_read_b64_tr_b16 v[182:183],v37 offset:12288
v_mfma_f32_16x16x32_bf16 a[20:23],v[196:199],v[112:115],a[20:23]
v_add_u32 v37,0x4000,v37
v_mfma_f32_16x16x32_bf16 a[24:27],v[200:203],v[112:115],a[24:27]
ds_read_b64_tr_b16 v[184:185],v38 offset:8192
v_mfma_f32_16x16x32_bf16 a[56:59],v[200:203],v[116:119],a[56:59]
buffer_load_dwordx4 v[92:95],v7,s[8:11],s80 offen offset:0 sc1
v_mfma_f32_16x16x32_bf16 a[88:91],v[200:203],v[120:123],a[88:91]
ds_read_b64_tr_b16 v[186:187],v38 offset:12288
v_add_u32 v38,0x4000,v38
v_mfma_f32_16x16x32_bf16 a[120:123],v[200:203],v[124:127],a[120:123]
s_add_u32 m0,s92,115712
s_waitcnt lgkmcnt(4)
v_mfma_f32_16x16x32_bf16 a[124:127],v[204:207],v[124:127],a[124:127]
ds_read_b64_tr_b16 v[188:189],v39 offset:8192
v_mfma_f32_16x16x32_bf16 a[92:95],v[204:207],v[120:123],a[92:95]
buffer_load_dwordx4 v33,s[36:39],s58 offen lds
v_mfma_f32_16x16x32_bf16 a[60:63],v[204:207],v[116:119],a[60:63]
ds_read_b64_tr_b16 v[190:191],v39 offset:12288
v_mfma_f32_16x16x32_bf16 a[28:31],v[204:207],v[112:115],a[28:31]
v_add_u32 v39,0x4000,v39
v_mfma_f32_16x16x32_bf16 a[0:3],v[176:179],v[128:131],a[0:3]
ds_read_b64_tr_b16 v[192:193],v40 offset:8192
v_mfma_f32_16x16x32_bf16 a[32:35],v[176:179],v[132:135],a[32:35]
buffer_load_dwordx4 v[96:99],v4,s[8:11],s80 offen offset:2048 sc1
v_mfma_f32_16x16x32_bf16 a[64:67],v[176:179],v[136:139],a[64:67]
ds_read_b64_tr_b16 v[194:195],v40 offset:12288
v_add_u32 v40,0x4000,v40
v_mfma_f32_16x16x32_bf16 a[96:99],v[176:179],v[140:143],a[96:99]
s_waitcnt lgkmcnt(4)
v_mfma_f32_16x16x32_bf16 a[100:103],v[180:183],v[140:143],a[100:103]
ds_read_b64_tr_b16 v[196:197],v41 offset:8192
v_mfma_f32_16x16x32_bf16 a[68:71],v[180:183],v[136:139],a[68:71]
v_mfma_f32_16x16x32_bf16 a[36:39],v[180:183],v[132:135],a[36:39]
ds_read_b64_tr_b16 v[198:199],v41 offset:12288
v_mfma_f32_16x16x32_bf16 a[4:7],v[180:183],v[128:131],a[4:7]
buffer_load_dwordx4 v[100:103],v5,s[8:11],s80 offen offset:2048 sc1
v_add_u32 v41,0x4000,v41
v_mfma_f32_16x16x32_bf16 a[8:11],v[184:187],v[128:131],a[8:11]
ds_read_b64_tr_b16 v[200:201],v42 offset:8192
s_add_u32 m0,s92,116736
v_mfma_f32_16x16x32_bf16 a[40:43],v[184:187],v[132:135],a[40:43]
s_add_u32 s54,s87,0x4204000
v_mfma_f32_16x16x32_bf16 a[72:75],v[184:187],v[136:139],a[72:75]
ds_read_b64_tr_b16 v[202:203],v42 offset:12288
v_add_u32 v42,0x4000,v42
v_mfma_f32_16x16x32_bf16 a[104:107],v[184:187],v[140:143],a[104:107]
s_waitcnt lgkmcnt(4)
v_mfma_f32_16x16x32_bf16 a[108:111],v[188:191],v[140:143],a[108:111]
ds_read_b64_tr_b16 v[204:205],v43 offset:8192
v_mfma_f32_16x16x32_bf16 a[76:79],v[188:191],v[136:139],a[76:79]
buffer_load_dwordx4 v34,s[36:39],s58 offen lds
v_mfma_f32_16x16x32_bf16 a[44:47],v[188:191],v[132:135],a[44:47]
ds_read_b64_tr_b16 v[206:207],v43 offset:12288
v_mfma_f32_16x16x32_bf16 a[12:15],v[188:191],v[128:131],a[12:15]
s_waitcnt vmcnt(9)
s_barrier
v_add_u32 v43,0x4000,v43
v_mfma_f32_16x16x32_bf16 a[16:19],v[192:195],v[128:131],a[16:19]
ds_read_b64_tr_b16 v[176:177],v36 offset:0
v_mfma_f32_16x16x32_bf16 a[48:51],v[192:195],v[132:135],a[48:51]
buffer_load_dwordx4 v[104:107],v6,s[8:11],s80 offen offset:2048 sc1
v_mfma_f32_16x16x32_bf16 a[80:83],v[192:195],v[136:139],a[80:83]
ds_read_b64_tr_b16 v[178:179],v36 offset:4096
v_mfma_f32_16x16x32_bf16 a[112:115],v[192:195],v[140:143],a[112:115]
s_waitcnt lgkmcnt(4)
v_mfma_f32_16x16x32_bf16 a[116:119],v[196:199],v[140:143],a[116:119]
ds_read_b64_tr_b16 v[180:181],v37 offset:0
v_mfma_f32_16x16x32_bf16 a[84:87],v[196:199],v[136:139],a[84:87]
v_mfma_f32_16x16x32_bf16 a[52:55],v[196:199],v[132:135],a[52:55]
ds_read_b64_tr_b16 v[182:183],v37 offset:4096
v_mfma_f32_16x16x32_bf16 a[20:23],v[196:199],v[128:131],a[20:23]
buffer_load_dwordx4 v[108:111],v7,s[8:11],s80 offen offset:2048 sc1
v_mfma_f32_16x16x32_bf16 a[24:27],v[200:203],v[128:131],a[24:27]
ds_read_b64_tr_b16 v[184:185],v38 offset:0
s_add_u32 s80,s80,0x40000
v_mfma_f32_16x16x32_bf16 a[56:59],v[200:203],v[132:135],a[56:59]
s_add_u32 m0,s92,117760
v_mfma_f32_16x16x32_bf16 a[88:91],v[200:203],v[136:139],a[88:91]
ds_read_b64_tr_b16 v[186:187],v38 offset:4096
v_mfma_f32_16x16x32_bf16 a[120:123],v[200:203],v[140:143],a[120:123]
s_waitcnt lgkmcnt(6)
v_mfma_f32_16x16x32_bf16 a[124:127],v[204:207],v[140:143],a[124:127]
ds_read_b64_tr_b16 v[188:189],v39 offset:0
v_mfma_f32_16x16x32_bf16 a[92:95],v[204:207],v[136:139],a[92:95]
buffer_load_dwordx4 v35,s[36:39],s58 offen lds
v_mfma_f32_16x16x32_bf16 a[60:63],v[204:207],v[132:135],a[60:63]
ds_read_b64_tr_b16 v[190:191],v39 offset:4096
v_mfma_f32_16x16x32_bf16 a[28:31],v[204:207],v[128:131],a[28:31]
s_waitcnt lgkmcnt(6)
v_mfma_f32_16x16x32_bf16 a[0:3],v[176:179],v[48:51],a[0:3]
ds_read_b64_tr_b16 v[192:193],v40 offset:0
v_mfma_f32_16x16x32_bf16 a[32:35],v[176:179],v[52:55],a[32:35]
buffer_load_dword v47,v31,s[8:11],s54 offen sc1
v_mfma_f32_16x16x32_bf16 a[64:67],v[176:179],v[56:59],a[64:67]
ds_read_b64_tr_b16 v[194:195],v40 offset:4096
v_mfma_f32_16x16x32_bf16 a[96:99],v[176:179],v[60:63],a[96:99]
s_waitcnt lgkmcnt(4)
v_mfma_f32_16x16x32_bf16 a[100:103],v[180:183],v[60:63],a[100:103]
ds_read_b64_tr_b16 v[196:197],v41 offset:0
v_mfma_f32_16x16x32_bf16 a[68:71],v[180:183],v[56:59],a[68:71]
buffer_load_dwordx4 v[112:115],v4,s[8:11],s80 offen offset:0 sc1
v_mfma_f32_16x16x32_bf16 a[36:39],v[180:183],v[52:55],a[36:39]
ds_read_b64_tr_b16 v[198:199],v41 offset:4096
v_mfma_f32_16x16x32_bf16 a[4:7],v[180:183],v[48:51],a[4:7]
v_mfma_f32_16x16x32_bf16 a[8:11],v[184:187],v[48:51],a[8:11]
ds_read_b64_tr_b16 v[200:201],v42 offset:0
v_mfma_f32_16x16x32_bf16 a[40:43],v[184:187],v[52:55],a[40:43]
buffer_load_dwordx4 v[116:119],v5,s[8:11],s80 offen offset:0 sc1
v_mfma_f32_16x16x32_bf16 a[72:75],v[184:187],v[56:59],a[72:75]
ds_read_b64_tr_b16 v[202:203],v42 offset:4096
s_add_u32 s58,s58,0x20000
v_mfma_f32_16x16x32_bf16 a[104:107],v[184:187],v[60:63],a[104:107]
s_add_u32 m0,s92,131072
s_waitcnt lgkmcnt(4)
v_mfma_f32_16x16x32_bf16 a[108:111],v[188:191],v[60:63],a[108:111]
ds_read_b64_tr_b16 v[204:205],v43 offset:0
v_mfma_f32_16x16x32_bf16 a[76:79],v[188:191],v[56:59],a[76:79]
v_mfma_f32_16x16x32_bf16 a[44:47],v[188:191],v[52:55],a[44:47]
ds_read_b64_tr_b16 v[206:207],v43 offset:4096
v_mfma_f32_16x16x32_bf16 a[12:15],v[188:191],v[48:51],a[12:15]
buffer_load_dwordx4 v32,s[36:39],s58 offen lds
v_mfma_f32_16x16x32_bf16 a[16:19],v[192:195],v[48:51],a[16:19]
ds_read_b64_tr_b16 v[176:177],v36 offset:8192
v_mfma_f32_16x16x32_bf16 a[48:51],v[192:195],v[52:55],a[48:51]
v_mfma_f32_16x16x32_bf16 a[80:83],v[192:195],v[56:59],a[80:83]
ds_read_b64_tr_b16 v[178:179],v36 offset:12288
v_add_u32 v36,0x4000,v36
v_mfma_f32_16x16x32_bf16 a[112:115],v[192:195],v[60:63],a[112:115]
s_waitcnt lgkmcnt(4)
v_mfma_f32_16x16x32_bf16 a[116:119],v[196:199],v[60:63],a[116:119]
ds_read_b64_tr_b16 v[180:181],v37 offset:8192
v_mfma_f32_16x16x32_bf16 a[84:87],v[196:199],v[56:59],a[84:87]
buffer_load_dwordx4 v[120:123],v6,s[8:11],s80 offen offset:0 sc1
v_mfma_f32_16x16x32_bf16 a[52:55],v[196:199],v[52:55],a[52:55]
ds_read_b64_tr_b16 v[182:183],v37 offset:12288
v_mfma_f32_16x16x32_bf16 a[20:23],v[196:199],v[48:51],a[20:23]
v_add_u32 v37,0x4000,v37
v_mfma_f32_16x16x32_bf16 a[24:27],v[200:203],v[48:51],a[24:27]
ds_read_b64_tr_b16 v[184:185],v38 offset:8192
v_mfma_f32_16x16x32_bf16 a[56:59],v[200:203],v[52:55],a[56:59]
buffer_load_dwordx4 v[124:127],v7,s[8:11],s80 offen offset:0 sc1
v_mfma_f32_16x16x32_bf16 a[88:91],v[200:203],v[56:59],a[88:91]
ds_read_b64_tr_b16 v[186:187],v38 offset:12288
v_add_u32 v38,0x4000,v38
v_mfma_f32_16x16x32_bf16 a[120:123],v[200:203],v[60:63],a[120:123]
s_add_u32 m0,s92,132096
s_waitcnt lgkmcnt(4)
v_mfma_f32_16x16x32_bf16 a[124:127],v[204:207],v[60:63],a[124:127]
ds_read_b64_tr_b16 v[188:189],v39 offset:8192
v_mfma_f32_16x16x32_bf16 a[92:95],v[204:207],v[56:59],a[92:95]
buffer_load_dwordx4 v33,s[36:39],s58 offen lds
v_mfma_f32_16x16x32_bf16 a[60:63],v[204:207],v[52:55],a[60:63]
ds_read_b64_tr_b16 v[190:191],v39 offset:12288
v_mfma_f32_16x16x32_bf16 a[28:31],v[204:207],v[48:51],a[28:31]
v_add_u32 v39,0x4000,v39
v_mfma_f32_16x16x32_bf16 a[0:3],v[176:179],v[64:67],a[0:3]
ds_read_b64_tr_b16 v[192:193],v40 offset:8192
v_mfma_f32_16x16x32_bf16 a[32:35],v[176:179],v[68:71],a[32:35]
v_mfma_f32_16x16x32_bf16 a[64:67],v[176:179],v[72:75],a[64:67]
ds_read_b64_tr_b16 v[194:195],v40 offset:12288
v_add_u32 v40,0x4000,v40
v_mfma_f32_16x16x32_bf16 a[96:99],v[176:179],v[76:79],a[96:99]
buffer_load_dwordx4 v[128:131],v4,s[8:11],s80 offen offset:2048 sc1
s_waitcnt lgkmcnt(4)
v_mfma_f32_16x16x32_bf16 a[100:103],v[180:183],v[76:79],a[100:103]
ds_read_b64_tr_b16 v[196:197],v41 offset:8192
v_mfma_f32_16x16x32_bf16 a[68:71],v[180:183],v[72:75],a[68:71]
v_mfma_f32_16x16x32_bf16 a[36:39],v[180:183],v[68:71],a[36:39]
ds_read_b64_tr_b16 v[198:199],v41 offset:12288
v_mfma_f32_16x16x32_bf16 a[4:7],v[180:183],v[64:67],a[4:7]
v_add_u32 v41,0x4000,v41
v_mfma_f32_16x16x32_bf16 a[8:11],v[184:187],v[64:67],a[8:11]
ds_read_b64_tr_b16 v[200:201],v42 offset:8192
v_mfma_f32_16x16x32_bf16 a[40:43],v[184:187],v[68:71],a[40:43]
buffer_load_dwordx4 v[132:135],v5,s[8:11],s80 offen offset:2048 sc1
v_mfma_f32_16x16x32_bf16 a[72:75],v[184:187],v[72:75],a[72:75]
ds_read_b64_tr_b16 v[202:203],v42 offset:12288
v_add_u32 v42,0x4000,v42
v_mfma_f32_16x16x32_bf16 a[104:107],v[184:187],v[76:79],a[104:107]
s_add_u32 m0,s92,133120
s_waitcnt lgkmcnt(4)
v_mfma_f32_16x16x32_bf16 a[108:111],v[188:191],v[76:79],a[108:111]
ds_read_b64_tr_b16 v[204:205],v43 offset:8192
v_mfma_f32_16x16x32_bf16 a[76:79],v[188:191],v[72:75],a[76:79]
buffer_load_dwordx4 v34,s[36:39],s58 offen lds
v_mfma_f32_16x16x32_bf16 a[44:47],v[188:191],v[68:71],a[44:47]
ds_read_b64_tr_b16 v[206:207],v43 offset:12288
v_mfma_f32_16x16x32_bf16 a[12:15],v[188:191],v[64:67],a[12:15]
s_waitcnt vmcnt(10)
s_barrier
v_add_u32 v43,0x4000,v43
v_mfma_f32_16x16x32_bf16 a[16:19],v[192:195],v[64:67],a[16:19]
ds_read_b64_tr_b16 v[176:177],v36 offset:0
v_mfma_f32_16x16x32_bf16 a[48:51],v[192:195],v[68:71],a[48:51]
buffer_load_dwordx4 v[136:139],v6,s[8:11],s80 offen offset:2048 sc1
v_mfma_f32_16x16x32_bf16 a[80:83],v[192:195],v[72:75],a[80:83]
ds_read_b64_tr_b16 v[178:179],v36 offset:4096
v_mfma_f32_16x16x32_bf16 a[112:115],v[192:195],v[76:79],a[112:115]
s_waitcnt lgkmcnt(4)
v_mfma_f32_16x16x32_bf16 a[116:119],v[196:199],v[76:79],a[116:119]
ds_read_b64_tr_b16 v[180:181],v37 offset:0
v_mfma_f32_16x16x32_bf16 a[84:87],v[196:199],v[72:75],a[84:87]
v_mfma_f32_16x16x32_bf16 a[52:55],v[196:199],v[68:71],a[52:55]
ds_read_b64_tr_b16 v[182:183],v37 offset:4096
v_mfma_f32_16x16x32_bf16 a[20:23],v[196:199],v[64:67],a[20:23]
buffer_load_dwordx4 v[140:143],v7,s[8:11],s80 offen offset:2048 sc1
v_mfma_f32_16x16x32_bf16 a[24:27],v[200:203],v[64:67],a[24:27]
ds_read_b64_tr_b16 v[184:185],v38 offset:0
s_add_u32 s80,s80,0x40000
v_mfma_f32_16x16x32_bf16 a[56:59],v[200:203],v[68:71],a[56:59]
s_add_u32 m0,s92,134144
v_mfma_f32_16x16x32_bf16 a[88:91],v[200:203],v[72:75],a[88:91]
ds_read_b64_tr_b16 v[186:187],v38 offset:4096
v_mfma_f32_16x16x32_bf16 a[120:123],v[200:203],v[76:79],a[120:123]
s_waitcnt lgkmcnt(6)
v_mfma_f32_16x16x32_bf16 a[124:127],v[204:207],v[76:79],a[124:127]
ds_read_b64_tr_b16 v[188:189],v39 offset:0
v_mfma_f32_16x16x32_bf16 a[92:95],v[204:207],v[72:75],a[92:95]
buffer_load_dwordx4 v35,s[36:39],s58 offen lds
v_mfma_f32_16x16x32_bf16 a[60:63],v[204:207],v[68:71],a[60:63]
ds_read_b64_tr_b16 v[190:191],v39 offset:4096
v_mfma_f32_16x16x32_bf16 a[28:31],v[204:207],v[64:67],a[28:31]
s_waitcnt lgkmcnt(6)
v_mfma_f32_16x16x32_bf16 a[0:3],v[176:179],v[144:147],a[0:3]
ds_read_b64_tr_b16 v[192:193],v40 offset:0
v_mfma_f32_16x16x32_bf16 a[32:35],v[176:179],v[148:151],a[32:35]
s_waitcnt vmcnt(12)
v_cmp_ne_u32 vcc,s49,v47
v_mfma_f32_16x16x32_bf16 a[64:67],v[176:179],v[152:155],a[64:67]
ds_read_b64_tr_b16 v[194:195],v40 offset:4096
v_mfma_f32_16x16x32_bf16 a[96:99],v[176:179],v[156:159],a[96:99]
s_waitcnt lgkmcnt(4)
v_mfma_f32_16x16x32_bf16 a[100:103],v[180:183],v[156:159],a[100:103]
ds_read_b64_tr_b16 v[196:197],v41 offset:0
v_mfma_f32_16x16x32_bf16 a[68:71],v[180:183],v[152:155],a[68:71]
s_cbranch_vccnz L_spin_bp
L_ok_bp:
v_mfma_f32_16x16x32_bf16 a[36:39],v[180:183],v[148:151],a[36:39]
ds_read_b64_tr_b16 v[198:199],v41 offset:4096
v_mfma_f32_16x16x32_bf16 a[4:7],v[180:183],v[144:147],a[4:7]
buffer_load_dwordx4 v[48:51],v4,s[8:11],s80 offen offset:0 sc1
v_mfma_f32_16x16x32_bf16 a[8:11],v[184:187],v[144:147],a[8:11]
ds_read_b64_tr_b16 v[200:201],v42 offset:0
v_mfma_f32_16x16x32_bf16 a[40:43],v[184:187],v[148:151],a[40:43]
v_mfma_f32_16x16x32_bf16 a[72:75],v[184:187],v[152:155],a[72:75]
ds_read_b64_tr_b16 v[202:203],v42 offset:4096
v_mfma_f32_16x16x32_bf16 a[104:107],v[184:187],v[156:159],a[104:107]
s_waitcnt lgkmcnt(4)
v_mfma_f32_16x16x32_bf16 a[108:111],v[188:191],v[156:159],a[108:111]
ds_read_b64_tr_b16 v[204:205],v43 offset:0
v_mfma_f32_16x16x32_bf16 a[76:79],v[188:191],v[152:155],a[76:79]
buffer_load_dwordx4 v[52:55],v5,s[8:11],s80 offen offset:0 sc1
v_mfma_f32_16x16x32_bf16 a[44:47],v[188:191],v[148:151],a[44:47]
ds_read_b64_tr_b16 v[206:207],v43 offset:4096
s_add_u32 s58,s58,0x20000
s_add_u32 m0,s92,147456
v_mfma_f32_16x16x32_bf16 a[12:15],v[188:191],v[144:147],a[12:15]
buffer_load_dwordx4 v32,s[36:39],s58 offen lds
v_mfma_f32_16x16x32_bf16 a[16:19],v[192:195],v[144:147],a[16:19]
ds_read_b64_tr_b16 v[176:177],v36 offset:8192
v_mfma_f32_16x16x32_bf16 a[48:51],v[192:195],v[148:151],a[48:51]
v_mfma_f32_16x16x32_bf16 a[80:83],v[192:195],v[152:155],a[80:83]
ds_read_b64_tr_b16 v[178:179],v36 offset:12288
v_add_u32 v36,0x4000,v36
v_mfma_f32_16x16x32_bf16 a[112:115],v[192:195],v[156:159],a[112:115]
buffer_load_dwordx4 v[56:59],v6,s[8:11],s80 offen offset:0 sc1
s_waitcnt lgkmcnt(4)
v_mfma_f32_16x16x32_bf16 a[116:119],v[196:199],v[156:159],a[116:119]
ds_read_b64_tr_b16 v[180:181],v37 offset:8192
v_mfma_f32_16x16x32_bf16 a[84:87],v[196:199],v[152:155],a[84:87]
buffer_load_dwordx4 v[60:63],v7,s[8:11],s80 offen offset:0 sc1
v_mfma_f32_16x16x32_bf16 a[52:55],v[196:199],v[148:151],a[52:55]
ds_read_b64_tr_b16 v[182:183],v37 offset:12288
s_add_u32 m0,s92,148480
v_mfma_f32_16x16x32_bf16 a[20:23],v[196:199],v[144:147],a[20:23]
v_add_u32 v37,0x4000,v37
v_mfma_f32_16x16x32_bf16 a[24:27],v[200:203],v[144:147],a[24:27]
ds_read_b64_tr_b16 v[184:185],v38 offset:8192
v_mfma_f32_16x16x32_bf16 a[56:59],v[200:203],v[148:151],a[56:59]
buffer_load_dwordx4 v33,s[36:39],s58 offen lds
v_mfma_f32_16x16x32_bf16 a[88:91],v[200:203],v[152:155],a[88:91]
ds_read_b64_tr_b16 v[186:187],v38 offset:12288
v_add_u32 v38,0x4000,v38
v_mfma_f32_16x16x32_bf16 a[120:123],v[200:203],v[156:159],a[120:123]
s_waitcnt lgkmcnt(4)
v_mfma_f32_16x16x32_bf16 a[124:127],v[204:207],v[156:159],a[124:127]
ds_read_b64_tr_b16 v[188:189],v39 offset:8192
v_mfma_f32_16x16x32_bf16 a[92:95],v[204:207],v[152:155],a[92:95]
buffer_load_dwordx4 v[64:67],v4,s[8:11],s80 offen offset:2048 sc1
v_mfma_f32_16x16x32_bf16 a[60:63],v[204:207],v[148:151],a[60:63]
ds_read_b64_tr_b16 v[190:191],v39 offset:12288
v_mfma_f32_16x16x32_bf16 a[28:31],v[204:207],v[144:147],a[28:31]
v_add_u32 v39,0x4000,v39
v_mfma_f32_16x16x32_bf16 a[0:3],v[176:179],v[160:163],a[0:3]
ds_read_b64_tr_b16 v[192:193],v40 offset:8192
v_mfma_f32_16x16x32_bf16 a[32:35],v[176:179],v[164:167],a[32:35]
buffer_load_dwordx4 v[68:71],v5,s[8:11],s80 offen offset:2048 sc1
v_mfma_f32_16x16x32_bf16 a[64:67],v[176:179],v[168:171],a[64:67]
ds_read_b64_tr_b16 v[194:195],v40 offset:12288
v_add_u32 v40,0x4000,v40
v_mfma_f32_16x16x32_bf16 a[96:99],v[176:179],v[172:175],a[96:99]
s_add_u32 m0,s92,149504
s_waitcnt lgkmcnt(4)
v_mfma_f32_16x16x32_bf16 a[100:103],v[180:183],v[172:175],a[100:103]
ds_read_b64_tr_b16 v[196:197],v41 offset:8192
v_mfma_f32_16x16x32_bf16 a[68:71],v[180:183],v[168:171],a[68:71]
buffer_load_dwordx4 v34,s[36:39],s58 offen lds
v_mfma_f32_16x16x32_bf16 a[36:39],v[180:183],v[164:167],a[36:39]
ds_read_b64_tr_b16 v[198:199],v41 offset:12288
v_mfma_f32_16x16x32_bf16 a[4:7],v[180:183],v[160:163],a[4:7]
v_add_u32 v41,0x4000,v41
v_mfma_f32_16x16x32_bf16 a[8:11],v[184:187],v[160:163],a[8:11]
ds_read_b64_tr_b16 v[200:201],v42 offset:8192
v_mfma_f32_16x16x32_bf16 a[40:43],v[184:187],v[164:167],a[40:43]
buffer_load_dwordx4 v[72:75],v6,s[8:11],s80 offen offset:2048 sc1
v_mfma_f32_16x16x32_bf16 a[72:75],v[184:187],v[168:171],a[72:75]
ds_read_b64_tr_b16 v[202:203],v42 offset:12288
v_add_u32 v42,0x4000,v42
v_mfma_f32_16x16x32_bf16 a[104:107],v[184:187],v[172:175],a[104:107]
buffer_load_dwordx4 v[76:79],v7,s[8:11],s80 offen offset:2048 sc1
s_waitcnt lgkmcnt(4)
v_mfma_f32_16x16x32_bf16 a[108:111],v[188:191],v[172:175],a[108:111]
ds_read_b64_tr_b16 v[204:205],v43 offset:8192
s_add_u32 m0,s92,150528
v_mfma_f32_16x16x32_bf16 a[76:79],v[188:191],v[168:171],a[76:79]
v_mfma_f32_16x16x32_bf16 a[44:47],v[188:191],v[164:167],a[44:47]
ds_read_b64_tr_b16 v[206:207],v43 offset:12288
v_mfma_f32_16x16x32_bf16 a[12:15],v[188:191],v[160:163],a[12:15]
s_waitcnt vmcnt(11)
s_barrier
v_add_u32 v43,0x4000,v43
v_mfma_f32_16x16x32_bf16 a[16:19],v[192:195],v[160:163],a[16:19]
ds_read_b64_tr_b16 v[176:177],v36 offset:0
v_mfma_f32_16x16x32_bf16 a[48:51],v[192:195],v[164:167],a[48:51]
buffer_load_dwordx4 v35,s[36:39],s58 offen lds
v_mfma_f32_16x16x32_bf16 a[80:83],v[192:195],v[168:171],a[80:83]
ds_read_b64_tr_b16 v[178:179],v36 offset:4096
s_add_u32 s80,s80,0x40000
s_add_u32 s86,s82,0x2200000
v_mfma_f32_16x16x32_bf16 a[112:115],v[192:195],v[172:175],a[112:115]
buffer_load_dwordx4 a[160:163],v1,s[8:11],s86 offen offset:0 sc1
s_waitcnt lgkmcnt(4)
v_mfma_f32_16x16x32_bf16 a[116:119],v[196:199],v[172:175],a[116:119]
ds_read_b64_tr_b16 v[180:181],v37 offset:0
v_mfma_f32_16x16x32_bf16 a[84:87],v[196:199],v[168:171],a[84:87]
buffer_load_dwordx4 a[164:167],v1,s[8:11],s86 offen offset:1024 sc1
v_mfma_f32_16x16x32_bf16 a[52:55],v[196:199],v[164:167],a[52:55]
ds_read_b64_tr_b16 v[182:183],v37 offset:4096
v_mfma_f32_16x16x32_bf16 a[20:23],v[196:199],v[160:163],a[20:23]
v_mfma_f32_16x16x32_bf16 a[24:27],v[200:203],v[160:163],a[24:27]
ds_read_b64_tr_b16 v[184:185],v38 offset:0
v_mfma_f32_16x16x32_bf16 a[56:59],v[200:203],v[164:167],a[56:59]
buffer_load_dwordx4 a[168:171],v1,s[8:11],s86 offen offset:2048 sc1
v_mfma_f32_16x16x32_bf16 a[88:91],v[200:203],v[168:171],a[88:91]
ds_read_b64_tr_b16 v[186:187],v38 offset:4096
v_mfma_f32_16x16x32_bf16 a[120:123],v[200:203],v[172:175],a[120:123]
s_waitcnt lgkmcnt(6)
v_mfma_f32_16x16x32_bf16 a[124:127],v[204:207],v[172:175],a[124:127]
ds_read_b64_tr_b16 v[188:189],v39 offset:0
v_mfma_f32_16x16x32_bf16 a[92:95],v[204:207],v[168:171],a[92:95]
buffer_load_dwordx4 a[172:175],v1,s[8:11],s86 offen offset:3072 sc1
v_mfma_f32_16x16x32_bf16 a[60:63],v[204:207],v[164:167],a[60:63]
ds_read_b64_tr_b16 v[190:191],v39 offset:4096
v_mfma_f32_16x16x32_bf16 a[28:31],v[204:207],v[160:163],a[28:31]
s_waitcnt lgkmcnt(6)
v_mfma_f32_16x16x32_bf16 a[0:3],v[176:179],v[80:83],a[0:3]
ds_read_b64_tr_b16 v[192:193],v40 offset:0
v_mfma_f32_16x16x32_bf16 a[32:35],v[176:179],v[84:87],a[32:35]
buffer_load_dwordx4 v[144:147],v4,s[8:11],s80 offen offset:0 sc1
v_mfma_f32_16x16x32_bf16 a[64:67],v[176:179],v[88:91],a[64:67]
ds_read_b64_tr_b16 v[194:195],v40 offset:4096
v_mfma_f32_16x16x32_bf16 a[96:99],v[176:179],v[92:95],a[96:99]
s_waitcnt lgkmcnt(4)
v_mfma_f32_16x16x32_bf16 a[100:103],v[180:183],v[92:95],a[100:103]
ds_read_b64_tr_b16 v[196:197],v41 offset:0
v_mfma_f32_16x16x32_bf16 a[68:71],v[180:183],v[88:91],a[68:71]
buffer_load_dwordx4 v[148:151],v5,s[8:11],s80 offen offset:0 sc1
v_mfma_f32_16x16x32_bf16 a[36:39],v[180:183],v[84:87],a[36:39]
ds_read_b64_tr_b16 v[198:199],v41 offset:4096
s_add_u32 s58,s58,0x20000
v_mfma_f32_16x16x32_bf16 a[4:7],v[180:183],v[80:83],a[4:7]
s_add_u32 m0,s92,0
v_mfma_f32_16x16x32_bf16 a[8:11],v[184:187],v[80:83],a[8:11]
ds_read_b64_tr_b16 v[200:201],v42 offset:0
v_mov_b32 v24,0
v_mfma_f32_16x16x32_bf16 a[40:43],v[184:187],v[84:87],a[40:43]
buffer_load_dwordx4 v32,s[36:39],s58 offen lds
v_mfma_f32_16x16x32_bf16 a[72:75],v[184:187],v[88:91],a[72:75]
ds_read_b64_tr_b16 v[202:203],v42 offset:4096
v_mov_b32 v25,0
v_mfma_f32_16x16x32_bf16 a[104:107],v[184:187],v[92:95],a[104:107]
v_mov_b32 v28,0
s_waitcnt lgkmcnt(4)
v_mfma_f32_16x16x32_bf16 a[108:111],v[188:191],v[92:95],a[108:111]
ds_read_b64_tr_b16 v[204:205],v43 offset:0
v_mov_b32 v29,0
v_mfma_f32_16x16x32_bf16 a[76:79],v[188:191],v[88:91],a[76:79]
buffer_load_dwordx4 v[152:155],v6,s[8:11],s80 offen offset:0 sc1
v_mfma_f32_16x16x32_bf16 a[44:47],v[188:191],v[84:87],a[44:47]
ds_read_b64_tr_b16 v[206:207],v43 offset:4096
v_and_b32 v8,1,v2
v_mfma_f32_16x16x32_bf16 a[12:15],v[188:191],v[80:83],a[12:15]
v_lshlrev_b32 v8,4,v8
v_mov_b32 v9,0x3f80
v_mfma_f32_16x16x32_bf16 a[16:19],v[192:195],v[80:83],a[16:19]
ds_read_b64_tr_b16 v[176:177],v36 offset:8192
v_lshlrev_b32 v8,v8,v9
v_mfma_f32_16x16x32_bf16 a[48:51],v[192:195],v[84:87],a[48:51]
buffer_load_dwordx4 v[156:159],v7,s[8:11],s80 offen offset:0 sc1
v_mfma_f32_16x16x32_bf16 a[80:83],v[192:195],v[88:91],a[80:83]
ds_read_b64_tr_b16 v[178:179],v36 offset:12288
v_add_u32 v36,0x4000,v36
v_mfma_f32_16x16x32_bf16 a[112:115],v[192:195],v[92:95],a[112:115]
s_add_u32 m0,s92,1024
s_waitcnt lgkmcnt(4)
v_mfma_f32_16x16x32_bf16 a[116:119],v[196:199],v[92:95],a[116:119]
ds_read_b64_tr_b16 v[180:181],v37 offset:8192
v_bfe_u32 v9,v2,2,2
v_mfma_f32_16x16x32_bf16 a[84:87],v[196:199],v[88:91],a[84:87]
buffer_load_dwordx4 v33,s[36:39],s58 offen lds
v_mfma_f32_16x16x32_bf16 a[52:55],v[196:199],v[84:87],a[52:55]
ds_read_b64_tr_b16 v[182:183],v37 offset:12288
v_lshrrev_b32 v10,4,v2
v_mfma_f32_16x16x32_bf16 a[20:23],v[196:199],v[80:83],a[20:23]
v_add_u32 v37,0x4000,v37
v_cmp_eq_u32 vcc,v9,v10
v_mfma_f32_16x16x32_bf16 a[24:27],v[200:203],v[80:83],a[24:27]
ds_read_b64_tr_b16 v[184:185],v38 offset:8192
v_mfma_f32_16x16x32_bf16 a[56:59],v[200:203],v[84:87],a[56:59]
buffer_load_dwordx4 v[160:163],v4,s[8:11],s80 offen offset:2048 sc1
v_mfma_f32_16x16x32_bf16 a[88:91],v[200:203],v[88:91],a[88:91]
ds_read_b64_tr_b16 v[186:187],v38 offset:12288
v_add_u32 v38,0x4000,v38
v_mfma_f32_16x16x32_bf16 a[120:123],v[200:203],v[92:95],a[120:123]
v_cndmask_b32 v8,0,v8,vcc
s_waitcnt lgkmcnt(4)
v_mfma_f32_16x16x32_bf16 a[124:127],v[204:207],v[92:95],a[124:127]
ds_read_b64_tr_b16 v[188:189],v39 offset:8192
v_bfe_u32 v9,v2,1,1
v_mfma_f32_16x16x32_bf16 a[92:95],v[204:207],v[88:91],a[92:95]
buffer_load_dwordx4 v[164:167],v5,s[8:11],s80 offen offset:2048 sc1
v_mfma_f32_16x16x32_bf16 a[60:63],v[204:207],v[84:87],a[60:63]
ds_read_b64_tr_b16 v[190:191],v39 offset:12288
s_add_u32 m0,s92,2048
v_mfma_f32_16x16x32_bf16 a[28:31],v[204:207],v[80:83],a[28:31]
v_add_u32 v39,0x4000,v39
v_cmp_eq_u32 vcc,0,v9
v_mfma_f32_16x16x32_bf16 a[0:3],v[176:179],v[96:99],a[0:3]
ds_read_b64_tr_b16 v[192:193],v40 offset:8192
v_mfma_f32_16x16x32_bf16 a[32:35],v[176:179],v[100:103],a[32:35]
buffer_load_dwordx4 v34,s[36:39],s58 offen lds
v_mfma_f32_16x16x32_bf16 a[64:67],v[176:179],v[104:107],a[64:67]
ds_read_b64_tr_b16 v[194:195],v40 offset:12288
v_add_u32 v40,0x4000,v40
v_mfma_f32_16x16x32_bf16 a[96:99],v[176:179],v[108:111],a[96:99]
v_cndmask_b32 v26,0,v8,vcc
s_waitcnt lgkmcnt(4)
v_mfma_f32_16x16x32_bf16 a[100:103],v[180:183],v[108:111],a[100:103]
ds_read_b64_tr_b16 v[196:197],v41 offset:8192
v_cndmask_b32 v27,v8,0,vcc
v_mfma_f32_16x16x32_bf16 a[68:71],v[180:183],v[104:107],a[68:71]
buffer_load_dwordx4 v[168:171],v6,s[8:11],s80 offen offset:2048 sc1
v_mfma_f32_16x16x32_bf16 a[36:39],v[180:183],v[100:103],a[36:39]
ds_read_b64_tr_b16 v[198:199],v41 offset:12288
v_mfma_f32_16x16x32_bf16 a[4:7],v[180:183],v[96:99],a[4:7]
v_add_u32 v41,0x4000,v41
v_mfma_f32_16x16x32_bf16 a[8:11],v[184:187],v[96:99],a[8:11]
ds_read_b64_tr_b16 v[200:201],v42 offset:8192
v_mfma_f32_16x16x32_bf16 a[40:43],v[184:187],v[100:103],a[40:43]
buffer_load_dwordx4 v[172:175],v7,s[8:11],s80 offen offset:2048 sc1
v_mfma_f32_16x16x32_bf16 a[72:75],v[184:187],v[104:107],a[72:75]
ds_read_b64_tr_b16 v[202:203],v42 offset:12288
v_add_u32 v42,0x4000,v42
v_mfma_f32_16x16x32_bf16 a[104:107],v[184:187],v[108:111],a[104:107]
s_add_u32 m0,s92,3072
s_waitcnt lgkmcnt(4)
v_mfma_f32_16x16x32_bf16 a[108:111],v[188:191],v[108:111],a[108:111]
ds_read_b64_tr_b16 v[204:205],v43 offset:8192
v_mfma_f32_16x16x32_bf16 a[76:79],v[188:191],v[104:107],a[76:79]
buffer_load_dwordx4 v35,s[36:39],s58 offen lds
v_mfma_f32_16x16x32_bf16 a[44:47],v[188:191],v[100:103],a[44:47]
ds_read_b64_tr_b16 v[206:207],v43 offset:12288
s_add_u32 s80,s80,0x40000
v_mfma_f32_16x16x32_bf16 a[12:15],v[188:191],v[96:99],a[12:15]
s_waitcnt vmcnt(16)
s_barrier
v_add_u32 v43,0x4000,v43
v_mfma_f32_16x16x32_bf16 a[16:19],v[192:195],v[96:99],a[16:19]
ds_read_b64_tr_b16 v[176:177],v36 offset:0
s_add_u32 s86,s82,0x2201000
v_mfma_f32_16x16x32_bf16 a[48:51],v[192:195],v[100:103],a[48:51]
buffer_load_dwordx4 a[176:179],v1,s[8:11],s86 offen offset:0 sc1
v_mfma_f32_16x16x32_bf16 a[80:83],v[192:195],v[104:107],a[80:83]
ds_read_b64_tr_b16 v[178:179],v36 offset:4096
v_mfma_f32_16x16x32_bf16 a[112:115],v[192:195],v[108:111],a[112:115]
s_waitcnt lgkmcnt(4)
v_mfma_f32_16x16x32_bf16 a[116:119],v[196:199],v[108:111],a[116:119]
ds_read_b64_tr_b16 v[180:181],v37 offset:0
v_mfma_f32_16x16x32_bf16 a[84:87],v[196:199],v[104:107],a[84:87]
buffer_load_dwordx4 a[180:183],v1,s[8:11],s86 offen offset:1024 sc1
v_mfma_f32_16x16x32_bf16 a[52:55],v[196:199],v[100:103],a[52:55]
ds_read_b64_tr_b16 v[182:183],v37 offset:4096
v_mfma_f32_16x16x32_bf16 a[20:23],v[196:199],v[96:99],a[20:23]
v_mfma_f32_16x16x32_bf16 a[24:27],v[200:203],v[96:99],a[24:27]
ds_read_b64_tr_b16 v[184:185],v38 offset:0
v_mfma_f32_16x16x32_bf16 a[56:59],v[200:203],v[100:103],a[56:59]
buffer_load_dwordx4 a[184:187],v1,s[8:11],s86 offen offset:2048 sc1
v_mfma_f32_16x16x32_bf16 a[88:91],v[200:203],v[104:107],a[88:91]
ds_read_b64_tr_b16 v[186:187],v38 offset:4096
v_mfma_f32_16x16x32_bf16 a[120:123],v[200:203],v[108:111],a[120:123]
s_waitcnt lgkmcnt(6)
v_mfma_f32_16x16x32_bf16 a[124:127],v[204:207],v[108:111],a[124:127]
ds_read_b64_tr_b16 v[188:189],v39 offset:0
v_mfma_f32_16x16x32_bf16 a[92:95],v[204:207],v[104:107],a[92:95]
buffer_load_dwordx4 a[188:191],v1,s[8:11],s86 offen offset:3072 sc1
v_mfma_f32_16x16x32_bf16 a[60:63],v[204:207],v[100:103],a[60:63]
ds_read_b64_tr_b16 v[190:191],v39 offset:4096
v_mfma_f32_16x16x32_bf16 a[28:31],v[204:207],v[96:99],a[28:31]
s_waitcnt lgkmcnt(6)
v_mfma_f32_16x16x32_bf16 a[0:3],v[176:179],v[112:115],a[0:3]
ds_read_b64_tr_b16 v[192:193],v40 offset:0
v_mfma_f32_16x16x32_bf16 a[32:35],v[176:179],v[116:119],a[32:35]
buffer_load_dwordx4 v[80:83],v4,s[8:11],s80 offen offset:0 sc1
v_mfma_f32_16x16x32_bf16 a[64:67],v[176:179],v[120:123],a[64:67]
ds_read_b64_tr_b16 v[194:195],v40 offset:4096
v_mfma_f32_16x16x32_bf16 a[96:99],v[176:179],v[124:127],a[96:99]
s_waitcnt lgkmcnt(4)
v_mfma_f32_16x16x32_bf16 a[100:103],v[180:183],v[124:127],a[100:103]
ds_read_b64_tr_b16 v[196:197],v41 offset:0
v_mfma_f32_16x16x32_bf16 a[68:71],v[180:183],v[120:123],a[68:71]
buffer_load_dwordx4 v[84:87],v5,s[8:11],s80 offen offset:0 sc1
v_mfma_f32_16x16x32_bf16 a[36:39],v[180:183],v[116:119],a[36:39]
ds_read_b64_tr_b16 v[198:199],v41 offset:4096
s_add_u32 s58,s58,0x20000
v_mfma_f32_16x16x32_bf16 a[4:7],v[180:183],v[112:115],a[4:7]
s_add_u32 m0,s92,16384
v_mfma_f32_16x16x32_bf16 a[8:11],v[184:187],v[112:115],a[8:11]
ds_read_b64_tr_b16 v[200:201],v42 offset:0
v_mfma_f32_16x16x32_bf16 a[40:43],v[184:187],v[116:119],a[40:43]
buffer_load_dwordx4 v32,s[36:39],s58 offen lds
v_mfma_f32_16x16x32_bf16 a[72:75],v[184:187],v[120:123],a[72:75]
ds_read_b64_tr_b16 v[202:203],v42 offset:4096
v_mfma_f32_16x16x32_bf16 a[104:107],v[184:187],v[124:127],a[104:107]
s_waitcnt lgkmcnt(4)
v_mfma_f32_16x16x32_bf16 a[108:111],v[188:191],v[124:127],a[108:111]
ds_read_b64_tr_b16 v[204:205],v43 offset:0
v_mfma_f32_16x16x32_bf16 a[76:79],v[188:191],v[120:123],a[76:79]
buffer_load_dwordx4 v[88:91],v6,s[8:11],s80 offen offset:0 sc1
v_mfma_f32_16x16x32_bf16 a[44:47],v[188:191],v[116:119],a[44:47]
ds_read_b64_tr_b16 v[206:207],v43 offset:4096
v_mfma_f32_16x16x32_bf16 a[12:15],v[188:191],v[112:115],a[12:15]
v_mfma_f32_16x16x32_bf16 a[16:19],v[192:195],v[112:115],a[16:19]
ds_read_b64_tr_b16 v[176:177],v36 offset:8192
v_mfma_f32_16x16x32_bf16 a[48:51],v[192:195],v[116:119],a[48:51]
buffer_load_dwordx4 v[92:95],v7,s[8:11],s80 offen offset:0 sc1
v_mfma_f32_16x16x32_bf16 a[80:83],v[192:195],v[120:123],a[80:83]
ds_read_b64_tr_b16 v[178:179],v36 offset:12288
v_add_u32 v36,0xfffdc000,v36
v_mfma_f32_16x16x32_bf16 a[112:115],v[192:195],v[124:127],a[112:115]
s_add_u32 m0,s92,17408
s_waitcnt lgkmcnt(4)
v_mfma_f32_16x16x32_bf16 a[116:119],v[196:199],v[124:127],a[116:119]
ds_read_b64_tr_b16 v[180:181],v37 offset:8192
v_mfma_f32_16x16x32_bf16 a[84:87],v[196:199],v[120:123],a[84:87]
buffer_load_dwordx4 v33,s[36:39],s58 offen lds
v_mfma_f32_16x16x32_bf16 a[52:55],v[196:199],v[116:119],a[52:55]
ds_read_b64_tr_b16 v[182:183],v37 offset:12288
v_mfma_f32_16x16x32_bf16 a[20:23],v[196:199],v[112:115],a[20:23]
v_add_u32 v37,0xfffdc000,v37
v_mfma_f32_16x16x32_bf16 a[24:27],v[200:203],v[112:115],a[24:27]
ds_read_b64_tr_b16 v[184:185],v38 offset:8192
v_mfma_f32_16x16x32_bf16 a[56:59],v[200:203],v[116:119],a[56:59]
buffer_load_dwordx4 v[96:99],v4,s[8:11],s80 offen offset:2048 sc1
v_mfma_f32_16x16x32_bf16 a[88:91],v[200:203],v[120:123],a[88:91]
ds_read_b64_tr_b16 v[186:187],v38 offset:12288
v_add_u32 v38,0xfffdc000,v38
v_mfma_f32_16x16x32_bf16 a[120:123],v[200:203],v[124:127],a[120:123]
s_waitcnt lgkmcnt(4)
v_mfma_f32_16x16x32_bf16 a[124:127],v[204:207],v[124:127],a[124:127]
ds_read_b64_tr_b16 v[188:189],v39 offset:8192
v_mfma_f32_16x16x32_bf16 a[92:95],v[204:207],v[120:123],a[92:95]
buffer_load_dwordx4 v[100:103],v5,s[8:11],s80 offen offset:2048 sc1
v_mfma_f32_16x16x32_bf16 a[60:63],v[204:207],v[116:119],a[60:63]
ds_read_b64_tr_b16 v[190:191],v39 offset:12288
s_add_u32 m0,s92,18432
v_mfma_f32_16x16x32_bf16 a[28:31],v[204:207],v[112:115],a[28:31]
v_add_u32 v39,0xfffdc000,v39
v_mfma_f32_16x16x32_bf16 a[0:3],v[176:179],v[128:131],a[0:3]
ds_read_b64_tr_b16 v[192:193],v40 offset:8192
v_mfma_f32_16x16x32_bf16 a[32:35],v[176:179],v[132:135],a[32:35]
buffer_load_dwordx4 v34,s[36:39],s58 offen lds
v_mfma_f32_16x16x32_bf16 a[64:67],v[176:179],v[136:139],a[64:67]
ds_read_b64_tr_b16 v[194:195],v40 offset:12288
v_add_u32 v40,0xfffdc000,v40
v_mfma_f32_16x16x32_bf16 a[96:99],v[176:179],v[140:143],a[96:99]
s_waitcnt lgkmcnt(4)
v_mfma_f32_16x16x32_bf16 a[100:103],v[180:183],v[140:143],a[100:103]
ds_read_b64_tr_b16 v[196:197],v41 offset:8192
v_mfma_f32_16x16x32_bf16 a[68:71],v[180:183],v[136:139],a[68:71]
buffer_load_dwordx4 v[104:107],v6,s[8:11],s80 offen offset:2048 sc1
v_mfma_f32_16x16x32_bf16 a[36:39],v[180:183],v[132:135],a[36:39]
ds_read_b64_tr_b16 v[198:199],v41 offset:12288
v_mfma_f32_16x16x32_bf16 a[4:7],v[180:183],v[128:131],a[4:7]
v_add_u32 v41,0xfffdc000,v41
v_mfma_f32_16x16x32_bf16 a[8:11],v[184:187],v[128:131],a[8:11]
ds_read_b64_tr_b16 v[200:201],v42 offset:8192
v_mfma_f32_16x16x32_bf16 a[40:43],v[184:187],v[132:135],a[40:43]
buffer_load_dwordx4 v[108:111],v7,s[8:11],s80 offen offset:2048 sc1
v_mfma_f32_16x16x32_bf16 a[72:75],v[184:187],v[136:139],a[72:75]
ds_read_b64_tr_b16 v[202:203],v42 offset:12288
v_add_u32 v42,0xfffdc000,v42
v_mfma_f32_16x16x32_bf16 a[104:107],v[184:187],v[140:143],a[104:107]
s_add_u32 m0,s92,19456
s_waitcnt lgkmcnt(4)
v_mfma_f32_16x16x32_bf16 a[108:111],v[188:191],v[140:143],a[108:111]
ds_read_b64_tr_b16 v[204:205],v43 offset:8192
v_mfma_f32_16x16x32_bf16 a[76:79],v[188:191],v[136:139],a[76:79]
buffer_load_dwordx4 v35,s[36:39],s58 offen lds
v_mfma_f32_16x16x32_bf16 a[44:47],v[188:191],v[132:135],a[44:47]
ds_read_b64_tr_b16 v[206:207],v43 offset:12288
s_add_u32 s80,s80,0x40000
v_mfma_f32_16x16x32_bf16 a[12:15],v[188:191],v[128:131],a[12:15]
s_waitcnt vmcnt(16)
s_barrier
v_add_u32 v43,0xfffdc000,v43
v_mfma_f32_16x16x32_bf16 a[16:19],v[192:195],v[128:131],a[16:19]
ds_read_b64_tr_b16 v[176:177],v36 offset:0
s_add_u32 s86,s82,0x2202000
v_mfma_f32_16x16x32_bf16 a[48:51],v[192:195],v[132:135],a[48:51]
buffer_load_dwordx4 a[192:195],v1,s[8:11],s86 offen offset:0 sc1
v_mfma_f32_16x16x32_bf16 a[80:83],v[192:195],v[136:139],a[80:83]
ds_read_b64_tr_b16 v[178:179],v36 offset:4096
v_mfma_f32_16x16x32_bf16 a[112:115],v[192:195],v[140:143],a[112:115]
s_waitcnt lgkmcnt(4)
v_mfma_f32_16x16x32_bf16 a[116:119],v[196:199],v[140:143],a[116:119]
ds_read_b64_tr_b16 v[180:181],v37 offset:0
v_mfma_f32_16x16x32_bf16 a[84:87],v[196:199],v[136:139],a[84:87]
buffer_load_dwordx4 a[196:199],v1,s[8:11],s86 offen offset:1024 sc1
v_mfma_f32_16x16x32_bf16 a[52:55],v[196:199],v[132:135],a[52:55]
ds_read_b64_tr_b16 v[182:183],v37 offset:4096
v_mfma_f32_16x16x32_bf16 a[20:23],v[196:199],v[128:131],a[20:23]
v_mfma_f32_16x16x32_bf16 a[24:27],v[200:203],v[128:131],a[24:27]
ds_read_b64_tr_b16 v[184:185],v38 offset:0
v_mfma_f32_16x16x32_bf16 a[56:59],v[200:203],v[132:135],a[56:59]
buffer_load_dwordx4 a[200:203],v1,s[8:11],s86 offen offset:2048 sc1
v_mfma_f32_16x16x32_bf16 a[88:91],v[200:203],v[136:139],a[88:91]
ds_read_b64_tr_b16 v[186:187],v38 offset:4096
v_mfma_f32_16x16x32_bf16 a[120:123],v[200:203],v[140:143],a[120:123]
s_waitcnt lgkmcnt(6)
v_mfma_f32_16x16x32_bf16 a[124:127],v[204:207],v[140:143],a[124:127]
ds_read_b64_tr_b16 v[188:189],v39 offset:0
v_mfma_f32_16x16x32_bf16 a[92:95],v[204:207],v[136:139],a[92:95]
buffer_load_dwordx4 a[204:207],v1,s[8:11],s86 offen offset:3072 sc1
v_mfma_f32_16x16x32_bf16 a[60:63],v[204:207],v[132:135],a[60:63]
ds_read_b64_tr_b16 v[190:191],v39 offset:4096
v_mfma_f32_16x16x32_bf16 a[28:31],v[204:207],v[128:131],a[28:31]
s_waitcnt lgkmcnt(6)
v_mfma_f32_16x16x32_bf16 a[0:3],v[176:179],v[48:51],a[0:3]
ds_read_b64_tr_b16 v[192:193],v40 offset:0
v_mfma_f32_16x16x32_bf16 a[32:35],v[176:179],v[52:55],a[32:35]
v_mfma_f32_16x16x32_bf16 a[64:67],v[176:179],v[56:59],a[64:67]
ds_read_b64_tr_b16 v[194:195],v40 offset:4096
v_mfma_f32_16x16x32_bf16 a[96:99],v[176:179],v[60:63],a[96:99]
buffer_load_dwordx4 v[112:115],v4,s[8:11],s80 offen offset:0 sc1
s_waitcnt lgkmcnt(4)
v_mfma_f32_16x16x32_bf16 a[100:103],v[180:183],v[60:63],a[100:103]
ds_read_b64_tr_b16 v[196:197],v41 offset:0
v_mfma_f32_16x16x32_bf16 a[68:71],v[180:183],v[56:59],a[68:71]
v_mfma_f32_16x16x32_bf16 a[36:39],v[180:183],v[52:55],a[36:39]
ds_read_b64_tr_b16 v[198:199],v41 offset:4096
v_mfma_f32_16x16x32_bf16 a[4:7],v[180:183],v[48:51],a[4:7]
buffer_load_dwordx4 v[116:119],v5,s[8:11],s80 offen offset:0 sc1
v_mfma_f32_16x16x32_bf16 a[8:11],v[184:187],v[48:51],a[8:11]
ds_read_b64_tr_b16 v[200:201],v42 offset:0
s_add_u32 s58,s58,0x20000
v_mfma_f32_16x16x32_bf16 a[40:43],v[184:187],v[52:55],a[40:43]
s_add_u32 m0,s92,32768
v_mfma_f32_16x16x32_bf16 a[72:75],v[184:187],v[56:59],a[72:75]
ds_read_b64_tr_b16 v[202:203],v42 offset:4096
v_mfma_f32_16x16x32_bf16 a[104:107],v[184:187],v[60:63],a[104:107]
s_waitcnt lgkmcnt(4)
v_mfma_f32_16x16x32_bf16 a[108:111],v[188:191],v[60:63],a[108:111]
ds_read_b64_tr_b16 v[204:205],v43 offset:0
v_mfma_f32_16x16x32_bf16 a[76:79],v[188:191],v[56:59],a[76:79]
buffer_load_dwordx4 v32,s[36:39],s58 offen lds
v_mfma_f32_16x16x32_bf16 a[44:47],v[188:191],v[52:55],a[44:47]
ds_read_b64_tr_b16 v[206:207],v43 offset:4096
v_mfma_f32_16x16x32_bf16 a[12:15],v[188:191],v[48:51],a[12:15]
v_mfma_f32_16x16x32_bf16 a[16:19],v[192:195],v[48:51],a[16:19]
ds_read_b64_tr_b16 v[176:177],v36 offset:8192
v_mfma_f32_16x16x32_bf16 a[48:51],v[192:195],v[52:55],a[48:51]
v_mfma_f32_16x16x32_bf16 a[80:83],v[192:195],v[56:59],a[80:83]
ds_read_b64_tr_b16 v[178:179],v36 offset:12288
v_add_u32 v36,0x4000,v36
v_mfma_f32_16x16x32_bf16 a[112:115],v[192:195],v[60:63],a[112:115]
buffer_load_dwordx4 v[120:123],v6,s[8:11],s80 offen offset:0 sc1
s_waitcnt lgkmcnt(4)
v_mfma_f32_16x16x32_bf16 a[116:119],v[196:199],v[60:63],a[116:119]
ds_read_b64_tr_b16 v[180:181],v37 offset:8192
v_mfma_f32_16x16x32_bf16 a[84:87],v[196:199],v[56:59],a[84:87]
v_mfma_f32_16x16x32_bf16 a[52:55],v[196:199],v[52:55],a[52:55]
ds_read_b64_tr_b16 v[182:183],v37 offset:12288
v_mfma_f32_16x16x32_bf16 a[20:23],v[196:199],v[48:51],a[20:23]
v_add_u32 v37,0x4000,v37
v_mfma_f32_16x16x32_bf16 a[24:27],v[200:203],v[48:51],a[24:27]
ds_read_b64_tr_b16 v[184:185],v38 offset:8192
v_mfma_f32_16x16x32_bf16 a[56:59],v[200:203],v[52:55],a[56:59]
buffer_load_dwordx4 v[124:127],v7,s[8:11],s80 offen offset:0 sc1
v_mfma_f32_16x16x32_bf16 a[88:91],v[200:203],v[56:59],a[88:91]
ds_read_b64_tr_b16 v[186:187],v38 offset:12288
v_add_u32 v38,0x4000,v38
v_mfma_f32_16x16x32_bf16 a[120:123],v[200:203],v[60:63],a[120:123]
s_add_u32 m0,s92,33792
s_waitcnt lgkmcnt(4)
v_mfma_f32_16x16x32_bf16 a[124:127],v[204:207],v[60:63],a[124:127]
ds_read_b64_tr_b16 v[188:189],v39 offset:8192
v_mfma_f32_16x16x32_bf16 a[92:95],v[204:207],v[56:59],a[92:95]
buffer_load_dwordx4 v33,s[36:39],s58 offen lds
v_mfma_f32_16x16x32_bf16 a[60:63],v[204:207],v[52:55],a[60:63]
ds_read_b64_tr_b16 v[190:191],v39 offset:12288
v_mfma_f32_16x16x32_bf16 a[28:31],v[204:207],v[48:51],a[28:31]
v_add_u32 v39,0x4000,v39
v_mfma_f32_16x16x32_bf16 a[0:3],v[176:179],v[64:67],a[0:3]
ds_read_b64_tr_b16 v[192:193],v40 offset:8192
v_mfma_f32_16x16x32_bf16 a[32:35],v[176:179],v[68:71],a[32:35]
buffer_load_dwordx4 v[128:131],v4,s[8:11],s80 offen offset:2048 sc1
v_mfma_f32_16x16x32_bf16 a[64:67],v[176:179],v[72:75],a[64:67]
ds_read_b64_tr_b16 v[194:195],v40 offset:12288
v_add_u32 v40,0x4000,v40
v_mfma_f32_16x16x32_bf16 a[96:99],v[176:179],v[76:79],a[96:99]
s_waitcnt lgkmcnt(4)
v_mfma_f32_16x16x32_bf16 a[100:103],v[180:183],v[76:79],a[100:103]
ds_read_b64_tr_b16 v[196:197],v41 offset:8192
v_mfma_f32_16x16x32_bf16 a[68:71],v[180:183],v[72:75],a[68:71]
v_mfma_f32_16x16x32_bf16 a[36:39],v[180:183],v[68:71],a[36:39]
ds_read_b64_tr_b16 v[198:199],v41 offset:12288
v_mfma_f32_16x16x32_bf16 a[4:7],v[180:183],v[64:67],a[4:7]
buffer_load_dwordx4 v[132:135],v5,s[8:11],s80 offen offset:2048 sc1
v_add_u32 v41,0x4000,v41
v_mfma_f32_16x16x32_bf16 a[8:11],v[184:187],v[64:67],a[8:11]
ds_read_b64_tr_b16 v[200:201],v42 offset:8192
s_add_u32 m0,s92,34816
v_mfma_f32_16x16x32_bf16 a[40:43],v[184:187],v[68:71],a[40:43]
v_mfma_f32_16x16x32_bf16 a[72:75],v[184:187],v[72:75],a[72:75]
ds_read_b64_tr_b16 v[202:203],v42 offset:12288
v_add_u32 v42,0x4000,v42
v_mfma_f32_16x16x32_bf16 a[104:107],v[184:187],v[76:79],a[104:107]
s_waitcnt lgkmcnt(4)
v_mfma_f32_16x16x32_bf16 a[108:111],v[188:191],v[76:79],a[108:111]
ds_read_b64_tr_b16 v[204:205],v43 offset:8192
v_mfma_f32_16x16x32_bf16 a[76:79],v[188:191],v[72:75],a[76:79]
buffer_load_dwordx4 v34,s[36:39],s58 offen lds
v_mfma_f32_16x16x32_bf16 a[44:47],v[188:191],v[68:71],a[44:47]
ds_read_b64_tr_b16 v[206:207],v43 offset:12288
v_mfma_f32_16x16x32_bf16 a[12:15],v[188:191],v[64:67],a[12:15]
s_waitcnt vmcnt(13)
s_barrier
v_add_u32 v43,0x4000,v43
v_mfma_f32_16x16x32_bf16 a[16:19],v[192:195],v[64:67],a[16:19]
ds_read_b64_tr_b16 v[176:177],v36 offset:0
v_mfma_f32_16x16x32_bf16 a[48:51],v[192:195],v[68:71],a[48:51]
buffer_load_dwordx4 v[136:139],v6,s[8:11],s80 offen offset:2048 sc1
v_mfma_f32_16x16x32_bf16 a[80:83],v[192:195],v[72:75],a[80:83]
ds_read_b64_tr_b16 v[178:179],v36 offset:4096
v_mfma_f32_16x16x32_bf16 a[112:115],v[192:195],v[76:79],a[112:115]
s_waitcnt lgkmcnt(4)
v_mfma_f32_16x16x32_bf16 a[116:119],v[196:199],v[76:79],a[116:119]
ds_read_b64_tr_b16 v[180:181],v37 offset:0
v_mfma_f32_16x16x32_bf16 a[84:87],v[196:199],v[72:75],a[84:87]
v_mfma_f32_16x16x32_bf16 a[52:55],v[196:199],v[68:71],a[52:55]
ds_read_b64_tr_b16 v[182:183],v37 offset:4096
v_mfma_f32_16x16x32_bf16 a[20:23],v[196:199],v[64:67],a[20:23]
buffer_load_dwordx4 v[140:143],v7,s[8:11],s80 offen offset:2048 sc1
v_mfma_f32_16x16x32_bf16 a[24:27],v[200:203],v[64:67],a[24:27]
ds_read_b64_tr_b16 v[184:185],v38 offset:0
s_add_u32 s80,s80,0x40000
v_mfma_f32_16x16x32_bf16 a[56:59],v[200:203],v[68:71],a[56:59]
s_add_u32 m0,s92,35840
v_mfma_f32_16x16x32_bf16 a[88:91],v[200:203],v[72:75],a[88:91]
ds_read_b64_tr_b16 v[186:187],v38 offset:4096
v_mfma_f32_16x16x32_bf16 a[120:123],v[200:203],v[76:79],a[120:123]
s_waitcnt lgkmcnt(6)
v_mfma_f32_16x16x32_bf16 a[124:127],v[204:207],v[76:79],a[124:127]
ds_read_b64_tr_b16 v[188:189],v39 offset:0
v_mfma_f32_16x16x32_bf16 a[92:95],v[204:207],v[72:75],a[92:95]
buffer_load_dwordx4 v35,s[36:39],s58 offen lds
v_mfma_f32_16x16x32_bf16 a[60:63],v[204:207],v[68:71],a[60:63]
ds_read_b64_tr_b16 v[190:191],v39 offset:4096
v_mfma_f32_16x16x32_bf16 a[28:31],v[204:207],v[64:67],a[28:31]
v_mfma_f32_16x16x32_bf16 a[128:131],v[26:29],a[160:163],a[128:131]
v_mov_b32 v0,v23
v_and_b32 v44,15,v2
v_mfma_f32_16x16x32_bf16 a[132:135],v[24:27],a[160:163],a[132:135]
v_lshlrev_b32 v44,11,v44
v_lshrrev_b32 v8,4,v2
v_mfma_f32_16x16x32_bf16 a[136:139],v[26:29],a[164:167],a[136:139]
v_lshl_add_u32 v45,v8,3,v44
v_mfma_f32_16x16x32_bf16 a[140:143],v[24:27],a[164:167],a[140:143]
s_lshl_b32 s54,s46,19
s_lshl_b32 s55,s44,17
v_mfma_f32_16x16x32_bf16 a[144:147],v[26:29],a[168:171],a[144:147]
s_add_u32 s54,s54,s55
s_lshl_b32 s55,s47,15
v_mfma_f32_16x16x32_bf16 a[148:151],v[24:27],a[168:171],a[148:151]
s_add_u32 s54,s54,s55
s_lshl_b32 s55,s48,8
v_mfma_f32_16x16x32_bf16 a[152:155],v[26:29],a[172:175],a[152:155]
s_add_u32 s54,s54,s55
v_and_b32 v9,1,v8
v_mfma_f32_16x16x32_bf16 a[156:159],v[24:27],a[172:175],a[156:159]
v_lshl_add_u32 v44,v9,5,v44
v_lshrrev_b32 v8,1,v8
v_mfma_f32_16x16x32_bf16 a[128:131],v[26:29],a[176:179],a[128:131]
v_lshl_add_u32 v44,v8,4,v44
v_sub_u32 v31,s47,v2
v_mfma_f32_16x16x32_bf16 a[132:135],v[24:27],a[176:179],a[132:135]
v_and_b32 v31,3,v31
v_lshlrev_b32 v31,2,v31
v_mfma_f32_16x16x32_bf16 a[136:139],v[26:29],a[180:183],a[136:139]
v_mfma_f32_16x16x32_bf16 a[140:143],v[24:27],a[180:183],a[140:143]
v_mfma_f32_16x16x32_bf16 a[144:147],v[26:29],a[184:187],a[144:147]
v_mfma_f32_16x16x32_bf16 a[148:151],v[24:27],a[184:187],a[148:151]
v_mfma_f32_16x16x32_bf16 a[152:155],v[26:29],a[188:191],a[152:155]
v_mfma_f32_16x16x32_bf16 a[156:159],v[24:27],a[188:191],a[156:159]
s_waitcnt vmcnt(15)
v_mfma_f32_16x16x32_bf16 a[128:131],v[26:29],a[192:195],a[128:131]
v_mfma_f32_16x16x32_bf16 a[132:135],v[24:27],a[192:195],a[132:135]
s_waitcnt vmcnt(14)
v_mfma_f32_16x16x32_bf16 a[136:139],v[26:29],a[196:199],a[136:139]
v_mfma_f32_16x16x32_bf16 a[140:143],v[24:27],a[196:199],a[140:143]
s_waitcnt vmcnt(13)
v_mfma_f32_16x16x32_bf16 a[144:147],v[26:29],a[200:203],a[144:147]
v_mfma_f32_16x16x32_bf16 a[148:151],v[24:27],a[200:203],a[148:151]
s_waitcnt vmcnt(12)
v_mfma_f32_16x16x32_bf16 a[152:155],v[26:29],a[204:207],a[152:155]
v_mfma_f32_16x16x32_bf16 a[156:159],v[24:27],a[204:207],a[156:159]
s_waitcnt lgkmcnt(6)
v_mfma_f32_16x16x32_bf16 a[0:3],v[176:179],v[144:147],a[0:3]
ds_read_b64_tr_b16 v[192:193],v40 offset:0
s_add_u32 s58,s58,0x20000
v_mfma_f32_16x16x32_bf16 a[32:35],v[176:179],v[148:151],a[32:35]
s_add_u32 m0,s92,49152
v_mfma_f32_16x16x32_bf16 a[64:67],v[176:179],v[152:155],a[64:67]
ds_read_b64_tr_b16 v[194:195],v40 offset:4096
v_accvgpr_read_b32 v8,a128
v_mfma_f32_16x16x32_bf16 a[96:99],v[176:179],v[156:159],a[96:99]
buffer_load_dwordx4 v32,s[36:39],s58 offen lds
s_waitcnt lgkmcnt(4)
v_mfma_f32_16x16x32_bf16 a[100:103],v[180:183],v[156:159],a[100:103]
ds_read_b64_tr_b16 v[196:197],v41 offset:0
s_add_u32 m0,s92,50176
v_mfma_f32_16x16x32_bf16 a[68:71],v[180:183],v[152:155],a[68:71]
v_accvgpr_read_b32 v9,a129
v_accvgpr_read_b32 v10,a130
v_mfma_f32_16x16x32_bf16 a[36:39],v[180:183],v[148:151],a[36:39]
ds_read_b64_tr_b16 v[198:199],v41 offset:4096
v_accvgpr_read_b32 v11,a131
v_mfma_f32_16x16x32_bf16 a[4:7],v[180:183],v[144:147],a[4:7]
buffer_load_dwordx4 v33,s[36:39],s58 offen lds
v_mfma_f32_16x16x32_bf16 a[8:11],v[184:187],v[144:147],a[8:11]
ds_read_b64_tr_b16 v[200:201],v42 offset:0
s_add_u32 m0,s92,51200
v_mfma_f32_16x16x32_bf16 a[40:43],v[184:187],v[148:151],a[40:43]
v_mul_f32 v12,s59,v8
v_mul_f32 v13,s59,v9
v_mfma_f32_16x16x32_bf16 a[72:75],v[184:187],v[152:155],a[72:75]
ds_read_b64_tr_b16 v[202:203],v42 offset:4096
v_mul_f32 v14,s59,v10
v_mfma_f32_16x16x32_bf16 a[104:107],v[184:187],v[156:159],a[104:107]
v_mul_f32 v15,s59,v11
s_waitcnt lgkmcnt(4)
v_mfma_f32_16x16x32_bf16 a[108:111],v[188:191],v[156:159],a[108:111]
ds_read_b64_tr_b16 v[204:205],v43 offset:0
v_mfma_f32_16x16x32_bf16 a[76:79],v[188:191],v[152:155],a[76:79]
buffer_load_dwordx4 v34,s[36:39],s58 offen lds
v_mfma_f32_16x16x32_bf16 a[44:47],v[188:191],v[148:151],a[44:47]
ds_read_b64_tr_b16 v[206:207],v43 offset:4096
s_add_u32 m0,s92,52224
v_mfma_f32_16x16x32_bf16 a[12:15],v[188:191],v[144:147],a[12:15]
v_exp_f32 v12,v12
v_mfma_f32_16x16x32_bf16 a[16:19],v[192:195],v[144:147],a[16:19]
ds_read_b64_tr_b16 v[176:177],v36 offset:8192
v_mfma_f32_16x16x32_bf16 a[48:51],v[192:195],v[148:151],a[48:51]
v_exp_f32 v13,v13
v_mfma_f32_16x16x32_bf16 a[80:83],v[192:195],v[152:155],a[80:83]
ds_read_b64_tr_b16 v[178:179],v36 offset:12288
v_add_u32 v36,0x4000,v36
v_mfma_f32_16x16x32_bf16 a[112:115],v[192:195],v[156:159],a[112:115]
buffer_load_dwordx4 v35,s[36:39],s58 offen lds
s_waitcnt lgkmcnt(4)
v_mfma_f32_16x16x32_bf16 a[116:119],v[196:199],v[156:159],a[116:119]
ds_read_b64_tr_b16 v[180:181],v37 offset:8192
v_mfma_f32_16x16x32_bf16 a[84:87],v[196:199],v[152:155],a[84:87]
v_exp_f32 v14,v14
v_mfma_f32_16x16x32_bf16 a[52:55],v[196:199],v[148:151],a[52:55]
ds_read_b64_tr_b16 v[182:183],v37 offset:12288
v_mfma_f32_16x16x32_bf16 a[20:23],v[196:199],v[144:147],a[20:23]
v_add_u32 v37,0x4000,v37
v_mfma_f32_16x16x32_bf16 a[24:27],v[200:203],v[144:147],a[24:27]
ds_read_b64_tr_b16 v[184:185],v38 offset:8192
v_mfma_f32_16x16x32_bf16 a[56:59],v[200:203],v[148:151],a[56:59]
buffer_load_dwordx4 v[48:51],v4,s[8:11],s80 offen offset:0 sc1
v_mfma_f32_16x16x32_bf16 a[88:91],v[200:203],v[152:155],a[88:91]
ds_read_b64_tr_b16 v[186:187],v38 offset:12288
v_add_u32 v38,0x4000,v38
v_mfma_f32_16x16x32_bf16 a[120:123],v[200:203],v[156:159],a[120:123]
s_waitcnt lgkmcnt(4)
v_mfma_f32_16x16x32_bf16 a[124:127],v[204:207],v[156:159],a[124:127]
ds_read_b64_tr_b16 v[188:189],v39 offset:8192
v_mfma_f32_16x16x32_bf16 a[92:95],v[204:207],v[152:155],a[92:95]
buffer_load_dwordx4 v[52:55],v5,s[8:11],s80 offen offset:0 sc1
v_mfma_f32_16x16x32_bf16 a[60:63],v[204:207],v[148:151],a[60:63]
ds_read_b64_tr_b16 v[190:191],v39 offset:12288
v_mfma_f32_16x16x32_bf16 a[28:31],v[204:207],v[144:147],a[28:31]
v_add_u32 v39,0x4000,v39
v_mfma_f32_16x16x32_bf16 a[0:3],v[176:179],v[160:163],a[0:3]
ds_read_b64_tr_b16 v[192:193],v40 offset:8192
v_mfma_f32_16x16x32_bf16 a[32:35],v[176:179],v[164:167],a[32:35]
buffer_load_dwordx4 v[56:59],v6,s[8:11],s80 offen offset:0 sc1
v_mfma_f32_16x16x32_bf16 a[64:67],v[176:179],v[168:171],a[64:67]
ds_read_b64_tr_b16 v[194:195],v40 offset:12288
v_add_u32 v40,0x4000,v40
v_mfma_f32_16x16x32_bf16 a[96:99],v[176:179],v[172:175],a[96:99]
s_waitcnt lgkmcnt(4)
v_mfma_f32_16x16x32_bf16 a[100:103],v[180:183],v[172:175],a[100:103]
ds_read_b64_tr_b16 v[196:197],v41 offset:8192
v_mfma_f32_16x16x32_bf16 a[68:71],v[180:183],v[168:171],a[68:71]
v_exp_f32 v15,v15
v_mfma_f32_16x16x32_bf16 a[36:39],v[180:183],v[164:167],a[36:39]
ds_read_b64_tr_b16 v[198:199],v41 offset:12288
v_add_f32 v12,1.0,v12
v_mfma_f32_16x16x32_bf16 a[4:7],v[180:183],v[160:163],a[4:7]
buffer_load_dwordx4 v[60:63],v7,s[8:11],s80 offen offset:0 sc1
v_add_u32 v41,0x4000,v41
v_mfma_f32_16x16x32_bf16 a[8:11],v[184:187],v[160:163],a[8:11]
ds_read_b64_tr_b16 v[200:201],v42 offset:8192
v_add_f32 v13,1.0,v13
v_mfma_f32_16x16x32_bf16 a[40:43],v[184:187],v[164:167],a[40:43]
v_add_f32 v14,1.0,v14
v_add_f32 v15,1.0,v15
v_mfma_f32_16x16x32_bf16 a[72:75],v[184:187],v[168:171],a[72:75]
ds_read_b64_tr_b16 v[202:203],v42 offset:12288
v_add_u32 v42,0x4000,v42
v_mfma_f32_16x16x32_bf16 a[104:107],v[184:187],v[172:175],a[104:107]
s_waitcnt lgkmcnt(4)
v_mfma_f32_16x16x32_bf16 a[108:111],v[188:191],v[172:175],a[108:111]
ds_read_b64_tr_b16 v[204:205],v43 offset:8192
v_mfma_f32_16x16x32_bf16 a[76:79],v[188:191],v[168:171],a[76:79]
buffer_load_dwordx4 v[64:67],v4,s[8:11],s80 offen offset:2048 sc1
v_mfma_f32_16x16x32_bf16 a[44:47],v[188:191],v[164:167],a[44:47]
ds_read_b64_tr_b16 v[206:207],v43 offset:12288
v_mfma_f32_16x16x32_bf16 a[12:15],v[188:191],v[160:163],a[12:15]
s_waitcnt vmcnt(9)
s_barrier
v_add_u32 v43,0x4000,v43
v_mfma_f32_16x16x32_bf16 a[16:19],v[192:195],v[160:163],a[16:19]
ds_read_b64_tr_b16 v[176:177],v36 offset:0
v_mfma_f32_16x16x32_bf16 a[48:51],v[192:195],v[164:167],a[48:51]
buffer_load_dwordx4 v[68:71],v5,s[8:11],s80 offen offset:2048 sc1
v_mfma_f32_16x16x32_bf16 a[80:83],v[192:195],v[168:171],a[80:83]
ds_read_b64_tr_b16 v[178:179],v36 offset:4096
v_mfma_f32_16x16x32_bf16 a[112:115],v[192:195],v[172:175],a[112:115]
s_waitcnt lgkmcnt(4)
v_mfma_f32_16x16x32_bf16 a[116:119],v[196:199],v[172:175],a[116:119]
ds_read_b64_tr_b16 v[180:181],v37 offset:0
v_mfma_f32_16x16x32_bf16 a[84:87],v[196:199],v[168:171],a[84:87]
v_rcp_f32 v12,v12
v_mfma_f32_16x16x32_bf16 a[52:55],v[196:199],v[164:167],a[52:55]
ds_read_b64_tr_b16 v[182:183],v37 offset:4096
v_mfma_f32_16x16x32_bf16 a[20:23],v[196:199],v[160:163],a[20:23]
buffer_load_dwordx4 v[72:75],v6,s[8:11],s80 offen offset:2048 sc1
v_mfma_f32_16x16x32_bf16 a[24:27],v[200:203],v[160:163],a[24:27]
ds_read_b64_tr_b16 v[184:185],v36 offset:8192
v_mfma_f32_16x16x32_bf16 a[56:59],v[200:203],v[164:167],a[56:59]
v_rcp_f32 v13,v13
v_mfma_f32_16x16x32_bf16 a[88:91],v[200:203],v[168:171],a[88:91]
ds_read_b64_tr_b16 v[186:187],v36 offset:12288
v_mfma_f32_16x16x32_bf16 a[120:123],v[200:203],v[172:175],a[120:123]
s_waitcnt lgkmcnt(6)
v_mfma_f32_16x16x32_bf16 a[124:127],v[204:207],v[172:175],a[124:127]
ds_read_b64_tr_b16 v[188:189],v37 offset:8192
v_mfma_f32_16x16x32_bf16 a[92:95],v[204:207],v[168:171],a[92:95]
buffer_load_dwordx4 v[76:79],v7,s[8:11],s80 offen offset:2048 sc1
v_mfma_f32_16x16x32_bf16 a[60:63],v[204:207],v[164:167],a[60:63]
ds_read_b64_tr_b16 v[190:191],v37 offset:12288
s_add_u32 s80,s80,0x40000
v_mfma_f32_16x16x32_bf16 a[28:31],v[204:207],v[160:163],a[28:31]
s_waitcnt lgkmcnt(6)
v_mfma_f32_16x16x32_bf16 a[0:3],v[176:179],v[80:83],a[0:3]
ds_read_b64_tr_b16 v[192:193],v38 offset:0
s_add_u32 s58,s58,0x20000
s_add_u32 m0,s92,65536
v_mfma_f32_16x16x32_bf16 a[32:35],v[176:179],v[84:87],a[32:35]
buffer_load_dwordx4 v32,s[36:39],s58 offen lds
v_mfma_f32_16x16x32_bf16 a[64:67],v[176:179],v[88:91],a[64:67]
ds_read_b64_tr_b16 v[194:195],v38 offset:4096
s_add_u32 m0,s92,66560
v_mfma_f32_16x16x32_bf16 a[96:99],v[176:179],v[92:95],a[96:99]
s_waitcnt lgkmcnt(4)
v_mfma_f32_16x16x32_bf16 a[100:103],v[180:183],v[92:95],a[100:103]
ds_read_b64_tr_b16 v[196:197],v39 offset:0
v_mfma_f32_16x16x32_bf16 a[68:71],v[180:183],v[88:91],a[68:71]
buffer_load_dwordx4 v33,s[36:39],s58 offen lds
v_mfma_f32_16x16x32_bf16 a[36:39],v[180:183],v[84:87],a[36:39]
ds_read_b64_tr_b16 v[198:199],v39 offset:4096
s_add_u32 m0,s92,67584
v_mfma_f32_16x16x32_bf16 a[4:7],v[180:183],v[80:83],a[4:7]
v_rcp_f32 v14,v14
v_mfma_f32_16x16x32_bf16 a[0:3],v[184:187],v[96:99],a[0:3]
ds_read_b64_tr_b16 v[200:201],v38 offset:8192
v_mfma_f32_16x16x32_bf16 a[32:35],v[184:187],v[100:103],a[32:35]
buffer_load_dwordx4 v34,s[36:39],s58 offen lds
v_mfma_f32_16x16x32_bf16 a[64:67],v[184:187],v[104:107],a[64:67]
ds_read_b64_tr_b16 v[202:203],v38 offset:12288
s_add_u32 m0,s92,68608
v_mfma_f32_16x16x32_bf16 a[96:99],v[184:187],v[108:111],a[96:99]
s_waitcnt lgkmcnt(4)
v_mfma_f32_16x16x32_bf16 a[100:103],v[188:191],v[108:111],a[100:103]
ds_read_b64_tr_b16 v[204:205],v39 offset:8192
v_mfma_f32_16x16x32_bf16 a[68:71],v[188:191],v[104:107],a[68:71]
buffer_load_dwordx4 v35,s[36:39],s58 offen lds
v_mfma_f32_16x16x32_bf16 a[36:39],v[188:191],v[100:103],a[36:39]
ds_read_b64_tr_b16 v[206:207],v39 offset:12288
s_add_u32 s58,s58,0x20000
v_mfma_f32_16x16x32_bf16 a[4:7],v[188:191],v[96:99],a[4:7]
s_waitcnt vmcnt(12)
s_barrier
s_add_u32 m0,s92,81920
v_mfma_f32_16x16x32_bf16 a[8:11],v[192:195],v[80:83],a[8:11]
ds_read_b64_tr_b16 v[176:177],v36 offset:16384
v_mfma_f32_16x16x32_bf16 a[40:43],v[192:195],v[84:87],a[40:43]
buffer_load_dwordx4 v32,s[36:39],s58 offen lds
v_mfma_f32_16x16x32_bf16 a[72:75],v[192:195],v[88:91],a[72:75]
ds_read_b64_tr_b16 v[178:179],v36 offset:20480
s_add_u32 m0,s92,82944
v_mfma_f32_16x16x32_bf16 a[104:107],v[192:195],v[92:95],a[104:107]
s_waitcnt lgkmcnt(4)
v_mfma_f32_16x16x32_bf16 a[108:111],v[196:199],v[92:95],a[108:111]
ds_read_b64_tr_b16 v[180:181],v37 offset:16384
v_mfma_f32_16x16x32_bf16 a[76:79],v[196:199],v[88:91],a[76:79]
buffer_load_dwordx4 v33,s[36:39],s58 offen lds
v_mfma_f32_16x16x32_bf16 a[44:47],v[196:199],v[84:87],a[44:47]
ds_read_b64_tr_b16 v[182:183],v37 offset:20480
s_add_u32 m0,s92,83968
v_mfma_f32_16x16x32_bf16 a[12:15],v[196:199],v[80:83],a[12:15]
v_rcp_f32 v15,v15
v_mfma_f32_16x16x32_bf16 a[8:11],v[200:203],v[96:99],a[8:11]
ds_read_b64_tr_b16 v[184:185],v36 offset:24576
v_mul_f32 v8,v8,v12
v_mfma_f32_16x16x32_bf16 a[40:43],v[200:203],v[100:103],a[40:43]
buffer_load_dwordx4 v34,s[36:39],s58 offen lds
v_mfma_f32_16x16x32_bf16 a[72:75],v[200:203],v[104:107],a[72:75]
ds_read_b64_tr_b16 v[186:187],v36 offset:28672
s_add_u32 m0,s92,84992
v_mfma_f32_16x16x32_bf16 a[104:107],v[200:203],v[108:111],a[104:107]
v_mul_f32 v9,v9,v13
s_waitcnt lgkmcnt(4)
v_mfma_f32_16x16x32_bf16 a[108:111],v[204:207],v[108:111],a[108:111]
ds_read_b64_tr_b16 v[188:189],v37 offset:24576
v_mul_f32 v10,v10,v14
v_mfma_f32_16x16x32_bf16 a[76:79],v[204:207],v[104:107],a[76:79]
buffer_load_dwordx4 v35,s[36:39],s58 offen lds
v_mfma_f32_16x16x32_bf16 a[44:47],v[204:207],v[100:103],a[44:47]
ds_read_b64_tr_b16 v[190:191],v37 offset:28672
s_add_u32 s58,s58,0x20000
v_mfma_f32_16x16x32_bf16 a[12:15],v[204:207],v[96:99],a[12:15]
v_mul_f32 v11,v11,v15
v_mfma_f32_16x16x32_bf16 a[0:3],v[176:179],v[112:115],a[0:3]
ds_read_b64_tr_b16 v[192:193],v38 offset:16384
v_accvgpr_write_b32 a128,v8
v_mfma_f32_16x16x32_bf16 a[32:35],v[176:179],v[116:119],a[32:35]
buffer_load_dwordx4 v[208:211],v4,s[8:11],s80 offen offset:0 sc1
v_mfma_f32_16x16x32_bf16 a[64:67],v[176:179],v[120:123],a[64:67]
ds_read_b64_tr_b16 v[194:195],v38 offset:20480
v_accvgpr_write_b32 a129,v9
v_mfma_f32_16x16x32_bf16 a[96:99],v[176:179],v[124:127],a[96:99]
v_accvgpr_write_b32 a130,v10
s_waitcnt lgkmcnt(4)
v_mfma_f32_16x16x32_bf16 a[100:103],v[180:183],v[124:127],a[100:103]
ds_read_b64_tr_b16 v[196:197],v39 offset:16384
v_accvgpr_write_b32 a131,v11
v_mfma_f32_16x16x32_bf16 a[68:71],v[180:183],v[120:123],a[68:71]
buffer_load_dwordx4 v[212:215],v5,s[8:11],s80 offen offset:0 sc1
v_mfma_f32_16x16x32_bf16 a[36:39],v[180:183],v[116:119],a[36:39]
ds_read_b64_tr_b16 v[198:199],v39 offset:20480
v_accvgpr_read_b32 v16,a132
v_mfma_f32_16x16x32_bf16 a[4:7],v[180:183],v[112:115],a[4:7]
buffer_load_dwordx4 v[216:219],v6,s[8:11],s80 offen offset:0 sc1
v_mfma_f32_16x16x32_bf16 a[0:3],v[184:187],v[128:131],a[0:3]
ds_read_b64_tr_b16 v[200:201],v38 offset:24576
v_accvgpr_read_b32 v17,a133
v_mfma_f32_16x16x32_bf16 a[32:35],v[184:187],v[132:135],a[32:35]
v_accvgpr_read_b32 v18,a134
v_accvgpr_read_b32 v19,a135
v_mfma_f32_16x16x32_bf16 a[64:67],v[184:187],v[136:139],a[64:67]
ds_read_b64_tr_b16 v[202:203],v38 offset:28672
v_mul_f32 v20,s59,v16
v_mfma_f32_16x16x32_bf16 a[96:99],v[184:187],v[140:143],a[96:99]
v_mul_f32 v21,s59,v17
s_waitcnt lgkmcnt(4)
v_mfma_f32_16x16x32_bf16 a[100:103],v[188:191],v[140:143],a[100:103]
ds_read_b64_tr_b16 v[204:205],v39 offset:24576
v_mul_f32 v22,s59,v18
v_mfma_f32_16x16x32_bf16 a[68:71],v[188:191],v[136:139],a[68:71]
buffer_load_dwordx4 v[220:223],v7,s[8:11],s80 offen offset:0 sc1
v_mfma_f32_16x16x32_bf16 a[36:39],v[188:191],v[132:135],a[36:39]
ds_read_b64_tr_b16 v[206:207],v39 offset:28672
v_mul_f32 v23,s59,v19
v_mfma_f32_16x16x32_bf16 a[4:7],v[188:191],v[128:131],a[4:7]
buffer_load_dwordx4 v[224:227],v4,s[8:11],s80 offen offset:2048 sc1
s_waitcnt vmcnt(9)
s_barrier
v_mfma_f32_16x16x32_bf16 a[8:11],v[192:195],v[112:115],a[8:11]
ds_read_b64_tr_b16 v[176:177],v36 offset:32768
v_mfma_f32_16x16x32_bf16 a[40:43],v[192:195],v[116:119],a[40:43]
v_exp_f32 v20,v20
v_mfma_f32_16x16x32_bf16 a[72:75],v[192:195],v[120:123],a[72:75]
ds_read_b64_tr_b16 v[178:179],v36 offset:36864
v_mfma_f32_16x16x32_bf16 a[104:107],v[192:195],v[124:127],a[104:107]
buffer_load_dwordx4 v[228:231],v5,s[8:11],s80 offen offset:2048 sc1
s_waitcnt lgkmcnt(4)
v_mfma_f32_16x16x32_bf16 a[108:111],v[196:199],v[124:127],a[108:111]
ds_read_b64_tr_b16 v[180:181],v37 offset:32768
v_mfma_f32_16x16x32_bf16 a[76:79],v[196:199],v[120:123],a[76:79]
v_exp_f32 v21,v21
v_mfma_f32_16x16x32_bf16 a[44:47],v[196:199],v[116:119],a[44:47]
ds_read_b64_tr_b16 v[182:183],v37 offset:36864
v_mfma_f32_16x16x32_bf16 a[12:15],v[196:199],v[112:115],a[12:15]
buffer_load_dwordx4 v[232:235],v6,s[8:11],s80 offen offset:2048 sc1
v_mfma_f32_16x16x32_bf16 a[8:11],v[200:203],v[128:131],a[8:11]
ds_read_b64_tr_b16 v[184:185],v36 offset:40960
v_mfma_f32_16x16x32_bf16 a[40:43],v[200:203],v[132:135],a[40:43]
v_exp_f32 v22,v22
v_mfma_f32_16x16x32_bf16 a[72:75],v[200:203],v[136:139],a[72:75]
ds_read_b64_tr_b16 v[186:187],v36 offset:45056
v_mfma_f32_16x16x32_bf16 a[104:107],v[200:203],v[140:143],a[104:107]
buffer_load_dwordx4 v[236:239],v7,s[8:11],s80 offen offset:2048 sc1
s_waitcnt lgkmcnt(4)
v_mfma_f32_16x16x32_bf16 a[108:111],v[204:207],v[140:143],a[108:111]
ds_read_b64_tr_b16 v[188:189],v37 offset:40960
s_add_u32 s80,s80,0x40000
v_mfma_f32_16x16x32_bf16 a[76:79],v[204:207],v[136:139],a[76:79]
v_exp_f32 v23,v23
v_mfma_f32_16x16x32_bf16 a[44:47],v[204:207],v[132:135],a[44:47]
ds_read_b64_tr_b16 v[190:191],v37 offset:45056
v_add_f32 v20,1.0,v20
v_mfma_f32_16x16x32_bf16 a[12:15],v[204:207],v[128:131],a[12:15]
s_waitcnt vmcnt(8)
s_barrier
v_mfma_f32_16x16x32_bf16 a[0:3],v[176:179],v[48:51],a[0:3]
ds_read_b64_tr_b16 v[192:193],v36 offset:49152
v_add_f32 v21,1.0,v21
v_mfma_f32_16x16x32_bf16 a[32:35],v[176:179],v[52:55],a[32:35]
v_add_f32 v22,1.0,v22
v_add_f32 v23,1.0,v23
v_mfma_f32_16x16x32_bf16 a[64:67],v[176:179],v[56:59],a[64:67]
ds_read_b64_tr_b16 v[194:195],v36 offset:53248
v_mfma_f32_16x16x32_bf16 a[96:99],v[176:179],v[60:63],a[96:99]
buffer_load_dwordx4 a[208:211],v44,s[28:31],s54 offen offset:0
s_waitcnt lgkmcnt(4)
v_mfma_f32_16x16x32_bf16 a[100:103],v[180:183],v[60:63],a[100:103]
ds_read_b64_tr_b16 v[196:197],v37 offset:49152
v_mfma_f32_16x16x32_bf16 a[68:71],v[180:183],v[56:59],a[68:71]
v_rcp_f32 v20,v20
v_mfma_f32_16x16x32_bf16 a[36:39],v[180:183],v[52:55],a[36:39]
ds_read_b64_tr_b16 v[198:199],v37 offset:53248
v_mfma_f32_16x16x32_bf16 a[4:7],v[180:183],v[48:51],a[4:7]
v_rcp_f32 v21,v21
v_mfma_f32_16x16x32_bf16 a[0:3],v[184:187],v[64:67],a[0:3]
ds_read_b64_tr_b16 v[200:201],v36 offset:57344
v_mfma_f32_16x16x32_bf16 a[32:35],v[184:187],v[68:71],a[32:35]
v_rcp_f32 v22,v22
v_mfma_f32_16x16x32_bf16 a[64:67],v[184:187],v[72:75],a[64:67]
ds_read_b64_tr_b16 v[202:203],v36 offset:61440
v_mfma_f32_16x16x32_bf16 a[96:99],v[184:187],v[76:79],a[96:99]
buffer_load_dwordx4 a[212:215],v44,s[28:31],s54 offen offset:64
s_waitcnt lgkmcnt(4)
v_mfma_f32_16x16x32_bf16 a[100:103],v[188:191],v[76:79],a[100:103]
ds_read_b64_tr_b16 v[204:205],v37 offset:57344
v_mfma_f32_16x16x32_bf16 a[68:71],v[188:191],v[72:75],a[68:71]
v_rcp_f32 v23,v23
v_mfma_f32_16x16x32_bf16 a[36:39],v[188:191],v[68:71],a[36:39]
ds_read_b64_tr_b16 v[206:207],v37 offset:61440
v_mul_f32 v16,v16,v20
v_mfma_f32_16x16x32_bf16 a[4:7],v[188:191],v[64:67],a[4:7]
v_mul_f32 v17,v17,v21
s_waitcnt vmcnt(2)
v_mfma_f32_16x16x32_bf16 a[0:3],v[192:195],v[208:211],a[0:3]
ds_read_b64_tr_b16 v[176:177],v38 offset:32768
v_mul_f32 v18,v18,v22
v_mfma_f32_16x16x32_bf16 a[32:35],v[192:195],v[212:215],a[32:35]
v_mul_f32 v19,v19,v23
v_accvgpr_write_b32 a132,v16
v_mfma_f32_16x16x32_bf16 a[64:67],v[192:195],v[216:219],a[64:67]
ds_read_b64_tr_b16 v[178:179],v38 offset:36864
v_accvgpr_write_b32 a133,v17
v_mfma_f32_16x16x32_bf16 a[96:99],v[192:195],v[220:223],a[96:99]
buffer_load_dwordx4 a[216:219],v44,s[28:31],s54 offen offset:128
s_waitcnt lgkmcnt(4)
v_mfma_f32_16x16x32_bf16 a[100:103],v[196:199],v[220:223],a[100:103]
ds_read_b64_tr_b16 v[180:181],v39 offset:32768
v_accvgpr_write_b32 a134,v18
v_mfma_f32_16x16x32_bf16 a[68:71],v[196:199],v[216:219],a[68:71]
v_accvgpr_write_b32 a135,v19
v_accvgpr_read_b32 v8,a136
v_mfma_f32_16x16x32_bf16 a[36:39],v[196:199],v[212:215],a[36:39]
ds_read_b64_tr_b16 v[182:183],v39 offset:36864
v_accvgpr_read_b32 v9,a137
v_mfma_f32_16x16x32_bf16 a[4:7],v[196:199],v[208:211],a[4:7]
v_accvgpr_read_b32 v10,a138
v_accvgpr_read_b32 v11,a139
v_mfma_f32_16x16x32_bf16 a[0:3],v[200:203],v[224:227],a[0:3]
ds_read_b64_tr_b16 v[184:185],v38 offset:40960
v_mul_f32 v12,s59,v8
v_mfma_f32_16x16x32_bf16 a[32:35],v[200:203],v[228:231],a[32:35]
v_mul_f32 v13,s59,v9
v_mul_f32 v14,s59,v10
v_mfma_f32_16x16x32_bf16 a[64:67],v[200:203],v[232:235],a[64:67]
ds_read_b64_tr_b16 v[186:187],v38 offset:45056
v_mul_f32 v15,s59,v11
v_mfma_f32_16x16x32_bf16 a[96:99],v[200:203],v[236:239],a[96:99]
buffer_load_dwordx4 a[220:223],v44,s[28:31],s54 offen offset:192
s_waitcnt lgkmcnt(4)
v_mfma_f32_16x16x32_bf16 a[100:103],v[204:207],v[236:239],a[100:103]
ds_read_b64_tr_b16 v[188:189],v39 offset:40960
v_mfma_f32_16x16x32_bf16 a[68:71],v[204:207],v[232:235],a[68:71]
v_exp_f32 v12,v12
v_mfma_f32_16x16x32_bf16 a[36:39],v[204:207],v[228:231],a[36:39]
ds_read_b64_tr_b16 v[190:191],v39 offset:45056
v_mfma_f32_16x16x32_bf16 a[4:7],v[204:207],v[224:227],a[4:7]
v_exp_f32 v13,v13
v_mfma_f32_16x16x32_bf16 a[8:11],v[176:179],v[48:51],a[8:11]
ds_read_b64_tr_b16 v[192:193],v38 offset:49152
v_mfma_f32_16x16x32_bf16 a[40:43],v[176:179],v[52:55],a[40:43]
v_exp_f32 v14,v14
v_mfma_f32_16x16x32_bf16 a[72:75],v[176:179],v[56:59],a[72:75]
ds_read_b64_tr_b16 v[194:195],v38 offset:53248
v_mfma_f32_16x16x32_bf16 a[104:107],v[176:179],v[60:63],a[104:107]
v_accvgpr_read_b32 v240,a32
s_waitcnt lgkmcnt(4)
v_mfma_f32_16x16x32_bf16 a[108:111],v[180:183],v[60:63],a[108:111]
ds_read_b64_tr_b16 v[196:197],v39 offset:49152
v_accvgpr_read_b32 v241,a33
v_mfma_f32_16x16x32_bf16 a[76:79],v[180:183],v[56:59],a[76:79]
v_accvgpr_read_b32 v242,a34
v_accvgpr_read_b32 v243,a35
v_mfma_f32_16x16x32_bf16 a[44:47],v[180:183],v[52:55],a[44:47]
ds_read_b64_tr_b16 v[198:199],v39 offset:53248
v_accvgpr_read_b32 v244,a36
v_mfma_f32_16x16x32_bf16 a[12:15],v[180:183],v[48:51],a[12:15]
v_accvgpr_read_b32 v245,a37
v_accvgpr_read_b32 v246,a38
v_mfma_f32_16x16x32_bf16 a[8:11],v[184:187],v[64:67],a[8:11]
ds_read_b64_tr_b16 v[200:201],v38 offset:57344
v_accvgpr_read_b32 v247,a39
v_mfma_f32_16x16x32_bf16 a[40:43],v[184:187],v[68:71],a[40:43]
v_cvt_pk_bf16_f32 v4,v240,v241
v_cvt_pk_bf16_f32 v5,v242,v243
v_mfma_f32_16x16x32_bf16 a[72:75],v[184:187],v[72:75],a[72:75]
ds_read_b64_tr_b16 v[202:203],v38 offset:61440
v_cvt_pk_bf16_f32 v6,v244,v245
v_mfma_f32_16x16x32_bf16 a[104:107],v[184:187],v[76:79],a[104:107]
v_cvt_pk_bf16_f32 v7,v246,v247
s_waitcnt lgkmcnt(4)
v_mfma_f32_16x16x32_bf16 a[108:111],v[188:191],v[76:79],a[108:111]
ds_read_b64_tr_b16 v[204:205],v39 offset:57344
v_accvgpr_read_b32 v248,a64
v_mfma_f32_16x16x32_bf16 a[76:79],v[188:191],v[72:75],a[76:79]
buffer_store_dwordx4 v[4:7],v1,s[8:11],s93 offen offset:0 sc1
v_mfma_f32_16x16x32_bf16 a[44:47],v[188:191],v[68:71],a[44:47]
ds_read_b64_tr_b16 v[206:207],v39 offset:61440
v_accvgpr_read_b32 v249,a65
v_mfma_f32_16x16x32_bf16 a[12:15],v[188:191],v[64:67],a[12:15]
v_accvgpr_read_b32 v250,a66
v_accvgpr_read_b32 v251,a67
v_mfma_f32_16x16x32_bf16 a[8:11],v[192:195],v[208:211],a[8:11]
ds_read_b64_tr_b16 v[176:177],v40 offset:0
v_accvgpr_read_b32 v252,a68
v_mfma_f32_16x16x32_bf16 a[40:43],v[192:195],v[212:215],a[40:43]
v_accvgpr_read_b32 v253,a69
v_accvgpr_read_b32 v254,a70
v_mfma_f32_16x16x32_bf16 a[72:75],v[192:195],v[216:219],a[72:75]
ds_read_b64_tr_b16 v[178:179],v40 offset:4096
v_accvgpr_read_b32 v255,a71
v_mfma_f32_16x16x32_bf16 a[104:107],v[192:195],v[220:223],a[104:107]
v_cvt_pk_bf16_f32 v32,v248,v249
s_waitcnt lgkmcnt(4)
v_mfma_f32_16x16x32_bf16 a[108:111],v[196:199],v[220:223],a[108:111]
ds_read_b64_tr_b16 v[180:181],v41 offset:0
v_cvt_pk_bf16_f32 v33,v250,v251
v_mfma_f32_16x16x32_bf16 a[76:79],v[196:199],v[216:219],a[76:79]
v_cvt_pk_bf16_f32 v34,v252,v253
v_cvt_pk_bf16_f32 v35,v254,v255
v_mfma_f32_16x16x32_bf16 a[44:47],v[196:199],v[212:215],a[44:47]
ds_read_b64_tr_b16 v[182:183],v41 offset:4096
v_accvgpr_read_b32 v240,a96
v_mfma_f32_16x16x32_bf16 a[12:15],v[196:199],v[208:211],a[12:15]
buffer_store_dwordx4 v[32:35],v1,s[8:11],s94 offen offset:0 sc1
v_mfma_f32_16x16x32_bf16 a[8:11],v[200:203],v[224:227],a[8:11]
ds_read_b64_tr_b16 v[184:185],v40 offset:8192
v_accvgpr_read_b32 v241,a97
v_mfma_f32_16x16x32_bf16 a[40:43],v[200:203],v[228:231],a[40:43]
v_accvgpr_read_b32 v242,a98
v_accvgpr_read_b32 v243,a99
v_mfma_f32_16x16x32_bf16 a[72:75],v[200:203],v[232:235],a[72:75]
ds_read_b64_tr_b16 v[186:187],v40 offset:12288
v_accvgpr_read_b32 v244,a100
v_mfma_f32_16x16x32_bf16 a[104:107],v[200:203],v[236:239],a[104:107]
v_accvgpr_read_b32 v245,a101
s_waitcnt lgkmcnt(4)
v_mfma_f32_16x16x32_bf16 a[108:111],v[204:207],v[236:239],a[108:111]
ds_read_b64_tr_b16 v[188:189],v41 offset:8192
v_accvgpr_read_b32 v246,a102
v_mfma_f32_16x16x32_bf16 a[76:79],v[204:207],v[232:235],a[76:79]
v_accvgpr_read_b32 v247,a103
v_cvt_pk_bf16_f32 v4,v240,v241
v_mfma_f32_16x16x32_bf16 a[44:47],v[204:207],v[228:231],a[44:47]
ds_read_b64_tr_b16 v[190:191],v41 offset:12288
v_cvt_pk_bf16_f32 v5,v242,v243
v_mfma_f32_16x16x32_bf16 a[12:15],v[204:207],v[224:227],a[12:15]
v_exp_f32 v15,v15
v_mfma_f32_16x16x32_bf16 a[16:19],v[176:179],v[80:83],a[16:19]
ds_read_b64_tr_b16 v[192:193],v40 offset:16384
v_add_f32 v12,1.0,v12
v_mfma_f32_16x16x32_bf16 a[48:51],v[176:179],v[84:87],a[48:51]
v_add_f32 v13,1.0,v13
v_add_f32 v14,1.0,v14
v_mfma_f32_16x16x32_bf16 a[80:83],v[176:179],v[88:91],a[80:83]
ds_read_b64_tr_b16 v[194:195],v40 offset:20480
v_add_f32 v15,1.0,v15
v_mfma_f32_16x16x32_bf16 a[112:115],v[176:179],v[92:95],a[112:115]
v_cvt_pk_bf16_f32 v6,v244,v245
s_waitcnt lgkmcnt(4)
v_mfma_f32_16x16x32_bf16 a[116:119],v[180:183],v[92:95],a[116:119]
ds_read_b64_tr_b16 v[196:197],v41 offset:16384
v_cvt_pk_bf16_f32 v7,v246,v247
v_mfma_f32_16x16x32_bf16 a[84:87],v[180:183],v[88:91],a[84:87]
buffer_store_dwordx4 v[4:7],v1,s[8:11],s81 offen offset:0 sc1
v_mfma_f32_16x16x32_bf16 a[52:55],v[180:183],v[84:87],a[52:55]
ds_read_b64_tr_b16 v[198:199],v41 offset:20480
v_accvgpr_read_b32 v248,a40
v_mfma_f32_16x16x32_bf16 a[20:23],v[180:183],v[80:83],a[20:23]
v_accvgpr_read_b32 v249,a41
v_accvgpr_read_b32 v250,a42
v_mfma_f32_16x16x32_bf16 a[16:19],v[184:187],v[96:99],a[16:19]
ds_read_b64_tr_b16 v[200:201],v40 offset:24576
v_accvgpr_read_b32 v251,a43
v_mfma_f32_16x16x32_bf16 a[48:51],v[184:187],v[100:103],a[48:51]
v_accvgpr_read_b32 v252,a44
v_accvgpr_read_b32 v253,a45
v_mfma_f32_16x16x32_bf16 a[80:83],v[184:187],v[104:107],a[80:83]
ds_read_b64_tr_b16 v[202:203],v40 offset:28672
v_accvgpr_read_b32 v254,a46
v_mfma_f32_16x16x32_bf16 a[112:115],v[184:187],v[108:111],a[112:115]
v_accvgpr_read_b32 v255,a47
s_waitcnt lgkmcnt(4)
v_mfma_f32_16x16x32_bf16 a[116:119],v[188:191],v[108:111],a[116:119]
ds_read_b64_tr_b16 v[204:205],v41 offset:24576
v_cvt_pk_bf16_f32 v32,v248,v249
v_mfma_f32_16x16x32_bf16 a[84:87],v[188:191],v[104:107],a[84:87]
v_cvt_pk_bf16_f32 v33,v250,v251
v_cvt_pk_bf16_f32 v34,v252,v253
v_mfma_f32_16x16x32_bf16 a[52:55],v[188:191],v[100:103],a[52:55]
ds_read_b64_tr_b16 v[206:207],v41 offset:28672
v_cvt_pk_bf16_f32 v35,v254,v255
v_mfma_f32_16x16x32_bf16 a[20:23],v[188:191],v[96:99],a[20:23]
buffer_store_dwordx4 v[32:35],v1,s[8:11],s93 offen offset:1024 sc1
v_mfma_f32_16x16x32_bf16 a[16:19],v[192:195],v[112:115],a[16:19]
ds_read_b64_tr_b16 v[176:177],v40 offset:32768
v_accvgpr_read_b32 v240,a72
v_mfma_f32_16x16x32_bf16 a[48:51],v[192:195],v[116:119],a[48:51]
v_accvgpr_read_b32 v241,a73
v_accvgpr_read_b32 v242,a74
v_mfma_f32_16x16x32_bf16 a[80:83],v[192:195],v[120:123],a[80:83]
ds_read_b64_tr_b16 v[178:179],v40 offset:36864
v_accvgpr_read_b32 v243,a75
v_mfma_f32_16x16x32_bf16 a[112:115],v[192:195],v[124:127],a[112:115]
v_accvgpr_read_b32 v244,a76
s_waitcnt lgkmcnt(4)
v_mfma_f32_16x16x32_bf16 a[116:119],v[196:199],v[124:127],a[116:119]
ds_read_b64_tr_b16 v[180:181],v41 offset:32768
v_accvgpr_read_b32 v245,a77
v_mfma_f32_16x16x32_bf16 a[84:87],v[196:199],v[120:123],a[84:87]
v_accvgpr_read_b32 v246,a78
v_accvgpr_read_b32 v247,a79
v_mfma_f32_16x16x32_bf16 a[52:55],v[196:199],v[116:119],a[52:55]
ds_read_b64_tr_b16 v[182:183],v41 offset:36864
v_cvt_pk_bf16_f32 v4,v240,v241
v_mfma_f32_16x16x32_bf16 a[20:23],v[196:199],v[112:115],a[20:23]
v_cvt_pk_bf16_f32 v5,v242,v243
v_cvt_pk_bf16_f32 v6,v244,v245
v_mfma_f32_16x16x32_bf16 a[16:19],v[200:203],v[128:131],a[16:19]
ds_read_b64_tr_b16 v[184:185],v40 offset:40960
v_cvt_pk_bf16_f32 v7,v246,v247
v_mfma_f32_16x16x32_bf16 a[48:51],v[200:203],v[132:135],a[48:51]
buffer_store_dwordx4 v[4:7],v1,s[8:11],s94 offen offset:1024 sc1
v_mfma_f32_16x16x32_bf16 a[80:83],v[200:203],v[136:139],a[80:83]
ds_read_b64_tr_b16 v[186:187],v40 offset:45056
v_accvgpr_read_b32 v248,a104
v_mfma_f32_16x16x32_bf16 a[112:115],v[200:203],v[140:143],a[112:115]
v_accvgpr_read_b32 v249,a105
s_waitcnt lgkmcnt(4)
v_mfma_f32_16x16x32_bf16 a[116:119],v[204:207],v[140:143],a[116:119]
ds_read_b64_tr_b16 v[188:189],v41 offset:40960
v_accvgpr_read_b32 v250,a106
v_mfma_f32_16x16x32_bf16 a[84:87],v[204:207],v[136:139],a[84:87]
v_accvgpr_read_b32 v251,a107
v_accvgpr_read_b32 v252,a108
v_mfma_f32_16x16x32_bf16 a[52:55],v[204:207],v[132:135],a[52:55]
ds_read_b64_tr_b16 v[190:191],v41 offset:45056
v_accvgpr_read_b32 v253,a109
v_mfma_f32_16x16x32_bf16 a[20:23],v[204:207],v[128:131],a[20:23]
v_accvgpr_read_b32 v254,a110
v_accvgpr_read_b32 v255,a111
v_mfma_f32_16x16x32_bf16 a[16:19],v[176:179],v[48:51],a[16:19]
ds_read_b64_tr_b16 v[192:193],v40 offset:49152
v_cvt_pk_bf16_f32 v32,v248,v249
v_mfma_f32_16x16x32_bf16 a[48:51],v[176:179],v[52:55],a[48:51]
v_cvt_pk_bf16_f32 v33,v250,v251
v_cvt_pk_bf16_f32 v34,v252,v253
v_mfma_f32_16x16x32_bf16 a[80:83],v[176:179],v[56:59],a[80:83]
ds_read_b64_tr_b16 v[194:195],v40 offset:53248
v_cvt_pk_bf16_f32 v35,v254,v255
v_mfma_f32_16x16x32_bf16 a[112:115],v[176:179],v[60:63],a[112:115]
s_waitcnt lgkmcnt(4)
v_mfma_f32_16x16x32_bf16 a[116:119],v[180:183],v[60:63],a[116:119]
ds_read_b64_tr_b16 v[196:197],v41 offset:49152
v_mfma_f32_16x16x32_bf16 a[84:87],v[180:183],v[56:59],a[84:87]
buffer_store_dwordx4 v[32:35],v1,s[8:11],s81 offen offset:1024 sc1
v_mfma_f32_16x16x32_bf16 a[52:55],v[180:183],v[52:55],a[52:55]
ds_read_b64_tr_b16 v[198:199],v41 offset:53248
v_mfma_f32_16x16x32_bf16 a[20:23],v[180:183],v[48:51],a[20:23]
v_rcp_f32 v12,v12
v_mfma_f32_16x16x32_bf16 a[16:19],v[184:187],v[64:67],a[16:19]
ds_read_b64_tr_b16 v[200:201],v40 offset:57344
v_mfma_f32_16x16x32_bf16 a[48:51],v[184:187],v[68:71],a[48:51]
v_rcp_f32 v13,v13
v_mfma_f32_16x16x32_bf16 a[80:83],v[184:187],v[72:75],a[80:83]
ds_read_b64_tr_b16 v[202:203],v40 offset:61440
v_mfma_f32_16x16x32_bf16 a[112:115],v[184:187],v[76:79],a[112:115]
s_waitcnt lgkmcnt(4)
v_mfma_f32_16x16x32_bf16 a[116:119],v[188:191],v[76:79],a[116:119]
ds_read_b64_tr_b16 v[204:205],v41 offset:57344
v_mfma_f32_16x16x32_bf16 a[84:87],v[188:191],v[72:75],a[84:87]
v_rcp_f32 v14,v14
v_mfma_f32_16x16x32_bf16 a[52:55],v[188:191],v[68:71],a[52:55]
ds_read_b64_tr_b16 v[206:207],v41 offset:61440
v_mfma_f32_16x16x32_bf16 a[20:23],v[188:191],v[64:67],a[20:23]
v_rcp_f32 v15,v15
v_mfma_f32_16x16x32_bf16 a[16:19],v[192:195],v[208:211],a[16:19]
ds_read_b64_tr_b16 v[176:177],v42 offset:0
v_mul_f32 v8,v8,v12
v_mfma_f32_16x16x32_bf16 a[48:51],v[192:195],v[212:215],a[48:51]
v_mul_f32 v9,v9,v13
v_mul_f32 v10,v10,v14
v_mfma_f32_16x16x32_bf16 a[80:83],v[192:195],v[216:219],a[80:83]
ds_read_b64_tr_b16 v[178:179],v42 offset:4096
v_mul_f32 v11,v11,v15
v_mfma_f32_16x16x32_bf16 a[112:115],v[192:195],v[220:223],a[112:115]
v_accvgpr_write_b32 a136,v8
s_waitcnt lgkmcnt(4)
v_mfma_f32_16x16x32_bf16 a[116:119],v[196:199],v[220:223],a[116:119]
ds_read_b64_tr_b16 v[180:181],v43 offset:0
v_accvgpr_write_b32 a137,v9
v_mfma_f32_16x16x32_bf16 a[84:87],v[196:199],v[216:219],a[84:87]
v_accvgpr_write_b32 a138,v10
v_accvgpr_write_b32 a139,v11
v_mfma_f32_16x16x32_bf16 a[52:55],v[196:199],v[212:215],a[52:55]
ds_read_b64_tr_b16 v[182:183],v43 offset:4096
v_accvgpr_read_b32 v16,a140
v_mfma_f32_16x16x32_bf16 a[20:23],v[196:199],v[208:211],a[20:23]
v_accvgpr_read_b32 v17,a141
v_accvgpr_read_b32 v18,a142
v_mfma_f32_16x16x32_bf16 a[16:19],v[200:203],v[224:227],a[16:19]
ds_read_b64_tr_b16 v[184:185],v42 offset:8192
v_accvgpr_read_b32 v19,a143
v_mfma_f32_16x16x32_bf16 a[48:51],v[200:203],v[228:231],a[48:51]
v_mul_f32 v20,s59,v16
v_mul_f32 v21,s59,v17
v_mfma_f32_16x16x32_bf16 a[80:83],v[200:203],v[232:235],a[80:83]
ds_read_b64_tr_b16 v[186:187],v42 offset:12288
v_mul_f32 v22,s59,v18
v_mfma_f32_16x16x32_bf16 a[112:115],v[200:203],v[236:239],a[112:115]
v_mul_f32 v23,s59,v19
s_waitcnt lgkmcnt(4)
v_mfma_f32_16x16x32_bf16 a[116:119],v[204:207],v[236:239],a[116:119]
ds_read_b64_tr_b16 v[188:189],v43 offset:8192
v_mfma_f32_16x16x32_bf16 a[84:87],v[204:207],v[232:235],a[84:87]
v_exp_f32 v20,v20
v_mfma_f32_16x16x32_bf16 a[52:55],v[204:207],v[228:231],a[52:55]
ds_read_b64_tr_b16 v[190:191],v43 offset:12288
v_mfma_f32_16x16x32_bf16 a[20:23],v[204:207],v[224:227],a[20:23]
v_exp_f32 v21,v21
v_mfma_f32_16x16x32_bf16 a[24:27],v[176:179],v[80:83],a[24:27]
ds_read_b64_tr_b16 v[192:193],v42 offset:16384
v_mfma_f32_16x16x32_bf16 a[56:59],v[176:179],v[84:87],a[56:59]
v_exp_f32 v22,v22
v_mfma_f32_16x16x32_bf16 a[88:91],v[176:179],v[88:91],a[88:91]
ds_read_b64_tr_b16 v[194:195],v42 offset:20480
v_mfma_f32_16x16x32_bf16 a[120:123],v[176:179],v[92:95],a[120:123]
v_accvgpr_read_b32 v240,a48
s_waitcnt lgkmcnt(4)
v_mfma_f32_16x16x32_bf16 a[124:127],v[180:183],v[92:95],a[124:127]
ds_read_b64_tr_b16 v[196:197],v43 offset:16384
v_accvgpr_read_b32 v241,a49
v_mfma_f32_16x16x32_bf16 a[92:95],v[180:183],v[88:91],a[92:95]
v_accvgpr_read_b32 v242,a50
v_accvgpr_read_b32 v243,a51
v_mfma_f32_16x16x32_bf16 a[60:63],v[180:183],v[84:87],a[60:63]
ds_read_b64_tr_b16 v[198:199],v43 offset:20480
v_accvgpr_read_b32 v244,a52
v_mfma_f32_16x16x32_bf16 a[28:31],v[180:183],v[80:83],a[28:31]
v_accvgpr_read_b32 v245,a53
v_accvgpr_read_b32 v246,a54
v_mfma_f32_16x16x32_bf16 a[24:27],v[184:187],v[96:99],a[24:27]
ds_read_b64_tr_b16 v[200:201],v42 offset:24576
v_accvgpr_read_b32 v247,a55
v_mfma_f32_16x16x32_bf16 a[56:59],v[184:187],v[100:103],a[56:59]
v_cvt_pk_bf16_f32 v4,v240,v241
v_cvt_pk_bf16_f32 v5,v242,v243
v_mfma_f32_16x16x32_bf16 a[88:91],v[184:187],v[104:107],a[88:91]
ds_read_b64_tr_b16 v[202:203],v42 offset:28672
v_cvt_pk_bf16_f32 v6,v244,v245
v_mfma_f32_16x16x32_bf16 a[120:123],v[184:187],v[108:111],a[120:123]
v_cvt_pk_bf16_f32 v7,v246,v247
s_waitcnt lgkmcnt(4)
v_mfma_f32_16x16x32_bf16 a[124:127],v[188:191],v[108:111],a[124:127]
ds_read_b64_tr_b16 v[204:205],v43 offset:24576
v_accvgpr_read_b32 v248,a80
v_mfma_f32_16x16x32_bf16 a[92:95],v[188:191],v[104:107],a[92:95]
buffer_store_dwordx4 v[4:7],v1,s[8:11],s93 offen offset:2048 sc1
v_mfma_f32_16x16x32_bf16 a[60:63],v[188:191],v[100:103],a[60:63]
ds_read_b64_tr_b16 v[206:207],v43 offset:28672
v_accvgpr_read_b32 v249,a81
v_mfma_f32_16x16x32_bf16 a[28:31],v[188:191],v[96:99],a[28:31]
v_accvgpr_read_b32 v250,a82
v_accvgpr_read_b32 v251,a83
v_mfma_f32_16x16x32_bf16 a[24:27],v[192:195],v[112:115],a[24:27]
ds_read_b64_tr_b16 v[176:177],v42 offset:32768
v_accvgpr_read_b32 v252,a84
v_mfma_f32_16x16x32_bf16 a[56:59],v[192:195],v[116:119],a[56:59]
v_accvgpr_read_b32 v253,a85
v_accvgpr_read_b32 v254,a86
v_mfma_f32_16x16x32_bf16 a[88:91],v[192:195],v[120:123],a[88:91]
ds_read_b64_tr_b16 v[178:179],v42 offset:36864
v_accvgpr_read_b32 v255,a87
v_mfma_f32_16x16x32_bf16 a[120:123],v[192:195],v[124:127],a[120:123]
v_cvt_pk_bf16_f32 v32,v248,v249
s_waitcnt lgkmcnt(4)
v_mfma_f32_16x16x32_bf16 a[124:127],v[196:199],v[124:127],a[124:127]
ds_read_b64_tr_b16 v[180:181],v43 offset:32768
v_cvt_pk_bf16_f32 v33,v250,v251
v_mfma_f32_16x16x32_bf16 a[92:95],v[196:199],v[120:123],a[92:95]
v_cvt_pk_bf16_f32 v34,v252,v253
v_cvt_pk_bf16_f32 v35,v254,v255
v_mfma_f32_16x16x32_bf16 a[60:63],v[196:199],v[116:119],a[60:63]
ds_read_b64_tr_b16 v[182:183],v43 offset:36864
v_accvgpr_read_b32 v240,a112
v_mfma_f32_16x16x32_bf16 a[28:31],v[196:199],v[112:115],a[28:31]
buffer_store_dwordx4 v[32:35],v1,s[8:11],s94 offen offset:2048 sc1
v_mfma_f32_16x16x32_bf16 a[24:27],v[200:203],v[128:131],a[24:27]
ds_read_b64_tr_b16 v[184:185],v42 offset:40960
v_accvgpr_read_b32 v241,a113
v_mfma_f32_16x16x32_bf16 a[56:59],v[200:203],v[132:135],a[56:59]
v_accvgpr_read_b32 v242,a114
v_accvgpr_read_b32 v243,a115
v_mfma_f32_16x16x32_bf16 a[88:91],v[200:203],v[136:139],a[88:91]
ds_read_b64_tr_b16 v[186:187],v42 offset:45056
v_accvgpr_read_b32 v244,a116
v_mfma_f32_16x16x32_bf16 a[120:123],v[200:203],v[140:143],a[120:123]
v_accvgpr_read_b32 v245,a117
s_waitcnt lgkmcnt(4)
v_mfma_f32_16x16x32_bf16 a[124:127],v[204:207],v[140:143],a[124:127]
ds_read_b64_tr_b16 v[188:189],v43 offset:40960
v_accvgpr_read_b32 v246,a118
v_mfma_f32_16x16x32_bf16 a[92:95],v[204:207],v[136:139],a[92:95]
v_accvgpr_read_b32 v247,a119
v_cvt_pk_bf16_f32 v4,v240,v241
v_mfma_f32_16x16x32_bf16 a[60:63],v[204:207],v[132:135],a[60:63]
ds_read_b64_tr_b16 v[190:191],v43 offset:45056
v_cvt_pk_bf16_f32 v5,v242,v243
v_mfma_f32_16x16x32_bf16 a[28:31],v[204:207],v[128:131],a[28:31]
v_cvt_pk_bf16_f32 v6,v244,v245
v_cvt_pk_bf16_f32 v7,v246,v247
v_mfma_f32_16x16x32_bf16 a[24:27],v[176:179],v[48:51],a[24:27]
ds_read_b64_tr_b16 v[192:193],v42 offset:49152
v_mfma_f32_16x16x32_bf16 a[56:59],v[176:179],v[52:55],a[56:59]
buffer_store_dwordx4 v[4:7],v1,s[8:11],s81 offen offset:2048 sc1
v_mfma_f32_16x16x32_bf16 a[88:91],v[176:179],v[56:59],a[88:91]
ds_read_b64_tr_b16 v[194:195],v42 offset:53248
v_mfma_f32_16x16x32_bf16 a[120:123],v[176:179],v[60:63],a[120:123]
s_waitcnt lgkmcnt(4)
v_mfma_f32_16x16x32_bf16 a[124:127],v[180:183],v[60:63],a[124:127]
ds_read_b64_tr_b16 v[196:197],v43 offset:49152
v_mfma_f32_16x16x32_bf16 a[92:95],v[180:183],v[56:59],a[92:95]
v_exp_f32 v23,v23
v_mfma_f32_16x16x32_bf16 a[60:63],v[180:183],v[52:55],a[60:63]
ds_read_b64_tr_b16 v[198:199],v43 offset:53248
v_add_f32 v20,1.0,v20
v_mfma_f32_16x16x32_bf16 a[28:31],v[180:183],v[48:51],a[28:31]
v_add_f32 v21,1.0,v21
v_add_f32 v22,1.0,v22
v_mfma_f32_16x16x32_bf16 a[24:27],v[184:187],v[64:67],a[24:27]
ds_read_b64_tr_b16 v[200:201],v42 offset:57344
v_add_f32 v23,1.0,v23
v_mfma_f32_16x16x32_bf16 a[56:59],v[184:187],v[68:71],a[56:59]
v_rcp_f32 v20,v20
v_mfma_f32_16x16x32_bf16 a[88:91],v[184:187],v[72:75],a[88:91]
ds_read_b64_tr_b16 v[202:203],v42 offset:61440
v_mfma_f32_16x16x32_bf16 a[120:123],v[184:187],v[76:79],a[120:123]
s_waitcnt lgkmcnt(4)
v_mfma_f32_16x16x32_bf16 a[124:127],v[188:191],v[76:79],a[124:127]
ds_read_b64_tr_b16 v[204:205],v43 offset:57344
v_mfma_f32_16x16x32_bf16 a[92:95],v[188:191],v[72:75],a[92:95]
v_rcp_f32 v21,v21
v_mfma_f32_16x16x32_bf16 a[60:63],v[188:191],v[68:71],a[60:63]
ds_read_b64_tr_b16 v[206:207],v43 offset:61440
v_mfma_f32_16x16x32_bf16 a[28:31],v[188:191],v[64:67],a[28:31]
v_rcp_f32 v22,v22
v_mfma_f32_16x16x32_bf16 a[24:27],v[192:195],v[208:211],a[24:27]
v_rcp_f32 v23,v23
v_mfma_f32_16x16x32_bf16 a[56:59],v[192:195],v[212:215],a[56:59]
v_mul_f32 v16,v16,v20
v_mul_f32 v17,v17,v21
v_mfma_f32_16x16x32_bf16 a[88:91],v[192:195],v[216:219],a[88:91]
v_mul_f32 v18,v18,v22
v_mul_f32 v19,v19,v23
v_mfma_f32_16x16x32_bf16 a[120:123],v[192:195],v[220:223],a[120:123]
v_accvgpr_write_b32 a140,v16
s_waitcnt lgkmcnt(2)
v_mfma_f32_16x16x32_bf16 a[124:127],v[196:199],v[220:223],a[124:127]
v_accvgpr_write_b32 a141,v17
v_accvgpr_write_b32 a142,v18
v_mfma_f32_16x16x32_bf16 a[92:95],v[196:199],v[216:219],a[92:95]
v_accvgpr_write_b32 a143,v19
v_accvgpr_read_b32 v8,a144
v_mfma_f32_16x16x32_bf16 a[60:63],v[196:199],v[212:215],a[60:63]
v_accvgpr_read_b32 v9,a145
v_accvgpr_read_b32 v10,a146
v_mfma_f32_16x16x32_bf16 a[28:31],v[196:199],v[208:211],a[28:31]
v_accvgpr_read_b32 v11,a147
v_mul_f32 v12,s59,v8
v_mfma_f32_16x16x32_bf16 a[24:27],v[200:203],v[224:227],a[24:27]
v_mul_f32 v13,s59,v9
v_mul_f32 v14,s59,v10
v_mfma_f32_16x16x32_bf16 a[56:59],v[200:203],v[228:231],a[56:59]
v_mul_f32 v15,s59,v11
v_mfma_f32_16x16x32_bf16 a[88:91],v[200:203],v[232:235],a[88:91]
v_exp_f32 v12,v12
v_mfma_f32_16x16x32_bf16 a[120:123],v[200:203],v[236:239],a[120:123]
s_waitcnt lgkmcnt(0)
v_mfma_f32_16x16x32_bf16 a[124:127],v[204:207],v[236:239],a[124:127]
v_exp_f32 v13,v13
v_mfma_f32_16x16x32_bf16 a[92:95],v[204:207],v[232:235],a[92:95]
v_exp_f32 v14,v14
v_mfma_f32_16x16x32_bf16 a[60:63],v[204:207],v[228:231],a[60:63]
v_exp_f32 v15,v15
v_mfma_f32_16x16x32_bf16 a[28:31],v[204:207],v[224:227],a[28:31]
v_accvgpr_read_b32 v248,a56
v_accvgpr_read_b32 v249,a57
v_accvgpr_read_b32 v250,a58
v_accvgpr_read_b32 v251,a59
s_nop 1
v_accvgpr_read_b32 v252,a60
v_accvgpr_read_b32 v253,a61
v_accvgpr_read_b32 v254,a62
v_accvgpr_read_b32 v255,a63
v_cvt_pk_bf16_f32 v32,v248,v249
v_cvt_pk_bf16_f32 v33,v250,v251
v_cvt_pk_bf16_f32 v34,v252,v253
v_cvt_pk_bf16_f32 v35,v254,v255
buffer_store_dwordx4 v[32:35],v1,s[8:11],s93 offen offset:3072 sc1
v_accvgpr_read_b32 v240,a88
v_accvgpr_read_b32 v241,a89
v_accvgpr_read_b32 v242,a90
v_accvgpr_read_b32 v243,a91
v_accvgpr_read_b32 v244,a92
v_accvgpr_read_b32 v245,a93
v_accvgpr_read_b32 v246,a94
v_accvgpr_read_b32 v247,a95
v_cvt_pk_bf16_f32 v4,v240,v241
v_cvt_pk_bf16_f32 v5,v242,v243
v_cvt_pk_bf16_f32 v6,v244,v245
v_cvt_pk_bf16_f32 v7,v246,v247
buffer_store_dwordx4 v[4:7],v1,s[8:11],s94 offen offset:3072 sc1
v_accvgpr_read_b32 v248,a120
v_accvgpr_read_b32 v249,a121
v_accvgpr_read_b32 v250,a122
v_accvgpr_read_b32 v251,a123
v_accvgpr_read_b32 v252,a124
v_accvgpr_read_b32 v253,a125
v_accvgpr_read_b32 v254,a126
v_accvgpr_read_b32 v255,a127
v_cvt_pk_bf16_f32 v32,v248,v249
v_cvt_pk_bf16_f32 v33,v250,v251
v_cvt_pk_bf16_f32 v34,v252,v253
v_cvt_pk_bf16_f32 v35,v254,v255
buffer_store_dwordx4 v[32:35],v1,s[8:11],s81 offen offset:3072 sc1
s_add_u32 s86,s83,0x4206000
s_add_u32 s55,s87,0x4206000
buffer_load_dword v47,v31,s[8:11],s55 offen sc1
s_waitcnt vmcnt(16)
v_accvgpr_read_b32 v208,a208
v_accvgpr_read_b32 v209,a209
v_accvgpr_read_b32 v210,a210
v_accvgpr_read_b32 v211,a211
s_waitcnt vmcnt(15)
v_accvgpr_read_b32 v212,a212
v_accvgpr_read_b32 v213,a213
v_accvgpr_read_b32 v214,a214
v_accvgpr_read_b32 v215,a215
s_waitcnt vmcnt(14)
v_accvgpr_read_b32 v216,a216
v_accvgpr_read_b32 v217,a217
v_accvgpr_read_b32 v218,a218
v_accvgpr_read_b32 v219,a219
s_waitcnt vmcnt(13)
v_accvgpr_read_b32 v220,a220
v_accvgpr_read_b32 v221,a221
v_accvgpr_read_b32 v222,a222
v_accvgpr_read_b32 v223,a223
v_accvgpr_read_b32 v80,a0
v_accvgpr_read_b32 v81,a1
v_accvgpr_read_b32 v82,a2
v_accvgpr_read_b32 v83,a3
v_accvgpr_read_b32 v84,a4
v_accvgpr_read_b32 v85,a5
v_accvgpr_read_b32 v86,a6
v_accvgpr_read_b32 v87,a7
v_accvgpr_read_b32 v88,a8
v_accvgpr_read_b32 v89,a9
v_accvgpr_read_b32 v90,a10
v_accvgpr_read_b32 v91,a11
v_accvgpr_read_b32 v92,a12
v_accvgpr_read_b32 v93,a13
v_accvgpr_read_b32 v94,a14
v_accvgpr_read_b32 v95,a15
v_accvgpr_read_b32 v96,a16
v_accvgpr_read_b32 v97,a17
v_accvgpr_read_b32 v98,a18
v_accvgpr_read_b32 v99,a19
v_accvgpr_read_b32 v100,a20
v_accvgpr_read_b32 v101,a21
v_accvgpr_read_b32 v102,a22
v_accvgpr_read_b32 v103,a23
v_accvgpr_read_b32 v104,a24
v_accvgpr_read_b32 v105,a25
v_accvgpr_read_b32 v106,a26
v_accvgpr_read_b32 v107,a27
v_accvgpr_read_b32 v108,a28
v_accvgpr_read_b32 v109,a29
v_accvgpr_read_b32 v110,a30
v_accvgpr_read_b32 v111,a31
v_permlane16_swap_b32 v208,v210
v_permlane16_swap_b32 v209,v211
v_permlane16_swap_b32 v212,v214
v_permlane16_swap_b32 v213,v215
v_permlane16_swap_b32 v216,v218
v_permlane16_swap_b32 v217,v219
v_permlane16_swap_b32 v220,v222
v_permlane16_swap_b32 v221,v223
s_waitcnt vmcnt(1)
s_barrier
buffer_store_dword v46,v0,s[8:11],s86 offen sc1
s_mov_b32 s56,14
s_mov_b32 s57,0
s_mov_b32 s91,0
s_mov_b32 s88,1
s_add_u32 s82,s82,0x3200000
s_waitcnt vmcnt(1)
v_cmp_eq_u32 vcc,s49,v47
s_nop 0
s_and_b32 s57,vcc_lo,s56
s_andn2_b32 s56,s56,s57
s_bitcmp1_b32 s57,1
s_cbranch_scc0 L_nla_1
s_add_u32 s86,s82,0
buffer_load_dwordx4 v[144:147],v1,s[8:11],s86 offen offset:0 sc1
buffer_load_dwordx4 v[148:151],v1,s[8:11],s86 offen offset:1024 sc1
buffer_load_dwordx4 v[152:155],v1,s[8:11],s86 offen offset:2048 sc1
buffer_load_dwordx4 v[156:159],v1,s[8:11],s86 offen offset:3072 sc1
L_nla_1:
s_bitcmp1_b32 s57,2
s_cbranch_scc0 L_nla_2
s_add_u32 s86,s82,4096
buffer_load_dwordx4 v[160:163],v1,s[8:11],s86 offen offset:0 sc1
buffer_load_dwordx4 v[164:167],v1,s[8:11],s86 offen offset:1024 sc1
buffer_load_dwordx4 v[168:171],v1,s[8:11],s86 offen offset:2048 sc1
buffer_load_dwordx4 v[172:175],v1,s[8:11],s86 offen offset:3072 sc1
L_nla_2:
s_bitcmp1_b32 s57,3
s_cbranch_scc0 L_nla_3
s_add_u32 s86,s82,8192
buffer_load_dwordx4 v[176:179],v1,s[8:11],s86 offen offset:0 sc1
buffer_load_dwordx4 v[180:183],v1,s[8:11],s86 offen offset:1024 sc1
buffer_load_dwordx4 v[184:187],v1,s[8:11],s86 offen offset:2048 sc1
buffer_load_dwordx4 v[188:191],v1,s[8:11],s86 offen offset:3072 sc1
L_nla_3:
v_add_f32 v12,1.0,v12
v_add_f32 v13,1.0,v13
v_add_f32 v14,1.0,v14
v_add_f32 v15,1.0,v15
v_rcp_f32 v12,v12
v_rcp_f32 v13,v13
v_rcp_f32 v14,v14
v_rcp_f32 v15,v15
v_mul_f32 v8,v8,v12
v_mul_f32 v9,v9,v13
v_mul_f32 v10,v10,v14
v_mul_f32 v11,v11,v15
v_accvgpr_write_b32 a144,v8
v_accvgpr_write_b32 a145,v9
v_accvgpr_write_b32 a146,v10
v_accvgpr_write_b32 a147,v11
v_accvgpr_read_b32 v16,a148
v_accvgpr_read_b32 v17,a149
v_accvgpr_read_b32 v18,a150
v_accvgpr_read_b32 v19,a151
v_mul_f32 v20,s59,v16
v_mul_f32 v21,s59,v17
v_mul_f32 v22,s59,v18
v_mul_f32 v23,s59,v19
v_exp_f32 v20,v20
v_exp_f32 v21,v21
v_exp_f32 v22,v22
v_exp_f32 v23,v23
v_add_f32 v20,1.0,v20
v_add_f32 v21,1.0,v21
v_add_f32 v22,1.0,v22
v_add_f32 v23,1.0,v23
v_rcp_f32 v20,v20
v_rcp_f32 v21,v21
v_rcp_f32 v22,v22
v_rcp_f32 v23,v23
v_mul_f32 v16,v16,v20
v_mul_f32 v17,v17,v21
v_mul_f32 v18,v18,v22
v_mul_f32 v19,v19,v23
v_accvgpr_write_b32 a148,v16
v_accvgpr_write_b32 a149,v17
v_accvgpr_write_b32 a150,v18
v_accvgpr_write_b32 a151,v19
v_accvgpr_read_b32 v8,a152
v_accvgpr_read_b32 v9,a153
v_accvgpr_read_b32 v10,a154
v_accvgpr_read_b32 v11,a155
v_mul_f32 v12,s59,v8
v_mul_f32 v13,s59,v9
v_mul_f32 v14,s59,v10
v_mul_f32 v15,s59,v11
v_exp_f32 v12,v12
v_exp_f32 v13,v13
v_exp_f32 v14,v14
v_exp_f32 v15,v15
v_add_f32 v12,1.0,v12
v_add_f32 v13,1.0,v13
v_add_f32 v14,1.0,v14
v_add_f32 v15,1.0,v15
v_rcp_f32 v12,v12
v_rcp_f32 v13,v13
v_rcp_f32 v14,v14
v_rcp_f32 v15,v15
v_mul_f32 v8,v8,v12
v_mul_f32 v9,v9,v13
v_mul_f32 v10,v10,v14
v_mul_f32 v11,v11,v15
v_accvgpr_write_b32 a152,v8
v_accvgpr_write_b32 a153,v9
v_accvgpr_write_b32 a154,v10
v_accvgpr_write_b32 a155,v11
v_accvgpr_read_b32 v16,a156
v_accvgpr_read_b32 v17,a157
v_accvgpr_read_b32 v18,a158
v_accvgpr_read_b32 v19,a159
v_mul_f32 v20,s59,v16
v_mul_f32 v21,s59,v17
v_mul_f32 v22,s59,v18
v_mul_f32 v23,s59,v19
v_exp_f32 v20,v20
v_exp_f32 v21,v21
v_exp_f32 v22,v22
v_exp_f32 v23,v23
v_add_f32 v20,1.0,v20
v_add_f32 v21,1.0,v21
v_add_f32 v22,1.0,v22
v_add_f32 v23,1.0,v23
v_rcp_f32 v20,v20
v_rcp_f32 v21,v21
v_rcp_f32 v22,v22
v_rcp_f32 v23,v23
v_mul_f32 v16,v16,v20
v_mul_f32 v17,v17,v21
v_mul_f32 v18,v18,v22
v_mul_f32 v19,v19,v23
v_accvgpr_write_b32 a156,v16
v_accvgpr_write_b32 a157,v17
v_accvgpr_write_b32 a158,v18
v_accvgpr_write_b32 a159,v19
v_accvgpr_read_b32 v48,a128
v_accvgpr_read_b32 v49,a129
v_accvgpr_read_b32 v50,a130
v_accvgpr_read_b32 v51,a131
v_accvgpr_read_b32 v52,a132
v_accvgpr_read_b32 v53,a133
v_accvgpr_read_b32 v54,a134
v_accvgpr_read_b32 v55,a135
v_accvgpr_read_b32 v56,a136
v_accvgpr_read_b32 v57,a137
v_accvgpr_read_b32 v58,a138
v_accvgpr_read_b32 v59,a139
v_accvgpr_read_b32 v60,a140
v_accvgpr_read_b32 v61,a141
v_accvgpr_read_b32 v62,a142
v_accvgpr_read_b32 v63,a143
v_accvgpr_read_b32 v64,a144
v_accvgpr_read_b32 v65,a145
v_accvgpr_read_b32 v66,a146
v_accvgpr_read_b32 v67,a147
v_accvgpr_read_b32 v68,a148
v_accvgpr_read_b32 v69,a149
v_accvgpr_read_b32 v70,a150
v_accvgpr_read_b32 v71,a151
v_accvgpr_read_b32 v72,a152
v_accvgpr_read_b32 v73,a153
v_accvgpr_read_b32 v74,a154
v_accvgpr_read_b32 v75,a155
v_accvgpr_read_b32 v76,a156
v_accvgpr_read_b32 v77,a157
v_accvgpr_read_b32 v78,a158
v_accvgpr_read_b32 v79,a159
v_lshlrev_b32 v112,16,v208
v_and_b32 v113,s90,v208
v_lshlrev_b32 v114,16,v209
v_and_b32 v115,s90,v209
v_lshlrev_b32 v116,16,v210
v_and_b32 v117,s90,v210
v_lshlrev_b32 v118,16,v211
v_and_b32 v119,s90,v211
v_lshlrev_b32 v120,16,v212
v_and_b32 v121,s90,v212
v_lshlrev_b32 v122,16,v213
v_and_b32 v123,s90,v213
v_lshlrev_b32 v124,16,v214
v_and_b32 v125,s90,v214
v_lshlrev_b32 v126,16,v215
v_and_b32 v127,s90,v215
v_lshlrev_b32 v128,16,v216
v_and_b32 v129,s90,v216
v_lshlrev_b32 v130,16,v217
v_and_b32 v131,s90,v217
v_lshlrev_b32 v132,16,v218
v_and_b32 v133,s90,v218
v_lshlrev_b32 v134,16,v219
v_and_b32 v135,s90,v219
v_lshlrev_b32 v136,16,v220
v_and_b32 v137,s90,v220
v_lshlrev_b32 v138,16,v221
v_and_b32 v139,s90,v221
v_lshlrev_b32 v140,16,v222
v_and_b32 v141,s90,v222
v_lshlrev_b32 v142,16,v223
v_and_b32 v143,s90,v223
L_fin_loop:
s_cmp_eq_u32 s56,0
s_cbranch_scc1 L_fin_nopoll
buffer_load_dword v47,v31,s[8:11],s55 offen sc1
L_fin_nopoll:
s_waitcnt vmcnt(0)
s_or_b32 s91,s91,s57
s_lshl_b32 s86,s88,1
s_and_b32 s86,s86,s91
s_andn2_b32 s86,s86,s88
s_bitcmp1_b32 s86,1
s_cbranch_scc0 L_na_1
v_lshlrev_b32 v192,16,v144
v_and_b32 v193,s90,v144
v_pk_add_f32 v[80:81],v[80:81],v[192:193]
v_lshlrev_b32 v194,16,v145
v_and_b32 v195,s90,v145
v_pk_add_f32 v[82:83],v[82:83],v[194:195]
v_lshlrev_b32 v196,16,v146
v_and_b32 v197,s90,v146
v_pk_add_f32 v[84:85],v[84:85],v[196:197]
v_lshlrev_b32 v198,16,v147
v_and_b32 v199,s90,v147
v_pk_add_f32 v[86:87],v[86:87],v[198:199]
v_lshlrev_b32 v192,16,v148
v_and_b32 v193,s90,v148
v_pk_add_f32 v[88:89],v[88:89],v[192:193]
v_lshlrev_b32 v194,16,v149
v_and_b32 v195,s90,v149
v_pk_add_f32 v[90:91],v[90:91],v[194:195]
v_lshlrev_b32 v196,16,v150
v_and_b32 v197,s90,v150
v_pk_add_f32 v[92:93],v[92:93],v[196:197]
v_lshlrev_b32 v198,16,v151
v_and_b32 v199,s90,v151
v_pk_add_f32 v[94:95],v[94:95],v[198:199]
v_lshlrev_b32 v192,16,v152
v_and_b32 v193,s90,v152
v_pk_add_f32 v[96:97],v[96:97],v[192:193]
v_lshlrev_b32 v194,16,v153
v_and_b32 v195,s90,v153
v_pk_add_f32 v[98:99],v[98:99],v[194:195]
v_lshlrev_b32 v196,16,v154
v_and_b32 v197,s90,v154
v_pk_add_f32 v[100:101],v[100:101],v[196:197]
v_lshlrev_b32 v198,16,v155
v_and_b32 v199,s90,v155
v_pk_add_f32 v[102:103],v[102:103],v[198:199]
v_lshlrev_b32 v192,16,v156
v_and_b32 v193,s90,v156
v_pk_add_f32 v[104:105],v[104:105],v[192:193]
v_lshlrev_b32 v194,16,v157
v_and_b32 v195,s90,v157
v_pk_add_f32 v[106:107],v[106:107],v[194:195]
v_lshlrev_b32 v196,16,v158
v_and_b32 v197,s90,v158
v_pk_add_f32 v[108:109],v[108:109],v[196:197]
v_lshlrev_b32 v198,16,v159
v_and_b32 v199,s90,v159
v_pk_add_f32 v[110:111],v[110:111],v[198:199]
s_bitset1_b32 s88,1
L_na_1:
s_lshl_b32 s86,s88,1
s_and_b32 s86,s86,s91
s_andn2_b32 s86,s86,s88
s_bitcmp1_b32 s86,2
s_cbranch_scc0 L_na_2
v_lshlrev_b32 v192,16,v160
v_and_b32 v193,s90,v160
v_pk_add_f32 v[80:81],v[80:81],v[192:193]
v_lshlrev_b32 v194,16,v161
v_and_b32 v195,s90,v161
v_pk_add_f32 v[82:83],v[82:83],v[194:195]
v_lshlrev_b32 v196,16,v162
v_and_b32 v197,s90,v162
v_pk_add_f32 v[84:85],v[84:85],v[196:197]
v_lshlrev_b32 v198,16,v163
v_and_b32 v199,s90,v163
v_pk_add_f32 v[86:87],v[86:87],v[198:199]
v_lshlrev_b32 v192,16,v164
v_and_b32 v193,s90,v164
v_pk_add_f32 v[88:89],v[88:89],v[192:193]
v_lshlrev_b32 v194,16,v165
v_and_b32 v195,s90,v165
v_pk_add_f32 v[90:91],v[90:91],v[194:195]
v_lshlrev_b32 v196,16,v166
v_and_b32 v197,s90,v166
v_pk_add_f32 v[92:93],v[92:93],v[196:197]
v_lshlrev_b32 v198,16,v167
v_and_b32 v199,s90,v167
v_pk_add_f32 v[94:95],v[94:95],v[198:199]
v_lshlrev_b32 v192,16,v168
v_and_b32 v193,s90,v168
v_pk_add_f32 v[96:97],v[96:97],v[192:193]
v_lshlrev_b32 v194,16,v169
v_and_b32 v195,s90,v169
v_pk_add_f32 v[98:99],v[98:99],v[194:195]
v_lshlrev_b32 v196,16,v170
v_and_b32 v197,s90,v170
v_pk_add_f32 v[100:101],v[100:101],v[196:197]
v_lshlrev_b32 v198,16,v171
v_and_b32 v199,s90,v171
v_pk_add_f32 v[102:103],v[102:103],v[198:199]
v_lshlrev_b32 v192,16,v172
v_and_b32 v193,s90,v172
v_pk_add_f32 v[104:105],v[104:105],v[192:193]
v_lshlrev_b32 v194,16,v173
v_and_b32 v195,s90,v173
v_pk_add_f32 v[106:107],v[106:107],v[194:195]
v_lshlrev_b32 v196,16,v174
v_and_b32 v197,s90,v174
v_pk_add_f32 v[108:109],v[108:109],v[196:197]
v_lshlrev_b32 v198,16,v175
v_and_b32 v199,s90,v175
v_pk_add_f32 v[110:111],v[110:111],v[198:199]
s_bitset1_b32 s88,2
L_na_2:
s_lshl_b32 s86,s88,1
s_and_b32 s86,s86,s91
s_andn2_b32 s86,s86,s88
s_bitcmp1_b32 s86,3
s_cbranch_scc0 L_na_3
v_lshlrev_b32 v192,16,v176
v_and_b32 v193,s90,v176
v_pk_add_f32 v[80:81],v[80:81],v[192:193]
v_lshlrev_b32 v194,16,v177
v_and_b32 v195,s90,v177
v_pk_add_f32 v[82:83],v[82:83],v[194:195]
v_lshlrev_b32 v196,16,v178
v_and_b32 v197,s90,v178
v_pk_add_f32 v[84:85],v[84:85],v[196:197]
v_lshlrev_b32 v198,16,v179
v_and_b32 v199,s90,v179
v_pk_add_f32 v[86:87],v[86:87],v[198:199]
v_lshlrev_b32 v192,16,v180
v_and_b32 v193,s90,v180
v_pk_add_f32 v[88:89],v[88:89],v[192:193]
v_lshlrev_b32 v194,16,v181
v_and_b32 v195,s90,v181
v_pk_add_f32 v[90:91],v[90:91],v[194:195]
v_lshlrev_b32 v196,16,v182
v_and_b32 v197,s90,v182
v_pk_add_f32 v[92:93],v[92:93],v[196:197]
v_lshlrev_b32 v198,16,v183
v_and_b32 v199,s90,v183
v_pk_add_f32 v[94:95],v[94:95],v[198:199]
v_lshlrev_b32 v192,16,v184
v_and_b32 v193,s90,v184
v_pk_add_f32 v[96:97],v[96:97],v[192:193]
v_lshlrev_b32 v194,16,v185
v_and_b32 v195,s90,v185
v_pk_add_f32 v[98:99],v[98:99],v[194:195]
v_lshlrev_b32 v196,16,v186
v_and_b32 v197,s90,v186
v_pk_add_f32 v[100:101],v[100:101],v[196:197]
v_lshlrev_b32 v198,16,v187
v_and_b32 v199,s90,v187
v_pk_add_f32 v[102:103],v[102:103],v[198:199]
v_lshlrev_b32 v192,16,v188
v_and_b32 v193,s90,v188
v_pk_add_f32 v[104:105],v[104:105],v[192:193]
v_lshlrev_b32 v194,16,v189
v_and_b32 v195,s90,v189
v_pk_add_f32 v[106:107],v[106:107],v[194:195]
v_lshlrev_b32 v196,16,v190
v_and_b32 v197,s90,v190
v_pk_add_f32 v[108:109],v[108:109],v[196:197]
v_lshlrev_b32 v198,16,v191
v_and_b32 v199,s90,v191
v_pk_add_f32 v[110:111],v[110:111],v[198:199]
s_bitset1_b32 s88,3
L_na_3:
v_cmp_eq_u32 vcc,s49,v47
s_nop 0
s_and_b32 s57,vcc_lo,s56
s_andn2_b32 s56,s56,s57
s_bitcmp1_b32 s57,1
s_cbranch_scc0 L_nlb_1
s_add_u32 s86,s82,0
buffer_load_dwordx4 v[144:147],v1,s[8:11],s86 offen offset:0 sc1
buffer_load_dwordx4 v[148:151],v1,s[8:11],s86 offen offset:1024 sc1
buffer_load_dwordx4 v[152:155],v1,s[8:11],s86 offen offset:2048 sc1
buffer_load_dwordx4 v[156:159],v1,s[8:11],s86 offen offset:3072 sc1
L_nlb_1:
s_bitcmp1_b32 s57,2
s_cbranch_scc0 L_nlb_2
s_add_u32 s86,s82,4096
buffer_load_dwordx4 v[160:163],v1,s[8:11],s86 offen offset:0 sc1
buffer_load_dwordx4 v[164:167],v1,s[8:11],s86 offen offset:1024 sc1
buffer_load_dwordx4 v[168:171],v1,s[8:11],s86 offen offset:2048 sc1
buffer_load_dwordx4 v[172:175],v1,s[8:11],s86 offen offset:3072 sc1
L_nlb_2:
s_bitcmp1_b32 s57,3
s_cbranch_scc0 L_nlb_3
s_add_u32 s86,s82,8192
buffer_load_dwordx4 v[176:179],v1,s[8:11],s86 offen offset:0 sc1
buffer_load_dwordx4 v[180:183],v1,s[8:11],s86 offen offset:1024 sc1
buffer_load_dwordx4 v[184:187],v1,s[8:11],s86 offen offset:2048 sc1
buffer_load_dwordx4 v[188:191],v1,s[8:11],s86 offen offset:3072 sc1
L_nlb_3:
s_add_u32 s100,s100,1
s_cmp_gt_u32 s100,524288
s_cbranch_scc1 L_fin_done
s_cmp_lg_u32 s88,15
s_cbranch_scc1 L_fin_loop
L_fin_done:
v_pk_fma_f32 v[80:81],v[80:81],v[48:49],v[112:113]
v_pk_fma_f32 v[82:83],v[82:83],v[50:51],v[114:115]
v_pk_fma_f32 v[84:85],v[84:85],v[52:53],v[116:117]
v_pk_fma_f32 v[86:87],v[86:87],v[54:55],v[118:119]
v_cvt_pk_bf16_f32 v192,v80,v81
v_cvt_pk_bf16_f32 v193,v82,v83
v_cvt_pk_bf16_f32 v194,v84,v85
v_cvt_pk_bf16_f32 v195,v86,v87
s_nop 0
v_permlane16_swap_b32 v192,v194
v_permlane16_swap_b32 v193,v195
buffer_store_dwordx4 v[192:195],v44,s[40:43],s54 offen offset:0 sc1
v_pk_fma_f32 v[88:89],v[88:89],v[56:57],v[120:121]
v_pk_fma_f32 v[90:91],v[90:91],v[58:59],v[122:123]
v_pk_fma_f32 v[92:93],v[92:93],v[60:61],v[124:125]
v_pk_fma_f32 v[94:95],v[94:95],v[62:63],v[126:127]
v_cvt_pk_bf16_f32 v196,v88,v89
v_cvt_pk_bf16_f32 v197,v90,v91
v_cvt_pk_bf16_f32 v198,v92,v93
v_cvt_pk_bf16_f32 v199,v94,v95
s_nop 0
v_permlane16_swap_b32 v196,v198
v_permlane16_swap_b32 v197,v199
buffer_store_dwordx4 v[196:199],v44,s[40:43],s54 offen offset:64 sc1
v_pk_fma_f32 v[96:97],v[96:97],v[64:65],v[128:129]
v_pk_fma_f32 v[98:99],v[98:99],v[66:67],v[130:131]
v_pk_fma_f32 v[100:101],v[100:101],v[68:69],v[132:133]
v_pk_fma_f32 v[102:103],v[102:103],v[70:71],v[134:135]
v_cvt_pk_bf16_f32 v200,v96,v97
v_cvt_pk_bf16_f32 v201,v98,v99
v_cvt_pk_bf16_f32 v202,v100,v101
v_cvt_pk_bf16_f32 v203,v102,v103
s_nop 0
v_permlane16_swap_b32 v200,v202
v_permlane16_swap_b32 v201,v203
buffer_store_dwordx4 v[200:203],v44,s[40:43],s54 offen offset:128 sc1
v_pk_fma_f32 v[104:105],v[104:105],v[72:73],v[136:137]
v_pk_fma_f32 v[106:107],v[106:107],v[74:75],v[138:139]
v_pk_fma_f32 v[108:109],v[108:109],v[76:77],v[140:141]
v_pk_fma_f32 v[110:111],v[110:111],v[78:79],v[142:143]
v_cvt_pk_bf16_f32 v204,v104,v105
v_cvt_pk_bf16_f32 v205,v106,v107
v_cvt_pk_bf16_f32 v206,v108,v109
v_cvt_pk_bf16_f32 v207,v110,v111
s_nop 0
v_permlane16_swap_b32 v204,v206
v_permlane16_swap_b32 v205,v207
buffer_store_dwordx4 v[204:207],v44,s[40:43],s54 offen offset:192 sc1
L_end:
s_endpgm
L_spin_h:
buffer_load_dword v47,v30,s[8:11],s85 offen sc1
s_waitcnt vmcnt(0)
v_cmp_ne_u32 vcc,s49,v47
s_add_u32 s100,s100,1
s_cmp_gt_u32 s100,524288
s_cbranch_scc1 L_ok_h
s_nop 4
s_cbranch_vccnz L_spin_h
s_branch L_ok_h
L_spin_o:
buffer_load_dword v47,v30,s[8:11],s89 offen sc1
s_waitcnt vmcnt(0)
v_cmp_ne_u32 vcc,s49,v47
s_add_u32 s100,s100,1
s_cmp_gt_u32 s100,524288
s_cbranch_scc1 L_ok_o
s_nop 4
s_cbranch_vccnz L_spin_o
s_branch L_ok_o
L_spin_bp:
buffer_load_dword v47,v31,s[8:11],s54 offen sc1
s_waitcnt vmcnt(0)
v_cmp_ne_u32 vcc,s49,v47
s_add_u32 s100,s100,1
s_cmp_gt_u32 s100,524288
s_cbranch_scc1 L_ok_bp
s_nop 4
s_cbranch_vccnz L_spin_bp
s_branch L_ok_bp
L_fallback:
s_waitcnt vmcnt(0) lgkmcnt(0)
s_barrier
v_and_b32 v24,15,v2
v_lshrrev_b32 v25,4,v2
v_bfe_u32 v26,v2,2,2
v_lshrrev_b32 v27,1,v25
v_xor_b32 v27,v27,v26
v_lshlrev_b32 v24,6,v24
v_lshl_add_u32 v24,v27,4,v24
v_and_b32 v27,1,v25
v_lshl_add_u32 v13,v27,3,v24
v_xor_b32 v22,32,v13
v_mov_b32 v64,0xff800000
v_mov_b32 v65,0xff800000
v_mov_b32 v66,0xff800000
v_mov_b32 v67,0xff800000
s_mov_b32 s51,s50
s_mov_b32 s55,8
L_fb_loop:
s_add_u32 m0,s91,0
s_nop 0
buffer_load_dwordx4 v11,s[20:23],s51 offen offset:0 lds
s_add_u32 m0,s91,4032
s_nop 0
buffer_load_dwordx4 v11,s[20:23],s51 offen offset:64 lds
s_add_u32 m0,s91,8064
s_nop 0
buffer_load_dwordx4 v11,s[20:23],s51 offen offset:128 lds
s_add_u32 m0,s91,12096
s_nop 0
buffer_load_dwordx4 v11,s[20:23],s51 offen offset:192 lds
s_add_u32 s51,s51,0x4000
s_waitcnt vmcnt(0)
s_barrier
ds_read_b64 a[128:129],v13 offset:0
ds_read_b64 a[130:131],v22 offset:0
ds_read_b64 a[132:133],v13 offset:4096
ds_read_b64 a[134:135],v22 offset:4096
ds_read_b64 a[136:137],v13 offset:8192
ds_read_b64 a[138:139],v22 offset:8192
ds_read_b64 a[140:141],v13 offset:12288
ds_read_b64 a[142:143],v22 offset:12288
ds_read_b64 a[144:145],v13 offset:1024
ds_read_b64 a[146:147],v22 offset:1024
ds_read_b64 a[148:149],v13 offset:5120
ds_read_b64 a[150:151],v22 offset:5120
ds_read_b64 a[152:153],v13 offset:9216
ds_read_b64 a[154:155],v22 offset:9216
ds_read_b64 a[156:157],v13 offset:13312
ds_read_b64 a[158:159],v22 offset:13312
s_waitcnt lgkmcnt(14)
v_mfma_f32_16x16x32_bf16 v[144:147],a[128:131],v[80:83],0
v_mfma_f32_16x16x32_bf16 v[148:151],a[128:131],v[96:99],0
v_mfma_f32_16x16x32_bf16 v[152:155],a[128:131],v[112:115],0
v_mfma_f32_16x16x32_bf16 v[156:159],a[128:131],v[128:131],0
s_waitcnt lgkmcnt(12)
v_mfma_f32_16x16x32_bf16 v[144:147],a[132:135],v[84:87],v[144:147]
v_mfma_f32_16x16x32_bf16 v[148:151],a[132:135],v[100:103],v[148:151]
v_mfma_f32_16x16x32_bf16 v[152:155],a[132:135],v[116:119],v[152:155]
v_mfma_f32_16x16x32_bf16 v[156:159],a[132:135],v[132:135],v[156:159]
s_waitcnt lgkmcnt(10)
v_mfma_f32_16x16x32_bf16 v[144:147],a[136:139],v[88:91],v[144:147]
v_mfma_f32_16x16x32_bf16 v[148:151],a[136:139],v[104:107],v[148:151]
v_mfma_f32_16x16x32_bf16 v[152:155],a[136:139],v[120:123],v[152:155]
v_mfma_f32_16x16x32_bf16 v[156:159],a[136:139],v[136:139],v[156:159]
s_waitcnt lgkmcnt(8)
v_mfma_f32_16x16x32_bf16 v[144:147],a[140:143],v[92:95],v[144:147]
v_mfma_f32_16x16x32_bf16 v[148:151],a[140:143],v[108:111],v[148:151]
v_mfma_f32_16x16x32_bf16 v[152:155],a[140:143],v[124:127],v[152:155]
v_mfma_f32_16x16x32_bf16 v[156:159],a[140:143],v[140:143],v[156:159]
s_waitcnt lgkmcnt(6)
v_mfma_f32_16x16x32_bf16 v[160:163],a[144:147],v[80:83],0
v_mfma_f32_16x16x32_bf16 v[164:167],a[144:147],v[96:99],0
v_mfma_f32_16x16x32_bf16 v[168:171],a[144:147],v[112:115],0
v_mfma_f32_16x16x32_bf16 v[172:175],a[144:147],v[128:131],0
s_waitcnt lgkmcnt(4)
v_mfma_f32_16x16x32_bf16 v[160:163],a[148:151],v[84:87],v[160:163]
v_mfma_f32_16x16x32_bf16 v[164:167],a[148:151],v[100:103],v[164:167]
v_mfma_f32_16x16x32_bf16 v[168:171],a[148:151],v[116:119],v[168:171]
v_mfma_f32_16x16x32_bf16 v[172:175],a[148:151],v[132:135],v[172:175]
s_waitcnt lgkmcnt(2)
v_mfma_f32_16x16x32_bf16 v[160:163],a[152:155],v[88:91],v[160:163]
v_mfma_f32_16x16x32_bf16 v[164:167],a[152:155],v[104:107],v[164:167]
v_mfma_f32_16x16x32_bf16 v[168:171],a[152:155],v[120:123],v[168:171]
v_mfma_f32_16x16x32_bf16 v[172:175],a[152:155],v[136:139],v[172:175]
s_waitcnt lgkmcnt(0)
v_mfma_f32_16x16x32_bf16 v[160:163],a[156:159],v[92:95],v[160:163]
v_mfma_f32_16x16x32_bf16 v[164:167],a[156:159],v[108:111],v[164:167]
v_mfma_f32_16x16x32_bf16 v[168:171],a[156:159],v[124:127],v[168:171]
v_mfma_f32_16x16x32_bf16 v[172:175],a[156:159],v[140:143],v[172:175]
s_nop 7
ds_read_b64 a[128:129],v13 offset:2048
ds_read_b64 a[130:131],v22 offset:2048
ds_read_b64 a[132:133],v13 offset:6144
ds_read_b64 a[134:135],v22 offset:6144
ds_read_b64 a[136:137],v13 offset:10240
ds_read_b64 a[138:139],v22 offset:10240
ds_read_b64 a[140:141],v13 offset:14336
ds_read_b64 a[142:143],v22 offset:14336
ds_read_b64 a[144:145],v13 offset:3072
ds_read_b64 a[146:147],v22 offset:3072
ds_read_b64 a[148:149],v13 offset:7168
ds_read_b64 a[150:151],v22 offset:7168
ds_read_b64 a[152:153],v13 offset:11264
ds_read_b64 a[154:155],v22 offset:11264
ds_read_b64 a[156:157],v13 offset:15360
ds_read_b64 a[158:159],v22 offset:15360
s_waitcnt lgkmcnt(14)
v_mfma_f32_16x16x32_bf16 v[176:179],a[128:131],v[80:83],0
v_mfma_f32_16x16x32_bf16 v[180:183],a[128:131],v[96:99],0
v_mfma_f32_16x16x32_bf16 v[184:187],a[128:131],v[112:115],0
v_mfma_f32_16x16x32_bf16 v[188:191],a[128:131],v[128:131],0
s_waitcnt lgkmcnt(12)
v_mfma_f32_16x16x32_bf16 v[176:179],a[132:135],v[84:87],v[176:179]
v_mfma_f32_16x16x32_bf16 v[180:183],a[132:135],v[100:103],v[180:183]
v_mfma_f32_16x16x32_bf16 v[184:187],a[132:135],v[116:119],v[184:187]
v_mfma_f32_16x16x32_bf16 v[188:191],a[132:135],v[132:135],v[188:191]
s_waitcnt lgkmcnt(10)
v_mfma_f32_16x16x32_bf16 v[176:179],a[136:139],v[88:91],v[176:179]
v_mfma_f32_16x16x32_bf16 v[180:183],a[136:139],v[104:107],v[180:183]
v_mfma_f32_16x16x32_bf16 v[184:187],a[136:139],v[120:123],v[184:187]
v_mfma_f32_16x16x32_bf16 v[188:191],a[136:139],v[136:139],v[188:191]
s_waitcnt lgkmcnt(8)
v_mfma_f32_16x16x32_bf16 v[176:179],a[140:143],v[92:95],v[176:179]
v_mfma_f32_16x16x32_bf16 v[180:183],a[140:143],v[108:111],v[180:183]
v_mfma_f32_16x16x32_bf16 v[184:187],a[140:143],v[124:127],v[184:187]
v_mfma_f32_16x16x32_bf16 v[188:191],a[140:143],v[140:143],v[188:191]
s_waitcnt lgkmcnt(6)
v_mfma_f32_16x16x32_bf16 v[192:195],a[144:147],v[80:83],0
v_mfma_f32_16x16x32_bf16 v[196:199],a[144:147],v[96:99],0
v_mfma_f32_16x16x32_bf16 v[200:203],a[144:147],v[112:115],0
v_mfma_f32_16x16x32_bf16 v[204:207],a[144:147],v[128:131],0
s_waitcnt lgkmcnt(4)
v_mfma_f32_16x16x32_bf16 v[192:195],a[148:151],v[84:87],v[192:195]
v_mfma_f32_16x16x32_bf16 v[196:199],a[148:151],v[100:103],v[196:199]
v_mfma_f32_16x16x32_bf16 v[200:203],a[148:151],v[116:119],v[200:203]
v_mfma_f32_16x16x32_bf16 v[204:207],a[148:151],v[132:135],v[204:207]
s_waitcnt lgkmcnt(2)
v_mfma_f32_16x16x32_bf16 v[192:195],a[152:155],v[88:91],v[192:195]
v_mfma_f32_16x16x32_bf16 v[196:199],a[152:155],v[104:107],v[196:199]
v_mfma_f32_16x16x32_bf16 v[200:203],a[152:155],v[120:123],v[200:203]
v_mfma_f32_16x16x32_bf16 v[204:207],a[152:155],v[136:139],v[204:207]
s_waitcnt lgkmcnt(0)
v_mfma_f32_16x16x32_bf16 v[192:195],a[156:159],v[92:95],v[192:195]
v_mfma_f32_16x16x32_bf16 v[196:199],a[156:159],v[108:111],v[196:199]
v_mfma_f32_16x16x32_bf16 v[200:203],a[156:159],v[124:127],v[200:203]
v_mfma_f32_16x16x32_bf16 v[204:207],a[156:159],v[140:143],v[204:207]
s_nop 7
v_max3_f32 v64,v64,v144,v145
v_max3_f32 v64,v64,v146,v147
v_max3_f32 v65,v65,v148,v149
v_max3_f32 v65,v65,v150,v151
v_max3_f32 v66,v66,v152,v153
v_max3_f32 v66,v66,v154,v155
v_max3_f32 v67,v67,v156,v157
v_max3_f32 v67,v67,v158,v159
v_max3_f32 v64,v64,v160,v161
v_max3_f32 v64,v64,v162,v163
v_max3_f32 v65,v65,v164,v165
v_max3_f32 v65,v65,v166,v167
v_max3_f32 v66,v66,v168,v169
v_max3_f32 v66,v66,v170,v171
v_max3_f32 v67,v67,v172,v173
v_max3_f32 v67,v67,v174,v175
v_max3_f32 v64,v64,v176,v177
v_max3_f32 v64,v64,v178,v179
v_max3_f32 v65,v65,v180,v181
v_max3_f32 v65,v65,v182,v183
v_max3_f32 v66,v66,v184,v185
v_max3_f32 v66,v66,v186,v187
v_max3_f32 v67,v67,v188,v189
v_max3_f32 v67,v67,v190,v191
v_max3_f32 v64,v64,v192,v193
v_max3_f32 v64,v64,v194,v195
v_max3_f32 v65,v65,v196,v197
v_max3_f32 v65,v65,v198,v199
v_max3_f32 v66,v66,v200,v201
v_max3_f32 v66,v66,v202,v203
v_max3_f32 v67,v67,v204,v205
v_max3_f32 v67,v67,v206,v207
s_barrier
s_sub_u32 s55,s55,1
s_cmp_lg_u32 s55,0
s_cbranch_scc1 L_fb_loop
v_mov_b32 v68,v64
v_mov_b32 v69,v65
v_mov_b32 v70,v66
v_mov_b32 v71,v67
v_permlane16_swap_b32 v64,v68
v_permlane16_swap_b32 v65,v69
v_permlane16_swap_b32 v66,v70
v_permlane16_swap_b32 v67,v71
v_max_f32 v64,v64,v68
v_max_f32 v65,v65,v69
v_max_f32 v66,v66,v70
v_max_f32 v67,v67,v71
v_mov_b32 v68,v64
v_mov_b32 v69,v65
v_mov_b32 v70,v66
v_mov_b32 v71,v67
v_permlane32_swap_b32 v64,v68
v_permlane32_swap_b32 v65,v69
v_permlane32_swap_b32 v66,v70
v_permlane32_swap_b32 v67,v71
v_max_f32 v64,v64,v68
v_max_f32 v65,v65,v69
v_max_f32 v66,v66,v70
v_max_f32 v67,v67,v71
s_mov_b32 s51,s50
s_add_u32 m0,s91,0
s_nop 0
buffer_load_dwordx4 v11,s[20:23],s51 offen offset:0 lds
s_add_u32 m0,s91,4032
s_nop 0
buffer_load_dwordx4 v11,s[20:23],s51 offen offset:64 lds
s_add_u32 m0,s91,8064
s_nop 0
buffer_load_dwordx4 v11,s[20:23],s51 offen offset:128 lds
s_add_u32 m0,s91,12096
s_nop 0
buffer_load_dwordx4 v11,s[20:23],s51 offen offset:192 lds
s_add_u32 m0,s91,16384
s_nop 0
buffer_load_dwordx4 v12,s[24:27],s51 offen offset:0 lds
s_add_u32 m0,s91,20416
s_nop 0
buffer_load_dwordx4 v12,s[24:27],s51 offen offset:64 lds
s_add_u32 m0,s91,24448
s_nop 0
buffer_load_dwordx4 v12,s[24:27],s51 offen offset:128 lds
s_add_u32 m0,s91,28480
s_nop 0
buffer_load_dwordx4 v12,s[24:27],s51 offen offset:192 lds
s_add_u32 s51,s51,0x4000
s_add_u32 m0,s91,32768
s_nop 0
buffer_load_dwordx4 v11,s[20:23],s51 offen offset:0 lds
s_add_u32 m0,s91,36800
s_nop 0
buffer_load_dwordx4 v11,s[20:23],s51 offen offset:64 lds
s_add_u32 m0,s91,40832
s_nop 0
buffer_load_dwordx4 v11,s[20:23],s51 offen offset:128 lds
s_add_u32 m0,s91,44864
s_nop 0
buffer_load_dwordx4 v11,s[20:23],s51 offen offset:192 lds
s_add_u32 m0,s91,49152
s_nop 0
buffer_load_dwordx4 v12,s[24:27],s51 offen offset:0 lds
s_add_u32 m0,s91,53184
s_nop 0
buffer_load_dwordx4 v12,s[24:27],s51 offen offset:64 lds
s_add_u32 m0,s91,57216
s_nop 0
buffer_load_dwordx4 v12,s[24:27],s51 offen offset:128 lds
s_add_u32 m0,s91,61248
s_nop 0
buffer_load_dwordx4 v12,s[24:27],s51 offen offset:192 lds
s_add_u32 s51,s51,0x4000
s_add_u32 m0,s91,65536
s_nop 0
buffer_load_dwordx4 v11,s[20:23],s51 offen offset:0 lds
s_add_u32 m0,s91,69568
s_nop 0
buffer_load_dwordx4 v11,s[20:23],s51 offen offset:64 lds
s_add_u32 m0,s91,73600
s_nop 0
buffer_load_dwordx4 v11,s[20:23],s51 offen offset:128 lds
s_add_u32 m0,s91,77632
s_nop 0
buffer_load_dwordx4 v11,s[20:23],s51 offen offset:192 lds
s_add_u32 m0,s91,81920
s_nop 0
buffer_load_dwordx4 v12,s[24:27],s51 offen offset:0 lds
s_add_u32 m0,s91,85952
s_nop 0
buffer_load_dwordx4 v12,s[24:27],s51 offen offset:64 lds
s_add_u32 m0,s91,89984
s_nop 0
buffer_load_dwordx4 v12,s[24:27],s51 offen offset:128 lds
s_add_u32 m0,s91,94016
s_nop 0
buffer_load_dwordx4 v12,s[24:27],s51 offen offset:192 lds
s_add_u32 s51,s51,0x4000
s_add_u32 m0,s91,98304
s_nop 0
buffer_load_dwordx4 v11,s[20:23],s51 offen offset:0 lds
s_add_u32 m0,s91,102336
s_nop 0
buffer_load_dwordx4 v11,s[20:23],s51 offen offset:64 lds
s_add_u32 m0,s91,106368
s_nop 0
buffer_load_dwordx4 v11,s[20:23],s51 offen offset:128 lds
s_add_u32 m0,s91,110400
s_nop 0
buffer_load_dwordx4 v11,s[20:23],s51 offen offset:192 lds
s_add_u32 m0,s91,114688
s_nop 0
buffer_load_dwordx4 v12,s[24:27],s51 offen offset:0 lds
s_add_u32 m0,s91,118720
s_nop 0
buffer_load_dwordx4 v12,s[24:27],s51 offen offset:64 lds
s_add_u32 m0,s91,122752
s_nop 0
buffer_load_dwordx4 v12,s[24:27],s51 offen offset:128 lds
s_add_u32 m0,s91,126784
s_nop 0
buffer_load_dwordx4 v12,s[24:27],s51 offen offset:192 lds
s_add_u32 s51,s51,0x4000
s_mov_b32 s95,1
s_waitcnt vmcnt(0)
s_branch L_att_entry
L_code_end:
.section .rodata,"a"
.p2align 6
.amdhsa_kernel recurrent_scan__sliding_block_cached__glu_gated_glu__prompt_kernel
  .amdhsa_next_free_vgpr 512
  .amdhsa_next_free_sgpr 102
  .amdhsa_accum_offset 256
  .amdhsa_group_segment_fixed_size 0
  .amdhsa_kernarg_size 96
  .amdhsa_user_sgpr_count 2
  .amdhsa_user_sgpr_kernarg_segment_ptr 1
  .amdhsa_system_sgpr_workgroup_id_x 1
.end_amdhsa_kernel
```
